```python
import torch

def _softmax(x, axis=-1):
    return torch.softmax(x, dim=axis)
def _gelu(x):
    return torch.nn.functional.gelu(x, approximate="tanh")
def _silu(x):
    return torch.nn.functional.silu(x)
def _sigmoid(x):
    return torch.sigmoid(x)
def _layernorm(x, axis=-1, eps=1e-5):
    m = x.mean(dim=axis, keepdim=True)
    v = x.var(dim=axis, keepdim=True, unbiased=False)
    return (x - m) / torch.sqrt(v + eps)
def _scatter_add(tgt, idx, src, axis=0):
    return tgt.clone().index_add_(axis, idx, src)
def _segment_sum(src, seg, n):
    out = torch.zeros((n,) + src.shape[1:], dtype=src.dtype)
    return out.index_add_(0, seg, src)
def _pad(x, pw):
    flat = tuple(v for pair in reversed(pw) for v in pair)
    return torch.nn.functional.pad(x, flat)

kernel_name = 'standalone__gqa_softmax__near_ridge'

def setup_inputs():

    _w = (lambda a: (lambda t: t.to(torch.bfloat16) if t.is_floating_point() else t)(torch.as_tensor(a)))
    B, Hq, Hkv, Sq, Sk, D = 8, 32, 32, 736, 512, 128
    return {
        "q": _w((lambda *s: torch.randn(*s, dtype=torch.bfloat16) * 0.8)(B, Hq, Sq, D)),
        "k": _w((lambda *s: torch.randn(*s, dtype=torch.bfloat16) * 0.8)(B, Hkv, Sk, D)),
        "v": _w((lambda *s: torch.randn(*s, dtype=torch.bfloat16) * 0.05)(B, Hkv, Sk, D)),
    }

def reference(q, k, v):
    B, Hq, Sq, D = q.shape
    Hkv = k.shape[1]
    rep = Hq // Hkv
    k = (lambda x, n, axis: torch.repeat_interleave(x, n, dim=axis))(k, rep, axis=1)
    v = (lambda x, n, axis: torch.repeat_interleave(x, n, dim=axis))(v, rep, axis=1)
    scale = D ** -0.5
    scores = torch.einsum("bhqd,bhkd->bhqk", q, k) * scale
    p = _softmax(scores, axis=-1)
    return torch.einsum("bhqk,bhkd->bhqd", p, v)
```

```asm
; @launch grid=(256,1,1) block=(256,1,1) lds=163840
.amdgcn_target "amdgcn-amd-amdhsa--gfx950"
.text
.globl standalone__gqa_softmax__near_ridge_kernel
.p2align 8
.type standalone__gqa_softmax__near_ridge_kernel,@function
standalone__gqa_softmax__near_ridge_kernel:
  s_cmpk_ge_u32 s2, 0x100
  s_cbranch_scc1 L_end
  s_load_dwordx2 s[12:13], s[0:1], 0
  s_load_dwordx2 s[4:5], s[0:1], 8
  s_load_dwordx2 s[8:9], s[0:1], 16
  s_load_dwordx2 s[16:17], s[0:1], 24
  s_mov_b32 s99, 0
  s_getpc_b64 s[100:101]
L_pc:
  v_and_b32 v226, 15, v0
  v_lshrrev_b32 v227, 6, v0
  v_lshl_add_u32 v226, v227, 4, v226
  v_lshlrev_b32 v226, 7, v226
  global_load_dword a255, v226, s[100:101] offset:256
  s_add_u32 s100, s100, L_main - L_pc
  s_addc_u32 s101, s101, 0
  v_lshrrev_b32 v64, 6, v0
  v_and_b32 v65, 63, v0
  v_readfirstlane_b32 s23, v64
  s_and_b32 s54, s2, 7
  s_lshl_b32 s54, s54, 5
  s_lshr_b32 s55, s2, 3
  v_lshrrev_b32 v70, 3, v65
  v_and_b32 v68, 6, v70
  v_and_b32 v69, 7, v65
  v_xor_b32 v68, v68, v69
  v_lshlrev_b32 v66, 8, v70
  v_lshl_add_u32 v66, v68, 4, v66
  v_lshl_add_u32 v245, v64, 12, v66
  v_lshrrev_b32 v67, 4, v65
  v_and_b32 v68, 15, v65
  v_lshlrev_b32 v66, 8, v68
  v_lshl_add_u32 v66, v67, 4, v66
  v_lshl_add_u32 v247, v64, 12, v66
  s_add_u32 s3, s55, 0
  s_mul_i32 s45, s3, 43691
  s_lshr_b32 s45, s45, 17
  s_mul_i32 s41, s45, 3
  s_sub_u32 s3, s3, s41
  s_add_u32 s45, s45, s54
  s_lshl_b32 s20, s45, 17
  s_mul_i32 s45, s45, 188416
  s_lshl_b32 s41, s3, 16
  s_add_u32 s45, s45, s41
  s_mul_i32 s41, s23, 12288
  s_add_u32 s24, s45, s41
  s_add_u32 s25, s24, 4096
  s_lshl_b32 s3, s3, 2
  s_add_u32 s3, s3, s23
  s_add_u32 s3, s3, 5
  s_lshr_b32 s3, s3, 4
  s_mov_b32 s53, s3
  s_mul_i32 s41, s3, 0x70000000
  s_add_u32 s41, s41, s24
  s_add_u32 s26, s41, 8192
  s_add_u32 s27, s41, 12288
  s_lshl_b32 s36, s23, 12
  s_add_u32 s36, s36, 65552
  s_mov_b32 s6, 33554432
  s_mov_b32 s7, 0x20000
  s_mov_b32 s14, 48234496
  s_mov_b32 s15, 0x20000
  s_mov_b32 s10, 33554432
  s_mov_b32 s11, 0x20000
  s_mov_b32 s18, 48234496
  s_mov_b32 s19, 0x20000
  s_mul_i32 s3, s23, 7168
  s_add_u32 s38, s3, 131088
  s_waitcnt lgkmcnt(0)
  s_add_u32 m0, s38, 0
  s_nop 0
  buffer_load_dwordx4 v245, s[12:15], s24 offen nt lds
  s_add_u32 m0, s38, -1024
  s_nop 0
  buffer_load_dwordx4 v245, s[12:15], s24 offen offset:2048 nt lds
  s_add_u32 m0, s38, 1920
  s_nop 0
  buffer_load_dwordx4 v245, s[12:15], s24 offen offset:128 nt lds
  s_add_u32 m0, s38, 896
  s_nop 0
  buffer_load_dwordx4 v245, s[12:15], s24 offen offset:2176 nt lds
  s_add_u32 s39, s20, 0
  s_add_u32 m0, s36, 0
  s_nop 0
  buffer_load_dwordx4 v245, s[4:7], s39 offen nt lds
  s_add_u32 m0, s36, -1024
  s_nop 0
  buffer_load_dwordx4 v245, s[4:7], s39 offen offset:2048 nt lds
  s_add_u32 m0, s36, 1920
  s_nop 0
  buffer_load_dwordx4 v245, s[4:7], s39 offen offset:128 nt lds
  s_add_u32 m0, s36, 896
  s_nop 0
  buffer_load_dwordx4 v245, s[4:7], s39 offen offset:2176 nt lds
  s_lshl_b32 s3, s55, 2
  s_add_u32 s3, s3, s23
  s_and_b32 s3, s3, 63
  s_lshl_b32 s3, s3, 7
  v_lshlrev_b32 v66, 13, v69
  v_add_u32 v66, s3, v66
  global_load_dword a255, v66, s[100:101]
  s_lshr_b32 s3, s23, 1
  s_mul_i32 s3, s3, 24592
  s_add_u32 s3, s3, s36
  s_add_u32 s62, s3, -40976
  s_add_u32 m0, s62, 0
  s_nop 0
  buffer_load_dwordx4 v245, s[12:15], s25 offen nt lds
  s_add_u32 m0, s62, -1024
  s_nop 0
  buffer_load_dwordx4 v245, s[12:15], s25 offen offset:2048 nt lds
  s_add_u32 m0, s62, 1920
  s_nop 0
  buffer_load_dwordx4 v245, s[12:15], s25 offen offset:128 nt lds
  s_add_u32 m0, s62, 896
  s_nop 0
  buffer_load_dwordx4 v245, s[12:15], s25 offen offset:2176 nt lds
  v_and_b32 v66, 2, v70
  v_lshlrev_b32 v66, 1, v66
  v_xor_b32 v66, v66, v69
  v_and_b32 v69, 4, v70
  v_add_u32 v69, v69, v70
  v_lshlrev_b32 v69, 8, v69
  v_lshl_add_u32 v66, v66, 4, v69
  v_lshl_add_u32 v246, v64, 12, v66
  s_lshl_b32 s37, s23, 11
  v_and_b32 v66, 6, v68
  v_xor_b32 v66, v66, v67
  v_lshlrev_b32 v66, 4, v66
  v_lshl_add_u32 v240, v68, 7, v66
  v_xor_b32 v241, 64, v240
  v_add_u32 v249, s38, v240
  v_add_u32 v232, s62, v240
  v_add_u32 v234, s36, v240
  v_add_u32 v240, 65552, v240
  v_add_u32 v250, s38, v241
  v_add_u32 v233, s62, v241
  v_add_u32 v235, s36, v241
  v_add_u32 v241, 65552, v241
  v_and_b32 v66, 1, v67
  v_mul_u32_u24 v66, 32776, v66
  v_lshrrev_b32 v70, 1, v67
  v_lshl_add_u32 v66, v70, 9, v66
  v_bfe_u32 v70, v65, 2, 2
  v_lshl_add_u32 v66, v70, 7, v66
  v_and_b32 v69, 3, v65
  v_lshl_add_u32 v66, v69, 4, v66
  v_and_b32 v70, 2, v70
  v_lshlrev_b32 v70, 5, v70
  v_add_u32 v242, v66, v70
  v_xor_b32 v70, 64, v70
  v_add_u32 v243, v66, v70
  v_and_b32 v66, 1, v65
  v_mul_u32_u24 v66, 0xaaaa, v66
  v_add_u32 v66, 0x4444, v66
  v_lshl_add_u32 v248, v66, 16, v66
  v_mov_b32 v66, 0x3f803f80
  v_accvgpr_write_b32 a208, v66
  v_accvgpr_write_b32 a209, v66
  v_accvgpr_write_b32 a210, v66
  v_accvgpr_write_b32 a211, v66
  v_accvgpr_write_b32 a192, 0
  v_accvgpr_write_b32 a193, 0
  v_accvgpr_write_b32 a194, 0
  v_accvgpr_write_b32 a195, 0
  v_accvgpr_write_b32 a196, 0
  v_accvgpr_write_b32 a197, 0
  v_accvgpr_write_b32 a198, 0
  v_accvgpr_write_b32 a199, 0
  v_accvgpr_write_b32 a200, 0
  v_accvgpr_write_b32 a201, 0
  v_accvgpr_write_b32 a202, 0
  v_accvgpr_write_b32 a203, 0
  v_accvgpr_write_b32 a204, 0
  v_accvgpr_write_b32 a205, 0
  v_accvgpr_write_b32 a206, 0
  v_accvgpr_write_b32 a207, 0
  v_and_b32 v66, 8, v65
  v_mul_u32_u24 v66, 248, v66
  v_sub_u32 v251, v247, v66
  s_mov_b32 s58, 0x00ff00ff
  s_mov_b32 s59, 0x00ff00ff
  s_mul_i32 s60, s53, 0x71c9f2ca
  s_add_u32 s60, s60, 0x7f800000
  s_mov_b32 s42, 0x3e0293ee
  s_mov_b32 s43, 0x3e0293ee
  s_mov_b32 s44, 0x53800000
  s_mov_b32 s46, 0
  s_mov_b32 s47, 0
  s_mov_b32 s48, 0
  s_mov_b32 s49, 0
  s_mov_b32 s50, 0
  s_mov_b32 s51, 0
  s_mov_b32 s99, 1
  s_cmp_eq_u32 s23, 0
  s_cbranch_scc1 L_stub0
  s_cmp_eq_u32 s23, 1
  s_cbranch_scc1 L_stub1
  s_cmp_eq_u32 s23, 2
  s_cbranch_scc1 L_stub2
  s_cmp_eq_u32 s23, 3
  s_cbranch_scc1 L_stub3
L_ret0:
  s_mov_b32 s99, 0
  s_add_u32 m0, s36, 32768
  s_nop 0
  buffer_load_dwordx4 v245, s[12:15], s26 offen nt lds
  s_add_u32 m0, s36, 31744
  s_nop 0
  buffer_load_dwordx4 v245, s[12:15], s26 offen offset:2048 nt lds
  s_add_u32 m0, s36, 34688
  s_nop 0
  buffer_load_dwordx4 v245, s[12:15], s26 offen offset:128 nt lds
  s_add_u32 m0, s36, 33664
  s_nop 0
  buffer_load_dwordx4 v245, s[12:15], s26 offen offset:2176 nt lds
  s_branch L_main
.p2align 12
L_main:
L_stub0:
  s_cmp_eq_u32 s99, 1
  s_cbranch_scc1 L_ret0
  s_waitcnt vmcnt(15)
  ds_read_b128 v[0:3], v249 offset:0
  ds_read_b128 v[4:7], v250 offset:0
  s_waitcnt vmcnt(13)
  ds_read_b128 v[8:11], v249 offset:2048
  ds_read_b128 v[12:15], v250 offset:2048
  s_waitcnt lgkmcnt(2)
  v_lshlrev_b32 v224, 16, v0
  v_and_b32 v225, 0xffff0000, v0
  v_lshlrev_b32 v226, 16, v1
  v_and_b32 v227, 0xffff0000, v1
  v_lshlrev_b32 v228, 16, v2
  v_and_b32 v229, 0xffff0000, v2
  v_lshlrev_b32 v230, 16, v3
  v_and_b32 v231, 0xffff0000, v3
  v_pk_mul_f32 v[224:225], v[224:225], s[42:43]
  v_pk_mul_f32 v[226:227], v[226:227], s[42:43]
  s_add_u32 m0, s36, 49152
  v_pk_mul_f32 v[228:229], v[228:229], s[42:43]
  buffer_load_dwordx4 v245, s[12:15], s27 offen nt lds
  v_pk_mul_f32 v[230:231], v[230:231], s[42:43]
  v_cvt_pk_bf16_f32 v0, v224, v225
  v_cvt_pk_bf16_f32 v1, v226, v227
  v_cvt_pk_bf16_f32 v2, v228, v229
  v_cvt_pk_bf16_f32 v3, v230, v231
  v_accvgpr_write_b32 a0, v0
  v_accvgpr_write_b32 a1, v1
  v_accvgpr_write_b32 a2, v2
  v_accvgpr_write_b32 a3, v3
  v_lshlrev_b32 v224, 16, v4
  v_and_b32 v225, 0xffff0000, v4
  v_lshlrev_b32 v226, 16, v5
  v_and_b32 v227, 0xffff0000, v5
  v_lshlrev_b32 v228, 16, v6
  v_and_b32 v229, 0xffff0000, v6
  s_add_u32 m0, s36, 48128
  v_lshlrev_b32 v230, 16, v7
  buffer_load_dwordx4 v245, s[12:15], s27 offen offset:2048 nt lds
  v_and_b32 v231, 0xffff0000, v7
  v_pk_mul_f32 v[224:225], v[224:225], s[42:43]
  v_pk_mul_f32 v[226:227], v[226:227], s[42:43]
  v_pk_mul_f32 v[228:229], v[228:229], s[42:43]
  v_pk_mul_f32 v[230:231], v[230:231], s[42:43]
  v_cvt_pk_bf16_f32 v4, v224, v225
  v_cvt_pk_bf16_f32 v5, v226, v227
  v_cvt_pk_bf16_f32 v6, v228, v229
  v_cvt_pk_bf16_f32 v7, v230, v231
  v_accvgpr_write_b32 a4, v4
  v_accvgpr_write_b32 a5, v5
  v_accvgpr_write_b32 a6, v6
  v_accvgpr_write_b32 a7, v7
  s_waitcnt lgkmcnt(0)
  v_lshlrev_b32 v224, 16, v8
  v_and_b32 v225, 0xffff0000, v8
  s_add_u32 m0, s36, 51072
  v_lshlrev_b32 v226, 16, v9
  buffer_load_dwordx4 v245, s[12:15], s27 offen offset:128 nt lds
  v_and_b32 v227, 0xffff0000, v9
  v_lshlrev_b32 v228, 16, v10
  v_and_b32 v229, 0xffff0000, v10
  v_lshlrev_b32 v230, 16, v11
  v_and_b32 v231, 0xffff0000, v11
  v_pk_mul_f32 v[224:225], v[224:225], s[42:43]
  v_pk_mul_f32 v[226:227], v[226:227], s[42:43]
  v_pk_mul_f32 v[228:229], v[228:229], s[42:43]
  v_pk_mul_f32 v[230:231], v[230:231], s[42:43]
  v_cvt_pk_bf16_f32 v8, v224, v225
  v_cvt_pk_bf16_f32 v9, v226, v227
  v_cvt_pk_bf16_f32 v10, v228, v229
  v_cvt_pk_bf16_f32 v11, v230, v231
  v_accvgpr_write_b32 a8, v8
  v_accvgpr_write_b32 a9, v9
  s_add_u32 m0, s36, 50048
  v_accvgpr_write_b32 a10, v10
  buffer_load_dwordx4 v245, s[12:15], s27 offen offset:2176 nt lds
  v_accvgpr_write_b32 a11, v11
  v_lshlrev_b32 v224, 16, v12
  v_and_b32 v225, 0xffff0000, v12
  v_lshlrev_b32 v226, 16, v13
  v_and_b32 v227, 0xffff0000, v13
  v_lshlrev_b32 v228, 16, v14
  v_and_b32 v229, 0xffff0000, v14
  v_lshlrev_b32 v230, 16, v15
  v_and_b32 v231, 0xffff0000, v15
  v_pk_mul_f32 v[224:225], v[224:225], s[42:43]
  v_pk_mul_f32 v[226:227], v[226:227], s[42:43]
  v_pk_mul_f32 v[228:229], v[228:229], s[42:43]
  v_pk_mul_f32 v[230:231], v[230:231], s[42:43]
  v_cvt_pk_bf16_f32 v12, v224, v225
  v_cvt_pk_bf16_f32 v13, v226, v227
  v_cvt_pk_bf16_f32 v14, v228, v229
  v_cvt_pk_bf16_f32 v15, v230, v231
  v_accvgpr_write_b32 a12, v12
  v_accvgpr_write_b32 a13, v13
  v_accvgpr_write_b32 a14, v14
  v_accvgpr_write_b32 a15, v15
  s_mov_b32 s99, 1
  s_cmp_eq_u32 s23, 0
  s_cbranch_scc1 L_stub4
  s_cmp_eq_u32 s23, 1
  s_cbranch_scc1 L_stub5
  s_cmp_eq_u32 s23, 2
  s_cbranch_scc1 L_stub6
  s_cmp_eq_u32 s23, 3
  s_cbranch_scc1 L_stub7
L_ret1:
  s_mov_b32 s99, 0
  s_mov_b32 s99, 1
  s_cmp_eq_u32 s23, 0
  s_cbranch_scc1 L_stub8
  s_cmp_eq_u32 s23, 1
  s_cbranch_scc1 L_stub9
  s_cmp_eq_u32 s23, 2
  s_cbranch_scc1 L_stub10
  s_cmp_eq_u32 s23, 3
  s_cbranch_scc1 L_stub11
L_ret2:
  s_mov_b32 s99, 0
  s_mov_b32 s99, 1
  s_cmp_eq_u32 s23, 0
  s_cbranch_scc1 L_stub12
  s_cmp_eq_u32 s23, 1
  s_cbranch_scc1 L_stub13
  s_cmp_eq_u32 s23, 2
  s_cbranch_scc1 L_stub14
  s_cmp_eq_u32 s23, 3
  s_cbranch_scc1 L_stub15
L_ret3:
  s_mov_b32 s99, 0
  s_waitcnt vmcnt(13)
  s_barrier
  ds_read_b128 a[64:67], v240 offset:0
  ds_read_b128 a[68:71], v241 offset:0
  ds_read_b128 a[72:75], v240 offset:2048
  ds_read_b128 a[76:79], v241 offset:2048
  ds_read_b128 a[80:83], v240 offset:4096
  ds_read_b128 a[84:87], v241 offset:4096
  ds_read_b128 a[88:91], v240 offset:6144
  ds_read_b128 a[92:95], v241 offset:6144
  ds_read_b128 a[96:99], v240 offset:8192
  ds_read_b128 a[100:103], v241 offset:8192
  ds_read_b128 a[104:107], v240 offset:10240
  ds_read_b128 a[108:111], v241 offset:10240
  ds_read_b128 a[112:115], v240 offset:12288
  ds_read_b128 a[116:119], v241 offset:12288
  ds_read_b128 a[120:123], v240 offset:14336
  ds_read_b128 a[124:127], v241 offset:14336
  s_add_u32 s39, s20, 16384
  s_add_u32 m0, s36, 16384
  s_nop 0
  buffer_load_dwordx4 v245, s[4:7], s39 offen nt lds
  s_add_u32 m0, s36, 15360
  s_nop 0
  buffer_load_dwordx4 v245, s[4:7], s39 offen offset:2048 nt lds
  s_waitcnt lgkmcnt(12)
  v_mfma_f32_16x16x32_bf16 v[64:67], a[64:67], a[0:3], 0
  s_add_u32 s40, s20, 0
  v_mfma_f32_16x16x32_bf16 v[64:67], a[68:71], a[4:7], v[64:67]
  v_mfma_f32_16x16x32_bf16 v[64:67], a[72:75], a[8:11], v[64:67]
  v_mfma_f32_16x16x32_bf16 v[64:67], a[76:79], a[12:15], v[64:67]
  s_waitcnt lgkmcnt(0)
  s_nop 0
  s_nop 0
  s_nop 0
  s_nop 0
  s_nop 0
  s_nop 0
  s_nop 0
  v_max3_f32 v192, v64, v65, v66
  v_max_f32 v192, v192, v67
  v_mov_b32 v193, v192
  s_nop 0
  s_nop 0
  v_permlane32_swap_b32 v192, v193
  v_max_f32 v192, v192, v193
  v_mov_b32 v193, v192
  s_nop 0
  s_nop 0
  v_permlane16_swap_b32 v192, v193
  v_min_f32_e64 v200, -v192, -v193
  v_min_f32_e64 v201, -v192, -v193
  v_min_f32_e64 v202, -v192, -v193
  v_min_f32_e64 v203, -v192, -v193
  v_add_f32 v64, v200, v64
  v_add_f32 v65, v200, v65
  v_mfma_f32_16x16x32_bf16 v[68:71], a[80:83], a[0:3], v[200:203]
  s_add_u32 m0, s36, 18304
  v_add_f32 v66, v200, v66
  v_mfma_f32_16x16x32_bf16 v[68:71], a[84:87], a[4:7], v[68:71]
  buffer_load_dwordx4 v245, s[4:7], s39 offen offset:128 nt lds
  v_add_f32 v67, v200, v67
  v_mfma_f32_16x16x32_bf16 v[68:71], a[88:91], a[8:11], v[68:71]
  v_exp_f32 v64, v64
  v_mfma_f32_16x16x32_bf16 v[68:71], a[92:95], a[12:15], v[68:71]
  v_exp_f32 v65, v65
  v_mfma_f32_16x16x32_bf16 v[72:75], a[96:99], a[0:3], v[200:203]
  s_add_u32 m0, s36, 17280
  v_exp_f32 v66, v66
  v_mfma_f32_16x16x32_bf16 v[72:75], a[100:103], a[4:7], v[72:75]
  buffer_load_dwordx4 v245, s[4:7], s39 offen offset:2176 nt lds
  s_add_u32 s39, s20, 32768
  v_mfma_f32_16x16x32_bf16 v[72:75], a[104:107], a[8:11], v[72:75]
  v_exp_f32 v67, v67
  v_mfma_f32_16x16x32_bf16 v[72:75], a[108:111], a[12:15], v[72:75]
  v_cvt_pk_bf16_f32 v128, v64, v65
  v_cvt_pk_bf16_f32 v129, v66, v67
  v_mfma_f32_16x16x32_bf16 v[76:79], a[112:115], a[0:3], v[200:203]
  s_waitcnt vmcnt(12)
  ds_read_b128 v[16:19], v232 offset:0
  v_mfma_f32_16x16x32_bf16 v[76:79], a[116:119], a[4:7], v[76:79]
  ds_read_b128 v[20:23], v233 offset:0
  ds_read_b128 v[24:27], v232 offset:2048
  v_mfma_f32_16x16x32_bf16 v[76:79], a[120:123], a[8:11], v[76:79]
  ds_read_b128 v[28:31], v233 offset:2048
  v_exp_f32 v68, v68
  v_mfma_f32_16x16x32_bf16 v[76:79], a[124:127], a[12:15], v[76:79]
  v_exp_f32 v69, v69
  v_exp_f32 v70, v70
  v_exp_f32 v71, v71
  v_cvt_pk_bf16_f32 v130, v68, v69
  v_cvt_pk_bf16_f32 v131, v70, v71
  s_waitcnt lgkmcnt(0)
  v_lshlrev_b32 v224, 16, v16
  v_and_b32 v225, 0xffff0000, v16
  v_lshlrev_b32 v226, 16, v17
  v_and_b32 v227, 0xffff0000, v17
  v_lshlrev_b32 v228, 16, v18
  v_and_b32 v229, 0xffff0000, v18
  v_lshlrev_b32 v230, 16, v19
  v_and_b32 v231, 0xffff0000, v19
  v_pk_mul_f32 v[224:225], v[224:225], s[42:43]
  v_pk_mul_f32 v[226:227], v[226:227], s[42:43]
  v_pk_mul_f32 v[228:229], v[228:229], s[42:43]
  v_pk_mul_f32 v[230:231], v[230:231], s[42:43]
  v_cvt_pk_bf16_f32 v16, v224, v225
  v_cvt_pk_bf16_f32 v17, v226, v227
  v_cvt_pk_bf16_f32 v18, v228, v229
  v_cvt_pk_bf16_f32 v19, v230, v231
  v_accvgpr_write_b32 a16, v16
  v_accvgpr_write_b32 a17, v17
  v_accvgpr_write_b32 a18, v18
  v_accvgpr_write_b32 a19, v19
  v_lshlrev_b32 v224, 16, v20
  v_and_b32 v225, 0xffff0000, v20
  v_mfma_f32_16x16x32_bf16 v[80:83], a[64:67], a[16:19], 0
  v_lshlrev_b32 v226, 16, v21
  v_and_b32 v227, 0xffff0000, v21
  v_lshlrev_b32 v228, 16, v22
  v_and_b32 v229, 0xffff0000, v22
  v_lshlrev_b32 v230, 16, v23
  v_and_b32 v231, 0xffff0000, v23
  v_pk_mul_f32 v[224:225], v[224:225], s[42:43]
  v_pk_mul_f32 v[226:227], v[226:227], s[42:43]
  v_pk_mul_f32 v[228:229], v[228:229], s[42:43]
  v_pk_mul_f32 v[230:231], v[230:231], s[42:43]
  v_cvt_pk_bf16_f32 v20, v224, v225
  v_cvt_pk_bf16_f32 v21, v226, v227
  v_cvt_pk_bf16_f32 v22, v228, v229
  v_cvt_pk_bf16_f32 v23, v230, v231
  v_accvgpr_write_b32 a20, v20
  v_accvgpr_write_b32 a21, v21
  v_accvgpr_write_b32 a22, v22
  v_accvgpr_write_b32 a23, v23
  v_lshlrev_b32 v224, 16, v24
  v_and_b32 v225, 0xffff0000, v24
  v_mfma_f32_16x16x32_bf16 v[80:83], a[68:71], a[20:23], v[80:83]
  v_lshlrev_b32 v226, 16, v25
  v_and_b32 v227, 0xffff0000, v25
  v_lshlrev_b32 v228, 16, v26
  v_and_b32 v229, 0xffff0000, v26
  v_lshlrev_b32 v230, 16, v27
  v_and_b32 v231, 0xffff0000, v27
  v_pk_mul_f32 v[224:225], v[224:225], s[42:43]
  v_pk_mul_f32 v[226:227], v[226:227], s[42:43]
  v_pk_mul_f32 v[228:229], v[228:229], s[42:43]
  v_pk_mul_f32 v[230:231], v[230:231], s[42:43]
  v_cvt_pk_bf16_f32 v24, v224, v225
  v_cvt_pk_bf16_f32 v25, v226, v227
  v_cvt_pk_bf16_f32 v26, v228, v229
  v_cvt_pk_bf16_f32 v27, v230, v231
  v_accvgpr_write_b32 a24, v24
  v_accvgpr_write_b32 a25, v25
  v_accvgpr_write_b32 a26, v26
  v_accvgpr_write_b32 a27, v27
  v_lshlrev_b32 v224, 16, v28
  v_and_b32 v225, 0xffff0000, v28
  v_mfma_f32_16x16x32_bf16 v[80:83], a[72:75], a[24:27], v[80:83]
  v_lshlrev_b32 v226, 16, v29
  v_and_b32 v227, 0xffff0000, v29
  v_lshlrev_b32 v228, 16, v30
  v_and_b32 v229, 0xffff0000, v30
  v_lshlrev_b32 v230, 16, v31
  v_and_b32 v231, 0xffff0000, v31
  v_pk_mul_f32 v[224:225], v[224:225], s[42:43]
  v_pk_mul_f32 v[226:227], v[226:227], s[42:43]
  v_pk_mul_f32 v[228:229], v[228:229], s[42:43]
  v_pk_mul_f32 v[230:231], v[230:231], s[42:43]
  v_cvt_pk_bf16_f32 v28, v224, v225
  v_cvt_pk_bf16_f32 v29, v226, v227
  v_cvt_pk_bf16_f32 v30, v228, v229
  v_cvt_pk_bf16_f32 v31, v230, v231
  v_accvgpr_write_b32 a28, v28
  v_accvgpr_write_b32 a29, v29
  v_accvgpr_write_b32 a30, v30
  v_accvgpr_write_b32 a31, v31
  v_exp_f32 v72, v72
  v_exp_f32 v73, v73
  v_mfma_f32_16x16x32_bf16 v[80:83], a[76:79], a[28:31], v[80:83]
  v_exp_f32 v74, v74
  v_exp_f32 v75, v75
  v_cvt_pk_bf16_f32 v132, v72, v73
  v_cvt_pk_bf16_f32 v133, v74, v75
  v_exp_f32 v76, v76
  v_exp_f32 v77, v77
  v_exp_f32 v78, v78
  v_exp_f32 v79, v79
  v_cvt_pk_bf16_f32 v134, v76, v77
  v_cvt_pk_bf16_f32 v135, v78, v79
  v_max3_f32 v192, v80, v81, v82
  v_max_f32 v192, v192, v83
  v_mov_b32 v193, v192
  s_nop 0
  s_nop 0
  v_permlane32_swap_b32 v192, v193
  v_max_f32 v192, v192, v193
  v_mov_b32 v193, v192
  s_nop 0
  s_nop 0
  v_permlane16_swap_b32 v192, v193
  v_min_f32_e64 v204, -v192, -v193
  v_min_f32_e64 v205, -v192, -v193
  v_min_f32_e64 v206, -v192, -v193
  v_min_f32_e64 v207, -v192, -v193
  v_add_f32 v80, v204, v80
  v_add_f32 v81, v204, v81
  v_mfma_f32_16x16x32_bf16 v[84:87], a[80:83], a[16:19], v[204:207]
  v_add_f32 v82, v204, v82
  v_add_f32 v83, v204, v83
  v_mfma_f32_16x16x32_bf16 v[84:87], a[84:87], a[20:23], v[84:87]
  v_exp_f32 v80, v80
  v_mfma_f32_16x16x32_bf16 v[84:87], a[88:91], a[24:27], v[84:87]
  v_exp_f32 v81, v81
  v_mfma_f32_16x16x32_bf16 v[84:87], a[92:95], a[28:31], v[84:87]
  v_exp_f32 v82, v82
  v_mfma_f32_16x16x32_bf16 v[88:91], a[96:99], a[16:19], v[204:207]
  v_exp_f32 v83, v83
  v_mfma_f32_16x16x32_bf16 v[88:91], a[100:103], a[20:23], v[88:91]
  v_cvt_pk_bf16_f32 v136, v80, v81
  v_cvt_pk_bf16_f32 v137, v82, v83
  v_mfma_f32_16x16x32_bf16 v[88:91], a[104:107], a[24:27], v[88:91]
  s_waitcnt vmcnt(8)
  ds_read_b128 v[32:35], v234 offset:32768
  v_mfma_f32_16x16x32_bf16 v[88:91], a[108:111], a[28:31], v[88:91]
  ds_read_b128 v[36:39], v235 offset:32768
  ds_read_b128 v[40:43], v234 offset:34816
  v_mfma_f32_16x16x32_bf16 v[92:95], a[112:115], a[16:19], v[204:207]
  ds_read_b128 v[44:47], v235 offset:34816
  v_exp_f32 v84, v84
  v_mfma_f32_16x16x32_bf16 v[92:95], a[116:119], a[20:23], v[92:95]
  v_exp_f32 v85, v85
  v_mfma_f32_16x16x32_bf16 v[92:95], a[120:123], a[24:27], v[92:95]
  v_exp_f32 v86, v86
  v_mfma_f32_16x16x32_bf16 v[92:95], a[124:127], a[28:31], v[92:95]
  v_exp_f32 v87, v87
  v_cvt_pk_bf16_f32 v138, v84, v85
  v_cvt_pk_bf16_f32 v139, v86, v87
  s_waitcnt lgkmcnt(0)
  v_lshlrev_b32 v224, 16, v32
  s_add_u32 m0, s37, 0
  v_and_b32 v225, 0xffff0000, v32
  buffer_load_dwordx4 v246, s[8:11], s40 offen nt lds
  v_lshlrev_b32 v226, 16, v33
  v_and_b32 v227, 0xffff0000, v33
  v_lshlrev_b32 v228, 16, v34
  v_and_b32 v229, 0xffff0000, v34
  v_lshlrev_b32 v230, 16, v35
  v_and_b32 v231, 0xffff0000, v35
  v_pk_mul_f32 v[224:225], v[224:225], s[42:43]
  v_pk_mul_f32 v[226:227], v[226:227], s[42:43]
  v_pk_mul_f32 v[228:229], v[228:229], s[42:43]
  v_pk_mul_f32 v[230:231], v[230:231], s[42:43]
  v_cvt_pk_bf16_f32 v32, v224, v225
  v_cvt_pk_bf16_f32 v33, v226, v227
  v_cvt_pk_bf16_f32 v34, v228, v229
  v_cvt_pk_bf16_f32 v35, v230, v231
  v_accvgpr_write_b32 a32, v32
  v_accvgpr_write_b32 a33, v33
  v_accvgpr_write_b32 a34, v34
  v_accvgpr_write_b32 a35, v35
  v_lshlrev_b32 v224, 16, v36
  s_add_u32 m0, s37, 31752
  v_mfma_f32_16x16x32_bf16 v[96:99], a[64:67], a[32:35], 0
  buffer_load_dwordx4 v246, s[8:11], s40 offen offset:1024 nt lds
  v_and_b32 v225, 0xffff0000, v36
  v_lshlrev_b32 v226, 16, v37
  v_and_b32 v227, 0xffff0000, v37
  v_lshlrev_b32 v228, 16, v38
  v_and_b32 v229, 0xffff0000, v38
  v_lshlrev_b32 v230, 16, v39
  v_and_b32 v231, 0xffff0000, v39
  v_pk_mul_f32 v[224:225], v[224:225], s[42:43]
  v_pk_mul_f32 v[226:227], v[226:227], s[42:43]
  v_pk_mul_f32 v[228:229], v[228:229], s[42:43]
  v_pk_mul_f32 v[230:231], v[230:231], s[42:43]
  v_cvt_pk_bf16_f32 v36, v224, v225
  v_cvt_pk_bf16_f32 v37, v226, v227
  v_cvt_pk_bf16_f32 v38, v228, v229
  v_cvt_pk_bf16_f32 v39, v230, v231
  v_accvgpr_write_b32 a36, v36
  v_accvgpr_write_b32 a37, v37
  v_accvgpr_write_b32 a38, v38
  v_accvgpr_write_b32 a39, v39
  v_lshlrev_b32 v224, 16, v40
  s_add_u32 m0, s37, 896
  v_mfma_f32_16x16x32_bf16 v[96:99], a[68:71], a[36:39], v[96:99]
  buffer_load_dwordx4 v246, s[8:11], s40 offen offset:128 nt lds
  v_and_b32 v225, 0xffff0000, v40
  v_lshlrev_b32 v226, 16, v41
  v_and_b32 v227, 0xffff0000, v41
  v_lshlrev_b32 v228, 16, v42
  v_and_b32 v229, 0xffff0000, v42
  v_lshlrev_b32 v230, 16, v43
  v_and_b32 v231, 0xffff0000, v43
  v_pk_mul_f32 v[224:225], v[224:225], s[42:43]
  v_pk_mul_f32 v[226:227], v[226:227], s[42:43]
  v_pk_mul_f32 v[228:229], v[228:229], s[42:43]
  v_pk_mul_f32 v[230:231], v[230:231], s[42:43]
  v_cvt_pk_bf16_f32 v40, v224, v225
  v_cvt_pk_bf16_f32 v41, v226, v227
  v_cvt_pk_bf16_f32 v42, v228, v229
  v_cvt_pk_bf16_f32 v43, v230, v231
  v_accvgpr_write_b32 a40, v40
  v_accvgpr_write_b32 a41, v41
  v_accvgpr_write_b32 a42, v42
  v_accvgpr_write_b32 a43, v43
  v_lshlrev_b32 v224, 16, v44
  s_add_u32 m0, s37, 32648
  v_mfma_f32_16x16x32_bf16 v[96:99], a[72:75], a[40:43], v[96:99]
  buffer_load_dwordx4 v246, s[8:11], s40 offen offset:1152 nt lds
  s_add_u32 s40, s20, 16384
  v_and_b32 v225, 0xffff0000, v44
  v_lshlrev_b32 v226, 16, v45
  v_and_b32 v227, 0xffff0000, v45
  v_lshlrev_b32 v228, 16, v46
  v_and_b32 v229, 0xffff0000, v46
  v_lshlrev_b32 v230, 16, v47
  v_and_b32 v231, 0xffff0000, v47
  v_pk_mul_f32 v[224:225], v[224:225], s[42:43]
  v_pk_mul_f32 v[226:227], v[226:227], s[42:43]
  v_pk_mul_f32 v[228:229], v[228:229], s[42:43]
  v_pk_mul_f32 v[230:231], v[230:231], s[42:43]
  v_cvt_pk_bf16_f32 v44, v224, v225
  v_cvt_pk_bf16_f32 v45, v226, v227
  v_cvt_pk_bf16_f32 v46, v228, v229
  v_cvt_pk_bf16_f32 v47, v230, v231
  v_accvgpr_write_b32 a44, v44
  v_accvgpr_write_b32 a45, v45
  v_accvgpr_write_b32 a46, v46
  v_accvgpr_write_b32 a47, v47
  v_exp_f32 v88, v88
  v_exp_f32 v89, v89
  v_mfma_f32_16x16x32_bf16 v[96:99], a[76:79], a[44:47], v[96:99]
  v_exp_f32 v90, v90
  v_exp_f32 v91, v91
  v_cvt_pk_bf16_f32 v140, v88, v89
  v_cvt_pk_bf16_f32 v141, v90, v91
  v_exp_f32 v92, v92
  v_exp_f32 v93, v93
  v_exp_f32 v94, v94
  v_exp_f32 v95, v95
  v_cvt_pk_bf16_f32 v142, v92, v93
  v_cvt_pk_bf16_f32 v143, v94, v95
  v_max3_f32 v192, v96, v97, v98
  v_max_f32 v192, v192, v99
  v_mov_b32 v193, v192
  s_nop 0
  s_nop 0
  v_permlane32_swap_b32 v192, v193
  v_max_f32 v192, v192, v193
  v_mov_b32 v193, v192
  s_nop 0
  s_nop 0
  v_permlane16_swap_b32 v192, v193
  v_min3_f32 v208, -v192, -v193, s60
  v_min3_f32 v209, -v192, -v193, s60
  v_min3_f32 v210, -v192, -v193, s60
  v_min3_f32 v211, -v192, -v193, s60
  v_add_f32 v96, v208, v96
  v_add_f32 v97, v208, v97
  v_mfma_f32_16x16x32_bf16 v[100:103], a[80:83], a[32:35], v[208:211]
  v_add_f32 v98, v208, v98
  v_add_f32 v99, v208, v99
  v_mfma_f32_16x16x32_bf16 v[100:103], a[84:87], a[36:39], v[100:103]
  v_exp_f32 v96, v96
  v_mfma_f32_16x16x32_bf16 v[100:103], a[88:91], a[40:43], v[100:103]
  v_exp_f32 v97, v97
  v_mfma_f32_16x16x32_bf16 v[100:103], a[92:95], a[44:47], v[100:103]
  v_exp_f32 v98, v98
  v_mfma_f32_16x16x32_bf16 v[104:107], a[96:99], a[32:35], v[208:211]
  v_exp_f32 v99, v99
  v_mfma_f32_16x16x32_bf16 v[104:107], a[100:103], a[36:39], v[104:107]
  v_cvt_pk_bf16_f32 v144, v96, v97
  v_cvt_pk_bf16_f32 v145, v98, v99
  v_mfma_f32_16x16x32_bf16 v[104:107], a[104:107], a[40:43], v[104:107]
  s_waitcnt vmcnt(8)
  ds_read_b128 v[48:51], v234 offset:49152
  v_mfma_f32_16x16x32_bf16 v[104:107], a[108:111], a[44:47], v[104:107]
  ds_read_b128 v[52:55], v235 offset:49152
  ds_read_b128 v[56:59], v234 offset:51200
  v_mfma_f32_16x16x32_bf16 v[108:111], a[112:115], a[32:35], v[208:211]
  ds_read_b128 v[60:63], v235 offset:51200
  v_exp_f32 v100, v100
  v_mfma_f32_16x16x32_bf16 v[108:111], a[116:119], a[36:39], v[108:111]
  v_exp_f32 v101, v101
  v_mfma_f32_16x16x32_bf16 v[108:111], a[120:123], a[40:43], v[108:111]
  v_exp_f32 v102, v102
  v_mfma_f32_16x16x32_bf16 v[108:111], a[124:127], a[44:47], v[108:111]
  v_exp_f32 v103, v103
  v_cvt_pk_bf16_f32 v146, v100, v101
  v_cvt_pk_bf16_f32 v147, v102, v103
  s_waitcnt lgkmcnt(0)
  v_lshlrev_b32 v224, 16, v48
  s_add_u32 m0, s36, 32768
  v_and_b32 v225, 0xffff0000, v48
  buffer_load_dwordx4 v245, s[4:7], s39 offen nt lds
  v_lshlrev_b32 v226, 16, v49
  v_and_b32 v227, 0xffff0000, v49
  v_lshlrev_b32 v228, 16, v50
  v_and_b32 v229, 0xffff0000, v50
  v_lshlrev_b32 v230, 16, v51
  v_and_b32 v231, 0xffff0000, v51
  v_pk_mul_f32 v[224:225], v[224:225], s[42:43]
  v_pk_mul_f32 v[226:227], v[226:227], s[42:43]
  v_pk_mul_f32 v[228:229], v[228:229], s[42:43]
  v_pk_mul_f32 v[230:231], v[230:231], s[42:43]
  v_cvt_pk_bf16_f32 v48, v224, v225
  s_add_u32 m0, s36, 31744
  v_cvt_pk_bf16_f32 v49, v226, v227
  buffer_load_dwordx4 v245, s[4:7], s39 offen offset:2048 nt lds
  v_cvt_pk_bf16_f32 v50, v228, v229
  v_cvt_pk_bf16_f32 v51, v230, v231
  v_accvgpr_write_b32 a48, v48
  v_accvgpr_write_b32 a49, v49
  v_accvgpr_write_b32 a50, v50
  v_accvgpr_write_b32 a51, v51
  v_lshlrev_b32 v224, 16, v52
  v_and_b32 v225, 0xffff0000, v52
  v_mfma_f32_16x16x32_bf16 v[112:115], a[64:67], a[48:51], 0
  v_lshlrev_b32 v226, 16, v53
  v_and_b32 v227, 0xffff0000, v53
  v_lshlrev_b32 v228, 16, v54
  s_add_u32 m0, s36, 34688
  v_and_b32 v229, 0xffff0000, v54
  buffer_load_dwordx4 v245, s[4:7], s39 offen offset:128 nt lds
  v_lshlrev_b32 v230, 16, v55
  v_and_b32 v231, 0xffff0000, v55
  v_pk_mul_f32 v[224:225], v[224:225], s[42:43]
  v_pk_mul_f32 v[226:227], v[226:227], s[42:43]
  v_pk_mul_f32 v[228:229], v[228:229], s[42:43]
  v_pk_mul_f32 v[230:231], v[230:231], s[42:43]
  v_cvt_pk_bf16_f32 v52, v224, v225
  v_cvt_pk_bf16_f32 v53, v226, v227
  v_cvt_pk_bf16_f32 v54, v228, v229
  v_cvt_pk_bf16_f32 v55, v230, v231
  v_accvgpr_write_b32 a52, v52
  s_add_u32 m0, s36, 33664
  v_accvgpr_write_b32 a53, v53
  buffer_load_dwordx4 v245, s[4:7], s39 offen offset:2176 nt lds
  v_accvgpr_write_b32 a54, v54
  v_accvgpr_write_b32 a55, v55
  v_lshlrev_b32 v224, 16, v56
  v_and_b32 v225, 0xffff0000, v56
  v_mfma_f32_16x16x32_bf16 v[112:115], a[68:71], a[52:55], v[112:115]
  v_lshlrev_b32 v226, 16, v57
  v_and_b32 v227, 0xffff0000, v57
  v_lshlrev_b32 v228, 16, v58
  v_and_b32 v229, 0xffff0000, v58
  v_lshlrev_b32 v230, 16, v59
  v_and_b32 v231, 0xffff0000, v59
  v_pk_mul_f32 v[224:225], v[224:225], s[42:43]
  s_add_u32 m0, s37, 8192
  v_pk_mul_f32 v[226:227], v[226:227], s[42:43]
  buffer_load_dwordx4 v246, s[8:11], s40 offen nt lds
  v_pk_mul_f32 v[228:229], v[228:229], s[42:43]
  v_pk_mul_f32 v[230:231], v[230:231], s[42:43]
  v_cvt_pk_bf16_f32 v56, v224, v225
  v_cvt_pk_bf16_f32 v57, v226, v227
  v_cvt_pk_bf16_f32 v58, v228, v229
  v_cvt_pk_bf16_f32 v59, v230, v231
  v_accvgpr_write_b32 a56, v56
  v_accvgpr_write_b32 a57, v57
  v_accvgpr_write_b32 a58, v58
  v_accvgpr_write_b32 a59, v59
  v_lshlrev_b32 v224, 16, v60
  s_add_u32 m0, s37, 39944
  v_mfma_f32_16x16x32_bf16 v[112:115], a[72:75], a[56:59], v[112:115]
  buffer_load_dwordx4 v246, s[8:11], s40 offen offset:1024 nt lds
  v_and_b32 v225, 0xffff0000, v60
  v_lshlrev_b32 v226, 16, v61
  v_and_b32 v227, 0xffff0000, v61
  v_lshlrev_b32 v228, 16, v62
  v_and_b32 v229, 0xffff0000, v62
  v_lshlrev_b32 v230, 16, v63
  v_and_b32 v231, 0xffff0000, v63
  v_pk_mul_f32 v[224:225], v[224:225], s[42:43]
  v_pk_mul_f32 v[226:227], v[226:227], s[42:43]
  v_pk_mul_f32 v[228:229], v[228:229], s[42:43]
  s_add_u32 m0, s37, 9088
  v_pk_mul_f32 v[230:231], v[230:231], s[42:43]
  buffer_load_dwordx4 v246, s[8:11], s40 offen offset:128 nt lds
  v_cvt_pk_bf16_f32 v60, v224, v225
  v_cvt_pk_bf16_f32 v61, v226, v227
  v_cvt_pk_bf16_f32 v62, v228, v229
  v_cvt_pk_bf16_f32 v63, v230, v231
  v_accvgpr_write_b32 a60, v60
  v_accvgpr_write_b32 a61, v61
  v_accvgpr_write_b32 a62, v62
  v_accvgpr_write_b32 a63, v63
  s_add_u32 m0, s37, 40840
  v_exp_f32 v104, v104
  v_mfma_f32_16x16x32_bf16 v[112:115], a[76:79], a[60:63], v[112:115]
L_stub1:
  s_cmp_eq_u32 s99, 1
  s_cbranch_scc1 L_ret0
  buffer_load_dwordx4 v246, s[8:11], s40 offen offset:1152 nt lds
  v_exp_f32 v105, v105
  v_exp_f32 v106, v106
  v_exp_f32 v107, v107
  v_cvt_pk_bf16_f32 v148, v104, v105
  v_cvt_pk_bf16_f32 v149, v106, v107
  v_exp_f32 v108, v108
  v_exp_f32 v109, v109
  v_exp_f32 v110, v110
  v_exp_f32 v111, v111
  v_cvt_pk_bf16_f32 v150, v108, v109
  v_cvt_pk_bf16_f32 v151, v110, v111
  v_max3_f32 v192, v112, v113, v114
  v_max_f32 v192, v192, v115
  v_mov_b32 v193, v192
  s_nop 0
  s_nop 0
  v_permlane32_swap_b32 v192, v193
  v_max_f32 v192, v192, v193
  v_mov_b32 v193, v192
  s_nop 0
  s_nop 0
  v_permlane16_swap_b32 v192, v193
  v_min3_f32 v212, -v192, -v193, s60
  v_min3_f32 v213, -v192, -v193, s60
  v_min3_f32 v214, -v192, -v193, s60
  v_min3_f32 v215, -v192, -v193, s60
  v_add_f32 v112, v212, v112
  v_add_f32 v113, v212, v113
  v_mfma_f32_16x16x32_bf16 v[116:119], a[80:83], a[48:51], v[212:215]
  s_waitcnt vmcnt(8) lgkmcnt(0)
  s_barrier
  v_mfma_f32_16x16x32_bf16 v[116:119], a[84:87], a[52:55], v[116:119]
  ds_read_b64_tr_b16 a[160:161], v242 offset:0
  ds_read_b64_tr_b16 a[162:163], v242 offset:2048
  v_mfma_f32_16x16x32_bf16 v[116:119], a[88:91], a[56:59], v[116:119]
  ds_read_b64_tr_b16 a[164:165], v242 offset:4096
  ds_read_b64_tr_b16 a[166:167], v242 offset:6144
  v_mfma_f32_16x16x32_bf16 v[116:119], a[92:95], a[60:63], v[116:119]
  ds_read_b128 a[128:131], v240 offset:16384
  ds_read_b128 a[132:135], v241 offset:16384
  v_mfma_f32_16x16x32_bf16 v[120:123], a[96:99], a[48:51], v[212:215]
  ds_read_b128 a[136:139], v240 offset:18432
  ds_read_b128 a[140:143], v241 offset:18432
  v_mfma_f32_16x16x32_bf16 v[120:123], a[100:103], a[52:55], v[120:123]
  ds_read_b64_tr_b16 a[168:169], v242 offset:8
  ds_read_b64_tr_b16 a[170:171], v242 offset:2056
  v_mfma_f32_16x16x32_bf16 v[120:123], a[104:107], a[56:59], v[120:123]
  ds_read_b64_tr_b16 a[172:173], v242 offset:4104
  ds_read_b64_tr_b16 a[174:175], v242 offset:6152
  v_mfma_f32_16x16x32_bf16 v[120:123], a[108:111], a[60:63], v[120:123]
  ds_read_b64_tr_b16 a[176:177], v243 offset:0
  ds_read_b64_tr_b16 a[178:179], v243 offset:2048
  v_mfma_f32_16x16x32_bf16 v[124:127], a[112:115], a[48:51], v[212:215]
  ds_read_b128 a[144:147], v240 offset:20480
  v_add_f32 v114, v212, v114
  v_mfma_f32_16x16x32_bf16 v[124:127], a[116:119], a[52:55], v[124:127]
  v_add_f32 v115, v212, v115
  v_exp_f32 v112, v112
  v_mfma_f32_16x16x32_bf16 v[124:127], a[120:123], a[56:59], v[124:127]
  v_exp_f32 v113, v113
  v_mfma_f32_16x16x32_bf16 v[124:127], a[124:127], a[60:63], v[124:127]
  v_exp_f32 v114, v114
  v_exp_f32 v115, v115
  v_cvt_pk_bf16_f32 v152, v112, v113
  v_cvt_pk_bf16_f32 v153, v114, v115
  v_exp_f32 v116, v116
  v_exp_f32 v117, v117
  v_exp_f32 v118, v118
  v_exp_f32 v119, v119
  v_cvt_pk_bf16_f32 v154, v116, v117
  v_cvt_pk_bf16_f32 v155, v118, v119
  v_exp_f32 v120, v120
  v_exp_f32 v121, v121
  v_exp_f32 v122, v122
  v_exp_f32 v123, v123
  v_cvt_pk_bf16_f32 v156, v120, v121
  v_cvt_pk_bf16_f32 v157, v122, v123
  v_exp_f32 v124, v124
  v_exp_f32 v125, v125
  v_exp_f32 v126, v126
  v_exp_f32 v127, v127
  v_cvt_pk_bf16_f32 v158, v124, v125
  v_cvt_pk_bf16_f32 v159, v126, v127
  s_waitcnt lgkmcnt(3)
  v_mfma_f32_16x16x32_bf16 v[192:195], a[128:131], a[0:3], v[200:203]
  s_add_u32 m0, s36, 49152
  ds_read_b128 a[148:151], v241 offset:20480
  ds_read_b128 a[152:155], v240 offset:22528
  v_mfma_f32_16x16x32_bf16 v[192:195], a[132:135], a[4:7], v[192:195]
  s_add_u32 s3, s55, 32
  ds_read_b128 a[156:159], v241 offset:22528
  ds_read_b64_tr_b16 a[180:181], v243 offset:4096
  v_mfma_f32_16x16x32_bf16 v[192:195], a[136:139], a[8:11], v[192:195]
  s_mul_i32 s45, s3, 43691
  ds_read_b64_tr_b16 a[182:183], v243 offset:6144
  ds_read_b64_tr_b16 a[184:185], v243 offset:8
  v_mfma_f32_16x16x32_bf16 v[192:195], a[140:143], a[12:15], v[192:195]
  s_lshr_b32 s45, s45, 17
  ds_read_b64_tr_b16 a[186:187], v243 offset:2056
  ds_read_b64_tr_b16 a[188:189], v243 offset:4104
  v_mfma_f32_16x16x32_bf16 v[0:3], a[160:163], v[128:131], 0
  s_mul_i32 s41, s45, 3
  ds_read_b64_tr_b16 a[190:191], v243 offset:6152
  v_mfma_f32_16x16x32_bf16 v[0:3], a[164:167], v[132:135], v[0:3]
  s_sub_u32 s3, s3, s41
  v_exp_f32 v192, v192
  v_mfma_f32_16x16x32_bf16 v[8:11], a[160:163], v[136:139], 0
  s_add_u32 s45, s45, s54
  v_exp_f32 v193, v193
  v_mfma_f32_16x16x32_bf16 v[8:11], a[164:167], v[140:143], v[8:11]
  s_lshl_b32 s21, s45, 17
  v_exp_f32 v194, v194
  v_mfma_f32_16x16x32_bf16 v[196:199], a[128:131], a[16:19], v[204:207]
  s_mul_i32 s45, s45, 188416
  v_exp_f32 v195, v195
  v_mfma_f32_16x16x32_bf16 v[196:199], a[132:135], a[20:23], v[196:199]
  s_lshl_b32 s41, s3, 16
  v_cvt_pk_bf16_f32 v160, v192, v193
  v_cvt_pk_bf16_f32 v161, v194, v195
  v_mfma_f32_16x16x32_bf16 v[196:199], a[136:139], a[24:27], v[196:199]
  s_add_u32 s45, s45, s41
  v_mfma_f32_16x16x32_bf16 v[196:199], a[140:143], a[28:31], v[196:199]
  s_mul_i32 s41, s23, 12288
  v_mfma_f32_16x16x32_bf16 v[16:19], a[160:163], v[144:147], 0
  s_add_u32 s28, s45, s41
  v_mfma_f32_16x16x32_bf16 v[16:19], a[164:167], v[148:151], v[16:19]
  s_add_u32 s29, s28, 4096
  v_mfma_f32_16x16x32_bf16 v[24:27], a[160:163], v[152:155], 0
  s_lshl_b32 s3, s3, 2
  ds_read_b64_tr_b16 a[160:161], v242 offset:1024
  ds_read_b64_tr_b16 a[162:163], v242 offset:3072
  v_mfma_f32_16x16x32_bf16 v[24:27], a[164:167], v[156:159], v[24:27]
  s_add_u32 s3, s3, s23
  v_exp_f32 v196, v196
  v_mfma_f32_16x16x32_bf16 v[192:195], a[128:131], a[32:35], v[208:211]
  s_add_u32 s3, s3, 5
  v_exp_f32 v197, v197
  v_mfma_f32_16x16x32_bf16 v[192:195], a[132:135], a[36:39], v[192:195]
  s_lshr_b32 s3, s3, 4
  v_exp_f32 v198, v198
  v_mfma_f32_16x16x32_bf16 v[192:195], a[136:139], a[40:43], v[192:195]
  s_mul_i32 s61, s3, 0x71c9f2ca
  v_exp_f32 v199, v199
  v_mfma_f32_16x16x32_bf16 v[192:195], a[140:143], a[44:47], v[192:195]
  s_add_u32 s61, s61, 0x7f800000
  ds_read_b64_tr_b16 a[164:165], v242 offset:5120
  ds_read_b64_tr_b16 a[166:167], v242 offset:7168
  v_mfma_f32_16x16x32_bf16 v[4:7], a[168:171], v[128:131], 0
  s_mul_i32 s41, s3, 0x70000000
  v_cvt_pk_bf16_f32 v168, v196, v197
  v_cvt_pk_bf16_f32 v169, v198, v199
  v_mfma_f32_16x16x32_bf16 v[4:7], a[172:175], v[132:135], v[4:7]
  s_add_u32 s41, s41, s28
  v_exp_f32 v192, v192
  v_mfma_f32_16x16x32_bf16 v[12:15], a[168:171], v[136:139], 0
  s_add_u32 s30, s41, 8192
  v_exp_f32 v193, v193
  v_mfma_f32_16x16x32_bf16 v[12:15], a[172:175], v[140:143], v[12:15]
  s_add_u32 s31, s41, 12288
  v_exp_f32 v194, v194
  v_smfmac_f32_16x16x64_bf16 a[192:195], a[208:211], v[128:135], v248
  v_exp_f32 v195, v195
  v_mfma_f32_16x16x32_bf16 v[196:199], a[128:131], a[48:51], v[212:215]
  s_add_u32 s39, s20, 49152
  ds_read_b128 a[128:131], v240 offset:24576
  buffer_load_dwordx4 v245, s[4:7], s39 offen nt lds
  v_mfma_f32_16x16x32_bf16 v[196:199], a[132:135], a[52:55], v[196:199]
  s_add_u32 m0, s37, 16384
  ds_read_b128 a[132:135], v241 offset:24576
  v_cvt_pk_bf16_f32 v176, v192, v193
  v_mfma_f32_16x16x32_bf16 v[196:199], a[136:139], a[56:59], v[196:199]
  s_add_u32 s40, s20, 32768
  ds_read_b128 a[136:139], v240 offset:26624
  v_cvt_pk_bf16_f32 v177, v194, v195
  v_mfma_f32_16x16x32_bf16 v[196:199], a[140:143], a[60:63], v[196:199]
  ds_read_b128 a[140:143], v241 offset:26624
  v_mfma_f32_16x16x32_bf16 v[20:23], a[168:171], v[144:147], 0
  s_add_u32 s3, s55, 64
  v_mfma_f32_16x16x32_bf16 v[20:23], a[172:175], v[148:151], v[20:23]
  v_mfma_f32_16x16x32_bf16 v[28:31], a[168:171], v[152:155], 0
  s_mul_i32 s45, s3, 43691
  ds_read_b64_tr_b16 a[168:169], v242 offset:1032
  ds_read_b64_tr_b16 a[170:171], v242 offset:3080
  v_mfma_f32_16x16x32_bf16 v[28:31], a[172:175], v[156:159], v[28:31]
  s_waitcnt lgkmcnt(5)
  v_exp_f32 v196, v196
  v_mfma_f32_16x16x32_bf16 v[192:195], a[144:147], a[0:3], v[200:203]
  s_lshr_b32 s45, s45, 17
  v_exp_f32 v197, v197
  v_mfma_f32_16x16x32_bf16 v[192:195], a[148:151], a[4:7], v[192:195]
  v_exp_f32 v198, v198
  v_mfma_f32_16x16x32_bf16 v[192:195], a[152:155], a[8:11], v[192:195]
  s_mul_i32 s41, s45, 3
  v_exp_f32 v199, v199
  v_mfma_f32_16x16x32_bf16 v[192:195], a[156:159], a[12:15], v[192:195]
  buffer_load_dwordx4 v246, s[8:11], s40 offen nt lds
  ds_read_b64_tr_b16 a[172:173], v242 offset:5128
  v_mfma_f32_16x16x32_bf16 v[32:35], a[176:179], v[128:131], 0
  s_add_u32 m0, s36, 48128
  ds_read_b64_tr_b16 a[174:175], v242 offset:7176
  v_cvt_pk_bf16_f32 v184, v196, v197
  v_mfma_f32_16x16x32_bf16 v[32:35], a[180:183], v[132:135], v[32:35]
  v_cvt_pk_bf16_f32 v185, v198, v199
  v_mfma_f32_16x16x32_bf16 v[40:43], a[176:179], v[136:139], 0
  s_sub_u32 s3, s3, s41
  v_exp_f32 v192, v192
  v_mfma_f32_16x16x32_bf16 v[40:43], a[180:183], v[140:143], v[40:43]
  v_exp_f32 v193, v193
  v_smfmac_f32_16x16x64_bf16 a[196:199], a[208:211], v[136:143], v248
  s_add_u32 s45, s45, s54
  v_exp_f32 v194, v194
  v_mfma_f32_16x16x32_bf16 v[196:199], a[144:147], a[16:19], v[204:207]
  v_exp_f32 v195, v195
  v_mfma_f32_16x16x32_bf16 v[196:199], a[148:151], a[20:23], v[196:199]
  s_lshl_b32 s22, s45, 17
  v_cvt_pk_bf16_f32 v162, v192, v193
  v_cvt_pk_bf16_f32 v163, v194, v195
  v_mfma_f32_16x16x32_bf16 v[196:199], a[152:155], a[24:27], v[196:199]
  v_mfma_f32_16x16x32_bf16 v[196:199], a[156:159], a[28:31], v[196:199]
  s_mul_i32 s45, s45, 188416
  v_mfma_f32_16x16x32_bf16 v[48:51], a[176:179], v[144:147], 0
  buffer_load_dwordx4 v245, s[4:7], s39 offen offset:2048 nt lds
  v_mfma_f32_16x16x32_bf16 v[48:51], a[180:183], v[148:151], v[48:51]
  s_add_u32 m0, s37, 48136
  v_mfma_f32_16x16x32_bf16 v[56:59], a[176:179], v[152:155], 0
  ds_read_b64_tr_b16 a[176:177], v243 offset:1024
  ds_read_b64_tr_b16 a[178:179], v243 offset:3072
  v_mfma_f32_16x16x32_bf16 v[56:59], a[180:183], v[156:159], v[56:59]
  s_lshl_b32 s41, s3, 16
  v_exp_f32 v196, v196
  v_mfma_f32_16x16x32_bf16 v[192:195], a[144:147], a[32:35], v[208:211]
  v_exp_f32 v197, v197
  v_mfma_f32_16x16x32_bf16 v[192:195], a[148:151], a[36:39], v[192:195]
  s_add_u32 s45, s45, s41
  v_exp_f32 v198, v198
  v_mfma_f32_16x16x32_bf16 v[192:195], a[152:155], a[40:43], v[192:195]
  v_exp_f32 v199, v199
  v_mfma_f32_16x16x32_bf16 v[192:195], a[156:159], a[44:47], v[192:195]
  s_mul_i32 s41, s23, 12288
  ds_read_b64_tr_b16 a[180:181], v243 offset:5120
  ds_read_b64_tr_b16 a[182:183], v243 offset:7168
  v_mfma_f32_16x16x32_bf16 v[36:39], a[184:187], v[128:131], 0
  v_cvt_pk_bf16_f32 v170, v196, v197
  v_cvt_pk_bf16_f32 v171, v198, v199
  v_mfma_f32_16x16x32_bf16 v[36:39], a[188:191], v[132:135], v[36:39]
  s_add_u32 s32, s45, s41
  v_exp_f32 v192, v192
  v_mfma_f32_16x16x32_bf16 v[44:47], a[184:187], v[136:139], 0
  v_exp_f32 v193, v193
  v_mfma_f32_16x16x32_bf16 v[44:47], a[188:191], v[140:143], v[44:47]
  s_add_u32 s33, s32, 4096
  v_exp_f32 v194, v194
  v_smfmac_f32_16x16x64_bf16 a[200:203], a[208:211], v[144:151], v248
  v_exp_f32 v195, v195
  v_mfma_f32_16x16x32_bf16 v[196:199], a[144:147], a[48:51], v[212:215]
  s_lshl_b32 s3, s3, 2
  buffer_load_dwordx4 v246, s[8:11], s40 offen offset:1024 nt lds
  ds_read_b128 a[144:147], v240 offset:28672
  v_mfma_f32_16x16x32_bf16 v[196:199], a[148:151], a[52:55], v[196:199]
  s_add_u32 m0, s36, 51072
  ds_read_b128 a[148:151], v241 offset:28672
  v_cvt_pk_bf16_f32 v178, v192, v193
  v_mfma_f32_16x16x32_bf16 v[196:199], a[152:155], a[56:59], v[196:199]
  s_add_u32 s3, s3, s23
  ds_read_b128 a[152:155], v240 offset:30720
  v_cvt_pk_bf16_f32 v179, v194, v195
  v_mfma_f32_16x16x32_bf16 v[196:199], a[156:159], a[60:63], v[196:199]
  ds_read_b128 a[156:159], v241 offset:30720
  v_mfma_f32_16x16x32_bf16 v[52:55], a[184:187], v[144:147], 0
  s_add_u32 s3, s3, 5
  v_mfma_f32_16x16x32_bf16 v[52:55], a[188:191], v[148:151], v[52:55]
  v_mfma_f32_16x16x32_bf16 v[60:63], a[184:187], v[152:155], 0
  s_lshr_b32 s3, s3, 4
  ds_read_b64_tr_b16 a[184:185], v243 offset:1032
  ds_read_b64_tr_b16 a[186:187], v243 offset:3080
  v_mfma_f32_16x16x32_bf16 v[60:63], a[188:191], v[156:159], v[60:63]
  s_waitcnt lgkmcnt(5)
  v_exp_f32 v196, v196
  v_mfma_f32_16x16x32_bf16 v[192:195], a[128:131], a[0:3], v[200:203]
  s_mul_i32 s63, s3, 0x71c9f2ca
  v_exp_f32 v197, v197
  v_mfma_f32_16x16x32_bf16 v[192:195], a[132:135], a[4:7], v[192:195]
  v_exp_f32 v198, v198
  v_mfma_f32_16x16x32_bf16 v[192:195], a[136:139], a[8:11], v[192:195]
  s_add_u32 s63, s63, 0x7f800000
  v_exp_f32 v199, v199
  v_mfma_f32_16x16x32_bf16 v[192:195], a[140:143], a[12:15], v[192:195]
  buffer_load_dwordx4 v245, s[4:7], s39 offen offset:128 nt lds
  ds_read_b64_tr_b16 a[188:189], v243 offset:5128
  v_mfma_f32_16x16x32_bf16 v[64:67], a[160:163], v[128:131], 0
  s_add_u32 m0, s37, 17280
  ds_read_b64_tr_b16 a[190:191], v243 offset:7176
  v_cvt_pk_bf16_f32 v186, v196, v197
  v_mfma_f32_16x16x32_bf16 v[64:67], a[164:167], v[132:135], v[64:67]
  v_cvt_pk_bf16_f32 v187, v198, v199
  v_mfma_f32_16x16x32_bf16 v[72:75], a[160:163], v[136:139], 0
  s_mul_i32 s41, s3, 0x70000000
  v_exp_f32 v192, v192
  v_mfma_f32_16x16x32_bf16 v[72:75], a[164:167], v[140:143], v[72:75]
  v_exp_f32 v193, v193
  v_smfmac_f32_16x16x64_bf16 a[204:207], a[208:211], v[152:159], v248
  s_add_u32 s41, s41, s32
  buffer_load_dwordx4 v246, s[8:11], s40 offen offset:128 nt lds
  v_cvt_pk_bf16_f32 v164, v192, v193
  s_add_u32 m0, s38, 4096
  v_mfma_f32_16x16x32_bf16 v[196:199], a[128:131], a[16:19], v[204:207]
  buffer_load_dwordx4 v245, s[12:15], s28 offen nt lds
  v_mfma_f32_16x16x32_bf16 v[196:199], a[132:135], a[20:23], v[196:199]
  s_add_u32 m0, s38, 3072
  v_exp_f32 v194, v194
  v_mfma_f32_16x16x32_bf16 v[196:199], a[136:139], a[24:27], v[196:199]
  v_exp_f32 v195, v195
  v_mfma_f32_16x16x32_bf16 v[196:199], a[140:143], a[28:31], v[196:199]
  s_add_u32 s34, s41, 8192
  v_cvt_pk_bf16_f32 v165, v194, v195
  v_mfma_f32_16x16x32_bf16 v[80:83], a[160:163], v[144:147], 0
  buffer_load_dwordx4 v245, s[12:15], s28 offen offset:2048 nt lds
  v_mfma_f32_16x16x32_bf16 v[80:83], a[164:167], v[148:151], v[80:83]
  s_add_u32 m0, s36, 50048
  v_mfma_f32_16x16x32_bf16 v[88:91], a[160:163], v[152:155], 0
  v_mfma_f32_16x16x32_bf16 v[88:91], a[164:167], v[156:159], v[88:91]
  s_add_u32 s35, s41, 12288
  v_exp_f32 v196, v196
  v_mfma_f32_16x16x32_bf16 v[192:195], a[128:131], a[32:35], v[208:211]
  v_exp_f32 v197, v197
  v_mfma_f32_16x16x32_bf16 v[192:195], a[132:135], a[36:39], v[192:195]
  s_mov_b64 vcc, s[58:59]
  v_exp_f32 v198, v198
  v_mfma_f32_16x16x32_bf16 v[192:195], a[136:139], a[40:43], v[192:195]
  v_exp_f32 v199, v199
  v_mfma_f32_16x16x32_bf16 v[192:195], a[140:143], a[44:47], v[192:195]
  s_waitcnt vmcnt(8) lgkmcnt(0)
  v_cvt_pk_bf16_f32 v172, v196, v197
  v_cvt_pk_bf16_f32 v173, v198, v199
  v_mfma_f32_16x16x32_bf16 v[68:71], a[168:171], v[128:131], 0
  s_barrier
  ds_read_b64_tr_b16 a[160:161], v242 offset:8192
  ds_read_b64_tr_b16 a[162:163], v242 offset:10240
  v_mfma_f32_16x16x32_bf16 v[68:71], a[172:175], v[132:135], v[68:71]
  v_exp_f32 v192, v192
  v_mfma_f32_16x16x32_bf16 v[76:79], a[168:171], v[136:139], 0
  v_exp_f32 v193, v193
  v_mfma_f32_16x16x32_bf16 v[76:79], a[172:175], v[140:143], v[76:79]
  v_exp_f32 v194, v194
  v_mfma_f32_16x16x32_bf16 v[196:199], a[128:131], a[48:51], v[212:215]
  v_exp_f32 v195, v195
  v_mfma_f32_16x16x32_bf16 v[196:199], a[132:135], a[52:55], v[196:199]
  buffer_load_dwordx4 v245, s[4:7], s39 offen offset:2176 nt lds
  ds_read_b128 a[128:131], v240 offset:32768
  v_mfma_f32_16x16x32_bf16 v[196:199], a[136:139], a[56:59], v[196:199]
  s_add_u32 m0, s37, 49032
  ds_read_b128 a[132:135], v241 offset:32768
  ds_read_b128 a[136:139], v240 offset:34816
  v_mfma_f32_16x16x32_bf16 v[196:199], a[140:143], a[60:63], v[196:199]
  s_add_u32 s39, s20, 65536
  ds_read_b128 a[140:143], v241 offset:34816
  ds_read_b64_tr_b16 a[164:165], v242 offset:12288
  v_mfma_f32_16x16x32_bf16 v[84:87], a[168:171], v[144:147], 0
  ds_read_b64_tr_b16 a[166:167], v242 offset:14336
  v_cvt_pk_bf16_f32 v180, v192, v193
  v_mfma_f32_16x16x32_bf16 v[84:87], a[172:175], v[148:151], v[84:87]
  v_cvt_pk_bf16_f32 v181, v194, v195
  v_mfma_f32_16x16x32_bf16 v[92:95], a[168:171], v[152:155], 0
  v_exp_f32 v196, v196
  v_mfma_f32_16x16x32_bf16 v[92:95], a[172:175], v[156:159], v[92:95]
  v_exp_f32 v197, v197
  v_mfma_f32_16x16x32_bf16 v[192:195], a[144:147], a[0:3], v[200:203]
  buffer_load_dwordx4 v246, s[8:11], s40 offen offset:1152 nt lds
  ds_read_b64_tr_b16 a[168:169], v242 offset:8200
  v_mfma_f32_16x16x32_bf16 v[192:195], a[148:151], a[4:7], v[192:195]
  s_add_u32 m0, s38, -128
  v_exp_f32 v198, v198
  v_mfma_f32_16x16x32_bf16 v[192:195], a[152:155], a[8:11], v[192:195]
  v_exp_f32 v199, v199
  v_mfma_f32_16x16x32_bf16 v[192:195], a[156:159], a[12:15], v[192:195]
  s_add_u32 s40, s20, 49152
  ds_read_b64_tr_b16 a[170:171], v242 offset:10248
  ds_read_b64_tr_b16 a[172:173], v242 offset:12296
  v_mfma_f32_16x16x32_bf16 v[96:99], a[176:179], v[128:131], 0
  ds_read_b64_tr_b16 a[174:175], v242 offset:14344
  v_cvt_pk_bf16_f32 v188, v196, v197
  v_mfma_f32_16x16x32_bf16 v[96:99], a[180:183], v[132:135], v[96:99]
  v_cvt_pk_bf16_f32 v189, v198, v199
  v_mfma_f32_16x16x32_bf16 v[104:107], a[176:179], v[136:139], 0
  v_exp_f32 v192, v192
  v_mfma_f32_16x16x32_bf16 v[104:107], a[180:183], v[140:143], v[104:107]
  v_exp_f32 v193, v193
  v_mfma_f32_16x16x32_bf16 v[196:199], a[144:147], a[16:19], v[204:207]
  v_exp_f32 v194, v194
  v_mfma_f32_16x16x32_bf16 v[196:199], a[148:151], a[20:23], v[196:199]
  v_exp_f32 v195, v195
  v_mfma_f32_16x16x32_bf16 v[196:199], a[152:155], a[24:27], v[196:199]
  buffer_load_dwordx4 v245, s[12:15], s28 offen offset:128 nt lds
  v_cvt_pk_bf16_f32 v166, v192, v193
  v_mfma_f32_16x16x32_bf16 v[196:199], a[156:159], a[28:31], v[196:199]
  s_add_u32 m0, s38, -1152
  v_cvt_pk_bf16_f32 v167, v194, v195
  v_mfma_f32_16x16x32_bf16 v[112:115], a[176:179], v[144:147], 0
  v_mfma_f32_16x16x32_bf16 v[112:115], a[180:183], v[148:151], v[112:115]
  v_mfma_f32_16x16x32_bf16 v[120:123], a[176:179], v[152:155], 0
  ds_read_b64_tr_b16 a[176:177], v243 offset:8192
  ds_read_b64_tr_b16 a[178:179], v243 offset:10240
  v_mfma_f32_16x16x32_bf16 v[120:123], a[180:183], v[156:159], v[120:123]
  buffer_load_dwordx4 v245, s[12:15], s28 offen offset:2176 nt lds
  ds_read_b64_tr_b16 a[180:181], v243 offset:12288
  v_mfma_f32_16x16x32_bf16 v[192:195], a[144:147], a[32:35], v[208:211]
  s_add_u32 m0, s38, 2048
  v_exp_f32 v196, v196
  v_mfma_f32_16x16x32_bf16 v[192:195], a[148:151], a[36:39], v[192:195]
  v_exp_f32 v197, v197
  v_mfma_f32_16x16x32_bf16 v[192:195], a[152:155], a[40:43], v[192:195]
  v_exp_f32 v198, v198
  v_mfma_f32_16x16x32_bf16 v[192:195], a[156:159], a[44:47], v[192:195]
  v_exp_f32 v199, v199
  v_mfma_f32_16x16x32_bf16 v[100:103], a[184:187], v[128:131], 0
  ds_read_b64_tr_b16 a[182:183], v243 offset:14336
  v_cvt_pk_bf16_f32 v174, v196, v197
  v_mfma_f32_16x16x32_bf16 v[100:103], a[188:191], v[132:135], v[100:103]
  v_cvt_pk_bf16_f32 v175, v198, v199
  v_mfma_f32_16x16x32_bf16 v[108:111], a[184:187], v[136:139], 0
  v_mfma_f32_16x16x32_bf16 v[108:111], a[188:191], v[140:143], v[108:111]
  v_exp_f32 v192, v192
  v_mfma_f32_16x16x32_bf16 v[196:199], a[144:147], a[48:51], v[212:215]
  v_exp_f32 v193, v193
  v_mfma_f32_16x16x32_bf16 v[196:199], a[148:151], a[52:55], v[196:199]
  v_exp_f32 v194, v194
  v_mfma_f32_16x16x32_bf16 v[196:199], a[152:155], a[56:59], v[196:199]
  v_exp_f32 v195, v195
  v_mfma_f32_16x16x32_bf16 v[196:199], a[156:159], a[60:63], v[196:199]
  ds_read_b128 a[144:147], v240 offset:36864
  ds_read_b128 a[148:151], v241 offset:36864
  v_mfma_f32_16x16x32_bf16 v[116:119], a[184:187], v[144:147], 0
  ds_read_b128 a[152:155], v240 offset:38912
  ds_read_b128 a[156:159], v241 offset:38912
  v_mfma_f32_16x16x32_bf16 v[116:119], a[188:191], v[148:151], v[116:119]
  buffer_load_dwordx4 v245, s[12:15], s29 offen nt lds
  v_cvt_pk_bf16_f32 v182, v192, v193
  v_mfma_f32_16x16x32_bf16 v[124:127], a[184:187], v[152:155], 0
  s_add_u32 m0, s38, 1024
  ds_read_b64_tr_b16 a[184:185], v243 offset:8200
  ds_read_b64_tr_b16 a[186:187], v243 offset:10248
  v_mfma_f32_16x16x32_bf16 v[124:127], a[188:191], v[156:159], v[124:127]
  s_waitcnt lgkmcnt(6)
  ds_read_b64_tr_b16 a[188:189], v243 offset:12296
  ds_read_b64_tr_b16 a[190:191], v243 offset:14344
  v_cvt_pk_bf16_f32 v183, v194, v195
  v_mfma_f32_16x16x32_bf16 v[192:195], a[128:131], a[0:3], v[200:203]
  v_exp_f32 v196, v196
  v_mfma_f32_16x16x32_bf16 v[192:195], a[132:135], a[4:7], v[192:195]
  v_exp_f32 v197, v197
  v_mfma_f32_16x16x32_bf16 v[192:195], a[136:139], a[8:11], v[192:195]
  v_exp_f32 v198, v198
  v_mfma_f32_16x16x32_bf16 v[192:195], a[140:143], a[12:15], v[192:195]
  v_exp_f32 v199, v199
  v_mfma_f32_16x16x32_bf16 v[0:3], a[160:163], v[160:163], v[0:3]
  v_cvt_pk_bf16_f32 v190, v196, v197
  v_cvt_pk_bf16_f32 v191, v198, v199
  v_mfma_f32_16x16x32_bf16 v[0:3], a[164:167], v[164:167], v[0:3]
  v_mfma_f32_16x16x32_bf16 v[8:11], a[160:163], v[168:171], v[8:11]
  v_mfma_f32_16x16x32_bf16 v[8:11], a[164:167], v[172:175], v[8:11]
  buffer_load_dwordx4 v245, s[12:15], s29 offen offset:2048 nt lds
  v_mfma_f32_16x16x32_bf16 v[196:199], a[128:131], a[16:19], v[204:207]
  s_add_u32 m0, s36, 0
  v_exp_f32 v192, v192
  v_mfma_f32_16x16x32_bf16 v[196:199], a[132:135], a[20:23], v[196:199]
  s_waitcnt vmcnt(6)
  v_exp_f32 v193, v193
  v_mfma_f32_16x16x32_bf16 v[196:199], a[136:139], a[24:27], v[196:199]
  v_exp_f32 v194, v194
  v_mfma_f32_16x16x32_bf16 v[196:199], a[140:143], a[28:31], v[196:199]
  v_exp_f32 v195, v195
  v_mfma_f32_16x16x32_bf16 v[16:19], a[160:163], v[176:179], v[16:19]
  v_cvt_pk_bf16_f32 v128, v192, v193
  v_cvt_pk_bf16_f32 v129, v194, v195
  v_mfma_f32_16x16x32_bf16 v[16:19], a[164:167], v[180:183], v[16:19]
  v_mfma_f32_16x16x32_bf16 v[24:27], a[160:163], v[184:187], v[24:27]
  ds_read_b64_tr_b16 a[160:161], v242 offset:9216
  ds_read_b64_tr_b16 a[162:163], v242 offset:11264
  v_mfma_f32_16x16x32_bf16 v[24:27], a[164:167], v[188:191], v[24:27]
  v_exp_f32 v196, v196
  v_mfma_f32_16x16x32_bf16 v[192:195], a[128:131], a[32:35], v[208:211]
  ds_read_b128 v[216:219], v249 offset:4096
  ds_read_b64_tr_b16 a[164:165], v242 offset:13312
  v_mfma_f32_16x16x32_bf16 v[192:195], a[132:135], a[36:39], v[192:195]
  v_exp_f32 v197, v197
  v_mfma_f32_16x16x32_bf16 v[192:195], a[136:139], a[40:43], v[192:195]
  v_exp_f32 v198, v198
  v_mfma_f32_16x16x32_bf16 v[192:195], a[140:143], a[44:47], v[192:195]
  v_exp_f32 v199, v199
  v_mfma_f32_16x16x32_bf16 v[4:7], a[168:171], v[160:163], v[4:7]
  ds_read_b64_tr_b16 a[166:167], v242 offset:15360
  buffer_load_dwordx4 v245, s[4:7], s39 offen nt lds
  v_mfma_f32_16x16x32_bf16 v[4:7], a[172:175], v[164:167], v[4:7]
  s_add_u32 m0, s37, 24576
  v_cvt_pk_bf16_f32 v136, v196, v197
  v_cvt_pk_bf16_f32 v137, v198, v199
  v_mfma_f32_16x16x32_bf16 v[12:15], a[168:171], v[168:171], v[12:15]
  v_exp_f32 v192, v192
  v_mfma_f32_16x16x32_bf16 v[12:15], a[172:175], v[172:175], v[12:15]
  v_exp_f32 v193, v193
  v_smfmac_f32_16x16x64_bf16 a[192:195], a[208:211], v[160:167], v248
  v_exp_f32 v194, v194
  v_mfma_f32_16x16x32_bf16 v[196:199], a[128:131], a[48:51], v[212:215]
  s_waitcnt lgkmcnt(1)
  ds_read_b128 a[128:131], v240 offset:40960
  v_lshlrev_b32 v224, 16, v216
  v_mfma_f32_16x16x32_bf16 v[196:199], a[132:135], a[52:55], v[196:199]
  v_exp_f32 v195, v195
  v_mfma_f32_16x16x32_bf16 v[196:199], a[136:139], a[56:59], v[196:199]
  ds_read_b128 a[132:135], v241 offset:40960
  ds_read_b128 a[136:139], v240 offset:43008
  v_mfma_f32_16x16x32_bf16 v[196:199], a[140:143], a[60:63], v[196:199]
  ds_read_b128 a[140:143], v241 offset:43008
  v_cvt_pk_bf16_f32 v144, v192, v193
  v_mfma_f32_16x16x32_bf16 v[20:23], a[168:171], v[176:179], v[20:23]
  v_cvt_pk_bf16_f32 v145, v194, v195
  v_and_b32 v225, 0xffff0000, v216
  v_mfma_f32_16x16x32_bf16 v[20:23], a[172:175], v[180:183], v[20:23]
  buffer_load_dwordx4 v246, s[8:11], s40 offen nt lds
  v_lshlrev_b32 v226, 16, v217
  v_mfma_f32_16x16x32_bf16 v[28:31], a[168:171], v[184:187], v[28:31]
  s_add_u32 m0, s36, -1024
  ds_read_b64_tr_b16 a[168:169], v242 offset:9224
  ds_read_b64_tr_b16 a[170:171], v242 offset:11272
  v_mfma_f32_16x16x32_bf16 v[28:31], a[172:175], v[188:191], v[28:31]
  ds_read_b64_tr_b16 a[172:173], v242 offset:13320
  ds_read_b64_tr_b16 a[174:175], v242 offset:15368
  v_mfma_f32_16x16x32_bf16 v[192:195], a[144:147], a[0:3], v[200:203]
  v_and_b32 v227, 0xffff0000, v217
  v_lshlrev_b32 v228, 16, v218
  v_mfma_f32_16x16x32_bf16 v[192:195], a[148:151], a[4:7], v[192:195]
  v_exp_f32 v196, v196
  v_mfma_f32_16x16x32_bf16 v[192:195], a[152:155], a[8:11], v[192:195]
  v_exp_f32 v197, v197
  v_mfma_f32_16x16x32_bf16 v[192:195], a[156:159], a[12:15], v[192:195]
  v_exp_f32 v198, v198
  v_mfma_f32_16x16x32_bf16 v[32:35], a[176:179], v[160:163], v[32:35]
  v_exp_f32 v199, v199
  v_mfma_f32_16x16x32_bf16 v[32:35], a[180:183], v[164:167], v[32:35]
  v_cvt_pk_bf16_f32 v152, v196, v197
  v_cvt_pk_bf16_f32 v153, v198, v199
  v_mfma_f32_16x16x32_bf16 v[40:43], a[176:179], v[168:171], v[40:43]
  v_and_b32 v229, 0xffff0000, v218
  v_lshlrev_b32 v230, 16, v219
  v_mfma_f32_16x16x32_bf16 v[40:43], a[180:183], v[172:175], v[40:43]
  buffer_load_dwordx4 v245, s[4:7], s39 offen offset:2048 nt lds
  v_and_b32 v231, 0xffff0000, v219
  v_smfmac_f32_16x16x64_bf16 a[196:199], a[208:211], v[168:175], v248
  s_add_u32 m0, s37, 56328
  v_exp_f32 v192, v192
  v_exp_f32 v193, v193
  v_pk_mul_f32 v[224:225], v[224:225], s[42:43]
  v_pk_mul_f32 v[226:227], v[226:227], s[42:43]
  v_pk_mul_f32 v[228:229], v[228:229], s[42:43]
  v_pk_mul_f32 v[230:231], v[230:231], s[42:43]
  v_mfma_f32_16x16x32_bf16 v[196:199], a[144:147], a[16:19], v[204:207]
  v_exp_f32 v194, v194
  v_mfma_f32_16x16x32_bf16 v[196:199], a[148:151], a[20:23], v[196:199]
  v_exp_f32 v195, v195
  v_mfma_f32_16x16x32_bf16 v[196:199], a[152:155], a[24:27], v[196:199]
  v_cvt_pk_bf16_f32 v130, v192, v193
  v_cvt_pk_bf16_f32 v131, v194, v195
  v_mfma_f32_16x16x32_bf16 v[196:199], a[156:159], a[28:31], v[196:199]
  v_cvt_pk_bf16_f32 v216, v224, v225
  v_cvt_pk_bf16_f32 v217, v226, v227
  v_mfma_f32_16x16x32_bf16 v[48:51], a[176:179], v[176:179], v[48:51]
  v_cvt_pk_bf16_f32 v218, v228, v229
  v_cvt_pk_bf16_f32 v219, v230, v231
  v_mfma_f32_16x16x32_bf16 v[48:51], a[180:183], v[180:183], v[48:51]
  v_accvgpr_write_b32 a64, v216
  v_accvgpr_write_b32 a65, v217
  v_mfma_f32_16x16x32_bf16 v[56:59], a[176:179], v[184:187], v[56:59]
  v_exp_f32 v196, v196
  v_mfma_f32_16x16x32_bf16 v[56:59], a[180:183], v[188:191], v[56:59]
  v_exp_f32 v197, v197
  v_mfma_f32_16x16x32_bf16 v[192:195], a[144:147], a[32:35], v[208:211]
  v_exp_f32 v198, v198
  v_mfma_f32_16x16x32_bf16 v[192:195], a[148:151], a[36:39], v[192:195]
  v_exp_f32 v199, v199
  v_mfma_f32_16x16x32_bf16 v[192:195], a[152:155], a[40:43], v[192:195]
  ds_read_b64_tr_b16 a[176:177], v243 offset:9216
  ds_read_b64_tr_b16 a[178:179], v243 offset:11264
  v_mfma_f32_16x16x32_bf16 v[192:195], a[156:159], a[44:47], v[192:195]
  ds_read_b64_tr_b16 a[180:181], v243 offset:13312
  ds_read_b64_tr_b16 a[182:183], v243 offset:15360
  v_mfma_f32_16x16x32_bf16 v[36:39], a[184:187], v[160:163], v[36:39]
  buffer_load_dwordx4 v246, s[8:11], s40 offen offset:1024 nt lds
  v_cvt_pk_bf16_f32 v138, v196, v197
  v_mfma_f32_16x16x32_bf16 v[36:39], a[188:191], v[164:167], v[36:39]
L_stub2:
  s_cmp_eq_u32 s99, 1
  s_cbranch_scc1 L_ret0
  s_add_u32 m0, s36, 1920
  v_cvt_pk_bf16_f32 v139, v198, v199
  v_accvgpr_write_b32 a66, v218
  v_mfma_f32_16x16x32_bf16 v[44:47], a[184:187], v[168:171], v[44:47]
  v_exp_f32 v192, v192
  v_mfma_f32_16x16x32_bf16 v[44:47], a[188:191], v[172:175], v[44:47]
  v_exp_f32 v193, v193
  v_smfmac_f32_16x16x64_bf16 a[200:203], a[208:211], v[176:183], v248
  v_exp_f32 v194, v194
  v_mfma_f32_16x16x32_bf16 v[196:199], a[144:147], a[48:51], v[212:215]
  v_exp_f32 v195, v195
  v_mfma_f32_16x16x32_bf16 v[196:199], a[148:151], a[52:55], v[196:199]
  ds_read_b128 a[144:147], v240 offset:45056
  ds_read_b128 a[148:151], v241 offset:45056
  v_mfma_f32_16x16x32_bf16 v[196:199], a[152:155], a[56:59], v[196:199]
  ds_read_b128 a[152:155], v240 offset:47104
  v_cvt_pk_bf16_f32 v146, v192, v193
  v_mfma_f32_16x16x32_bf16 v[196:199], a[156:159], a[60:63], v[196:199]
  ds_read_b128 a[156:159], v241 offset:47104
  v_cvt_pk_bf16_f32 v147, v194, v195
  v_mfma_f32_16x16x32_bf16 v[52:55], a[184:187], v[176:179], v[52:55]
  ds_read_b128 v[220:223], v250 offset:4096
  v_accvgpr_write_b32 a67, v219
  v_mfma_f32_16x16x32_bf16 v[52:55], a[188:191], v[180:183], v[52:55]
  buffer_load_dwordx4 v245, s[4:7], s39 offen offset:128 nt lds
  v_mfma_f32_16x16x32_bf16 v[60:63], a[184:187], v[184:187], v[60:63]
  s_add_u32 m0, s37, 25472
  v_exp_f32 v196, v196
  v_mfma_f32_16x16x32_bf16 v[60:63], a[188:191], v[188:191], v[60:63]
  s_waitcnt lgkmcnt(5)
  v_exp_f32 v197, v197
  v_mfma_f32_16x16x32_bf16 v[192:195], a[128:131], a[0:3], v[200:203]
  v_exp_f32 v198, v198
  v_mfma_f32_16x16x32_bf16 v[192:195], a[132:135], a[4:7], v[192:195]
  v_exp_f32 v199, v199
  v_mfma_f32_16x16x32_bf16 v[192:195], a[136:139], a[8:11], v[192:195]
  ds_read_b64_tr_b16 a[184:185], v243 offset:9224
  ds_read_b64_tr_b16 a[186:187], v243 offset:11272
  v_mfma_f32_16x16x32_bf16 v[192:195], a[140:143], a[12:15], v[192:195]
  ds_read_b64_tr_b16 a[188:189], v243 offset:13320
  ds_read_b64_tr_b16 a[190:191], v243 offset:15368
  v_mfma_f32_16x16x32_bf16 v[64:67], a[160:163], v[160:163], v[64:67]
  v_cvt_pk_bf16_f32 v154, v196, v197
  v_cvt_pk_bf16_f32 v155, v198, v199
  v_mfma_f32_16x16x32_bf16 v[64:67], a[164:167], v[164:167], v[64:67]
  s_waitcnt lgkmcnt(4)
  v_lshlrev_b32 v224, 16, v220
  v_and_b32 v225, 0xffff0000, v220
  v_mfma_f32_16x16x32_bf16 v[72:75], a[160:163], v[168:171], v[72:75]
  v_exp_f32 v192, v192
  v_mfma_f32_16x16x32_bf16 v[72:75], a[164:167], v[172:175], v[72:75]
  v_exp_f32 v193, v193
  v_smfmac_f32_16x16x64_bf16 a[204:207], a[208:211], v[184:191], v248
  v_exp_f32 v194, v194
  v_mfma_f32_16x16x32_bf16 v[196:199], a[128:131], a[16:19], v[204:207]
  v_exp_f32 v195, v195
  v_mfma_f32_16x16x32_bf16 v[196:199], a[132:135], a[20:23], v[196:199]
  buffer_load_dwordx4 v246, s[8:11], s40 offen offset:128 nt lds
  v_lshlrev_b32 v226, 16, v221
  v_mfma_f32_16x16x32_bf16 v[196:199], a[136:139], a[24:27], v[196:199]
  s_add_u32 m0, s36, 896
  v_cvt_pk_bf16_f32 v132, v192, v193
  v_cvt_pk_bf16_f32 v133, v194, v195
  v_mfma_f32_16x16x32_bf16 v[196:199], a[140:143], a[28:31], v[196:199]
  v_and_b32 v227, 0xffff0000, v221
  v_lshlrev_b32 v228, 16, v222
  v_mfma_f32_16x16x32_bf16 v[80:83], a[160:163], v[176:179], v[80:83]
  v_and_b32 v229, 0xffff0000, v222
  v_lshlrev_b32 v230, 16, v223
  v_mfma_f32_16x16x32_bf16 v[80:83], a[164:167], v[180:183], v[80:83]
  v_and_b32 v231, 0xffff0000, v223
  v_mfma_f32_16x16x32_bf16 v[88:91], a[160:163], v[184:187], v[88:91]
  v_exp_f32 v196, v196
  v_mfma_f32_16x16x32_bf16 v[88:91], a[164:167], v[188:191], v[88:91]
  v_exp_f32 v197, v197
  v_mfma_f32_16x16x32_bf16 v[192:195], a[128:131], a[32:35], v[208:211]
  v_exp_f32 v198, v198
  v_mfma_f32_16x16x32_bf16 v[192:195], a[132:135], a[36:39], v[192:195]
  v_exp_f32 v199, v199
  v_mfma_f32_16x16x32_bf16 v[192:195], a[136:139], a[40:43], v[192:195]
  v_cvt_pk_bf16_f32 v140, v196, v197
  v_cvt_pk_bf16_f32 v141, v198, v199
  v_mfma_f32_16x16x32_bf16 v[192:195], a[140:143], a[44:47], v[192:195]
  s_waitcnt vmcnt(10) lgkmcnt(0)
  buffer_load_dwordx4 v245, s[4:7], s39 offen offset:2176 nt lds
  v_mfma_f32_16x16x32_bf16 v[68:71], a[168:171], v[160:163], v[68:71]
  s_barrier
  ds_read_b64_tr_b16 a[160:161], v242 offset:16384
  ds_read_b64_tr_b16 a[162:163], v242 offset:18432
  v_mfma_f32_16x16x32_bf16 v[68:71], a[172:175], v[164:167], v[68:71]
  s_add_u32 m0, s37, 57224
  v_exp_f32 v192, v192
  v_exp_f32 v193, v193
  v_pk_mul_f32 v[224:225], v[224:225], s[42:43]
  v_pk_mul_f32 v[226:227], v[226:227], s[42:43]
  v_pk_mul_f32 v[228:229], v[228:229], s[42:43]
  v_pk_mul_f32 v[230:231], v[230:231], s[42:43]
  v_mfma_f32_16x16x32_bf16 v[76:79], a[168:171], v[168:171], v[76:79]
  v_exp_f32 v194, v194
  v_mfma_f32_16x16x32_bf16 v[76:79], a[172:175], v[172:175], v[76:79]
  s_add_u32 s39, s20, 81920
  v_exp_f32 v195, v195
  v_mfma_f32_16x16x32_bf16 v[196:199], a[128:131], a[48:51], v[212:215]
  ds_read_b128 a[128:131], v240 offset:49152
  ds_read_b64_tr_b16 a[164:165], v242 offset:20480
  v_mfma_f32_16x16x32_bf16 v[196:199], a[132:135], a[52:55], v[196:199]
  ds_read_b128 a[132:135], v241 offset:49152
  ds_read_b64_tr_b16 a[166:167], v242 offset:22528
  v_mfma_f32_16x16x32_bf16 v[196:199], a[136:139], a[56:59], v[196:199]
  ds_read_b128 a[136:139], v240 offset:51200
  v_cvt_pk_bf16_f32 v148, v192, v193
  v_mfma_f32_16x16x32_bf16 v[196:199], a[140:143], a[60:63], v[196:199]
  ds_read_b128 a[140:143], v241 offset:51200
  v_cvt_pk_bf16_f32 v149, v194, v195
  v_mfma_f32_16x16x32_bf16 v[84:87], a[168:171], v[176:179], v[84:87]
  v_cvt_pk_bf16_f32 v220, v224, v225
  v_cvt_pk_bf16_f32 v221, v226, v227
  v_mfma_f32_16x16x32_bf16 v[84:87], a[172:175], v[180:183], v[84:87]
  buffer_load_dwordx4 v246, s[8:11], s40 offen offset:1152 nt lds
  v_cvt_pk_bf16_f32 v222, v228, v229
  v_mfma_f32_16x16x32_bf16 v[92:95], a[168:171], v[184:187], v[92:95]
  s_add_u32 m0, s38, 3968
  v_exp_f32 v196, v196
  v_mfma_f32_16x16x32_bf16 v[92:95], a[172:175], v[188:191], v[92:95]
  s_add_u32 s40, s20, 65536
  v_exp_f32 v197, v197
  v_mfma_f32_16x16x32_bf16 v[192:195], a[144:147], a[0:3], v[200:203]
  v_exp_f32 v198, v198
  v_mfma_f32_16x16x32_bf16 v[192:195], a[148:151], a[4:7], v[192:195]
  v_exp_f32 v199, v199
  v_mfma_f32_16x16x32_bf16 v[192:195], a[152:155], a[8:11], v[192:195]
  ds_read_b64_tr_b16 a[168:169], v242 offset:16392
  ds_read_b64_tr_b16 a[170:171], v242 offset:18440
  v_mfma_f32_16x16x32_bf16 v[192:195], a[156:159], a[12:15], v[192:195]
  s_waitcnt vmcnt(10)
  ds_read_b64_tr_b16 a[172:173], v242 offset:20488
  ds_read_b64_tr_b16 a[174:175], v242 offset:22536
  v_mfma_f32_16x16x32_bf16 v[96:99], a[176:179], v[160:163], v[96:99]
  v_cvt_pk_bf16_f32 v156, v196, v197
  v_cvt_pk_bf16_f32 v157, v198, v199
  v_mfma_f32_16x16x32_bf16 v[96:99], a[180:183], v[164:167], v[96:99]
  v_cvt_pk_bf16_f32 v223, v230, v231
  v_accvgpr_write_b32 a68, v220
  v_mfma_f32_16x16x32_bf16 v[104:107], a[176:179], v[168:171], v[104:107]
  v_exp_f32 v192, v192
  v_mfma_f32_16x16x32_bf16 v[104:107], a[180:183], v[172:175], v[104:107]
  v_exp_f32 v193, v193
  v_mfma_f32_16x16x32_bf16 v[196:199], a[144:147], a[16:19], v[204:207]
  v_exp_f32 v194, v194
  v_mfma_f32_16x16x32_bf16 v[196:199], a[148:151], a[20:23], v[196:199]
  v_exp_f32 v195, v195
  v_mfma_f32_16x16x32_bf16 v[196:199], a[152:155], a[24:27], v[196:199]
  buffer_load_dwordx4 v245, s[12:15], s29 offen offset:128 nt lds
  v_cvt_pk_bf16_f32 v134, v192, v193
  v_mfma_f32_16x16x32_bf16 v[196:199], a[156:159], a[28:31], v[196:199]
  s_add_u32 m0, s38, 2944
  ds_read_b128 v[216:219], v249 offset:0
  v_cvt_pk_bf16_f32 v135, v194, v195
  v_mfma_f32_16x16x32_bf16 v[112:115], a[176:179], v[176:179], v[112:115]
  v_accvgpr_write_b32 a69, v221
  v_accvgpr_write_b32 a70, v222
  v_mfma_f32_16x16x32_bf16 v[112:115], a[180:183], v[180:183], v[112:115]
  v_accvgpr_write_b32 a71, v223
  v_mfma_f32_16x16x32_bf16 v[120:123], a[176:179], v[184:187], v[120:123]
  v_exp_f32 v196, v196
  v_mfma_f32_16x16x32_bf16 v[120:123], a[180:183], v[188:191], v[120:123]
  v_exp_f32 v197, v197
  v_mfma_f32_16x16x32_bf16 v[192:195], a[144:147], a[32:35], v[208:211]
  v_exp_f32 v198, v198
  v_mfma_f32_16x16x32_bf16 v[192:195], a[148:151], a[36:39], v[192:195]
  v_exp_f32 v199, v199
  v_mfma_f32_16x16x32_bf16 v[192:195], a[152:155], a[40:43], v[192:195]
  ds_read_b64_tr_b16 a[176:177], v243 offset:16384
  ds_read_b64_tr_b16 a[178:179], v243 offset:18432
  v_mfma_f32_16x16x32_bf16 v[192:195], a[156:159], a[44:47], v[192:195]
  ds_read_b64_tr_b16 a[180:181], v243 offset:20480
  ds_read_b64_tr_b16 a[182:183], v243 offset:22528
  v_mfma_f32_16x16x32_bf16 v[100:103], a[184:187], v[160:163], v[100:103]
  s_waitcnt lgkmcnt(4)
  buffer_load_dwordx4 v245, s[12:15], s29 offen offset:2176 nt lds
  v_cvt_pk_bf16_f32 v142, v196, v197
  v_mfma_f32_16x16x32_bf16 v[100:103], a[188:191], v[164:167], v[100:103]
  s_add_u32 m0, s36, 16384
  v_cvt_pk_bf16_f32 v143, v198, v199
  v_lshlrev_b32 v224, 16, v216
  v_mfma_f32_16x16x32_bf16 v[108:111], a[184:187], v[168:171], v[108:111]
  v_and_b32 v225, 0xffff0000, v216
  v_lshlrev_b32 v226, 16, v217
  v_mfma_f32_16x16x32_bf16 v[108:111], a[188:191], v[172:175], v[108:111]
  v_exp_f32 v192, v192
  v_mfma_f32_16x16x32_bf16 v[196:199], a[144:147], a[48:51], v[212:215]
  v_exp_f32 v193, v193
  v_mfma_f32_16x16x32_bf16 v[196:199], a[148:151], a[52:55], v[196:199]
  v_exp_f32 v194, v194
  v_mfma_f32_16x16x32_bf16 v[196:199], a[152:155], a[56:59], v[196:199]
  v_exp_f32 v195, v195
  v_mfma_f32_16x16x32_bf16 v[196:199], a[156:159], a[60:63], v[196:199]
  ds_read_b128 a[144:147], v240 offset:53248
  ds_read_b128 a[148:151], v241 offset:53248
  v_mfma_f32_16x16x32_bf16 v[116:119], a[184:187], v[176:179], v[116:119]
  ds_read_b128 a[152:155], v240 offset:55296
  ds_read_b128 a[156:159], v241 offset:55296
  v_mfma_f32_16x16x32_bf16 v[116:119], a[188:191], v[180:183], v[116:119]
  v_cvt_pk_bf16_f32 v150, v192, v193
  v_cvt_pk_bf16_f32 v151, v194, v195
  v_mfma_f32_16x16x32_bf16 v[124:127], a[184:187], v[184:187], v[124:127]
  ds_read_b64_tr_b16 a[184:185], v243 offset:16392
  ds_read_b64_tr_b16 a[186:187], v243 offset:18440
  v_mfma_f32_16x16x32_bf16 v[124:127], a[188:191], v[188:191], v[124:127]
  ds_read_b64_tr_b16 a[188:189], v243 offset:20488
  ds_read_b64_tr_b16 a[190:191], v243 offset:22536
  v_mfma_f32_16x16x32_bf16 v[192:195], a[128:131], a[0:3], v[200:203]
  buffer_load_dwordx4 v245, s[4:7], s39 offen nt lds
  v_and_b32 v227, 0xffff0000, v217
  v_mfma_f32_16x16x32_bf16 v[192:195], a[132:135], a[4:7], v[192:195]
  s_add_u32 m0, s37, 0
  v_lshlrev_b32 v228, 16, v218
  v_and_b32 v229, 0xffff0000, v218
  v_mfma_f32_16x16x32_bf16 v[192:195], a[136:139], a[8:11], v[192:195]
  v_exp_f32 v196, v196
  v_mfma_f32_16x16x32_bf16 v[192:195], a[140:143], a[12:15], v[192:195]
  v_exp_f32 v197, v197
  v_mfma_f32_16x16x32_bf16 v[0:3], a[160:163], v[128:131], v[0:3]
  v_exp_f32 v198, v198
  v_mfma_f32_16x16x32_bf16 v[0:3], a[164:167], v[132:135], v[0:3]
  v_exp_f32 v199, v199
  v_mfma_f32_16x16x32_bf16 v[8:11], a[160:163], v[136:139], v[8:11]
  v_cvt_pk_bf16_f32 v158, v196, v197
  v_cvt_pk_bf16_f32 v159, v198, v199
  v_mfma_f32_16x16x32_bf16 v[8:11], a[164:167], v[140:143], v[8:11]
  v_lshlrev_b32 v230, 16, v219
  v_and_b32 v231, 0xffff0000, v219
  v_mfma_f32_16x16x32_bf16 v[196:199], a[128:131], a[16:19], v[204:207]
  v_exp_f32 v192, v192
  v_exp_f32 v193, v193
  v_pk_mul_f32 v[224:225], v[224:225], s[42:43]
  v_pk_mul_f32 v[226:227], v[226:227], s[42:43]
  v_pk_mul_f32 v[228:229], v[228:229], s[42:43]
  v_pk_mul_f32 v[230:231], v[230:231], s[42:43]
  v_mfma_f32_16x16x32_bf16 v[196:199], a[132:135], a[20:23], v[196:199]
  v_exp_f32 v194, v194
  v_mfma_f32_16x16x32_bf16 v[196:199], a[136:139], a[24:27], v[196:199]
  v_exp_f32 v195, v195
  v_mfma_f32_16x16x32_bf16 v[196:199], a[140:143], a[28:31], v[196:199]
  buffer_load_dwordx4 v246, s[8:11], s40 offen nt lds
  v_cvt_pk_bf16_f32 v160, v192, v193
  v_mfma_f32_16x16x32_bf16 v[16:19], a[160:163], v[144:147], v[16:19]
  s_add_u32 m0, s36, 15360
  v_cvt_pk_bf16_f32 v161, v194, v195
  v_cvt_pk_bf16_f32 v216, v224, v225
  v_mfma_f32_16x16x32_bf16 v[16:19], a[164:167], v[148:151], v[16:19]
  v_cvt_pk_bf16_f32 v217, v226, v227
  v_cvt_pk_bf16_f32 v218, v228, v229
  v_mfma_f32_16x16x32_bf16 v[24:27], a[160:163], v[152:155], v[24:27]
  v_exp_f32 v196, v196
  v_mfma_f32_16x16x32_bf16 v[24:27], a[164:167], v[156:159], v[24:27]
  v_exp_f32 v197, v197
  v_mfma_f32_16x16x32_bf16 v[192:195], a[128:131], a[32:35], v[208:211]
  v_exp_f32 v198, v198
  v_mfma_f32_16x16x32_bf16 v[192:195], a[132:135], a[36:39], v[192:195]
  v_exp_f32 v199, v199
  v_mfma_f32_16x16x32_bf16 v[192:195], a[136:139], a[40:43], v[192:195]
  ds_read_b64_tr_b16 a[160:161], v242 offset:17408
  ds_read_b64_tr_b16 a[162:163], v242 offset:19456
  v_mfma_f32_16x16x32_bf16 v[192:195], a[140:143], a[44:47], v[192:195]
  ds_read_b64_tr_b16 a[164:165], v242 offset:21504
  ds_read_b64_tr_b16 a[166:167], v242 offset:23552
  v_mfma_f32_16x16x32_bf16 v[4:7], a[168:171], v[128:131], v[4:7]
  v_cvt_pk_bf16_f32 v168, v196, v197
  v_cvt_pk_bf16_f32 v169, v198, v199
  v_mfma_f32_16x16x32_bf16 v[4:7], a[172:175], v[132:135], v[4:7]
  buffer_load_dwordx4 v245, s[4:7], s39 offen offset:2048 nt lds
  v_cvt_pk_bf16_f32 v219, v230, v231
  v_mfma_f32_16x16x32_bf16 v[12:15], a[168:171], v[136:139], v[12:15]
  s_add_u32 m0, s37, 31752
  v_accvgpr_write_b32 a72, v216
  v_accvgpr_write_b32 a73, v217
  v_mfma_f32_16x16x32_bf16 v[12:15], a[172:175], v[140:143], v[12:15]
  v_exp_f32 v192, v192
  v_smfmac_f32_16x16x64_bf16 a[192:195], a[208:211], v[128:135], v248
  v_exp_f32 v193, v193
  v_mfma_f32_16x16x32_bf16 v[196:199], a[128:131], a[48:51], v[212:215]
  v_exp_f32 v194, v194
  v_mfma_f32_16x16x32_bf16 v[196:199], a[132:135], a[52:55], v[196:199]
  ds_read_b128 v[220:223], v250 offset:0
  ds_read_b128 a[128:131], v240 offset:57344
  v_mfma_f32_16x16x32_bf16 v[196:199], a[136:139], a[56:59], v[196:199]
  v_exp_f32 v195, v195
  v_mfma_f32_16x16x32_bf16 v[196:199], a[140:143], a[60:63], v[196:199]
  ds_read_b128 a[132:135], v241 offset:57344
  ds_read_b128 a[136:139], v240 offset:59392
  v_mfma_f32_16x16x32_bf16 v[20:23], a[168:171], v[144:147], v[20:23]
  ds_read_b128 a[140:143], v241 offset:59392
  v_cvt_pk_bf16_f32 v176, v192, v193
  v_mfma_f32_16x16x32_bf16 v[20:23], a[172:175], v[148:151], v[20:23]
  v_cvt_pk_bf16_f32 v177, v194, v195
  v_accvgpr_write_b32 a74, v218
  v_mfma_f32_16x16x32_bf16 v[28:31], a[168:171], v[152:155], v[28:31]
  ds_read_b64_tr_b16 a[168:169], v242 offset:17416
  ds_read_b64_tr_b16 a[170:171], v242 offset:19464
  v_mfma_f32_16x16x32_bf16 v[28:31], a[172:175], v[156:159], v[28:31]
  s_waitcnt lgkmcnt(7)
  ds_read_b64_tr_b16 a[172:173], v242 offset:21512
  ds_read_b64_tr_b16 a[174:175], v242 offset:23560
  v_mfma_f32_16x16x32_bf16 v[192:195], a[144:147], a[0:3], v[200:203]
  buffer_load_dwordx4 v246, s[8:11], s40 offen offset:1024 nt lds
  v_accvgpr_write_b32 a75, v219
  v_mfma_f32_16x16x32_bf16 v[192:195], a[148:151], a[4:7], v[192:195]
  s_add_u32 m0, s36, 18304
  v_exp_f32 v196, v196
  v_mfma_f32_16x16x32_bf16 v[192:195], a[152:155], a[8:11], v[192:195]
  v_exp_f32 v197, v197
  v_mfma_f32_16x16x32_bf16 v[192:195], a[156:159], a[12:15], v[192:195]
  v_exp_f32 v198, v198
  v_mfma_f32_16x16x32_bf16 v[32:35], a[176:179], v[128:131], v[32:35]
  v_exp_f32 v199, v199
  v_mfma_f32_16x16x32_bf16 v[32:35], a[180:183], v[132:135], v[32:35]
  s_waitcnt lgkmcnt(2)
  v_lshlrev_b32 v224, 16, v220
  v_cvt_pk_bf16_f32 v184, v196, v197
  v_mfma_f32_16x16x32_bf16 v[40:43], a[176:179], v[136:139], v[40:43]
  v_cvt_pk_bf16_f32 v185, v198, v199
  v_and_b32 v225, 0xffff0000, v220
  v_mfma_f32_16x16x32_bf16 v[40:43], a[180:183], v[140:143], v[40:43]
  v_lshlrev_b32 v226, 16, v221
  v_and_b32 v227, 0xffff0000, v221
  v_smfmac_f32_16x16x64_bf16 a[196:199], a[208:211], v[136:143], v248
  v_exp_f32 v192, v192
  v_mfma_f32_16x16x32_bf16 v[196:199], a[144:147], a[16:19], v[204:207]
  v_exp_f32 v193, v193
  v_mfma_f32_16x16x32_bf16 v[196:199], a[148:151], a[20:23], v[196:199]
  v_exp_f32 v194, v194
  v_mfma_f32_16x16x32_bf16 v[196:199], a[152:155], a[24:27], v[196:199]
  v_exp_f32 v195, v195
  v_mfma_f32_16x16x32_bf16 v[196:199], a[156:159], a[28:31], v[196:199]
  buffer_load_dwordx4 v245, s[4:7], s39 offen offset:128 nt lds
  v_cvt_pk_bf16_f32 v162, v192, v193
  v_mfma_f32_16x16x32_bf16 v[48:51], a[176:179], v[144:147], v[48:51]
  s_add_u32 m0, s37, 896
  v_cvt_pk_bf16_f32 v163, v194, v195
  v_lshlrev_b32 v228, 16, v222
  v_mfma_f32_16x16x32_bf16 v[48:51], a[180:183], v[148:151], v[48:51]
  v_and_b32 v229, 0xffff0000, v222
  v_lshlrev_b32 v230, 16, v223
  v_mfma_f32_16x16x32_bf16 v[56:59], a[176:179], v[152:155], v[56:59]
  v_exp_f32 v196, v196
  v_mfma_f32_16x16x32_bf16 v[56:59], a[180:183], v[156:159], v[56:59]
  v_exp_f32 v197, v197
  v_mfma_f32_16x16x32_bf16 v[192:195], a[144:147], a[32:35], v[208:211]
  v_exp_f32 v198, v198
  v_mfma_f32_16x16x32_bf16 v[192:195], a[148:151], a[36:39], v[192:195]
  v_exp_f32 v199, v199
  v_mfma_f32_16x16x32_bf16 v[192:195], a[152:155], a[40:43], v[192:195]
  ds_read_b64_tr_b16 a[176:177], v243 offset:17408
  ds_read_b64_tr_b16 a[178:179], v243 offset:19456
  v_mfma_f32_16x16x32_bf16 v[192:195], a[156:159], a[44:47], v[192:195]
  ds_read_b64_tr_b16 a[180:181], v243 offset:21504
  ds_read_b64_tr_b16 a[182:183], v243 offset:23552
  v_mfma_f32_16x16x32_bf16 v[36:39], a[184:187], v[128:131], v[36:39]
  v_and_b32 v231, 0xffff0000, v223
  v_cvt_pk_bf16_f32 v170, v196, v197
  v_mfma_f32_16x16x32_bf16 v[36:39], a[188:191], v[132:135], v[36:39]
  buffer_load_dwordx4 v246, s[8:11], s40 offen offset:128 nt lds
  v_cvt_pk_bf16_f32 v171, v198, v199
  v_mfma_f32_16x16x32_bf16 v[44:47], a[184:187], v[136:139], v[44:47]
  s_add_u32 m0, s36, 17280
  v_exp_f32 v192, v192
  v_exp_f32 v193, v193
  v_pk_mul_f32 v[224:225], v[224:225], s[42:43]
  v_pk_mul_f32 v[226:227], v[226:227], s[42:43]
  v_pk_mul_f32 v[228:229], v[228:229], s[42:43]
  v_pk_mul_f32 v[230:231], v[230:231], s[42:43]
  v_mfma_f32_16x16x32_bf16 v[44:47], a[188:191], v[140:143], v[44:47]
  v_exp_f32 v194, v194
  v_smfmac_f32_16x16x64_bf16 a[200:203], a[208:211], v[144:151], v248
  v_exp_f32 v195, v195
  v_mfma_f32_16x16x32_bf16 v[196:199], a[144:147], a[48:51], v[212:215]
  ds_read_b128 a[144:147], v240 offset:61440
  v_cvt_pk_bf16_f32 v178, v192, v193
  v_mfma_f32_16x16x32_bf16 v[196:199], a[148:151], a[52:55], v[196:199]
  ds_read_b128 a[148:151], v241 offset:61440
  v_cvt_pk_bf16_f32 v179, v194, v195
  v_mfma_f32_16x16x32_bf16 v[196:199], a[152:155], a[56:59], v[196:199]
  ds_read_b128 a[152:155], v240 offset:63488
  v_cvt_pk_bf16_f32 v220, v224, v225
  v_mfma_f32_16x16x32_bf16 v[196:199], a[156:159], a[60:63], v[196:199]
  ds_read_b128 a[156:159], v241 offset:63488
  v_cvt_pk_bf16_f32 v221, v226, v227
  v_mfma_f32_16x16x32_bf16 v[52:55], a[184:187], v[144:147], v[52:55]
  v_cvt_pk_bf16_f32 v222, v228, v229
  v_cvt_pk_bf16_f32 v223, v230, v231
  v_mfma_f32_16x16x32_bf16 v[52:55], a[188:191], v[148:151], v[52:55]
  v_accvgpr_write_b32 a76, v220
  v_accvgpr_write_b32 a77, v221
  v_mfma_f32_16x16x32_bf16 v[60:63], a[184:187], v[152:155], v[60:63]
  v_exp_f32 v196, v196
  v_mfma_f32_16x16x32_bf16 v[60:63], a[188:191], v[156:159], v[60:63]
  s_waitcnt vmcnt(16)
  v_exp_f32 v197, v197
  v_mfma_f32_16x16x32_bf16 v[192:195], a[128:131], a[0:3], v[200:203]
  v_exp_f32 v198, v198
  v_mfma_f32_16x16x32_bf16 v[192:195], a[132:135], a[4:7], v[192:195]
  v_exp_f32 v199, v199
  v_mfma_f32_16x16x32_bf16 v[192:195], a[136:139], a[8:11], v[192:195]
  ds_read_b64_tr_b16 a[184:185], v243 offset:17416
  ds_read_b64_tr_b16 a[186:187], v243 offset:19464
  v_mfma_f32_16x16x32_bf16 v[192:195], a[140:143], a[12:15], v[192:195]
  ds_read_b64_tr_b16 a[188:189], v243 offset:21512
  ds_read_b64_tr_b16 a[190:191], v243 offset:23560
  v_mfma_f32_16x16x32_bf16 v[64:67], a[160:163], v[128:131], v[64:67]
  buffer_load_dwordx4 v245, s[4:7], s39 offen offset:2176 nt lds
  v_cvt_pk_bf16_f32 v186, v196, v197
  v_mfma_f32_16x16x32_bf16 v[64:67], a[164:167], v[132:135], v[64:67]
  s_add_u32 m0, s37, 32648
  v_cvt_pk_bf16_f32 v187, v198, v199
  v_accvgpr_write_b32 a78, v222
  v_mfma_f32_16x16x32_bf16 v[72:75], a[160:163], v[136:139], v[72:75]
  s_add_u32 s39, s20, 98304
  v_exp_f32 v192, v192
  v_mfma_f32_16x16x32_bf16 v[72:75], a[164:167], v[140:143], v[72:75]
  ds_read_b128 v[216:219], v249 offset:2048
  v_accvgpr_write_b32 a79, v223
  v_smfmac_f32_16x16x64_bf16 a[204:207], a[208:211], v[152:159], v248
  v_exp_f32 v193, v193
  v_mfma_f32_16x16x32_bf16 v[196:199], a[128:131], a[16:19], v[204:207]
  v_exp_f32 v194, v194
  v_mfma_f32_16x16x32_bf16 v[196:199], a[132:135], a[20:23], v[196:199]
  v_exp_f32 v195, v195
  v_mfma_f32_16x16x32_bf16 v[196:199], a[136:139], a[24:27], v[196:199]
  v_cvt_pk_bf16_f32 v164, v192, v193
  v_cvt_pk_bf16_f32 v165, v194, v195
  v_mfma_f32_16x16x32_bf16 v[196:199], a[140:143], a[28:31], v[196:199]
  v_mfma_f32_16x16x32_bf16 v[80:83], a[160:163], v[144:147], v[80:83]
  v_mfma_f32_16x16x32_bf16 v[80:83], a[164:167], v[148:151], v[80:83]
  s_waitcnt lgkmcnt(0)
  buffer_load_dwordx4 v246, s[8:11], s40 offen offset:1152 nt lds
  v_mfma_f32_16x16x32_bf16 v[88:91], a[160:163], v[152:155], v[88:91]
  s_add_u32 m0, s38, 0
  v_mfma_f32_16x16x32_bf16 v[88:91], a[164:167], v[156:159], v[88:91]
  s_add_u32 s40, s20, 81920
  v_lshlrev_b32 v224, 16, v216
  v_and_b32 v225, 0xffff0000, v216
  v_mfma_f32_16x16x32_bf16 v[192:195], a[128:131], a[32:35], v[208:211]
  v_exp_f32 v196, v196
  v_mfma_f32_16x16x32_bf16 v[192:195], a[132:135], a[36:39], v[192:195]
  v_exp_f32 v197, v197
  v_mfma_f32_16x16x32_bf16 v[192:195], a[136:139], a[40:43], v[192:195]
  v_exp_f32 v198, v198
  v_mfma_f32_16x16x32_bf16 v[192:195], a[140:143], a[44:47], v[192:195]
  s_waitcnt vmcnt(10)
  v_exp_f32 v199, v199
  v_mfma_f32_16x16x32_bf16 v[68:71], a[168:171], v[128:131], v[68:71]
  s_barrier
  ds_read_b64_tr_b16 a[160:161], v242 offset:24576
  ds_read_b64_tr_b16 a[162:163], v242 offset:26624
  v_mfma_f32_16x16x32_bf16 v[68:71], a[172:175], v[132:135], v[68:71]
  ds_read_b64_tr_b16 a[164:165], v242 offset:28672
  ds_read_b64_tr_b16 a[166:167], v242 offset:30720
  v_mfma_f32_16x16x32_bf16 v[76:79], a[168:171], v[136:139], v[76:79]
  v_cvt_pk_bf16_f32 v172, v196, v197
  v_cvt_pk_bf16_f32 v173, v198, v199
  v_mfma_f32_16x16x32_bf16 v[76:79], a[172:175], v[140:143], v[76:79]
  buffer_load_dwordx4 v245, s[12:15], s30 offen nt lds
  v_lshlrev_b32 v226, 16, v217
  v_mfma_f32_16x16x32_bf16 v[196:199], a[128:131], a[48:51], v[212:215]
  s_add_u32 m0, s38, -1024
  ds_read_b128 a[128:131], v240 offset:0
  v_and_b32 v227, 0xffff0000, v217
  v_mfma_f32_16x16x32_bf16 v[196:199], a[132:135], a[52:55], v[196:199]
  ds_read_b128 a[132:135], v241 offset:0
  v_lshlrev_b32 v228, 16, v218
  v_mfma_f32_16x16x32_bf16 v[196:199], a[136:139], a[56:59], v[196:199]
  v_exp_f32 v192, v192
  v_mfma_f32_16x16x32_bf16 v[196:199], a[140:143], a[60:63], v[196:199]
  v_exp_f32 v193, v193
  v_mfma_f32_16x16x32_bf16 v[84:87], a[168:171], v[144:147], v[84:87]
  v_exp_f32 v194, v194
  v_mfma_f32_16x16x32_bf16 v[84:87], a[172:175], v[148:151], v[84:87]
  v_exp_f32 v195, v195
  v_mfma_f32_16x16x32_bf16 v[92:95], a[168:171], v[152:155], v[92:95]
  ds_read_b128 a[136:139], v240 offset:2048
  ds_read_b128 a[140:143], v241 offset:2048
  v_mfma_f32_16x16x32_bf16 v[92:95], a[172:175], v[156:159], v[92:95]
  ds_read_b64_tr_b16 a[168:169], v242 offset:24584
  ds_read_b64_tr_b16 a[170:171], v242 offset:26632
  v_cvt_pk_bf16_f32 v180, v192, v193
  v_cvt_pk_bf16_f32 v181, v194, v195
  v_mfma_f32_16x16x32_bf16 v[192:195], a[144:147], a[0:3], v[200:203]
  ds_read_b64_tr_b16 a[172:173], v242 offset:28680
  ds_read_b64_tr_b16 a[174:175], v242 offset:30728
  v_mfma_f32_16x16x32_bf16 v[192:195], a[148:151], a[4:7], v[192:195]
  buffer_load_dwordx4 v245, s[12:15], s30 offen offset:2048 nt lds
  v_and_b32 v229, 0xffff0000, v218
  v_mfma_f32_16x16x32_bf16 v[192:195], a[152:155], a[8:11], v[192:195]
  s_add_u32 m0, s36, 32768
  v_lshlrev_b32 v230, 16, v219
  v_and_b32 v231, 0xffff0000, v219
  v_mfma_f32_16x16x32_bf16 v[192:195], a[156:159], a[12:15], v[192:195]
  v_exp_f32 v196, v196
  v_exp_f32 v197, v197
  v_pk_mul_f32 v[224:225], v[224:225], s[42:43]
  v_pk_mul_f32 v[226:227], v[226:227], s[42:43]
  v_pk_mul_f32 v[228:229], v[228:229], s[42:43]
  v_pk_mul_f32 v[230:231], v[230:231], s[42:43]
  v_mfma_f32_16x16x32_bf16 v[96:99], a[176:179], v[128:131], v[96:99]
  v_exp_f32 v198, v198
  v_mfma_f32_16x16x32_bf16 v[96:99], a[180:183], v[132:135], v[96:99]
  v_exp_f32 v199, v199
  v_mfma_f32_16x16x32_bf16 v[104:107], a[176:179], v[136:139], v[104:107]
  v_cvt_pk_bf16_f32 v188, v196, v197
  v_cvt_pk_bf16_f32 v189, v198, v199
  v_mfma_f32_16x16x32_bf16 v[104:107], a[180:183], v[140:143], v[104:107]
  v_exp_f32 v192, v192
  v_mfma_f32_16x16x32_bf16 v[196:199], a[144:147], a[16:19], v[204:207]
  v_exp_f32 v193, v193
  v_mfma_f32_16x16x32_bf16 v[196:199], a[148:151], a[20:23], v[196:199]
  v_exp_f32 v194, v194
  v_mfma_f32_16x16x32_bf16 v[196:199], a[152:155], a[24:27], v[196:199]
  v_exp_f32 v195, v195
  v_mfma_f32_16x16x32_bf16 v[196:199], a[156:159], a[28:31], v[196:199]
  buffer_load_dwordx4 v245, s[4:7], s39 offen nt lds
  v_cvt_pk_bf16_f32 v166, v192, v193
  v_mfma_f32_16x16x32_bf16 v[112:115], a[176:179], v[144:147], v[112:115]
  s_add_u32 m0, s37, 8192
  v_cvt_pk_bf16_f32 v167, v194, v195
  v_cvt_pk_bf16_f32 v216, v224, v225
  v_mfma_f32_16x16x32_bf16 v[112:115], a[180:183], v[148:151], v[112:115]
  v_cvt_pk_bf16_f32 v217, v226, v227
  v_cvt_pk_bf16_f32 v218, v228, v229
  v_mfma_f32_16x16x32_bf16 v[120:123], a[176:179], v[152:155], v[120:123]
  v_exp_f32 v196, v196
  v_mfma_f32_16x16x32_bf16 v[120:123], a[180:183], v[156:159], v[120:123]
  v_exp_f32 v197, v197
  v_mfma_f32_16x16x32_bf16 v[192:195], a[144:147], a[32:35], v[208:211]
  v_exp_f32 v198, v198
  v_mfma_f32_16x16x32_bf16 v[192:195], a[148:151], a[36:39], v[192:195]
  v_exp_f32 v199, v199
  v_mfma_f32_16x16x32_bf16 v[192:195], a[152:155], a[40:43], v[192:195]
  ds_read_b64_tr_b16 a[176:177], v243 offset:24576
  ds_read_b64_tr_b16 a[178:179], v243 offset:26624
  v_mfma_f32_16x16x32_bf16 v[192:195], a[156:159], a[44:47], v[192:195]
  ds_read_b64_tr_b16 a[180:181], v243 offset:28672
  ds_read_b64_tr_b16 a[182:183], v243 offset:30720
  v_mfma_f32_16x16x32_bf16 v[100:103], a[184:187], v[128:131], v[100:103]
  v_cvt_pk_bf16_f32 v174, v196, v197
  v_cvt_pk_bf16_f32 v175, v198, v199
  v_mfma_f32_16x16x32_bf16 v[100:103], a[188:191], v[132:135], v[100:103]
  ds_read_b128 v[220:223], v250 offset:2048
  buffer_load_dwordx4 v246, s[8:11], s40 offen nt lds
  v_mfma_f32_16x16x32_bf16 v[108:111], a[184:187], v[136:139], v[108:111]
  s_add_u32 m0, s36, 31744
  v_cvt_pk_bf16_f32 v219, v230, v231
  v_accvgpr_write_b32 a80, v216
  v_mfma_f32_16x16x32_bf16 v[108:111], a[188:191], v[140:143], v[108:111]
  v_accvgpr_write_b32 a81, v217
  v_accvgpr_write_b32 a82, v218
  v_mfma_f32_16x16x32_bf16 v[196:199], a[144:147], a[48:51], v[212:215]
  v_exp_f32 v192, v192
  v_mfma_f32_16x16x32_bf16 v[196:199], a[148:151], a[52:55], v[196:199]
  v_exp_f32 v193, v193
  v_mfma_f32_16x16x32_bf16 v[196:199], a[152:155], a[56:59], v[196:199]
  v_exp_f32 v194, v194
  v_mfma_f32_16x16x32_bf16 v[196:199], a[156:159], a[60:63], v[196:199]
  v_exp_f32 v195, v195
  v_mfma_f32_16x16x32_bf16 v[116:119], a[184:187], v[144:147], v[116:119]
  ds_read_b128 a[144:147], v240 offset:4096
  ds_read_b128 a[148:151], v241 offset:4096
  v_mfma_f32_16x16x32_bf16 v[116:119], a[188:191], v[148:151], v[116:119]
  ds_read_b128 a[152:155], v240 offset:6144
  ds_read_b128 a[156:159], v241 offset:6144
  v_mfma_f32_16x16x32_bf16 v[124:127], a[184:187], v[152:155], v[124:127]
  ds_read_b64_tr_b16 a[184:185], v243 offset:24584
  ds_read_b64_tr_b16 a[186:187], v243 offset:26632
  v_mfma_f32_16x16x32_bf16 v[124:127], a[188:191], v[156:159], v[124:127]
  s_waitcnt lgkmcnt(6)
  ds_read_b64_tr_b16 a[188:189], v243 offset:28680
  ds_read_b64_tr_b16 a[190:191], v243 offset:30728
  v_cvt_pk_bf16_f32 v182, v192, v193
  v_cvt_pk_bf16_f32 v183, v194, v195
  v_mfma_f32_16x16x32_bf16 v[192:195], a[128:131], a[0:3], v[200:203]
L_stub3:
  s_cmp_eq_u32 s99, 1
  s_cbranch_scc1 L_ret0
  buffer_load_dwordx4 v245, s[4:7], s39 offen offset:2048 nt lds
  v_accvgpr_write_b32 a83, v219
  v_mfma_f32_16x16x32_bf16 v[192:195], a[132:135], a[4:7], v[192:195]
  s_add_u32 m0, s37, 39944
  v_lshlrev_b32 v224, 16, v220
  v_and_b32 v225, 0xffff0000, v220
  v_mfma_f32_16x16x32_bf16 v[192:195], a[136:139], a[8:11], v[192:195]
  v_exp_f32 v196, v196
  v_mfma_f32_16x16x32_bf16 v[192:195], a[140:143], a[12:15], v[192:195]
  v_exp_f32 v197, v197
  v_mfma_f32_16x16x32_bf16 v[0:3], a[160:163], v[160:163], v[0:3]
  v_exp_f32 v198, v198
  v_mfma_f32_16x16x32_bf16 v[0:3], a[164:167], v[164:167], v[0:3]
  v_exp_f32 v199, v199
  v_mfma_f32_16x16x32_bf16 v[8:11], a[160:163], v[168:171], v[8:11]
  v_cvt_pk_bf16_f32 v190, v196, v197
  v_cvt_pk_bf16_f32 v191, v198, v199
  v_mfma_f32_16x16x32_bf16 v[8:11], a[164:167], v[172:175], v[8:11]
  v_lshlrev_b32 v226, 16, v221
  v_and_b32 v227, 0xffff0000, v221
  v_mfma_f32_16x16x32_bf16 v[196:199], a[128:131], a[16:19], v[204:207]
  v_lshlrev_b32 v228, 16, v222
  v_and_b32 v229, 0xffff0000, v222
  v_mfma_f32_16x16x32_bf16 v[196:199], a[132:135], a[20:23], v[196:199]
  v_exp_f32 v192, v192
  v_mfma_f32_16x16x32_bf16 v[196:199], a[136:139], a[24:27], v[196:199]
  v_exp_f32 v193, v193
  v_mfma_f32_16x16x32_bf16 v[196:199], a[140:143], a[28:31], v[196:199]
  v_exp_f32 v194, v194
  v_mfma_f32_16x16x32_bf16 v[16:19], a[160:163], v[176:179], v[16:19]
  v_exp_f32 v195, v195
  v_mfma_f32_16x16x32_bf16 v[16:19], a[164:167], v[180:183], v[16:19]
  buffer_load_dwordx4 v246, s[8:11], s40 offen offset:1024 nt lds
  v_cvt_pk_bf16_f32 v128, v192, v193
  v_mfma_f32_16x16x32_bf16 v[24:27], a[160:163], v[184:187], v[24:27]
  s_add_u32 m0, s36, 34688
  ds_read_b64_tr_b16 a[160:161], v242 offset:25600
  ds_read_b64_tr_b16 a[162:163], v242 offset:27648
  v_mfma_f32_16x16x32_bf16 v[24:27], a[164:167], v[188:191], v[24:27]
  ds_read_b64_tr_b16 a[164:165], v242 offset:29696
  ds_read_b64_tr_b16 a[166:167], v242 offset:31744
  v_cvt_pk_bf16_f32 v129, v194, v195
  v_mfma_f32_16x16x32_bf16 v[192:195], a[128:131], a[32:35], v[208:211]
  v_lshlrev_b32 v230, 16, v223
  v_and_b32 v231, 0xffff0000, v223
  v_mfma_f32_16x16x32_bf16 v[192:195], a[132:135], a[36:39], v[192:195]
  v_exp_f32 v196, v196
  v_exp_f32 v197, v197
  v_pk_mul_f32 v[224:225], v[224:225], s[42:43]
  v_pk_mul_f32 v[226:227], v[226:227], s[42:43]
  v_pk_mul_f32 v[228:229], v[228:229], s[42:43]
  v_pk_mul_f32 v[230:231], v[230:231], s[42:43]
  v_mfma_f32_16x16x32_bf16 v[192:195], a[136:139], a[40:43], v[192:195]
  v_exp_f32 v198, v198
  v_mfma_f32_16x16x32_bf16 v[192:195], a[140:143], a[44:47], v[192:195]
  v_exp_f32 v199, v199
  v_mfma_f32_16x16x32_bf16 v[4:7], a[168:171], v[160:163], v[4:7]
  v_cvt_pk_bf16_f32 v136, v196, v197
  v_cvt_pk_bf16_f32 v137, v198, v199
  v_mfma_f32_16x16x32_bf16 v[4:7], a[172:175], v[164:167], v[4:7]
  v_cvt_pk_bf16_f32 v220, v224, v225
  v_cvt_pk_bf16_f32 v221, v226, v227
  v_mfma_f32_16x16x32_bf16 v[12:15], a[168:171], v[168:171], v[12:15]
  v_exp_f32 v192, v192
  v_mfma_f32_16x16x32_bf16 v[12:15], a[172:175], v[172:175], v[12:15]
  v_exp_f32 v193, v193
  v_smfmac_f32_16x16x64_bf16 a[192:195], a[208:211], v[160:167], v248
  v_exp_f32 v194, v194
  v_mfma_f32_16x16x32_bf16 v[196:199], a[128:131], a[48:51], v[212:215]
  v_exp_f32 v195, v195
  v_mfma_f32_16x16x32_bf16 v[196:199], a[132:135], a[52:55], v[196:199]
  ds_read_b128 a[128:131], v240 offset:8192
  ds_read_b128 a[132:135], v241 offset:8192
  v_mfma_f32_16x16x32_bf16 v[196:199], a[136:139], a[56:59], v[196:199]
  ds_read_b128 a[136:139], v240 offset:10240
  buffer_load_dwordx4 v245, s[4:7], s39 offen offset:128 nt lds
  v_mfma_f32_16x16x32_bf16 v[196:199], a[140:143], a[60:63], v[196:199]
  s_add_u32 m0, s38, 1920
  ds_read_b128 a[140:143], v241 offset:10240
  v_cvt_pk_bf16_f32 v144, v192, v193
  v_mfma_f32_16x16x32_bf16 v[20:23], a[168:171], v[176:179], v[20:23]
  s_waitcnt vmcnt(15)
  v_cvt_pk_bf16_f32 v145, v194, v195
  v_cvt_pk_bf16_f32 v222, v228, v229
  v_mfma_f32_16x16x32_bf16 v[20:23], a[172:175], v[180:183], v[20:23]
  v_cvt_pk_bf16_f32 v223, v230, v231
  v_accvgpr_write_b32 a84, v220
  v_mfma_f32_16x16x32_bf16 v[28:31], a[168:171], v[184:187], v[28:31]
  v_exp_f32 v196, v196
  v_mfma_f32_16x16x32_bf16 v[28:31], a[172:175], v[188:191], v[28:31]
  s_waitcnt lgkmcnt(4)
  v_exp_f32 v197, v197
  v_mfma_f32_16x16x32_bf16 v[192:195], a[144:147], a[0:3], v[200:203]
  v_exp_f32 v198, v198
  v_mfma_f32_16x16x32_bf16 v[192:195], a[148:151], a[4:7], v[192:195]
  v_exp_f32 v199, v199
  v_mfma_f32_16x16x32_bf16 v[192:195], a[152:155], a[8:11], v[192:195]
  ds_read_b64_tr_b16 a[168:169], v242 offset:25608
  ds_read_b64_tr_b16 a[170:171], v242 offset:27656
  v_mfma_f32_16x16x32_bf16 v[192:195], a[156:159], a[12:15], v[192:195]
  ds_read_b64_tr_b16 a[172:173], v242 offset:29704
  ds_read_b64_tr_b16 a[174:175], v242 offset:31752
  v_mfma_f32_16x16x32_bf16 v[32:35], a[176:179], v[160:163], v[32:35]
  ds_read_b128 v[216:219], v249 offset:4096
  buffer_load_dwordx4 v245, s[12:15], s30 offen offset:128 nt lds
  v_mfma_f32_16x16x32_bf16 v[32:35], a[180:183], v[164:167], v[32:35]
  s_add_u32 m0, s37, 9088
  v_cvt_pk_bf16_f32 v152, v196, v197
  v_cvt_pk_bf16_f32 v153, v198, v199
  v_mfma_f32_16x16x32_bf16 v[40:43], a[176:179], v[168:171], v[40:43]
  v_accvgpr_write_b32 a85, v221
  v_accvgpr_write_b32 a86, v222
  v_mfma_f32_16x16x32_bf16 v[40:43], a[180:183], v[172:175], v[40:43]
  v_exp_f32 v192, v192
  v_smfmac_f32_16x16x64_bf16 a[196:199], a[208:211], v[168:175], v248
  v_exp_f32 v193, v193
  v_mfma_f32_16x16x32_bf16 v[196:199], a[144:147], a[16:19], v[204:207]
  v_exp_f32 v194, v194
  v_mfma_f32_16x16x32_bf16 v[196:199], a[148:151], a[20:23], v[196:199]
  v_exp_f32 v195, v195
  v_mfma_f32_16x16x32_bf16 v[196:199], a[152:155], a[24:27], v[196:199]
  v_cvt_pk_bf16_f32 v130, v192, v193
  v_cvt_pk_bf16_f32 v131, v194, v195
  v_mfma_f32_16x16x32_bf16 v[196:199], a[156:159], a[28:31], v[196:199]
  v_accvgpr_write_b32 a87, v223
  v_mfma_f32_16x16x32_bf16 v[48:51], a[176:179], v[176:179], v[48:51]
  s_waitcnt lgkmcnt(0)
  v_lshlrev_b32 v224, 16, v216
  v_and_b32 v225, 0xffff0000, v216
  v_mfma_f32_16x16x32_bf16 v[48:51], a[180:183], v[180:183], v[48:51]
  buffer_load_dwordx4 v246, s[8:11], s40 offen offset:128 nt lds
  v_lshlrev_b32 v226, 16, v217
  v_mfma_f32_16x16x32_bf16 v[56:59], a[176:179], v[184:187], v[56:59]
  s_add_u32 m0, s38, 896
  v_exp_f32 v196, v196
  v_mfma_f32_16x16x32_bf16 v[56:59], a[180:183], v[188:191], v[56:59]
  v_exp_f32 v197, v197
  v_mfma_f32_16x16x32_bf16 v[192:195], a[144:147], a[32:35], v[208:211]
  v_exp_f32 v198, v198
  v_mfma_f32_16x16x32_bf16 v[192:195], a[148:151], a[36:39], v[192:195]
  v_exp_f32 v199, v199
  v_mfma_f32_16x16x32_bf16 v[192:195], a[152:155], a[40:43], v[192:195]
  ds_read_b64_tr_b16 a[176:177], v243 offset:25600
  ds_read_b64_tr_b16 a[178:179], v243 offset:27648
  v_mfma_f32_16x16x32_bf16 v[192:195], a[156:159], a[44:47], v[192:195]
  ds_read_b64_tr_b16 a[180:181], v243 offset:29696
  ds_read_b64_tr_b16 a[182:183], v243 offset:31744
  v_mfma_f32_16x16x32_bf16 v[36:39], a[184:187], v[160:163], v[36:39]
  v_cvt_pk_bf16_f32 v138, v196, v197
  v_cvt_pk_bf16_f32 v139, v198, v199
  v_mfma_f32_16x16x32_bf16 v[36:39], a[188:191], v[164:167], v[36:39]
  v_and_b32 v227, 0xffff0000, v217
  v_lshlrev_b32 v228, 16, v218
  v_mfma_f32_16x16x32_bf16 v[44:47], a[184:187], v[168:171], v[44:47]
  v_and_b32 v229, 0xffff0000, v218
  v_lshlrev_b32 v230, 16, v219
  v_mfma_f32_16x16x32_bf16 v[44:47], a[188:191], v[172:175], v[44:47]
  v_exp_f32 v192, v192
  v_smfmac_f32_16x16x64_bf16 a[200:203], a[208:211], v[176:183], v248
  v_exp_f32 v193, v193
  v_mfma_f32_16x16x32_bf16 v[196:199], a[144:147], a[48:51], v[212:215]
  v_exp_f32 v194, v194
  v_mfma_f32_16x16x32_bf16 v[196:199], a[148:151], a[52:55], v[196:199]
  v_exp_f32 v195, v195
  v_mfma_f32_16x16x32_bf16 v[196:199], a[152:155], a[56:59], v[196:199]
  ds_read_b128 a[144:147], v240 offset:12288
  ds_read_b128 a[148:151], v241 offset:12288
  v_mfma_f32_16x16x32_bf16 v[196:199], a[156:159], a[60:63], v[196:199]
  ds_read_b128 a[152:155], v240 offset:14336
  ds_read_b128 a[156:159], v241 offset:14336
  v_mfma_f32_16x16x32_bf16 v[52:55], a[184:187], v[176:179], v[52:55]
  buffer_load_dwordx4 v245, s[12:15], s30 offen offset:2176 nt lds
  v_cvt_pk_bf16_f32 v146, v192, v193
  v_mfma_f32_16x16x32_bf16 v[52:55], a[188:191], v[180:183], v[52:55]
  s_add_u32 m0, s36, 33664
  v_cvt_pk_bf16_f32 v147, v194, v195
  v_and_b32 v231, 0xffff0000, v219
  v_mfma_f32_16x16x32_bf16 v[60:63], a[184:187], v[184:187], v[60:63]
  v_exp_f32 v196, v196
  v_exp_f32 v197, v197
  v_pk_mul_f32 v[224:225], v[224:225], s[42:43]
  v_pk_mul_f32 v[226:227], v[226:227], s[42:43]
  v_pk_mul_f32 v[228:229], v[228:229], s[42:43]
  v_pk_mul_f32 v[230:231], v[230:231], s[42:43]
  v_mfma_f32_16x16x32_bf16 v[60:63], a[188:191], v[188:191], v[60:63]
  v_exp_f32 v198, v198
  v_mfma_f32_16x16x32_bf16 v[192:195], a[128:131], a[0:3], v[200:203]
  v_exp_f32 v199, v199
  v_mfma_f32_16x16x32_bf16 v[192:195], a[132:135], a[4:7], v[192:195]
  ds_read_b64_tr_b16 a[184:185], v243 offset:25608
  ds_read_b64_tr_b16 a[186:187], v243 offset:27656
  v_mfma_f32_16x16x32_bf16 v[192:195], a[136:139], a[8:11], v[192:195]
  ds_read_b64_tr_b16 a[188:189], v243 offset:29704
  ds_read_b64_tr_b16 a[190:191], v243 offset:31752
  v_mfma_f32_16x16x32_bf16 v[192:195], a[140:143], a[12:15], v[192:195]
  v_cvt_pk_bf16_f32 v154, v196, v197
  v_cvt_pk_bf16_f32 v155, v198, v199
  v_mfma_f32_16x16x32_bf16 v[64:67], a[160:163], v[160:163], v[64:67]
  v_cvt_pk_bf16_f32 v216, v224, v225
  v_cvt_pk_bf16_f32 v217, v226, v227
  v_mfma_f32_16x16x32_bf16 v[64:67], a[164:167], v[164:167], v[64:67]
  v_cvt_pk_bf16_f32 v218, v228, v229
  v_cvt_pk_bf16_f32 v219, v230, v231
  v_mfma_f32_16x16x32_bf16 v[72:75], a[160:163], v[168:171], v[72:75]
  v_exp_f32 v192, v192
  v_mfma_f32_16x16x32_bf16 v[72:75], a[164:167], v[172:175], v[72:75]
  v_exp_f32 v193, v193
  v_smfmac_f32_16x16x64_bf16 a[204:207], a[208:211], v[184:191], v248
  v_exp_f32 v194, v194
  v_mfma_f32_16x16x32_bf16 v[196:199], a[128:131], a[16:19], v[204:207]
  v_exp_f32 v195, v195
  v_mfma_f32_16x16x32_bf16 v[196:199], a[132:135], a[20:23], v[196:199]
  buffer_load_dwordx4 v245, s[4:7], s39 offen offset:2176 nt lds
  v_cvt_pk_bf16_f32 v132, v192, v193
  v_mfma_f32_16x16x32_bf16 v[196:199], a[136:139], a[24:27], v[196:199]
  s_add_u32 m0, s37, 40840
  v_cvt_pk_bf16_f32 v133, v194, v195
  v_accvgpr_write_b32 a88, v216
  v_mfma_f32_16x16x32_bf16 v[196:199], a[140:143], a[28:31], v[196:199]
  s_add_u32 s39, s20, 114688
  v_accvgpr_write_b32 a89, v217
  v_accvgpr_write_b32 a90, v218
  v_mfma_f32_16x16x32_bf16 v[80:83], a[160:163], v[176:179], v[80:83]
  v_accvgpr_write_b32 a91, v219
  v_mfma_f32_16x16x32_bf16 v[80:83], a[164:167], v[180:183], v[80:83]
  v_mfma_f32_16x16x32_bf16 v[88:91], a[160:163], v[184:187], v[88:91]
  v_mfma_f32_16x16x32_bf16 v[88:91], a[164:167], v[188:191], v[88:91]
  v_exp_f32 v196, v196
  v_mfma_f32_16x16x32_bf16 v[192:195], a[128:131], a[32:35], v[208:211]
  v_exp_f32 v197, v197
  v_mfma_f32_16x16x32_bf16 v[192:195], a[132:135], a[36:39], v[192:195]
  ds_read_b128 v[220:223], v250 offset:4096
  v_cvt_pk_bf16_f32 v140, v196, v197
  v_mfma_f32_16x16x32_bf16 v[192:195], a[136:139], a[40:43], v[192:195]
  v_exp_f32 v198, v198
  v_mfma_f32_16x16x32_bf16 v[192:195], a[140:143], a[44:47], v[192:195]
  s_waitcnt vmcnt(11) lgkmcnt(1)
  v_exp_f32 v199, v199
  v_mfma_f32_16x16x32_bf16 v[68:71], a[168:171], v[160:163], v[68:71]
  s_barrier
  buffer_load_dwordx4 v246, s[8:11], s40 offen offset:1152 nt lds
  ds_read_b64_tr_b16 a[160:161], v242 offset:0
  v_mfma_f32_16x16x32_bf16 v[68:71], a[172:175], v[164:167], v[68:71]
  s_add_u32 m0, s36, 49152
  ds_read_b64_tr_b16 a[162:163], v242 offset:2048
  ds_read_b64_tr_b16 a[164:165], v242 offset:4096
  v_mfma_f32_16x16x32_bf16 v[76:79], a[168:171], v[168:171], v[76:79]
  ds_read_b64_tr_b16 a[166:167], v242 offset:6144
  v_cvt_pk_bf16_f32 v141, v198, v199
  v_mfma_f32_16x16x32_bf16 v[76:79], a[172:175], v[172:175], v[76:79]
  s_add_u32 s40, s20, 98304
  v_exp_f32 v192, v192
  v_mfma_f32_16x16x32_bf16 v[196:199], a[128:131], a[48:51], v[212:215]
  v_exp_f32 v193, v193
  v_mfma_f32_16x16x32_bf16 v[196:199], a[132:135], a[52:55], v[196:199]
  v_exp_f32 v194, v194
  v_mfma_f32_16x16x32_bf16 v[196:199], a[136:139], a[56:59], v[196:199]
  v_exp_f32 v195, v195
  v_mfma_f32_16x16x32_bf16 v[196:199], a[140:143], a[60:63], v[196:199]
  ds_read_b128 a[128:131], v240 offset:16384
  ds_read_b128 a[132:135], v241 offset:16384
  v_mfma_f32_16x16x32_bf16 v[84:87], a[168:171], v[176:179], v[84:87]
  ds_read_b128 a[136:139], v240 offset:18432
  ds_read_b128 a[140:143], v241 offset:18432
  v_mfma_f32_16x16x32_bf16 v[84:87], a[172:175], v[180:183], v[84:87]
  s_waitcnt lgkmcnt(4)
  v_lshlrev_b32 v224, 16, v220
  v_cvt_pk_bf16_f32 v148, v192, v193
  v_mfma_f32_16x16x32_bf16 v[92:95], a[168:171], v[184:187], v[92:95]
  ds_read_b64_tr_b16 a[168:169], v242 offset:8
  ds_read_b64_tr_b16 a[170:171], v242 offset:2056
  v_mfma_f32_16x16x32_bf16 v[92:95], a[172:175], v[188:191], v[92:95]
  ds_read_b64_tr_b16 a[172:173], v242 offset:4104
  ds_read_b64_tr_b16 a[174:175], v242 offset:6152
  v_cvt_pk_bf16_f32 v149, v194, v195
  v_mfma_f32_16x16x32_bf16 v[192:195], a[144:147], a[0:3], v[200:203]
  buffer_load_dwordx4 v245, s[4:7], s39 offen nt lds
  v_and_b32 v225, 0xffff0000, v220
  v_mfma_f32_16x16x32_bf16 v[192:195], a[148:151], a[4:7], v[192:195]
  s_add_u32 m0, s37, 16384
  v_lshlrev_b32 v226, 16, v221
  v_and_b32 v227, 0xffff0000, v221
  v_mfma_f32_16x16x32_bf16 v[192:195], a[152:155], a[8:11], v[192:195]
  v_exp_f32 v196, v196
  v_mfma_f32_16x16x32_bf16 v[192:195], a[156:159], a[12:15], v[192:195]
  v_exp_f32 v197, v197
  v_mfma_f32_16x16x32_bf16 v[96:99], a[176:179], v[160:163], v[96:99]
  v_exp_f32 v198, v198
  v_mfma_f32_16x16x32_bf16 v[96:99], a[180:183], v[164:167], v[96:99]
  v_exp_f32 v199, v199
  v_mfma_f32_16x16x32_bf16 v[104:107], a[176:179], v[168:171], v[104:107]
  v_cvt_pk_bf16_f32 v156, v196, v197
  v_cvt_pk_bf16_f32 v157, v198, v199
  v_mfma_f32_16x16x32_bf16 v[104:107], a[180:183], v[172:175], v[104:107]
  v_lshlrev_b32 v228, 16, v222
  v_and_b32 v229, 0xffff0000, v222
  v_mfma_f32_16x16x32_bf16 v[196:199], a[144:147], a[16:19], v[204:207]
  v_lshlrev_b32 v230, 16, v223
  v_and_b32 v231, 0xffff0000, v223
  v_mfma_f32_16x16x32_bf16 v[196:199], a[148:151], a[20:23], v[196:199]
  v_exp_f32 v192, v192
  v_exp_f32 v193, v193
  v_pk_mul_f32 v[224:225], v[224:225], s[42:43]
  v_pk_mul_f32 v[226:227], v[226:227], s[42:43]
  v_pk_mul_f32 v[228:229], v[228:229], s[42:43]
  v_pk_mul_f32 v[230:231], v[230:231], s[42:43]
  v_mfma_f32_16x16x32_bf16 v[196:199], a[152:155], a[24:27], v[196:199]
  v_exp_f32 v194, v194
  v_mfma_f32_16x16x32_bf16 v[196:199], a[156:159], a[28:31], v[196:199]
  v_exp_f32 v195, v195
  v_mfma_f32_16x16x32_bf16 v[112:115], a[176:179], v[176:179], v[112:115]
  buffer_load_dwordx4 v246, s[8:11], s40 offen nt lds
  v_cvt_pk_bf16_f32 v134, v192, v193
  v_mfma_f32_16x16x32_bf16 v[112:115], a[180:183], v[180:183], v[112:115]
  s_add_u32 m0, s36, 48128
  v_cvt_pk_bf16_f32 v135, v194, v195
  v_cvt_pk_bf16_f32 v220, v224, v225
  v_mfma_f32_16x16x32_bf16 v[120:123], a[176:179], v[184:187], v[120:123]
  v_exp_f32 v196, v196
  v_mfma_f32_16x16x32_bf16 v[120:123], a[180:183], v[188:191], v[120:123]
  v_exp_f32 v197, v197
  v_mfma_f32_16x16x32_bf16 v[192:195], a[144:147], a[32:35], v[208:211]
  v_exp_f32 v198, v198
  v_mfma_f32_16x16x32_bf16 v[192:195], a[148:151], a[36:39], v[192:195]
  v_exp_f32 v199, v199
  v_mfma_f32_16x16x32_bf16 v[192:195], a[152:155], a[40:43], v[192:195]
  ds_read_b64_tr_b16 a[176:177], v243 offset:0
  ds_read_b64_tr_b16 a[178:179], v243 offset:2048
  v_mfma_f32_16x16x32_bf16 v[192:195], a[156:159], a[44:47], v[192:195]
  ds_read_b64_tr_b16 a[180:181], v243 offset:4096
  ds_read_b64_tr_b16 a[182:183], v243 offset:6144
  v_mfma_f32_16x16x32_bf16 v[100:103], a[184:187], v[160:163], v[100:103]
  v_cvt_pk_bf16_f32 v142, v196, v197
  v_cvt_pk_bf16_f32 v143, v198, v199
  v_mfma_f32_16x16x32_bf16 v[100:103], a[188:191], v[164:167], v[100:103]
  v_cvt_pk_bf16_f32 v221, v226, v227
  v_cvt_pk_bf16_f32 v222, v228, v229
  v_mfma_f32_16x16x32_bf16 v[108:111], a[184:187], v[168:171], v[108:111]
  v_exp_f32 v192, v192
  v_mfma_f32_16x16x32_bf16 v[108:111], a[188:191], v[172:175], v[108:111]
  v_exp_f32 v193, v193
  v_mfma_f32_16x16x32_bf16 v[196:199], a[144:147], a[48:51], v[212:215]
  s_waitcnt vmcnt(12)
  v_exp_f32 v194, v194
  v_mfma_f32_16x16x32_bf16 v[196:199], a[148:151], a[52:55], v[196:199]
  v_exp_f32 v195, v195
  v_mfma_f32_16x16x32_bf16 v[196:199], a[152:155], a[56:59], v[196:199]
  ds_read_b128 a[144:147], v240 offset:20480
  ds_read_b128 a[148:151], v241 offset:20480
  v_mfma_f32_16x16x32_bf16 v[196:199], a[156:159], a[60:63], v[196:199]
  ds_read_b128 a[152:155], v240 offset:22528
  ds_read_b128 a[156:159], v241 offset:22528
  v_mfma_f32_16x16x32_bf16 v[116:119], a[184:187], v[176:179], v[116:119]
  buffer_load_dwordx4 v245, s[4:7], s39 offen offset:2048 nt lds
  v_cvt_pk_bf16_f32 v150, v192, v193
  v_mfma_f32_16x16x32_bf16 v[116:119], a[188:191], v[180:183], v[116:119]
  s_add_u32 m0, s37, 48136
  v_cvt_pk_bf16_f32 v151, v194, v195
  v_cvt_pk_bf16_f32 v223, v230, v231
  v_mfma_f32_16x16x32_bf16 v[124:127], a[184:187], v[184:187], v[124:127]
  ds_read_b64_tr_b16 a[184:185], v243 offset:8
  ds_read_b64_tr_b16 a[186:187], v243 offset:2056
  v_mfma_f32_16x16x32_bf16 v[124:127], a[188:191], v[188:191], v[124:127]
  s_waitcnt lgkmcnt(6)
  ds_read_b64_tr_b16 a[188:189], v243 offset:4104
  ds_read_b64_tr_b16 a[190:191], v243 offset:6152
  v_mfma_f32_16x16x32_bf16 v[192:195], a[128:131], a[0:3], v[200:203]
  ds_read_b128 v[216:219], v249 offset:0
  v_accvgpr_write_b32 a92, v220
  v_mfma_f32_16x16x32_bf16 v[192:195], a[132:135], a[4:7], v[192:195]
  v_exp_f32 v196, v196
  v_mfma_f32_16x16x32_bf16 v[192:195], a[136:139], a[8:11], v[192:195]
  v_exp_f32 v197, v197
  v_mfma_f32_16x16x32_bf16 v[192:195], a[140:143], a[12:15], v[192:195]
  v_exp_f32 v198, v198
  v_mfma_f32_16x16x32_bf16 v[0:3], a[160:163], v[128:131], v[0:3]
  v_exp_f32 v199, v199
  v_mfma_f32_16x16x32_bf16 v[0:3], a[164:167], v[132:135], v[0:3]
  v_cvt_pk_bf16_f32 v158, v196, v197
  v_cvt_pk_bf16_f32 v159, v198, v199
  v_mfma_f32_16x16x32_bf16 v[8:11], a[160:163], v[136:139], v[8:11]
  buffer_load_dwordx4 v246, s[8:11], s40 offen offset:1024 nt lds
  v_accvgpr_write_b32 a93, v221
  v_mfma_f32_16x16x32_bf16 v[8:11], a[164:167], v[140:143], v[8:11]
  s_add_u32 m0, s38, 4096
  v_accvgpr_write_b32 a94, v222
  v_accvgpr_write_b32 a95, v223
  v_mfma_f32_16x16x32_bf16 v[196:199], a[128:131], a[16:19], v[204:207]
  v_exp_f32 v192, v192
  v_mfma_f32_16x16x32_bf16 v[196:199], a[132:135], a[20:23], v[196:199]
  v_exp_f32 v193, v193
  v_mfma_f32_16x16x32_bf16 v[196:199], a[136:139], a[24:27], v[196:199]
  v_exp_f32 v194, v194
  v_mfma_f32_16x16x32_bf16 v[196:199], a[140:143], a[28:31], v[196:199]
  v_exp_f32 v195, v195
  v_mfma_f32_16x16x32_bf16 v[16:19], a[160:163], v[144:147], v[16:19]
  s_waitcnt lgkmcnt(0)
  v_lshlrev_b32 v224, 16, v216
  v_cvt_pk_bf16_f32 v160, v192, v193
  v_mfma_f32_16x16x32_bf16 v[16:19], a[164:167], v[148:151], v[16:19]
  v_cvt_pk_bf16_f32 v161, v194, v195
  v_and_b32 v225, 0xffff0000, v216
  v_mfma_f32_16x16x32_bf16 v[24:27], a[160:163], v[152:155], v[24:27]
  ds_read_b64_tr_b16 a[160:161], v242 offset:1024
  ds_read_b64_tr_b16 a[162:163], v242 offset:3072
  v_mfma_f32_16x16x32_bf16 v[24:27], a[164:167], v[156:159], v[24:27]
  ds_read_b64_tr_b16 a[164:165], v242 offset:5120
  ds_read_b64_tr_b16 a[166:167], v242 offset:7168
  v_mfma_f32_16x16x32_bf16 v[192:195], a[128:131], a[32:35], v[208:211]
  buffer_load_dwordx4 v245, s[12:15], s31 offen nt lds
  v_lshlrev_b32 v226, 16, v217
  v_mfma_f32_16x16x32_bf16 v[192:195], a[132:135], a[36:39], v[192:195]
  s_add_u32 m0, s38, 3072
  v_and_b32 v227, 0xffff0000, v217
  v_lshlrev_b32 v228, 16, v218
  v_mfma_f32_16x16x32_bf16 v[192:195], a[136:139], a[40:43], v[192:195]
  v_exp_f32 v196, v196
  v_mfma_f32_16x16x32_bf16 v[192:195], a[140:143], a[44:47], v[192:195]
  v_exp_f32 v197, v197
  v_mfma_f32_16x16x32_bf16 v[4:7], a[168:171], v[128:131], v[4:7]
  v_exp_f32 v198, v198
  v_mfma_f32_16x16x32_bf16 v[4:7], a[172:175], v[132:135], v[4:7]
  v_exp_f32 v199, v199
  v_mfma_f32_16x16x32_bf16 v[12:15], a[168:171], v[136:139], v[12:15]
  v_cvt_pk_bf16_f32 v168, v196, v197
  v_cvt_pk_bf16_f32 v169, v198, v199
  v_mfma_f32_16x16x32_bf16 v[12:15], a[172:175], v[140:143], v[12:15]
  v_and_b32 v229, 0xffff0000, v218
  v_lshlrev_b32 v230, 16, v219
  v_smfmac_f32_16x16x64_bf16 a[192:195], a[208:211], v[128:135], v248
  v_exp_f32 v192, v192
  v_mfma_f32_16x16x32_bf16 v[196:199], a[128:131], a[48:51], v[212:215]
  ds_read_b128 a[128:131], v240 offset:24576
  v_and_b32 v231, 0xffff0000, v219
  v_mfma_f32_16x16x32_bf16 v[196:199], a[132:135], a[52:55], v[196:199]
  v_exp_f32 v193, v193
  v_exp_f32 v194, v194
  v_pk_mul_f32 v[224:225], v[224:225], s[42:43]
  v_pk_mul_f32 v[226:227], v[226:227], s[42:43]
  v_pk_mul_f32 v[228:229], v[228:229], s[42:43]
  v_pk_mul_f32 v[230:231], v[230:231], s[42:43]
  v_mfma_f32_16x16x32_bf16 v[196:199], a[136:139], a[56:59], v[196:199]
  v_exp_f32 v195, v195
  v_mfma_f32_16x16x32_bf16 v[196:199], a[140:143], a[60:63], v[196:199]
  ds_read_b128 a[132:135], v241 offset:24576
  ds_read_b128 a[136:139], v240 offset:26624
  v_mfma_f32_16x16x32_bf16 v[20:23], a[168:171], v[144:147], v[20:23]
  ds_read_b128 a[140:143], v241 offset:26624
  buffer_load_dwordx4 v245, s[12:15], s31 offen offset:2048 nt lds
  v_mfma_f32_16x16x32_bf16 v[20:23], a[172:175], v[148:151], v[20:23]
  s_add_u32 m0, s36, 51072
  v_cvt_pk_bf16_f32 v176, v192, v193
  v_cvt_pk_bf16_f32 v177, v194, v195
  v_mfma_f32_16x16x32_bf16 v[28:31], a[168:171], v[152:155], v[28:31]
  v_exp_f32 v196, v196
  v_mfma_f32_16x16x32_bf16 v[28:31], a[172:175], v[156:159], v[28:31]
  v_exp_f32 v197, v197
  v_mfma_f32_16x16x32_bf16 v[192:195], a[144:147], a[0:3], v[200:203]
  v_exp_f32 v198, v198
  v_mfma_f32_16x16x32_bf16 v[192:195], a[148:151], a[4:7], v[192:195]
  v_exp_f32 v199, v199
  v_mfma_f32_16x16x32_bf16 v[192:195], a[152:155], a[8:11], v[192:195]
  ds_read_b64_tr_b16 a[168:169], v242 offset:1032
  ds_read_b64_tr_b16 a[170:171], v242 offset:3080
  v_mfma_f32_16x16x32_bf16 v[192:195], a[156:159], a[12:15], v[192:195]
  ds_read_b64_tr_b16 a[172:173], v242 offset:5128
  ds_read_b64_tr_b16 a[174:175], v242 offset:7176
  v_mfma_f32_16x16x32_bf16 v[32:35], a[176:179], v[128:131], v[32:35]
  v_cvt_pk_bf16_f32 v184, v196, v197
  v_cvt_pk_bf16_f32 v185, v198, v199
  v_mfma_f32_16x16x32_bf16 v[32:35], a[180:183], v[132:135], v[32:35]
  v_cvt_pk_bf16_f32 v216, v224, v225
  v_cvt_pk_bf16_f32 v217, v226, v227
  v_mfma_f32_16x16x32_bf16 v[40:43], a[176:179], v[136:139], v[40:43]
  buffer_load_dwordx4 v245, s[4:7], s39 offen offset:128 nt lds
  v_cvt_pk_bf16_f32 v218, v228, v229
  v_mfma_f32_16x16x32_bf16 v[40:43], a[180:183], v[140:143], v[40:43]
  s_add_u32 m0, s37, 17280
  v_exp_f32 v192, v192
  v_smfmac_f32_16x16x64_bf16 a[196:199], a[208:211], v[136:143], v248
  v_exp_f32 v193, v193
  v_mfma_f32_16x16x32_bf16 v[196:199], a[144:147], a[16:19], v[204:207]
  v_exp_f32 v194, v194
  v_mfma_f32_16x16x32_bf16 v[196:199], a[148:151], a[20:23], v[196:199]
  v_exp_f32 v195, v195
  v_mfma_f32_16x16x32_bf16 v[196:199], a[152:155], a[24:27], v[196:199]
  v_cvt_pk_bf16_f32 v162, v192, v193
  v_cvt_pk_bf16_f32 v163, v194, v195
  v_mfma_f32_16x16x32_bf16 v[196:199], a[156:159], a[28:31], v[196:199]
  v_cvt_pk_bf16_f32 v219, v230, v231
  v_accvgpr_write_b32 a96, v216
  v_mfma_f32_16x16x32_bf16 v[48:51], a[176:179], v[144:147], v[48:51]
  v_accvgpr_write_b32 a97, v217
  v_accvgpr_write_b32 a98, v218
  v_mfma_f32_16x16x32_bf16 v[48:51], a[180:183], v[148:151], v[48:51]
  ds_read_b128 v[220:223], v250 offset:0
  v_accvgpr_write_b32 a99, v219
  v_mfma_f32_16x16x32_bf16 v[56:59], a[176:179], v[152:155], v[56:59]
  v_exp_f32 v196, v196
  v_mfma_f32_16x16x32_bf16 v[56:59], a[180:183], v[156:159], v[56:59]
  v_exp_f32 v197, v197
  v_mfma_f32_16x16x32_bf16 v[192:195], a[144:147], a[32:35], v[208:211]
  v_exp_f32 v198, v198
  v_mfma_f32_16x16x32_bf16 v[192:195], a[148:151], a[36:39], v[192:195]
  v_exp_f32 v199, v199
  v_mfma_f32_16x16x32_bf16 v[192:195], a[152:155], a[40:43], v[192:195]
  ds_read_b64_tr_b16 a[176:177], v243 offset:1024
  ds_read_b64_tr_b16 a[178:179], v243 offset:3072
  v_mfma_f32_16x16x32_bf16 v[192:195], a[156:159], a[44:47], v[192:195]
  ds_read_b64_tr_b16 a[180:181], v243 offset:5120
  ds_read_b64_tr_b16 a[182:183], v243 offset:7168
  v_mfma_f32_16x16x32_bf16 v[36:39], a[184:187], v[128:131], v[36:39]
  buffer_load_dwordx4 v246, s[8:11], s40 offen offset:128 nt lds
  v_cvt_pk_bf16_f32 v170, v196, v197
  v_mfma_f32_16x16x32_bf16 v[36:39], a[188:191], v[132:135], v[36:39]
  s_add_u32 m0, s36, 50048
  v_cvt_pk_bf16_f32 v171, v198, v199
  v_mfma_f32_16x16x32_bf16 v[44:47], a[184:187], v[136:139], v[44:47]
  s_waitcnt lgkmcnt(4)
  v_lshlrev_b32 v224, 16, v220
  v_and_b32 v225, 0xffff0000, v220
  v_mfma_f32_16x16x32_bf16 v[44:47], a[188:191], v[140:143], v[44:47]
  v_exp_f32 v192, v192
  v_smfmac_f32_16x16x64_bf16 a[200:203], a[208:211], v[144:151], v248
  v_exp_f32 v193, v193
  v_mfma_f32_16x16x32_bf16 v[196:199], a[144:147], a[48:51], v[212:215]
  v_exp_f32 v194, v194
  v_mfma_f32_16x16x32_bf16 v[196:199], a[148:151], a[52:55], v[196:199]
  v_exp_f32 v195, v195
  v_mfma_f32_16x16x32_bf16 v[196:199], a[152:155], a[56:59], v[196:199]
  ds_read_b128 a[144:147], v240 offset:28672
  ds_read_b128 a[148:151], v241 offset:28672
  v_mfma_f32_16x16x32_bf16 v[196:199], a[156:159], a[60:63], v[196:199]
  ds_read_b128 a[152:155], v240 offset:30720
  ds_read_b128 a[156:159], v241 offset:30720
  v_mfma_f32_16x16x32_bf16 v[52:55], a[184:187], v[144:147], v[52:55]
  v_cvt_pk_bf16_f32 v178, v192, v193
  v_cvt_pk_bf16_f32 v179, v194, v195
  v_mfma_f32_16x16x32_bf16 v[52:55], a[188:191], v[148:151], v[52:55]
  buffer_load_dwordx4 v245, s[4:7], s39 offen offset:2176 nt lds
  v_lshlrev_b32 v226, 16, v221
  v_mfma_f32_16x16x32_bf16 v[60:63], a[184:187], v[152:155], v[60:63]
  s_add_u32 m0, s37, 49032
  ds_read_b64_tr_b16 a[184:185], v243 offset:1032
  ds_read_b64_tr_b16 a[186:187], v243 offset:3080
  v_mfma_f32_16x16x32_bf16 v[60:63], a[188:191], v[156:159], v[60:63]
  ds_read_b64_tr_b16 a[188:189], v243 offset:5128
  ds_read_b64_tr_b16 a[190:191], v243 offset:7176
  v_mfma_f32_16x16x32_bf16 v[192:195], a[128:131], a[0:3], v[200:203]
  s_add_u32 s39, s21, 0
  v_and_b32 v227, 0xffff0000, v221
  v_lshlrev_b32 v228, 16, v222
  v_mfma_f32_16x16x32_bf16 v[192:195], a[132:135], a[4:7], v[192:195]
  v_and_b32 v229, 0xffff0000, v222
  v_lshlrev_b32 v230, 16, v223
  v_mfma_f32_16x16x32_bf16 v[192:195], a[136:139], a[8:11], v[192:195]
  v_exp_f32 v196, v196
  v_mfma_f32_16x16x32_bf16 v[192:195], a[140:143], a[12:15], v[192:195]
  v_exp_f32 v197, v197
  v_mfma_f32_16x16x32_bf16 v[64:67], a[160:163], v[128:131], v[64:67]
  v_exp_f32 v198, v198
  v_mfma_f32_16x16x32_bf16 v[64:67], a[164:167], v[132:135], v[64:67]
  v_exp_f32 v199, v199
  v_mfma_f32_16x16x32_bf16 v[72:75], a[160:163], v[136:139], v[72:75]
  v_cvt_pk_bf16_f32 v186, v196, v197
  v_cvt_pk_bf16_f32 v187, v198, v199
  v_mfma_f32_16x16x32_bf16 v[72:75], a[164:167], v[140:143], v[72:75]
  buffer_load_dwordx4 v246, s[8:11], s40 offen offset:1152 nt lds
  v_and_b32 v231, 0xffff0000, v223
  v_smfmac_f32_16x16x64_bf16 a[204:207], a[208:211], v[152:159], v248
  s_add_u32 m0, s36, 0
  v_exp_f32 v192, v192
  v_exp_f32 v193, v193
  v_pk_mul_f32 v[224:225], v[224:225], s[42:43]
  v_pk_mul_f32 v[226:227], v[226:227], s[42:43]
  v_pk_mul_f32 v[228:229], v[228:229], s[42:43]
  v_pk_mul_f32 v[230:231], v[230:231], s[42:43]
  v_mfma_f32_16x16x32_bf16 v[196:199], a[128:131], a[16:19], v[204:207]
L_stub4:
  s_cmp_eq_u32 s99, 1
  s_cbranch_scc1 L_ret1
  v_exp_f32 v194, v194
  v_mfma_f32_16x16x32_bf16 v[196:199], a[132:135], a[20:23], v[196:199]
  s_add_u32 s40, s20, 114688
  v_exp_f32 v195, v195
  v_mfma_f32_16x16x32_bf16 v[196:199], a[136:139], a[24:27], v[196:199]
  v_cvt_pk_bf16_f32 v164, v192, v193
  v_cvt_pk_bf16_f32 v165, v194, v195
  v_mfma_f32_16x16x32_bf16 v[196:199], a[140:143], a[28:31], v[196:199]
  v_cvt_pk_bf16_f32 v220, v224, v225
  v_cvt_pk_bf16_f32 v221, v226, v227
  v_mfma_f32_16x16x32_bf16 v[80:83], a[160:163], v[144:147], v[80:83]
  v_cvt_pk_bf16_f32 v222, v228, v229
  v_cvt_pk_bf16_f32 v223, v230, v231
  v_mfma_f32_16x16x32_bf16 v[80:83], a[164:167], v[148:151], v[80:83]
  v_accvgpr_write_b32 a100, v220
  v_accvgpr_write_b32 a101, v221
  v_mfma_f32_16x16x32_bf16 v[88:91], a[160:163], v[152:155], v[88:91]
  v_exp_f32 v196, v196
  v_mfma_f32_16x16x32_bf16 v[88:91], a[164:167], v[156:159], v[88:91]
  v_exp_f32 v197, v197
  v_mfma_f32_16x16x32_bf16 v[192:195], a[128:131], a[32:35], v[208:211]
  v_exp_f32 v198, v198
  v_mfma_f32_16x16x32_bf16 v[192:195], a[132:135], a[36:39], v[192:195]
  v_exp_f32 v199, v199
  v_mfma_f32_16x16x32_bf16 v[192:195], a[136:139], a[40:43], v[192:195]
  buffer_load_dwordx4 v245, s[4:7], s39 offen nt lds
  v_cvt_pk_bf16_f32 v172, v196, v197
  v_mfma_f32_16x16x32_bf16 v[192:195], a[140:143], a[44:47], v[192:195]
  s_waitcnt vmcnt(11) lgkmcnt(0)
  v_cvt_pk_bf16_f32 v173, v198, v199
  v_accvgpr_write_b32 a102, v222
  v_mfma_f32_16x16x32_bf16 v[68:71], a[168:171], v[128:131], v[68:71]
  s_barrier
  ds_read_b64_tr_b16 a[160:161], v242 offset:8192
  ds_read_b64_tr_b16 a[162:163], v242 offset:10240
  v_mfma_f32_16x16x32_bf16 v[68:71], a[172:175], v[132:135], v[68:71]
  s_add_u32 m0, s37, 24576
  v_exp_f32 v192, v192
  v_mfma_f32_16x16x32_bf16 v[76:79], a[168:171], v[136:139], v[76:79]
  s_waitcnt vmcnt(13)
  v_exp_f32 v193, v193
  v_mfma_f32_16x16x32_bf16 v[76:79], a[172:175], v[140:143], v[76:79]
  v_exp_f32 v194, v194
  v_mfma_f32_16x16x32_bf16 v[196:199], a[128:131], a[48:51], v[212:215]
  v_exp_f32 v195, v195
  v_mfma_f32_16x16x32_bf16 v[196:199], a[132:135], a[52:55], v[196:199]
  ds_read_b128 a[128:131], v240 offset:32768
  ds_read_b128 a[132:135], v241 offset:32768
  v_mfma_f32_16x16x32_bf16 v[196:199], a[136:139], a[56:59], v[196:199]
  ds_read_b128 a[136:139], v240 offset:34816
  ds_read_b64_tr_b16 a[164:165], v242 offset:12288
  v_mfma_f32_16x16x32_bf16 v[196:199], a[140:143], a[60:63], v[196:199]
  ds_read_b128 v[216:219], v249 offset:2048
  ds_read_b128 a[140:143], v241 offset:34816
  v_mfma_f32_16x16x32_bf16 v[84:87], a[168:171], v[144:147], v[84:87]
  ds_read_b64_tr_b16 a[166:167], v242 offset:14336
  buffer_load_dwordx4 v246, s[8:11], s40 offen nt lds
  v_mfma_f32_16x16x32_bf16 v[84:87], a[172:175], v[148:151], v[84:87]
  s_add_u32 m0, s38, -128
  v_cvt_pk_bf16_f32 v180, v192, v193
  v_cvt_pk_bf16_f32 v181, v194, v195
  v_mfma_f32_16x16x32_bf16 v[92:95], a[168:171], v[152:155], v[92:95]
  v_exp_f32 v196, v196
  v_mfma_f32_16x16x32_bf16 v[92:95], a[172:175], v[156:159], v[92:95]
  v_exp_f32 v197, v197
  v_mfma_f32_16x16x32_bf16 v[192:195], a[144:147], a[0:3], v[200:203]
  v_exp_f32 v198, v198
  v_mfma_f32_16x16x32_bf16 v[192:195], a[148:151], a[4:7], v[192:195]
  v_exp_f32 v199, v199
  v_mfma_f32_16x16x32_bf16 v[192:195], a[152:155], a[8:11], v[192:195]
  ds_read_b64_tr_b16 a[168:169], v242 offset:8200
  ds_read_b64_tr_b16 a[170:171], v242 offset:10248
  v_mfma_f32_16x16x32_bf16 v[192:195], a[156:159], a[12:15], v[192:195]
  ds_read_b64_tr_b16 a[172:173], v242 offset:12296
  ds_read_b64_tr_b16 a[174:175], v242 offset:14344
  v_mfma_f32_16x16x32_bf16 v[96:99], a[176:179], v[128:131], v[96:99]
  v_cvt_pk_bf16_f32 v188, v196, v197
  v_cvt_pk_bf16_f32 v189, v198, v199
  v_mfma_f32_16x16x32_bf16 v[96:99], a[180:183], v[132:135], v[96:99]
  s_waitcnt lgkmcnt(4)
  v_accvgpr_write_b32 a103, v223
  v_lshlrev_b32 v224, 16, v216
  v_mfma_f32_16x16x32_bf16 v[104:107], a[176:179], v[136:139], v[104:107]
  buffer_load_dwordx4 v245, s[12:15], s31 offen offset:128 nt lds
  v_and_b32 v225, 0xffff0000, v216
  v_mfma_f32_16x16x32_bf16 v[104:107], a[180:183], v[140:143], v[104:107]
  s_add_u32 m0, s38, -1152
  v_exp_f32 v192, v192
  v_mfma_f32_16x16x32_bf16 v[196:199], a[144:147], a[16:19], v[204:207]
  v_exp_f32 v193, v193
  v_mfma_f32_16x16x32_bf16 v[196:199], a[148:151], a[20:23], v[196:199]
  v_exp_f32 v194, v194
  v_mfma_f32_16x16x32_bf16 v[196:199], a[152:155], a[24:27], v[196:199]
  v_exp_f32 v195, v195
  v_mfma_f32_16x16x32_bf16 v[196:199], a[156:159], a[28:31], v[196:199]
  v_lshlrev_b32 v226, 16, v217
  v_cvt_pk_bf16_f32 v166, v192, v193
  v_mfma_f32_16x16x32_bf16 v[112:115], a[176:179], v[144:147], v[112:115]
  v_cvt_pk_bf16_f32 v167, v194, v195
  v_and_b32 v227, 0xffff0000, v217
  v_mfma_f32_16x16x32_bf16 v[112:115], a[180:183], v[148:151], v[112:115]
  v_lshlrev_b32 v228, 16, v218
  v_and_b32 v229, 0xffff0000, v218
  v_mfma_f32_16x16x32_bf16 v[120:123], a[176:179], v[152:155], v[120:123]
  v_exp_f32 v196, v196
  v_mfma_f32_16x16x32_bf16 v[120:123], a[180:183], v[156:159], v[120:123]
  v_exp_f32 v197, v197
  v_mfma_f32_16x16x32_bf16 v[192:195], a[144:147], a[32:35], v[208:211]
  v_exp_f32 v198, v198
  v_mfma_f32_16x16x32_bf16 v[192:195], a[148:151], a[36:39], v[192:195]
  v_exp_f32 v199, v199
  v_mfma_f32_16x16x32_bf16 v[192:195], a[152:155], a[40:43], v[192:195]
  buffer_load_dwordx4 v245, s[12:15], s31 offen offset:2176 nt lds
  ds_read_b64_tr_b16 a[176:177], v243 offset:8192
  v_mfma_f32_16x16x32_bf16 v[192:195], a[156:159], a[44:47], v[192:195]
  s_add_u32 m0, s36, -1024
  ds_read_b64_tr_b16 a[178:179], v243 offset:10240
  ds_read_b64_tr_b16 a[180:181], v243 offset:12288
  v_mfma_f32_16x16x32_bf16 v[100:103], a[184:187], v[128:131], v[100:103]
  ds_read_b64_tr_b16 a[182:183], v243 offset:14336
  v_cvt_pk_bf16_f32 v174, v196, v197
  v_mfma_f32_16x16x32_bf16 v[100:103], a[188:191], v[132:135], v[100:103]
  v_cvt_pk_bf16_f32 v175, v198, v199
  v_lshlrev_b32 v230, 16, v219
  v_mfma_f32_16x16x32_bf16 v[108:111], a[184:187], v[136:139], v[108:111]
  v_exp_f32 v192, v192
  v_mfma_f32_16x16x32_bf16 v[108:111], a[188:191], v[140:143], v[108:111]
  v_exp_f32 v193, v193
  v_mfma_f32_16x16x32_bf16 v[196:199], a[144:147], a[48:51], v[212:215]
  ds_read_b128 a[144:147], v240 offset:36864
  v_and_b32 v231, 0xffff0000, v219
  v_mfma_f32_16x16x32_bf16 v[196:199], a[148:151], a[52:55], v[196:199]
  v_exp_f32 v194, v194
  v_exp_f32 v195, v195
  v_pk_mul_f32 v[224:225], v[224:225], s[42:43]
  v_pk_mul_f32 v[226:227], v[226:227], s[42:43]
  v_pk_mul_f32 v[228:229], v[228:229], s[42:43]
  v_pk_mul_f32 v[230:231], v[230:231], s[42:43]
  v_mfma_f32_16x16x32_bf16 v[196:199], a[152:155], a[56:59], v[196:199]
  ds_read_b128 a[148:151], v241 offset:36864
  ds_read_b128 a[152:155], v240 offset:38912
  v_mfma_f32_16x16x32_bf16 v[196:199], a[156:159], a[60:63], v[196:199]
  ds_read_b128 a[156:159], v241 offset:38912
  v_cvt_pk_bf16_f32 v182, v192, v193
  v_mfma_f32_16x16x32_bf16 v[116:119], a[184:187], v[144:147], v[116:119]
  buffer_load_dwordx4 v245, s[4:7], s39 offen offset:2048 nt lds
  v_cvt_pk_bf16_f32 v183, v194, v195
  v_mfma_f32_16x16x32_bf16 v[116:119], a[188:191], v[148:151], v[116:119]
  s_add_u32 m0, s37, 56328
  v_cvt_pk_bf16_f32 v216, v224, v225
  v_cvt_pk_bf16_f32 v217, v226, v227
  v_mfma_f32_16x16x32_bf16 v[124:127], a[184:187], v[152:155], v[124:127]
  v_exp_f32 v196, v196
  v_mfma_f32_16x16x32_bf16 v[124:127], a[188:191], v[156:159], v[124:127]
  v_exp_f32 v197, v197
  v_mfma_f32_16x16x32_bf16 v[192:195], a[128:131], a[0:3], v[200:203]
  v_exp_f32 v198, v198
  v_mfma_f32_16x16x32_bf16 v[192:195], a[132:135], a[4:7], v[192:195]
  v_exp_f32 v199, v199
  v_mfma_f32_16x16x32_bf16 v[192:195], a[136:139], a[8:11], v[192:195]
  ds_read_b64_tr_b16 a[184:185], v243 offset:8200
  ds_read_b64_tr_b16 a[186:187], v243 offset:10248
  v_mfma_f32_16x16x32_bf16 v[192:195], a[140:143], a[12:15], v[192:195]
  ds_read_b64_tr_b16 a[188:189], v243 offset:12296
  ds_read_b64_tr_b16 a[190:191], v243 offset:14344
  v_mfma_f32_16x16x32_bf16 v[0:3], a[160:163], v[160:163], v[0:3]
  v_cvt_pk_bf16_f32 v190, v196, v197
  v_cvt_pk_bf16_f32 v191, v198, v199
  v_mfma_f32_16x16x32_bf16 v[0:3], a[164:167], v[164:167], v[0:3]
  v_cvt_pk_bf16_f32 v218, v228, v229
  v_cvt_pk_bf16_f32 v219, v230, v231
  v_mfma_f32_16x16x32_bf16 v[8:11], a[160:163], v[168:171], v[8:11]
  v_exp_f32 v192, v192
  v_mfma_f32_16x16x32_bf16 v[8:11], a[164:167], v[172:175], v[8:11]
  v_exp_f32 v193, v193
  v_mfma_f32_16x16x32_bf16 v[196:199], a[128:131], a[16:19], v[204:207]
  v_exp_f32 v194, v194
  v_mfma_f32_16x16x32_bf16 v[196:199], a[132:135], a[20:23], v[196:199]
  v_exp_f32 v195, v195
  v_mfma_f32_16x16x32_bf16 v[196:199], a[136:139], a[24:27], v[196:199]
  ds_read_b128 v[220:223], v250 offset:2048
  buffer_load_dwordx4 v246, s[8:11], s40 offen offset:1024 nt lds
  v_mfma_f32_16x16x32_bf16 v[196:199], a[140:143], a[28:31], v[196:199]
  s_add_u32 m0, s36, 1920
  v_accvgpr_write_b32 a104, v216
  v_cvt_pk_bf16_f32 v128, v192, v193
  v_mfma_f32_16x16x32_bf16 v[16:19], a[160:163], v[176:179], v[16:19]
  v_cvt_pk_bf16_f32 v129, v194, v195
  v_accvgpr_write_b32 a105, v217
  v_mfma_f32_16x16x32_bf16 v[16:19], a[164:167], v[180:183], v[16:19]
  v_accvgpr_write_b32 a106, v218
  v_accvgpr_write_b32 a107, v219
  v_mfma_f32_16x16x32_bf16 v[24:27], a[160:163], v[184:187], v[24:27]
  v_exp_f32 v196, v196
  v_mfma_f32_16x16x32_bf16 v[24:27], a[164:167], v[188:191], v[24:27]
  v_exp_f32 v197, v197
  v_mfma_f32_16x16x32_bf16 v[192:195], a[128:131], a[32:35], v[208:211]
  v_exp_f32 v198, v198
  v_mfma_f32_16x16x32_bf16 v[192:195], a[132:135], a[36:39], v[192:195]
  v_exp_f32 v199, v199
  v_mfma_f32_16x16x32_bf16 v[192:195], a[136:139], a[40:43], v[192:195]
  ds_read_b64_tr_b16 a[160:161], v242 offset:9216
  ds_read_b64_tr_b16 a[162:163], v242 offset:11264
  v_mfma_f32_16x16x32_bf16 v[192:195], a[140:143], a[44:47], v[192:195]
  s_waitcnt lgkmcnt(2)
  ds_read_b64_tr_b16 a[164:165], v242 offset:13312
  ds_read_b64_tr_b16 a[166:167], v242 offset:15360
  v_mfma_f32_16x16x32_bf16 v[4:7], a[168:171], v[160:163], v[4:7]
  buffer_load_dwordx4 v245, s[4:7], s39 offen offset:128 nt lds
  v_cvt_pk_bf16_f32 v136, v196, v197
  v_mfma_f32_16x16x32_bf16 v[4:7], a[172:175], v[164:167], v[4:7]
  s_add_u32 m0, s37, 25472
  v_cvt_pk_bf16_f32 v137, v198, v199
  v_lshlrev_b32 v224, 16, v220
  v_mfma_f32_16x16x32_bf16 v[12:15], a[168:171], v[168:171], v[12:15]
  v_and_b32 v225, 0xffff0000, v220
  v_lshlrev_b32 v226, 16, v221
  v_mfma_f32_16x16x32_bf16 v[12:15], a[172:175], v[172:175], v[12:15]
  v_exp_f32 v192, v192
  v_smfmac_f32_16x16x64_bf16 a[192:195], a[208:211], v[160:167], v248
  v_exp_f32 v193, v193
  v_mfma_f32_16x16x32_bf16 v[196:199], a[128:131], a[48:51], v[212:215]
  v_exp_f32 v194, v194
  v_mfma_f32_16x16x32_bf16 v[196:199], a[132:135], a[52:55], v[196:199]
  v_exp_f32 v195, v195
  v_mfma_f32_16x16x32_bf16 v[196:199], a[136:139], a[56:59], v[196:199]
  ds_read_b128 a[128:131], v240 offset:40960
  ds_read_b128 a[132:135], v241 offset:40960
  v_mfma_f32_16x16x32_bf16 v[196:199], a[140:143], a[60:63], v[196:199]
  ds_read_b128 a[136:139], v240 offset:43008
  ds_read_b128 a[140:143], v241 offset:43008
  v_mfma_f32_16x16x32_bf16 v[20:23], a[168:171], v[176:179], v[20:23]
  v_and_b32 v227, 0xffff0000, v221
  v_cvt_pk_bf16_f32 v144, v192, v193
  v_mfma_f32_16x16x32_bf16 v[20:23], a[172:175], v[180:183], v[20:23]
  buffer_load_dwordx4 v246, s[8:11], s40 offen offset:128 nt lds
  v_cvt_pk_bf16_f32 v145, v194, v195
  v_mfma_f32_16x16x32_bf16 v[28:31], a[168:171], v[184:187], v[28:31]
  s_add_u32 m0, s36, 896
  ds_read_b64_tr_b16 a[168:169], v242 offset:9224
  ds_read_b64_tr_b16 a[170:171], v242 offset:11272
  v_mfma_f32_16x16x32_bf16 v[28:31], a[172:175], v[188:191], v[28:31]
  ds_read_b64_tr_b16 a[172:173], v242 offset:13320
  ds_read_b64_tr_b16 a[174:175], v242 offset:15368
  v_mfma_f32_16x16x32_bf16 v[192:195], a[144:147], a[0:3], v[200:203]
  v_lshlrev_b32 v228, 16, v222
  v_and_b32 v229, 0xffff0000, v222
  v_mfma_f32_16x16x32_bf16 v[192:195], a[148:151], a[4:7], v[192:195]
  v_lshlrev_b32 v230, 16, v223
  v_and_b32 v231, 0xffff0000, v223
  v_mfma_f32_16x16x32_bf16 v[192:195], a[152:155], a[8:11], v[192:195]
  v_exp_f32 v196, v196
  v_exp_f32 v197, v197
  v_pk_mul_f32 v[224:225], v[224:225], s[42:43]
  v_pk_mul_f32 v[226:227], v[226:227], s[42:43]
  v_pk_mul_f32 v[228:229], v[228:229], s[42:43]
  v_pk_mul_f32 v[230:231], v[230:231], s[42:43]
  v_mfma_f32_16x16x32_bf16 v[192:195], a[156:159], a[12:15], v[192:195]
  v_exp_f32 v198, v198
  v_mfma_f32_16x16x32_bf16 v[32:35], a[176:179], v[160:163], v[32:35]
  v_exp_f32 v199, v199
  v_mfma_f32_16x16x32_bf16 v[32:35], a[180:183], v[164:167], v[32:35]
  v_cvt_pk_bf16_f32 v152, v196, v197
  v_cvt_pk_bf16_f32 v153, v198, v199
  v_mfma_f32_16x16x32_bf16 v[40:43], a[176:179], v[168:171], v[40:43]
  v_cvt_pk_bf16_f32 v220, v224, v225
  v_cvt_pk_bf16_f32 v221, v226, v227
  v_mfma_f32_16x16x32_bf16 v[40:43], a[180:183], v[172:175], v[40:43]
  v_exp_f32 v192, v192
  v_smfmac_f32_16x16x64_bf16 a[196:199], a[208:211], v[168:175], v248
  v_exp_f32 v193, v193
  v_mfma_f32_16x16x32_bf16 v[196:199], a[144:147], a[16:19], v[204:207]
  v_exp_f32 v194, v194
  v_mfma_f32_16x16x32_bf16 v[196:199], a[148:151], a[20:23], v[196:199]
  v_exp_f32 v195, v195
  v_mfma_f32_16x16x32_bf16 v[196:199], a[152:155], a[24:27], v[196:199]
  buffer_load_dwordx4 v245, s[4:7], s39 offen offset:2176 nt lds
  v_cvt_pk_bf16_f32 v130, v192, v193
  v_mfma_f32_16x16x32_bf16 v[196:199], a[156:159], a[28:31], v[196:199]
  s_add_u32 m0, s37, 57224
  v_cvt_pk_bf16_f32 v131, v194, v195
  v_cvt_pk_bf16_f32 v222, v228, v229
  v_mfma_f32_16x16x32_bf16 v[48:51], a[176:179], v[176:179], v[48:51]
  v_cvt_pk_bf16_f32 v223, v230, v231
  v_accvgpr_write_b32 a108, v220
  v_mfma_f32_16x16x32_bf16 v[48:51], a[180:183], v[180:183], v[48:51]
  s_add_u32 s39, s21, 16384
  v_exp_f32 v196, v196
  v_mfma_f32_16x16x32_bf16 v[56:59], a[176:179], v[184:187], v[56:59]
  v_exp_f32 v197, v197
  v_mfma_f32_16x16x32_bf16 v[56:59], a[180:183], v[188:191], v[56:59]
  v_exp_f32 v198, v198
  v_mfma_f32_16x16x32_bf16 v[192:195], a[144:147], a[32:35], v[208:211]
  s_waitcnt vmcnt(13)
  v_exp_f32 v199, v199
  v_mfma_f32_16x16x32_bf16 v[192:195], a[148:151], a[36:39], v[192:195]
  ds_read_b64_tr_b16 a[176:177], v243 offset:9216
  ds_read_b64_tr_b16 a[178:179], v243 offset:11264
  v_mfma_f32_16x16x32_bf16 v[192:195], a[152:155], a[40:43], v[192:195]
  ds_read_b64_tr_b16 a[180:181], v243 offset:13312
  ds_read_b64_tr_b16 a[182:183], v243 offset:15360
  v_mfma_f32_16x16x32_bf16 v[192:195], a[156:159], a[44:47], v[192:195]
  v_cvt_pk_bf16_f32 v138, v196, v197
  v_cvt_pk_bf16_f32 v139, v198, v199
  v_mfma_f32_16x16x32_bf16 v[36:39], a[184:187], v[160:163], v[36:39]
  buffer_load_dwordx4 v246, s[8:11], s40 offen offset:1152 nt lds
  v_accvgpr_write_b32 a109, v221
  v_mfma_f32_16x16x32_bf16 v[36:39], a[188:191], v[164:167], v[36:39]
  s_add_u32 m0, s36, 16384
  v_accvgpr_write_b32 a110, v222
  v_accvgpr_write_b32 a111, v223
  v_mfma_f32_16x16x32_bf16 v[44:47], a[184:187], v[168:171], v[44:47]
  v_exp_f32 v192, v192
  v_mfma_f32_16x16x32_bf16 v[44:47], a[188:191], v[172:175], v[44:47]
  s_add_u32 s40, s21, 0
  v_exp_f32 v193, v193
  v_smfmac_f32_16x16x64_bf16 a[200:203], a[208:211], v[176:183], v248
  ds_read_b128 v[216:219], v249 offset:4096
  v_cvt_pk_bf16_f32 v146, v192, v193
  v_mfma_f32_16x16x32_bf16 v[196:199], a[144:147], a[48:51], v[212:215]
  v_exp_f32 v194, v194
  v_mfma_f32_16x16x32_bf16 v[196:199], a[148:151], a[52:55], v[196:199]
  v_exp_f32 v195, v195
  v_mfma_f32_16x16x32_bf16 v[196:199], a[152:155], a[56:59], v[196:199]
  ds_read_b128 a[144:147], v240 offset:45056
  ds_read_b128 a[148:151], v241 offset:45056
  v_mfma_f32_16x16x32_bf16 v[196:199], a[156:159], a[60:63], v[196:199]
  ds_read_b128 a[152:155], v240 offset:47104
  ds_read_b128 a[156:159], v241 offset:47104
  v_mfma_f32_16x16x32_bf16 v[52:55], a[184:187], v[176:179], v[52:55]
  v_cvt_pk_bf16_f32 v147, v194, v195
  v_mfma_f32_16x16x32_bf16 v[52:55], a[188:191], v[180:183], v[52:55]
  buffer_load_dwordx4 v245, s[4:7], s39 offen nt lds
  v_mfma_f32_16x16x32_bf16 v[60:63], a[184:187], v[184:187], v[60:63]
  s_add_u32 m0, s37, 0
  v_exp_f32 v196, v196
  v_mfma_f32_16x16x32_bf16 v[60:63], a[188:191], v[188:191], v[60:63]
  s_waitcnt lgkmcnt(4)
  v_exp_f32 v197, v197
  v_mfma_f32_16x16x32_bf16 v[192:195], a[128:131], a[0:3], v[200:203]
  ds_read_b64_tr_b16 a[184:185], v243 offset:9224
  ds_read_b64_tr_b16 a[186:187], v243 offset:11272
  v_mfma_f32_16x16x32_bf16 v[192:195], a[132:135], a[4:7], v[192:195]
  ds_read_b64_tr_b16 a[188:189], v243 offset:13320
  ds_read_b64_tr_b16 a[190:191], v243 offset:15368
  v_mfma_f32_16x16x32_bf16 v[192:195], a[136:139], a[8:11], v[192:195]
  v_lshlrev_b32 v224, 16, v216
  v_and_b32 v225, 0xffff0000, v216
  v_mfma_f32_16x16x32_bf16 v[192:195], a[140:143], a[12:15], v[192:195]
  v_exp_f32 v198, v198
  v_mfma_f32_16x16x32_bf16 v[64:67], a[160:163], v[160:163], v[64:67]
  v_exp_f32 v199, v199
  v_mfma_f32_16x16x32_bf16 v[64:67], a[164:167], v[164:167], v[64:67]
  v_cvt_pk_bf16_f32 v154, v196, v197
  v_cvt_pk_bf16_f32 v155, v198, v199
  v_mfma_f32_16x16x32_bf16 v[72:75], a[160:163], v[168:171], v[72:75]
  v_lshlrev_b32 v226, 16, v217
  v_and_b32 v227, 0xffff0000, v217
  v_mfma_f32_16x16x32_bf16 v[72:75], a[164:167], v[172:175], v[72:75]
  buffer_load_dwordx4 v246, s[8:11], s40 offen nt lds
  v_lshlrev_b32 v228, 16, v218
  v_smfmac_f32_16x16x64_bf16 a[204:207], a[208:211], v[184:191], v248
  s_add_u32 m0, s36, 15360
  v_exp_f32 v192, v192
  v_mfma_f32_16x16x32_bf16 v[196:199], a[128:131], a[16:19], v[204:207]
  v_exp_f32 v193, v193
  v_mfma_f32_16x16x32_bf16 v[196:199], a[132:135], a[20:23], v[196:199]
  v_exp_f32 v194, v194
  v_mfma_f32_16x16x32_bf16 v[196:199], a[136:139], a[24:27], v[196:199]
  v_exp_f32 v195, v195
  v_mfma_f32_16x16x32_bf16 v[196:199], a[140:143], a[28:31], v[196:199]
  v_cvt_pk_bf16_f32 v132, v192, v193
  v_cvt_pk_bf16_f32 v133, v194, v195
  v_mfma_f32_16x16x32_bf16 v[80:83], a[160:163], v[176:179], v[80:83]
  v_and_b32 v229, 0xffff0000, v218
  v_lshlrev_b32 v230, 16, v219
  v_mfma_f32_16x16x32_bf16 v[80:83], a[164:167], v[180:183], v[80:83]
  v_and_b32 v231, 0xffff0000, v219
  v_mfma_f32_16x16x32_bf16 v[88:91], a[160:163], v[184:187], v[88:91]
  v_exp_f32 v196, v196
  v_exp_f32 v197, v197
  v_pk_mul_f32 v[224:225], v[224:225], s[42:43]
  v_pk_mul_f32 v[226:227], v[226:227], s[42:43]
  v_pk_mul_f32 v[228:229], v[228:229], s[42:43]
  v_pk_mul_f32 v[230:231], v[230:231], s[42:43]
  v_mfma_f32_16x16x32_bf16 v[88:91], a[164:167], v[188:191], v[88:91]
  v_exp_f32 v198, v198
  v_mfma_f32_16x16x32_bf16 v[192:195], a[128:131], a[32:35], v[208:211]
  v_exp_f32 v199, v199
  v_mfma_f32_16x16x32_bf16 v[192:195], a[132:135], a[36:39], v[192:195]
  buffer_load_dwordx4 v245, s[4:7], s39 offen offset:2048 nt lds
  v_cvt_pk_bf16_f32 v140, v196, v197
  v_mfma_f32_16x16x32_bf16 v[192:195], a[136:139], a[40:43], v[192:195]
  s_add_u32 m0, s37, 31752
  v_cvt_pk_bf16_f32 v141, v198, v199
  v_cvt_pk_bf16_f32 v216, v224, v225
  v_mfma_f32_16x16x32_bf16 v[192:195], a[140:143], a[44:47], v[192:195]
  s_waitcnt vmcnt(13) lgkmcnt(0)
  v_cvt_pk_bf16_f32 v217, v226, v227
  v_cvt_pk_bf16_f32 v218, v228, v229
  v_mfma_f32_16x16x32_bf16 v[68:71], a[168:171], v[160:163], v[68:71]
  s_barrier
  ds_read_b64_tr_b16 a[160:161], v242 offset:16384
  ds_read_b64_tr_b16 a[162:163], v242 offset:18432
  v_mfma_f32_16x16x32_bf16 v[68:71], a[172:175], v[164:167], v[68:71]
  v_exp_f32 v192, v192
  v_mfma_f32_16x16x32_bf16 v[76:79], a[168:171], v[168:171], v[76:79]
  v_exp_f32 v193, v193
  v_mfma_f32_16x16x32_bf16 v[76:79], a[172:175], v[172:175], v[76:79]
  v_exp_f32 v194, v194
  v_mfma_f32_16x16x32_bf16 v[196:199], a[128:131], a[48:51], v[212:215]
  v_exp_f32 v195, v195
  v_mfma_f32_16x16x32_bf16 v[196:199], a[132:135], a[52:55], v[196:199]
  ds_read_b128 a[128:131], v240 offset:49152
  ds_read_b128 a[132:135], v241 offset:49152
  v_mfma_f32_16x16x32_bf16 v[196:199], a[136:139], a[56:59], v[196:199]
  ds_read_b128 a[136:139], v240 offset:51200
  ds_read_b64_tr_b16 a[164:165], v242 offset:20480
  v_mfma_f32_16x16x32_bf16 v[196:199], a[140:143], a[60:63], v[196:199]
  ds_read_b128 a[140:143], v241 offset:51200
  ds_read_b64_tr_b16 a[166:167], v242 offset:22528
  v_mfma_f32_16x16x32_bf16 v[84:87], a[168:171], v[176:179], v[84:87]
  buffer_load_dwordx4 v246, s[8:11], s40 offen offset:1024 nt lds
  v_cvt_pk_bf16_f32 v148, v192, v193
  v_mfma_f32_16x16x32_bf16 v[84:87], a[172:175], v[180:183], v[84:87]
  s_add_u32 m0, s36, 18304
  v_cvt_pk_bf16_f32 v149, v194, v195
  v_cvt_pk_bf16_f32 v219, v230, v231
  v_mfma_f32_16x16x32_bf16 v[92:95], a[168:171], v[184:187], v[92:95]
  v_exp_f32 v196, v196
  v_mfma_f32_16x16x32_bf16 v[92:95], a[172:175], v[188:191], v[92:95]
  v_exp_f32 v197, v197
  v_mfma_f32_16x16x32_bf16 v[192:195], a[144:147], a[0:3], v[200:203]
  v_exp_f32 v198, v198
  v_mfma_f32_16x16x32_bf16 v[192:195], a[148:151], a[4:7], v[192:195]
  v_exp_f32 v199, v199
  v_mfma_f32_16x16x32_bf16 v[192:195], a[152:155], a[8:11], v[192:195]
  ds_read_b64_tr_b16 a[168:169], v242 offset:16392
  ds_read_b64_tr_b16 a[170:171], v242 offset:18440
  v_mfma_f32_16x16x32_bf16 v[192:195], a[156:159], a[12:15], v[192:195]
  ds_read_b64_tr_b16 a[172:173], v242 offset:20488
  ds_read_b64_tr_b16 a[174:175], v242 offset:22536
  v_mfma_f32_16x16x32_bf16 v[96:99], a[176:179], v[160:163], v[96:99]
  v_cvt_pk_bf16_f32 v156, v196, v197
  v_cvt_pk_bf16_f32 v157, v198, v199
  v_mfma_f32_16x16x32_bf16 v[96:99], a[180:183], v[164:167], v[96:99]
  ds_read_b128 v[220:223], v250 offset:4096
  v_accvgpr_write_b32 a112, v216
  v_mfma_f32_16x16x32_bf16 v[104:107], a[176:179], v[168:171], v[104:107]
  buffer_load_dwordx4 v245, s[4:7], s39 offen offset:128 nt lds
  v_accvgpr_write_b32 a113, v217
  v_mfma_f32_16x16x32_bf16 v[104:107], a[180:183], v[172:175], v[104:107]
  s_add_u32 m0, s37, 896
  v_exp_f32 v192, v192
  v_mfma_f32_16x16x32_bf16 v[196:199], a[144:147], a[16:19], v[204:207]
  v_exp_f32 v193, v193
  v_mfma_f32_16x16x32_bf16 v[196:199], a[148:151], a[20:23], v[196:199]
  v_exp_f32 v194, v194
  v_mfma_f32_16x16x32_bf16 v[196:199], a[152:155], a[24:27], v[196:199]
  v_exp_f32 v195, v195
  v_mfma_f32_16x16x32_bf16 v[196:199], a[156:159], a[28:31], v[196:199]
  v_accvgpr_write_b32 a114, v218
  v_cvt_pk_bf16_f32 v134, v192, v193
  v_mfma_f32_16x16x32_bf16 v[112:115], a[176:179], v[176:179], v[112:115]
  v_cvt_pk_bf16_f32 v135, v194, v195
  v_accvgpr_write_b32 a115, v219
  v_mfma_f32_16x16x32_bf16 v[112:115], a[180:183], v[180:183], v[112:115]
  v_mfma_f32_16x16x32_bf16 v[120:123], a[176:179], v[184:187], v[120:123]
  ds_read_b64_tr_b16 a[176:177], v243 offset:16384
  ds_read_b64_tr_b16 a[178:179], v243 offset:18432
  v_mfma_f32_16x16x32_bf16 v[120:123], a[180:183], v[188:191], v[120:123]
  ds_read_b64_tr_b16 a[180:181], v243 offset:20480
  ds_read_b64_tr_b16 a[182:183], v243 offset:22528
  v_mfma_f32_16x16x32_bf16 v[192:195], a[144:147], a[32:35], v[208:211]
  s_waitcnt lgkmcnt(4)
  buffer_load_dwordx4 v246, s[8:11], s40 offen offset:128 nt lds
  v_lshlrev_b32 v224, 16, v220
  v_mfma_f32_16x16x32_bf16 v[192:195], a[148:151], a[36:39], v[192:195]
  s_add_u32 m0, s36, 17280
  v_and_b32 v225, 0xffff0000, v220
  v_lshlrev_b32 v226, 16, v221
  v_mfma_f32_16x16x32_bf16 v[192:195], a[152:155], a[40:43], v[192:195]
  v_exp_f32 v196, v196
  v_mfma_f32_16x16x32_bf16 v[192:195], a[156:159], a[44:47], v[192:195]
  v_exp_f32 v197, v197
  v_mfma_f32_16x16x32_bf16 v[100:103], a[184:187], v[160:163], v[100:103]
  v_exp_f32 v198, v198
  v_mfma_f32_16x16x32_bf16 v[100:103], a[188:191], v[164:167], v[100:103]
  v_exp_f32 v199, v199
  v_mfma_f32_16x16x32_bf16 v[108:111], a[184:187], v[168:171], v[108:111]
  v_cvt_pk_bf16_f32 v142, v196, v197
  v_cvt_pk_bf16_f32 v143, v198, v199
  v_mfma_f32_16x16x32_bf16 v[108:111], a[188:191], v[172:175], v[108:111]
  v_and_b32 v227, 0xffff0000, v221
  v_lshlrev_b32 v228, 16, v222
  v_mfma_f32_16x16x32_bf16 v[196:199], a[144:147], a[48:51], v[212:215]
  v_exp_f32 v192, v192
  v_mfma_f32_16x16x32_bf16 v[196:199], a[148:151], a[52:55], v[196:199]
  v_exp_f32 v193, v193
  v_mfma_f32_16x16x32_bf16 v[196:199], a[152:155], a[56:59], v[196:199]
  v_exp_f32 v194, v194
  v_mfma_f32_16x16x32_bf16 v[196:199], a[156:159], a[60:63], v[196:199]
  v_exp_f32 v195, v195
  v_mfma_f32_16x16x32_bf16 v[116:119], a[184:187], v[176:179], v[116:119]
  ds_read_b128 a[144:147], v240 offset:53248
  ds_read_b128 a[148:151], v241 offset:53248
  v_mfma_f32_16x16x32_bf16 v[116:119], a[188:191], v[180:183], v[116:119]
  ds_read_b128 a[152:155], v240 offset:55296
  ds_read_b128 a[156:159], v241 offset:55296
  v_mfma_f32_16x16x32_bf16 v[124:127], a[184:187], v[184:187], v[124:127]
  ds_read_b64_tr_b16 a[184:185], v243 offset:16392
  ds_read_b64_tr_b16 a[186:187], v243 offset:18440
  v_mfma_f32_16x16x32_bf16 v[124:127], a[188:191], v[188:191], v[124:127]
  ds_read_b64_tr_b16 a[188:189], v243 offset:20488
  ds_read_b64_tr_b16 a[190:191], v243 offset:22536
  v_cvt_pk_bf16_f32 v150, v192, v193
  v_cvt_pk_bf16_f32 v151, v194, v195
  v_mfma_f32_16x16x32_bf16 v[192:195], a[128:131], a[0:3], v[200:203]
  buffer_load_dwordx4 v245, s[4:7], s39 offen offset:2176 nt lds
  v_and_b32 v229, 0xffff0000, v222
  v_mfma_f32_16x16x32_bf16 v[192:195], a[132:135], a[4:7], v[192:195]
  s_add_u32 m0, s37, 32648
  v_lshlrev_b32 v230, 16, v223
  v_and_b32 v231, 0xffff0000, v223
  v_mfma_f32_16x16x32_bf16 v[192:195], a[136:139], a[8:11], v[192:195]
  v_exp_f32 v196, v196
  v_exp_f32 v197, v197
  v_pk_mul_f32 v[224:225], v[224:225], s[42:43]
  v_pk_mul_f32 v[226:227], v[226:227], s[42:43]
  v_pk_mul_f32 v[228:229], v[228:229], s[42:43]
  v_pk_mul_f32 v[230:231], v[230:231], s[42:43]
  v_mfma_f32_16x16x32_bf16 v[192:195], a[140:143], a[12:15], v[192:195]
  s_add_u32 s39, s21, 32768
  v_exp_f32 v198, v198
  v_mfma_f32_16x16x32_bf16 v[0:3], a[160:163], v[128:131], v[0:3]
  v_exp_f32 v199, v199
  v_mfma_f32_16x16x32_bf16 v[0:3], a[164:167], v[132:135], v[0:3]
  v_cvt_pk_bf16_f32 v158, v196, v197
  v_cvt_pk_bf16_f32 v159, v198, v199
  v_mfma_f32_16x16x32_bf16 v[8:11], a[160:163], v[136:139], v[8:11]
  v_exp_f32 v192, v192
  v_mfma_f32_16x16x32_bf16 v[8:11], a[164:167], v[140:143], v[8:11]
  v_exp_f32 v193, v193
  v_mfma_f32_16x16x32_bf16 v[196:199], a[128:131], a[16:19], v[204:207]
  v_exp_f32 v194, v194
  v_mfma_f32_16x16x32_bf16 v[196:199], a[132:135], a[20:23], v[196:199]
  v_exp_f32 v195, v195
  v_mfma_f32_16x16x32_bf16 v[196:199], a[136:139], a[24:27], v[196:199]
  buffer_load_dwordx4 v246, s[8:11], s40 offen offset:1152 nt lds
  v_cvt_pk_bf16_f32 v160, v192, v193
  v_mfma_f32_16x16x32_bf16 v[196:199], a[140:143], a[28:31], v[196:199]
  s_add_u32 m0, s36, 32768
  v_cvt_pk_bf16_f32 v161, v194, v195
  v_cvt_pk_bf16_f32 v220, v224, v225
  v_mfma_f32_16x16x32_bf16 v[16:19], a[160:163], v[144:147], v[16:19]
  v_cvt_pk_bf16_f32 v221, v226, v227
  v_cvt_pk_bf16_f32 v222, v228, v229
  v_mfma_f32_16x16x32_bf16 v[16:19], a[164:167], v[148:151], v[16:19]
  s_waitcnt vmcnt(14)
  v_exp_f32 v196, v196
  v_mfma_f32_16x16x32_bf16 v[24:27], a[160:163], v[152:155], v[24:27]
  v_exp_f32 v197, v197
  v_mfma_f32_16x16x32_bf16 v[24:27], a[164:167], v[156:159], v[24:27]
  s_add_u32 s40, s21, 16384
  v_exp_f32 v198, v198
  v_mfma_f32_16x16x32_bf16 v[192:195], a[128:131], a[32:35], v[208:211]
  v_exp_f32 v199, v199
  v_mfma_f32_16x16x32_bf16 v[192:195], a[132:135], a[36:39], v[192:195]
  ds_read_b64_tr_b16 a[160:161], v242 offset:17408
  ds_read_b64_tr_b16 a[162:163], v242 offset:19456
  v_mfma_f32_16x16x32_bf16 v[192:195], a[136:139], a[40:43], v[192:195]
  ds_read_b64_tr_b16 a[164:165], v242 offset:21504
  ds_read_b64_tr_b16 a[166:167], v242 offset:23552
  v_mfma_f32_16x16x32_bf16 v[192:195], a[140:143], a[44:47], v[192:195]
L_stub5:
  s_cmp_eq_u32 s99, 1
  s_cbranch_scc1 L_ret1
  v_cvt_pk_bf16_f32 v223, v230, v231
  v_cvt_pk_bf16_f32 v168, v196, v197
  v_mfma_f32_16x16x32_bf16 v[4:7], a[168:171], v[128:131], v[4:7]
  buffer_load_dwordx4 v245, s[4:7], s39 offen nt lds
  v_cvt_pk_bf16_f32 v169, v198, v199
  v_mfma_f32_16x16x32_bf16 v[4:7], a[172:175], v[132:135], v[4:7]
  s_add_u32 m0, s37, 8192
  ds_read_b128 v[216:219], v249 offset:0
  v_accvgpr_write_b32 a116, v220
  v_mfma_f32_16x16x32_bf16 v[12:15], a[168:171], v[136:139], v[12:15]
  v_accvgpr_write_b32 a117, v221
  v_accvgpr_write_b32 a118, v222
  v_mfma_f32_16x16x32_bf16 v[12:15], a[172:175], v[140:143], v[12:15]
  v_exp_f32 v192, v192
  v_smfmac_f32_16x16x64_bf16 a[192:195], a[208:211], v[128:135], v248
  v_exp_f32 v193, v193
  v_mfma_f32_16x16x32_bf16 v[196:199], a[128:131], a[48:51], v[212:215]
  v_exp_f32 v194, v194
  v_mfma_f32_16x16x32_bf16 v[196:199], a[132:135], a[52:55], v[196:199]
  v_exp_f32 v195, v195
  v_mfma_f32_16x16x32_bf16 v[196:199], a[136:139], a[56:59], v[196:199]
  ds_read_b128 a[128:131], v240 offset:57344
  ds_read_b128 a[132:135], v241 offset:57344
  v_mfma_f32_16x16x32_bf16 v[196:199], a[140:143], a[60:63], v[196:199]
  ds_read_b128 a[136:139], v240 offset:59392
  ds_read_b128 a[140:143], v241 offset:59392
  v_mfma_f32_16x16x32_bf16 v[20:23], a[168:171], v[144:147], v[20:23]
  v_cvt_pk_bf16_f32 v176, v192, v193
  v_cvt_pk_bf16_f32 v177, v194, v195
  v_mfma_f32_16x16x32_bf16 v[20:23], a[172:175], v[148:151], v[20:23]
  buffer_load_dwordx4 v246, s[8:11], s40 offen nt lds
  v_accvgpr_write_b32 a119, v223
  v_mfma_f32_16x16x32_bf16 v[28:31], a[168:171], v[152:155], v[28:31]
  s_add_u32 m0, s36, 31744
  ds_read_b64_tr_b16 a[168:169], v242 offset:17416
  ds_read_b64_tr_b16 a[170:171], v242 offset:19464
  v_mfma_f32_16x16x32_bf16 v[28:31], a[172:175], v[156:159], v[28:31]
  s_waitcnt lgkmcnt(6)
  ds_read_b64_tr_b16 a[172:173], v242 offset:21512
  ds_read_b64_tr_b16 a[174:175], v242 offset:23560
  v_mfma_f32_16x16x32_bf16 v[192:195], a[144:147], a[0:3], v[200:203]
  v_lshlrev_b32 v224, 16, v216
  v_and_b32 v225, 0xffff0000, v216
  v_mfma_f32_16x16x32_bf16 v[192:195], a[148:151], a[4:7], v[192:195]
  v_exp_f32 v196, v196
  v_mfma_f32_16x16x32_bf16 v[192:195], a[152:155], a[8:11], v[192:195]
  v_exp_f32 v197, v197
  v_mfma_f32_16x16x32_bf16 v[192:195], a[156:159], a[12:15], v[192:195]
  v_exp_f32 v198, v198
  v_mfma_f32_16x16x32_bf16 v[32:35], a[176:179], v[128:131], v[32:35]
  v_exp_f32 v199, v199
  v_mfma_f32_16x16x32_bf16 v[32:35], a[180:183], v[132:135], v[32:35]
  v_lshlrev_b32 v226, 16, v217
  v_cvt_pk_bf16_f32 v184, v196, v197
  v_mfma_f32_16x16x32_bf16 v[40:43], a[176:179], v[136:139], v[40:43]
  v_cvt_pk_bf16_f32 v185, v198, v199
  v_and_b32 v227, 0xffff0000, v217
  v_mfma_f32_16x16x32_bf16 v[40:43], a[180:183], v[140:143], v[40:43]
  buffer_load_dwordx4 v245, s[4:7], s39 offen offset:2048 nt lds
  v_lshlrev_b32 v228, 16, v218
  v_smfmac_f32_16x16x64_bf16 a[196:199], a[208:211], v[136:143], v248
  s_add_u32 m0, s37, 39944
  v_and_b32 v229, 0xffff0000, v218
  v_lshlrev_b32 v230, 16, v219
  v_mfma_f32_16x16x32_bf16 v[196:199], a[144:147], a[16:19], v[204:207]
  v_exp_f32 v192, v192
  v_mfma_f32_16x16x32_bf16 v[196:199], a[148:151], a[20:23], v[196:199]
  v_exp_f32 v193, v193
  v_mfma_f32_16x16x32_bf16 v[196:199], a[152:155], a[24:27], v[196:199]
  v_exp_f32 v194, v194
  v_mfma_f32_16x16x32_bf16 v[196:199], a[156:159], a[28:31], v[196:199]
  v_exp_f32 v195, v195
  v_mfma_f32_16x16x32_bf16 v[48:51], a[176:179], v[144:147], v[48:51]
  v_cvt_pk_bf16_f32 v162, v192, v193
  v_cvt_pk_bf16_f32 v163, v194, v195
  v_mfma_f32_16x16x32_bf16 v[48:51], a[180:183], v[148:151], v[48:51]
  v_and_b32 v231, 0xffff0000, v219
  v_mfma_f32_16x16x32_bf16 v[56:59], a[176:179], v[152:155], v[56:59]
  ds_read_b64_tr_b16 a[176:177], v243 offset:17408
  ds_read_b64_tr_b16 a[178:179], v243 offset:19456
  v_mfma_f32_16x16x32_bf16 v[56:59], a[180:183], v[156:159], v[56:59]
  v_exp_f32 v196, v196
  v_exp_f32 v197, v197
  v_pk_mul_f32 v[224:225], v[224:225], s[42:43]
  v_pk_mul_f32 v[226:227], v[226:227], s[42:43]
  v_pk_mul_f32 v[228:229], v[228:229], s[42:43]
  v_pk_mul_f32 v[230:231], v[230:231], s[42:43]
  v_mfma_f32_16x16x32_bf16 v[192:195], a[144:147], a[32:35], v[208:211]
  v_exp_f32 v198, v198
  v_mfma_f32_16x16x32_bf16 v[192:195], a[148:151], a[36:39], v[192:195]
  v_exp_f32 v199, v199
  v_mfma_f32_16x16x32_bf16 v[192:195], a[152:155], a[40:43], v[192:195]
  ds_read_b64_tr_b16 a[180:181], v243 offset:21504
  ds_read_b64_tr_b16 a[182:183], v243 offset:23552
  v_mfma_f32_16x16x32_bf16 v[192:195], a[156:159], a[44:47], v[192:195]
  buffer_load_dwordx4 v246, s[8:11], s40 offen offset:1024 nt lds
  v_cvt_pk_bf16_f32 v170, v196, v197
  v_mfma_f32_16x16x32_bf16 v[36:39], a[184:187], v[128:131], v[36:39]
  s_add_u32 m0, s36, 34688
  v_cvt_pk_bf16_f32 v171, v198, v199
  v_cvt_pk_bf16_f32 v216, v224, v225
  v_mfma_f32_16x16x32_bf16 v[36:39], a[188:191], v[132:135], v[36:39]
  v_cvt_pk_bf16_f32 v217, v226, v227
  v_cvt_pk_bf16_f32 v218, v228, v229
  v_mfma_f32_16x16x32_bf16 v[44:47], a[184:187], v[136:139], v[44:47]
  v_exp_f32 v192, v192
  v_mfma_f32_16x16x32_bf16 v[44:47], a[188:191], v[140:143], v[44:47]
  v_exp_f32 v193, v193
  v_smfmac_f32_16x16x64_bf16 a[200:203], a[208:211], v[144:151], v248
  v_exp_f32 v194, v194
  v_mfma_f32_16x16x32_bf16 v[196:199], a[144:147], a[48:51], v[212:215]
  v_exp_f32 v195, v195
  v_mfma_f32_16x16x32_bf16 v[196:199], a[148:151], a[52:55], v[196:199]
  ds_read_b128 a[144:147], v240 offset:61440
  ds_read_b128 a[148:151], v241 offset:61440
  v_mfma_f32_16x16x32_bf16 v[196:199], a[152:155], a[56:59], v[196:199]
  ds_read_b128 a[152:155], v240 offset:63488
  v_cvt_pk_bf16_f32 v178, v192, v193
  v_mfma_f32_16x16x32_bf16 v[196:199], a[156:159], a[60:63], v[196:199]
  ds_read_b128 a[156:159], v241 offset:63488
  v_cvt_pk_bf16_f32 v179, v194, v195
  v_mfma_f32_16x16x32_bf16 v[52:55], a[184:187], v[144:147], v[52:55]
  buffer_load_dwordx4 v245, s[4:7], s39 offen offset:128 nt lds
  v_cvt_pk_bf16_f32 v219, v230, v231
  v_mfma_f32_16x16x32_bf16 v[52:55], a[188:191], v[148:151], v[52:55]
  s_add_u32 m0, s37, 9088
  v_accvgpr_write_b32 a120, v216
  v_accvgpr_write_b32 a121, v217
  v_mfma_f32_16x16x32_bf16 v[60:63], a[184:187], v[152:155], v[60:63]
  v_exp_f32 v196, v196
  v_mfma_f32_16x16x32_bf16 v[60:63], a[188:191], v[156:159], v[60:63]
  s_waitcnt lgkmcnt(4)
  v_exp_f32 v197, v197
  v_mfma_f32_16x16x32_bf16 v[192:195], a[128:131], a[0:3], v[200:203]
  v_exp_f32 v198, v198
  v_mfma_f32_16x16x32_bf16 v[192:195], a[132:135], a[4:7], v[192:195]
  ds_read_b128 v[220:223], v250 offset:0
  ds_read_b64_tr_b16 a[184:185], v243 offset:17416
  v_mfma_f32_16x16x32_bf16 v[192:195], a[136:139], a[8:11], v[192:195]
  v_exp_f32 v199, v199
  v_mfma_f32_16x16x32_bf16 v[192:195], a[140:143], a[12:15], v[192:195]
  ds_read_b64_tr_b16 a[186:187], v243 offset:19464
  ds_read_b64_tr_b16 a[188:189], v243 offset:21512
  v_mfma_f32_16x16x32_bf16 v[64:67], a[160:163], v[128:131], v[64:67]
  ds_read_b64_tr_b16 a[190:191], v243 offset:23560
  v_cvt_pk_bf16_f32 v186, v196, v197
  v_mfma_f32_16x16x32_bf16 v[64:67], a[164:167], v[132:135], v[64:67]
  v_cvt_pk_bf16_f32 v187, v198, v199
  v_accvgpr_write_b32 a122, v218
  v_mfma_f32_16x16x32_bf16 v[72:75], a[160:163], v[136:139], v[72:75]
  buffer_load_dwordx4 v246, s[8:11], s40 offen offset:128 nt lds
  v_accvgpr_write_b32 a123, v219
  v_mfma_f32_16x16x32_bf16 v[72:75], a[164:167], v[140:143], v[72:75]
  s_add_u32 m0, s36, 33664
  v_exp_f32 v192, v192
  v_smfmac_f32_16x16x64_bf16 a[204:207], a[208:211], v[152:159], v248
  v_exp_f32 v193, v193
  v_mfma_f32_16x16x32_bf16 v[196:199], a[128:131], a[16:19], v[204:207]
  v_exp_f32 v194, v194
  v_mfma_f32_16x16x32_bf16 v[196:199], a[132:135], a[20:23], v[196:199]
  v_exp_f32 v195, v195
  v_mfma_f32_16x16x32_bf16 v[196:199], a[136:139], a[24:27], v[196:199]
  s_waitcnt lgkmcnt(0)
  v_lshlrev_b32 v224, 16, v220
  v_cvt_pk_bf16_f32 v164, v192, v193
  v_mfma_f32_16x16x32_bf16 v[196:199], a[140:143], a[28:31], v[196:199]
  v_cvt_pk_bf16_f32 v165, v194, v195
  v_and_b32 v225, 0xffff0000, v220
  v_mfma_f32_16x16x32_bf16 v[80:83], a[160:163], v[144:147], v[80:83]
  v_lshlrev_b32 v226, 16, v221
  v_and_b32 v227, 0xffff0000, v221
  v_mfma_f32_16x16x32_bf16 v[80:83], a[164:167], v[148:151], v[80:83]
  v_lshlrev_b32 v228, 16, v222
  v_and_b32 v229, 0xffff0000, v222
  v_mfma_f32_16x16x32_bf16 v[88:91], a[160:163], v[152:155], v[88:91]
  v_exp_f32 v196, v196
  v_mfma_f32_16x16x32_bf16 v[88:91], a[164:167], v[156:159], v[88:91]
  v_exp_f32 v197, v197
  v_mfma_f32_16x16x32_bf16 v[192:195], a[128:131], a[32:35], v[208:211]
  v_exp_f32 v198, v198
  v_mfma_f32_16x16x32_bf16 v[192:195], a[132:135], a[36:39], v[192:195]
  v_exp_f32 v199, v199
  v_mfma_f32_16x16x32_bf16 v[192:195], a[136:139], a[40:43], v[192:195]
  buffer_load_dwordx4 v245, s[4:7], s39 offen offset:2176 nt lds
  v_cvt_pk_bf16_f32 v172, v196, v197
  v_mfma_f32_16x16x32_bf16 v[192:195], a[140:143], a[44:47], v[192:195]
  s_waitcnt vmcnt(15)
  v_cvt_pk_bf16_f32 v173, v198, v199
  v_lshlrev_b32 v230, 16, v223
  v_mfma_f32_16x16x32_bf16 v[68:71], a[168:171], v[128:131], v[68:71]
  s_barrier
  ds_read_b64_tr_b16 a[160:161], v242 offset:24576
  ds_read_b64_tr_b16 a[162:163], v242 offset:26624
  v_mfma_f32_16x16x32_bf16 v[68:71], a[172:175], v[132:135], v[68:71]
  s_add_u32 m0, s37, 40840
  v_exp_f32 v192, v192
  v_mfma_f32_16x16x32_bf16 v[76:79], a[168:171], v[136:139], v[76:79]
  v_exp_f32 v193, v193
  v_mfma_f32_16x16x32_bf16 v[76:79], a[172:175], v[140:143], v[76:79]
  s_add_u32 s39, s21, 49152
  v_exp_f32 v194, v194
  v_mfma_f32_16x16x32_bf16 v[196:199], a[128:131], a[48:51], v[212:215]
  v_exp_f32 v195, v195
  v_mfma_f32_16x16x32_bf16 v[196:199], a[132:135], a[52:55], v[196:199]
  ds_read_b128 a[128:131], v240 offset:0
  ds_read_b128 a[132:135], v241 offset:0
  v_mfma_f32_16x16x32_bf16 v[196:199], a[136:139], a[56:59], v[196:199]
  ds_read_b128 a[136:139], v240 offset:2048
  ds_read_b64_tr_b16 a[164:165], v242 offset:28672
  v_mfma_f32_16x16x32_bf16 v[196:199], a[140:143], a[60:63], v[196:199]
  ds_read_b128 a[140:143], v241 offset:2048
  ds_read_b64_tr_b16 a[166:167], v242 offset:30720
  v_mfma_f32_16x16x32_bf16 v[84:87], a[168:171], v[144:147], v[84:87]
  buffer_load_dwordx4 v246, s[8:11], s40 offen offset:1152 nt lds
  v_cvt_pk_bf16_f32 v180, v192, v193
  v_mfma_f32_16x16x32_bf16 v[84:87], a[172:175], v[148:151], v[84:87]
  s_add_u32 m0, s38, 2048
  v_cvt_pk_bf16_f32 v181, v194, v195
  v_and_b32 v231, 0xffff0000, v223
  v_mfma_f32_16x16x32_bf16 v[92:95], a[168:171], v[152:155], v[92:95]
  v_exp_f32 v196, v196
  v_exp_f32 v197, v197
  v_pk_mul_f32 v[224:225], v[224:225], s[42:43]
  v_pk_mul_f32 v[226:227], v[226:227], s[42:43]
  v_pk_mul_f32 v[228:229], v[228:229], s[42:43]
  v_pk_mul_f32 v[230:231], v[230:231], s[42:43]
  v_mfma_f32_16x16x32_bf16 v[92:95], a[172:175], v[156:159], v[92:95]
  s_add_u32 s40, s21, 32768
  v_exp_f32 v198, v198
  v_mfma_f32_16x16x32_bf16 v[192:195], a[144:147], a[0:3], v[200:203]
  v_exp_f32 v199, v199
  v_mfma_f32_16x16x32_bf16 v[192:195], a[148:151], a[4:7], v[192:195]
  ds_read_b64_tr_b16 a[168:169], v242 offset:24584
  ds_read_b64_tr_b16 a[170:171], v242 offset:26632
  v_mfma_f32_16x16x32_bf16 v[192:195], a[152:155], a[8:11], v[192:195]
  ds_read_b64_tr_b16 a[172:173], v242 offset:28680
  ds_read_b64_tr_b16 a[174:175], v242 offset:30728
  v_mfma_f32_16x16x32_bf16 v[192:195], a[156:159], a[12:15], v[192:195]
  v_cvt_pk_bf16_f32 v188, v196, v197
  v_cvt_pk_bf16_f32 v189, v198, v199
  v_mfma_f32_16x16x32_bf16 v[96:99], a[176:179], v[128:131], v[96:99]
  v_cvt_pk_bf16_f32 v220, v224, v225
  v_cvt_pk_bf16_f32 v221, v226, v227
  v_mfma_f32_16x16x32_bf16 v[96:99], a[180:183], v[132:135], v[96:99]
  v_cvt_pk_bf16_f32 v222, v228, v229
  v_cvt_pk_bf16_f32 v223, v230, v231
  v_mfma_f32_16x16x32_bf16 v[104:107], a[176:179], v[136:139], v[104:107]
  v_exp_f32 v192, v192
  v_mfma_f32_16x16x32_bf16 v[104:107], a[180:183], v[140:143], v[104:107]
  v_exp_f32 v193, v193
  v_mfma_f32_16x16x32_bf16 v[196:199], a[144:147], a[16:19], v[204:207]
  v_exp_f32 v194, v194
  v_mfma_f32_16x16x32_bf16 v[196:199], a[148:151], a[20:23], v[196:199]
  v_exp_f32 v195, v195
  v_mfma_f32_16x16x32_bf16 v[196:199], a[152:155], a[24:27], v[196:199]
  buffer_load_dwordx4 v245, s[12:15], s32 offen nt lds
  v_cvt_pk_bf16_f32 v166, v192, v193
  v_mfma_f32_16x16x32_bf16 v[196:199], a[156:159], a[28:31], v[196:199]
  s_add_u32 m0, s38, 1024
  v_cvt_pk_bf16_f32 v167, v194, v195
  v_accvgpr_write_b32 a124, v220
  v_mfma_f32_16x16x32_bf16 v[112:115], a[176:179], v[144:147], v[112:115]
  v_accvgpr_write_b32 a125, v221
  v_accvgpr_write_b32 a126, v222
  v_mfma_f32_16x16x32_bf16 v[112:115], a[180:183], v[148:151], v[112:115]
  v_accvgpr_write_b32 a127, v223
  v_mfma_f32_16x16x32_bf16 v[120:123], a[176:179], v[152:155], v[120:123]
  v_exp_f32 v196, v196
  v_mfma_f32_16x16x32_bf16 v[120:123], a[180:183], v[156:159], v[120:123]
  v_exp_f32 v197, v197
  v_mfma_f32_16x16x32_bf16 v[192:195], a[144:147], a[32:35], v[208:211]
  v_exp_f32 v198, v198
  v_mfma_f32_16x16x32_bf16 v[192:195], a[148:151], a[36:39], v[192:195]
  v_exp_f32 v199, v199
  v_mfma_f32_16x16x32_bf16 v[192:195], a[152:155], a[40:43], v[192:195]
  ds_read_b64_tr_b16 a[176:177], v243 offset:24576
  ds_read_b64_tr_b16 a[178:179], v243 offset:26624
  v_mfma_f32_16x16x32_bf16 v[192:195], a[156:159], a[44:47], v[192:195]
  ds_read_b64_tr_b16 a[180:181], v243 offset:28672
  ds_read_b64_tr_b16 a[182:183], v243 offset:30720
  v_mfma_f32_16x16x32_bf16 v[100:103], a[184:187], v[128:131], v[100:103]
  buffer_load_dwordx4 v245, s[12:15], s32 offen offset:2048 nt lds
  v_cvt_pk_bf16_f32 v174, v196, v197
  v_mfma_f32_16x16x32_bf16 v[100:103], a[188:191], v[132:135], v[100:103]
  s_add_u32 m0, s36, 49152
  v_cvt_pk_bf16_f32 v175, v198, v199
  v_mfma_f32_16x16x32_bf16 v[108:111], a[184:187], v[136:139], v[108:111]
  v_exp_f32 v192, v192
  v_mfma_f32_16x16x32_bf16 v[108:111], a[188:191], v[140:143], v[108:111]
  v_exp_f32 v193, v193
  v_mfma_f32_16x16x32_bf16 v[196:199], a[144:147], a[48:51], v[212:215]
  v_exp_f32 v194, v194
  v_mfma_f32_16x16x32_bf16 v[196:199], a[148:151], a[52:55], v[196:199]
  v_exp_f32 v195, v195
  v_mfma_f32_16x16x32_bf16 v[196:199], a[152:155], a[56:59], v[196:199]
  ds_read_b128 a[144:147], v240 offset:4096
  ds_read_b128 a[148:151], v241 offset:4096
  v_mfma_f32_16x16x32_bf16 v[196:199], a[156:159], a[60:63], v[196:199]
  ds_read_b128 a[152:155], v240 offset:6144
  ds_read_b128 a[156:159], v241 offset:6144
  v_mfma_f32_16x16x32_bf16 v[116:119], a[184:187], v[144:147], v[116:119]
  v_cvt_pk_bf16_f32 v182, v192, v193
  v_cvt_pk_bf16_f32 v183, v194, v195
  v_mfma_f32_16x16x32_bf16 v[116:119], a[188:191], v[148:151], v[116:119]
  v_mfma_f32_16x16x32_bf16 v[124:127], a[184:187], v[152:155], v[124:127]
  ds_read_b64_tr_b16 a[184:185], v243 offset:24584
  ds_read_b64_tr_b16 a[186:187], v243 offset:26632
  v_mfma_f32_16x16x32_bf16 v[124:127], a[188:191], v[156:159], v[124:127]
  s_waitcnt lgkmcnt(6)
  v_exp_f32 v196, v196
  v_mfma_f32_16x16x32_bf16 v[132:135], a[128:131], a[64:67], 0
  v_exp_f32 v197, v197
  v_mfma_f32_16x16x32_bf16 v[132:135], a[132:135], a[68:71], v[132:135]
  v_exp_f32 v198, v198
  v_mfma_f32_16x16x32_bf16 v[132:135], a[136:139], a[72:75], v[132:135]
  v_exp_f32 v199, v199
  v_mfma_f32_16x16x32_bf16 v[132:135], a[140:143], a[76:79], v[132:135]
  ds_read_b64_tr_b16 a[188:189], v243 offset:28680
  ds_read_b64_tr_b16 a[190:191], v243 offset:30728
  v_mfma_f32_16x16x32_bf16 v[0:3], a[160:163], v[160:163], v[0:3]
  buffer_load_dwordx4 v245, s[4:7], s39 offen nt lds
  v_cvt_pk_bf16_f32 v190, v196, v197
  v_mfma_f32_16x16x32_bf16 v[0:3], a[164:167], v[164:167], v[0:3]
  s_add_u32 m0, s37, 16384
  v_cvt_pk_bf16_f32 v191, v198, v199
  v_max3_f32 v224, v132, v133, v134
  v_mfma_f32_16x16x32_bf16 v[8:11], a[160:163], v[168:171], v[8:11]
  v_max_f32 v224, v224, v135
  v_mov_b32 v225, v224
  v_mfma_f32_16x16x32_bf16 v[8:11], a[164:167], v[172:175], v[8:11]
  v_mfma_f32_16x16x32_bf16 v[140:143], a[128:131], a[80:83], 0
  v_permlane32_swap_b32 v224, v225
  v_max_f32 v224, v224, v225
  v_mfma_f32_16x16x32_bf16 v[140:143], a[132:135], a[84:87], v[140:143]
  v_mov_b32 v225, v224
  v_mfma_f32_16x16x32_bf16 v[140:143], a[136:139], a[88:91], v[140:143]
  v_mfma_f32_16x16x32_bf16 v[140:143], a[140:143], a[92:95], v[140:143]
  v_permlane16_swap_b32 v224, v225
  v_min_f32_e64 v200, -v224, -v225
  v_mfma_f32_16x16x32_bf16 v[16:19], a[160:163], v[176:179], v[16:19]
  v_min_f32_e64 v201, -v224, -v225
  v_min_f32_e64 v202, -v224, -v225
  v_mfma_f32_16x16x32_bf16 v[16:19], a[164:167], v[180:183], v[16:19]
  v_min_f32_e64 v203, -v224, -v225
  v_add_f32 v132, v200, v132
  v_mfma_f32_16x16x32_bf16 v[24:27], a[160:163], v[184:187], v[24:27]
  ds_read_b64_tr_b16 a[160:161], v242 offset:25600
  ds_read_b64_tr_b16 a[162:163], v242 offset:27648
  v_mfma_f32_16x16x32_bf16 v[24:27], a[164:167], v[188:191], v[24:27]
  ds_read_b64_tr_b16 a[164:165], v242 offset:29696
  ds_read_b64_tr_b16 a[166:167], v242 offset:31744
  v_smfmac_f32_16x16x64_bf16 a[192:195], a[208:211], v[160:167], v248
  buffer_load_dwordx4 v246, s[8:11], s40 offen nt lds
  v_max3_f32 v224, v140, v141, v142
  v_smfmac_f32_16x16x64_bf16 a[196:199], a[208:211], v[168:175], v248
  s_add_u32 m0, s36, 48128
  v_max_f32 v224, v224, v143
  v_mov_b32 v225, v224
  v_mfma_f32_16x16x32_bf16 v[148:151], a[128:131], a[96:99], 0
  v_add_f32 v133, v200, v133
  v_permlane32_swap_b32 v224, v225
  v_mfma_f32_16x16x32_bf16 v[148:151], a[132:135], a[100:103], v[148:151]
  v_max_f32 v224, v224, v225
  v_mov_b32 v225, v224
  v_mfma_f32_16x16x32_bf16 v[148:151], a[136:139], a[104:107], v[148:151]
  v_exp_f32 v132, v132
  v_mfma_f32_16x16x32_bf16 v[148:151], a[140:143], a[108:111], v[148:151]
  v_permlane16_swap_b32 v224, v225
  v_min_f32_e64 v204, -v224, -v225
  v_mfma_f32_16x16x32_bf16 v[4:7], a[168:171], v[160:163], v[4:7]
  v_min_f32_e64 v205, -v224, -v225
  v_min_f32_e64 v206, -v224, -v225
  v_mfma_f32_16x16x32_bf16 v[4:7], a[172:175], v[164:167], v[4:7]
  v_min_f32_e64 v207, -v224, -v225
  v_accvgpr_read_b32 v226, a192
  v_mfma_f32_16x16x32_bf16 v[12:15], a[168:171], v[168:171], v[12:15]
  v_max3_f32 v224, v148, v149, v150
  v_max_f32 v224, v224, v151
  v_mfma_f32_16x16x32_bf16 v[12:15], a[172:175], v[172:175], v[12:15]
  v_mov_b32 v225, v224
  v_accvgpr_read_b32 v227, a193
  v_smfmac_f32_16x16x64_bf16 a[200:203], a[208:211], v[176:183], v248
  buffer_load_dwordx4 v245, s[4:7], s39 offen offset:2048 nt lds
  v_permlane32_swap_b32 v224, v225
  v_smfmac_f32_16x16x64_bf16 a[204:207], a[208:211], v[184:191], v248
  s_add_u32 m0, s37, 48136
  v_max_f32 v224, v224, v225
  v_mov_b32 v225, v224
  v_mfma_f32_16x16x32_bf16 v[156:159], a[128:131], a[112:115], 0
  ds_read_b128 a[128:131], v240 offset:8192
  v_permlane16_swap_b32 v224, v225
  v_mfma_f32_16x16x32_bf16 v[156:159], a[132:135], a[116:119], v[156:159]
  ds_read_b128 a[132:135], v241 offset:8192
  v_min3_f32 v208, -v224, -v225, s61
  v_mfma_f32_16x16x32_bf16 v[156:159], a[136:139], a[120:123], v[156:159]
  ds_read_b128 a[136:139], v240 offset:10240
  v_min3_f32 v209, -v224, -v225, s61
  v_mfma_f32_16x16x32_bf16 v[156:159], a[140:143], a[124:127], v[156:159]
  ds_read_b128 a[140:143], v241 offset:10240
  v_min3_f32 v210, -v224, -v225, s61
  v_mfma_f32_16x16x32_bf16 v[20:23], a[168:171], v[176:179], v[20:23]
  v_min3_f32 v211, -v224, -v225, s61
  v_add_f32 v226, v226, v227
  v_mfma_f32_16x16x32_bf16 v[20:23], a[172:175], v[180:183], v[20:23]
  v_exp_f32 v133, v133
  v_mfma_f32_16x16x32_bf16 v[28:31], a[168:171], v[184:187], v[28:31]
  ds_read_b64_tr_b16 a[168:169], v242 offset:25608
  ds_read_b64_tr_b16 a[170:171], v242 offset:27656
  v_mfma_f32_16x16x32_bf16 v[28:31], a[172:175], v[188:191], v[28:31]
  s_waitcnt lgkmcnt(5)
  ds_read_b64_tr_b16 a[172:173], v242 offset:29704
  ds_read_b64_tr_b16 a[174:175], v242 offset:31752
  v_mfma_f32_16x16x32_bf16 v[192:195], a[144:147], a[64:67], v[200:203]
  buffer_load_dwordx4 v246, s[8:11], s40 offen offset:1024 nt lds
  v_max3_f32 v224, v156, v157, v158
  v_mfma_f32_16x16x32_bf16 v[192:195], a[148:151], a[68:71], v[192:195]
  s_add_u32 m0, s36, 51072
  v_max_f32 v224, v224, v159
  v_mov_b32 v225, v224
  v_mfma_f32_16x16x32_bf16 v[192:195], a[152:155], a[72:75], v[192:195]
  v_cvt_pk_bf16_f32 v128, v132, v133
  v_permlane32_swap_b32 v224, v225
  v_mfma_f32_16x16x32_bf16 v[192:195], a[156:159], a[76:79], v[192:195]
  v_max_f32 v224, v224, v225
  v_mov_b32 v225, v224
  v_mfma_f32_16x16x32_bf16 v[32:35], a[176:179], v[160:163], v[32:35]
  v_rcp_f32 v232, v226
  v_mfma_f32_16x16x32_bf16 v[32:35], a[180:183], v[164:167], v[32:35]
  v_permlane16_swap_b32 v224, v225
  v_min3_f32 v212, -v224, -v225, s61
  v_mfma_f32_16x16x32_bf16 v[40:43], a[176:179], v[168:171], v[40:43]
  v_exp_f32 v192, v192
  v_mfma_f32_16x16x32_bf16 v[40:43], a[180:183], v[172:175], v[40:43]
  v_exp_f32 v193, v193
  v_mfma_f32_16x16x32_bf16 v[196:199], a[144:147], a[80:83], v[204:207]
  v_exp_f32 v194, v194
  v_mfma_f32_16x16x32_bf16 v[196:199], a[148:151], a[84:87], v[196:199]
  v_exp_f32 v195, v195
  v_mfma_f32_16x16x32_bf16 v[196:199], a[152:155], a[88:91], v[196:199]
  buffer_load_dwordx4 v245, s[4:7], s39 offen offset:128 nt lds
  v_cvt_pk_bf16_f32 v130, v192, v193
  v_mfma_f32_16x16x32_bf16 v[196:199], a[156:159], a[92:95], v[196:199]
  s_add_u32 m0, s37, 17280
  v_cvt_pk_bf16_f32 v131, v194, v195
  v_min3_f32 v213, -v224, -v225, s61
  v_mfma_f32_16x16x32_bf16 v[48:51], a[176:179], v[176:179], v[48:51]
  v_min3_f32 v214, -v224, -v225, s61
  v_min3_f32 v215, -v224, -v225, s61
  v_mfma_f32_16x16x32_bf16 v[48:51], a[180:183], v[180:183], v[48:51]
  v_add_f32 v140, v204, v140
  v_add_f32 v141, v204, v141
  v_mfma_f32_16x16x32_bf16 v[56:59], a[176:179], v[184:187], v[56:59]
  v_exp_f32 v196, v196
  v_mfma_f32_16x16x32_bf16 v[56:59], a[180:183], v[188:191], v[56:59]
  v_exp_f32 v197, v197
  v_mfma_f32_16x16x32_bf16 v[192:195], a[144:147], a[96:99], v[208:211]
  v_exp_f32 v198, v198
  v_mfma_f32_16x16x32_bf16 v[192:195], a[148:151], a[100:103], v[192:195]
  v_exp_f32 v199, v199
  v_mfma_f32_16x16x32_bf16 v[192:195], a[152:155], a[104:107], v[192:195]
  ds_read_b64_tr_b16 a[176:177], v243 offset:25600
  ds_read_b64_tr_b16 a[178:179], v243 offset:27648
  v_mfma_f32_16x16x32_bf16 v[192:195], a[156:159], a[108:111], v[192:195]
  ds_read_b64_tr_b16 a[180:181], v243 offset:29696
  ds_read_b64_tr_b16 a[182:183], v243 offset:31744
  v_mfma_f32_16x16x32_bf16 v[36:39], a[184:187], v[160:163], v[36:39]
  buffer_load_dwordx4 v246, s[8:11], s40 offen offset:128 nt lds
  v_cvt_pk_bf16_f32 v138, v196, v197
  v_mfma_f32_16x16x32_bf16 v[36:39], a[188:191], v[164:167], v[36:39]
  s_add_u32 m0, s38, 3968
  v_cvt_pk_bf16_f32 v139, v198, v199
  v_mov_b32 v233, v232
  v_mfma_f32_16x16x32_bf16 v[44:47], a[184:187], v[168:171], v[44:47]
  v_exp_f32 v192, v192
  v_mfma_f32_16x16x32_bf16 v[44:47], a[188:191], v[172:175], v[44:47]
  v_exp_f32 v193, v193
  v_mfma_f32_16x16x32_bf16 v[196:199], a[144:147], a[112:115], v[212:215]
  v_exp_f32 v194, v194
  v_mfma_f32_16x16x32_bf16 v[196:199], a[148:151], a[116:119], v[196:199]
  v_exp_f32 v195, v195
  v_mfma_f32_16x16x32_bf16 v[196:199], a[152:155], a[120:123], v[196:199]
  ds_read_b128 a[144:147], v240 offset:12288
  ds_read_b128 a[148:151], v241 offset:12288
  v_mfma_f32_16x16x32_bf16 v[196:199], a[156:159], a[124:127], v[196:199]
  ds_read_b128 a[152:155], v240 offset:14336
  ds_read_b128 a[156:159], v241 offset:14336
  v_mfma_f32_16x16x32_bf16 v[52:55], a[184:187], v[176:179], v[52:55]
  v_cvt_pk_bf16_f32 v146, v192, v193
  v_cvt_pk_bf16_f32 v147, v194, v195
  v_mfma_f32_16x16x32_bf16 v[52:55], a[188:191], v[180:183], v[52:55]
  v_exp_f32 v140, v140
  v_mfma_f32_16x16x32_bf16 v[60:63], a[184:187], v[184:187], v[60:63]
  v_exp_f32 v196, v196
  v_mfma_f32_16x16x32_bf16 v[60:63], a[188:191], v[188:191], v[60:63]
  v_exp_f32 v197, v197
  v_mfma_f32_16x16x32_bf16 v[192:195], a[128:131], a[64:67], v[200:203]
  s_waitcnt lgkmcnt(4)
  v_exp_f32 v198, v198
  v_mfma_f32_16x16x32_bf16 v[192:195], a[132:135], a[68:71], v[192:195]
  v_exp_f32 v199, v199
  v_mfma_f32_16x16x32_bf16 v[192:195], a[136:139], a[72:75], v[192:195]
  ds_read_b64_tr_b16 a[184:185], v243 offset:25608
  ds_read_b64_tr_b16 a[186:187], v243 offset:27656
  v_mfma_f32_16x16x32_bf16 v[192:195], a[140:143], a[76:79], v[192:195]
  ds_read_b64_tr_b16 a[188:189], v243 offset:29704
  ds_read_b64_tr_b16 a[190:191], v243 offset:31752
  v_mfma_f32_16x16x32_bf16 v[64:67], a[160:163], v[160:163], v[64:67]
  buffer_load_dwordx4 v245, s[12:15], s32 offen offset:128 nt lds
  v_cvt_pk_bf16_f32 v154, v196, v197
  v_mfma_f32_16x16x32_bf16 v[64:67], a[164:167], v[164:167], v[64:67]
  s_add_u32 m0, s36, 50048
  v_cvt_pk_bf16_f32 v155, v198, v199
  v_add_f32 v148, v208, v148
  v_mfma_f32_16x16x32_bf16 v[72:75], a[160:163], v[168:171], v[72:75]
  v_exp_f32 v192, v192
  v_mfma_f32_16x16x32_bf16 v[72:75], a[164:167], v[172:175], v[72:75]
  v_exp_f32 v193, v193
  v_mfma_f32_16x16x32_bf16 v[196:199], a[128:131], a[80:83], v[204:207]
  v_exp_f32 v194, v194
  v_mfma_f32_16x16x32_bf16 v[196:199], a[132:135], a[84:87], v[196:199]
  v_exp_f32 v195, v195
  v_mfma_f32_16x16x32_bf16 v[196:199], a[136:139], a[88:91], v[196:199]
  v_cvt_pk_bf16_f32 v132, v192, v193
  v_cvt_pk_bf16_f32 v133, v194, v195
  v_mfma_f32_16x16x32_bf16 v[196:199], a[140:143], a[92:95], v[196:199]
  v_exp_f32 v141, v141
  v_mfma_f32_16x16x32_bf16 v[80:83], a[160:163], v[176:179], v[80:83]
  v_cvt_pk_bf16_f32 v136, v140, v141
  v_add_f32 v149, v208, v149
  v_exp_f32 v148, v148
  v_pk_mul_f32 v[0:1], v[0:1], v[232:233]
  v_pk_mul_f32 v[2:3], v[2:3], v[232:233]
  v_pk_mul_f32 v[4:5], v[4:5], v[232:233]
  v_pk_mul_f32 v[6:7], v[6:7], v[232:233]
  v_mfma_f32_16x16x32_bf16 v[80:83], a[164:167], v[180:183], v[80:83]
  v_cvt_pk_bf16_f32 v0, v0, v1
  v_cvt_pk_bf16_f32 v1, v2, v3
  v_cvt_pk_bf16_f32 v2, v4, v5
  v_cvt_pk_bf16_f32 v3, v6, v7
  v_pk_mul_f32 v[32:33], v[32:33], v[232:233]
  v_pk_mul_f32 v[34:35], v[34:35], v[232:233]
  v_pk_mul_f32 v[36:37], v[36:37], v[232:233]
  v_pk_mul_f32 v[38:39], v[38:39], v[232:233]
  v_mfma_f32_16x16x32_bf16 v[88:91], a[160:163], v[184:187], v[88:91]
  buffer_load_dwordx4 v245, s[4:7], s39 offen offset:2176 nt lds
  v_cvt_pk_bf16_f32 v32, v32, v33
  v_mfma_f32_16x16x32_bf16 v[88:91], a[164:167], v[188:191], v[88:91]
  s_add_u32 m0, s37, 49032
  v_cvt_pk_bf16_f32 v33, v34, v35
  v_cvt_pk_bf16_f32 v34, v36, v37
  v_mfma_f32_16x16x32_bf16 v[192:195], a[128:131], a[96:99], v[208:211]
  v_cvt_pk_bf16_f32 v35, v38, v39
  v_cndmask_b32_dpp v4, v32, v0, vcc row_ror:8 row_mask:0xf bank_mask:0xf
  v_mfma_f32_16x16x32_bf16 v[192:195], a[132:135], a[100:103], v[192:195]
  s_add_u32 s39, s21, 65536
  v_exp_f32 v196, v196
  v_mfma_f32_16x16x32_bf16 v[192:195], a[136:139], a[104:107], v[192:195]
  v_exp_f32 v197, v197
  v_mfma_f32_16x16x32_bf16 v[192:195], a[140:143], a[108:111], v[192:195]
  s_waitcnt vmcnt(18) lgkmcnt(0)
  v_exp_f32 v198, v198
  v_mfma_f32_16x16x32_bf16 v[68:71], a[168:171], v[160:163], v[68:71]
  s_barrier
  v_exp_f32 v199, v199
  v_mfma_f32_16x16x32_bf16 v[68:71], a[172:175], v[164:167], v[68:71]
  ds_read_b64_tr_b16 a[160:161], v242 offset:0
  ds_read_b64_tr_b16 a[162:163], v242 offset:2048
  v_mfma_f32_16x16x32_bf16 v[76:79], a[168:171], v[168:171], v[76:79]
  ds_read_b64_tr_b16 a[164:165], v242 offset:4096
  ds_read_b64_tr_b16 a[166:167], v242 offset:6144
  v_mfma_f32_16x16x32_bf16 v[76:79], a[172:175], v[172:175], v[76:79]
  v_cndmask_b32_dpp v5, v33, v1, vcc row_ror:8 row_mask:0xf bank_mask:0xf
  v_cndmask_b32_dpp v6, v34, v2, vcc row_ror:8 row_mask:0xf bank_mask:0xf
  v_cndmask_b32_dpp v7, v35, v3, vcc row_ror:8 row_mask:0xf bank_mask:0xf
  v_cvt_pk_bf16_f32 v140, v196, v197
  v_cvt_pk_bf16_f32 v141, v198, v199
  v_mfma_f32_16x16x32_bf16 v[196:199], a[128:131], a[112:115], v[212:215]
  buffer_store_dwordx4 v[4:7], v251, s[16:19], s24 offen sc1
  v_mfma_f32_16x16x32_bf16 v[196:199], a[132:135], a[116:119], v[196:199]
L_stub6:
  s_cmp_eq_u32 s99, 1
  s_cbranch_scc1 L_ret1
  s_not_b64 vcc, s[58:59]
  v_exp_f32 v149, v149
  v_mfma_f32_16x16x32_bf16 v[196:199], a[136:139], a[120:123], v[196:199]
  v_exp_f32 v192, v192
  v_mfma_f32_16x16x32_bf16 v[196:199], a[140:143], a[124:127], v[196:199]
  v_exp_f32 v193, v193
  v_mfma_f32_16x16x32_bf16 v[84:87], a[168:171], v[176:179], v[84:87]
  v_exp_f32 v194, v194
  v_mfma_f32_16x16x32_bf16 v[84:87], a[172:175], v[180:183], v[84:87]
  v_exp_f32 v195, v195
  v_mfma_f32_16x16x32_bf16 v[92:95], a[168:171], v[184:187], v[92:95]
  ds_read_b128 a[128:131], v240 offset:16384
  ds_read_b128 a[132:135], v241 offset:16384
  v_mfma_f32_16x16x32_bf16 v[92:95], a[172:175], v[188:191], v[92:95]
  ds_read_b128 a[136:139], v240 offset:18432
  ds_read_b128 a[140:143], v241 offset:18432
  v_cvt_pk_bf16_f32 v144, v148, v149
  v_cvt_pk_bf16_f32 v148, v192, v193
  v_cvt_pk_bf16_f32 v149, v194, v195
  v_mfma_f32_16x16x32_bf16 v[192:195], a[144:147], a[64:67], v[200:203]
  ds_read_b64_tr_b16 a[168:169], v242 offset:8
  ds_read_b64_tr_b16 a[170:171], v242 offset:2056
  v_mfma_f32_16x16x32_bf16 v[192:195], a[148:151], a[68:71], v[192:195]
  ds_read_b64_tr_b16 a[172:173], v242 offset:4104
  ds_read_b64_tr_b16 a[174:175], v242 offset:6152
  v_mfma_f32_16x16x32_bf16 v[192:195], a[152:155], a[72:75], v[192:195]
  buffer_load_dwordx4 v246, s[8:11], s40 offen offset:1152 nt lds
  v_add_f32 v156, v212, v156
  v_mfma_f32_16x16x32_bf16 v[192:195], a[156:159], a[76:79], v[192:195]
  s_add_u32 m0, s38, 2944
  v_add_f32 v157, v212, v157
  v_add_f32 v134, v200, v134
  v_mfma_f32_16x16x32_bf16 v[96:99], a[176:179], v[160:163], v[96:99]
  v_exp_f32 v156, v156
  v_mfma_f32_16x16x32_bf16 v[96:99], a[180:183], v[164:167], v[96:99]
  s_add_u32 s40, s21, 49152
  v_exp_f32 v157, v157
  v_mfma_f32_16x16x32_bf16 v[104:107], a[176:179], v[168:171], v[104:107]
  v_exp_f32 v196, v196
  v_exp_f32 v197, v197
  v_exp_f32 v198, v198
  v_exp_f32 v199, v199
  v_mfma_f32_16x16x32_bf16 v[104:107], a[180:183], v[172:175], v[104:107]
  v_cvt_pk_bf16_f32 v152, v156, v157
  v_cvt_pk_bf16_f32 v156, v196, v197
  v_cvt_pk_bf16_f32 v157, v198, v199
  v_mfma_f32_16x16x32_bf16 v[196:199], a[144:147], a[80:83], v[204:207]
  v_add_f32 v135, v200, v135
  v_add_f32 v142, v204, v142
  v_mfma_f32_16x16x32_bf16 v[196:199], a[148:151], a[84:87], v[196:199]
  v_exp_f32 v134, v134
  v_mfma_f32_16x16x32_bf16 v[196:199], a[152:155], a[88:91], v[196:199]
  v_exp_f32 v135, v135
  v_mfma_f32_16x16x32_bf16 v[196:199], a[156:159], a[92:95], v[196:199]
  v_exp_f32 v192, v192
  v_mfma_f32_16x16x32_bf16 v[112:115], a[176:179], v[176:179], v[112:115]
  v_exp_f32 v193, v193
  v_mfma_f32_16x16x32_bf16 v[112:115], a[180:183], v[180:183], v[112:115]
  v_exp_f32 v194, v194
  v_mfma_f32_16x16x32_bf16 v[120:123], a[176:179], v[184:187], v[120:123]
  v_exp_f32 v195, v195
  v_mfma_f32_16x16x32_bf16 v[120:123], a[180:183], v[188:191], v[120:123]
  ds_read_b64_tr_b16 a[176:177], v243 offset:0
  ds_read_b64_tr_b16 a[178:179], v243 offset:2048
  v_cvt_pk_bf16_f32 v129, v134, v135
  v_cvt_pk_bf16_f32 v134, v192, v193
  v_cvt_pk_bf16_f32 v135, v194, v195
  v_mfma_f32_16x16x32_bf16 v[192:195], a[144:147], a[96:99], v[208:211]
  ds_read_b64_tr_b16 a[180:181], v243 offset:4096
  ds_read_b64_tr_b16 a[182:183], v243 offset:6144
  v_mfma_f32_16x16x32_bf16 v[192:195], a[148:151], a[100:103], v[192:195]
  buffer_load_dwordx4 v245, s[12:15], s32 offen offset:2176 nt lds
  v_add_f32 v143, v204, v143
  v_mfma_f32_16x16x32_bf16 v[192:195], a[152:155], a[104:107], v[192:195]
  s_add_u32 m0, s38, 0
  v_exp_f32 v142, v142
  v_mfma_f32_16x16x32_bf16 v[192:195], a[156:159], a[108:111], v[192:195]
  v_exp_f32 v143, v143
  v_mfma_f32_16x16x32_bf16 v[100:103], a[184:187], v[160:163], v[100:103]
  v_exp_f32 v196, v196
  v_mfma_f32_16x16x32_bf16 v[100:103], a[188:191], v[164:167], v[100:103]
  v_exp_f32 v197, v197
  v_mfma_f32_16x16x32_bf16 v[108:111], a[184:187], v[168:171], v[108:111]
  v_exp_f32 v198, v198
  v_exp_f32 v199, v199
  v_mfma_f32_16x16x32_bf16 v[108:111], a[188:191], v[172:175], v[108:111]
  v_cvt_pk_bf16_f32 v137, v142, v143
  v_cvt_pk_bf16_f32 v142, v196, v197
  v_cvt_pk_bf16_f32 v143, v198, v199
  v_mfma_f32_16x16x32_bf16 v[196:199], a[144:147], a[112:115], v[212:215]
  ds_read_b128 a[144:147], v240 offset:20480
  v_add_f32 v150, v208, v150
  v_mfma_f32_16x16x32_bf16 v[196:199], a[148:151], a[116:119], v[196:199]
  ds_read_b128 a[148:151], v241 offset:20480
  v_add_f32 v151, v208, v151
  v_mfma_f32_16x16x32_bf16 v[196:199], a[152:155], a[120:123], v[196:199]
  v_exp_f32 v150, v150
  v_mfma_f32_16x16x32_bf16 v[196:199], a[156:159], a[124:127], v[196:199]
  v_exp_f32 v151, v151
  v_mfma_f32_16x16x32_bf16 v[116:119], a[184:187], v[176:179], v[116:119]
  v_exp_f32 v192, v192
  v_mfma_f32_16x16x32_bf16 v[116:119], a[188:191], v[180:183], v[116:119]
  v_exp_f32 v193, v193
  v_mfma_f32_16x16x32_bf16 v[124:127], a[184:187], v[184:187], v[124:127]
  v_exp_f32 v194, v194
  v_exp_f32 v195, v195
  v_mfma_f32_16x16x32_bf16 v[124:127], a[188:191], v[188:191], v[124:127]
  s_waitcnt lgkmcnt(1)
  ds_read_b128 a[152:155], v240 offset:22528
  ds_read_b128 a[156:159], v241 offset:22528
  v_cvt_pk_bf16_f32 v145, v150, v151
  v_cvt_pk_bf16_f32 v150, v192, v193
  v_cvt_pk_bf16_f32 v151, v194, v195
  v_mfma_f32_16x16x32_bf16 v[192:195], a[128:131], a[64:67], v[200:203]
  ds_read_b64_tr_b16 a[184:185], v243 offset:8
  ds_read_b64_tr_b16 a[186:187], v243 offset:2056
  v_mfma_f32_16x16x32_bf16 v[192:195], a[132:135], a[68:71], v[192:195]
  ds_read_b64_tr_b16 a[188:189], v243 offset:4104
  ds_read_b64_tr_b16 a[190:191], v243 offset:6152
  v_mfma_f32_16x16x32_bf16 v[192:195], a[136:139], a[72:75], v[192:195]
  buffer_load_dwordx4 v245, s[12:15], s33 offen nt lds
  v_cmp_nlt_f32_e64 s[46:47], v226, s44
  v_accvgpr_read_b32 v226, a196
  v_accvgpr_read_b32 v227, a197
  v_add_f32 v226, v226, v227
  v_rcp_f32 v234, v226
  v_mfma_f32_16x16x32_bf16 v[192:195], a[140:143], a[76:79], v[192:195]
  s_add_u32 m0, s38, -1024
  v_mov_b32 v235, v234
  v_cndmask_b32_dpp v36, v0, v32, vcc row_ror:8 row_mask:0xf bank_mask:0xf
  v_cndmask_b32_dpp v37, v1, v33, vcc row_ror:8 row_mask:0xf bank_mask:0xf
  v_cndmask_b32_dpp v38, v2, v34, vcc row_ror:8 row_mask:0xf bank_mask:0xf
  v_cndmask_b32_dpp v39, v3, v35, vcc row_ror:8 row_mask:0xf bank_mask:0xf
  v_pk_mul_f32 v[8:9], v[8:9], v[234:235]
  v_pk_mul_f32 v[10:11], v[10:11], v[234:235]
  v_pk_mul_f32 v[12:13], v[12:13], v[234:235]
  v_pk_mul_f32 v[14:15], v[14:15], v[234:235]
  v_cvt_pk_bf16_f32 v8, v8, v9
  v_cvt_pk_bf16_f32 v9, v10, v11
  v_cvt_pk_bf16_f32 v10, v12, v13
  v_cvt_pk_bf16_f32 v11, v14, v15
  v_pk_mul_f32 v[40:41], v[40:41], v[234:235]
  v_pk_mul_f32 v[42:43], v[42:43], v[234:235]
  v_pk_mul_f32 v[44:45], v[44:45], v[234:235]
  v_pk_mul_f32 v[46:47], v[46:47], v[234:235]
  v_cvt_pk_bf16_f32 v40, v40, v41
  v_cvt_pk_bf16_f32 v41, v42, v43
  v_cvt_pk_bf16_f32 v42, v44, v45
  v_cvt_pk_bf16_f32 v43, v46, v47
  v_mfma_f32_16x16x32_bf16 v[0:3], a[160:163], v[128:131], 0
  s_mov_b64 vcc, s[58:59]
  v_cndmask_b32_dpp v12, v40, v8, vcc row_ror:8 row_mask:0xf bank_mask:0xf
  v_cndmask_b32_dpp v13, v41, v9, vcc row_ror:8 row_mask:0xf bank_mask:0xf
  v_cndmask_b32_dpp v14, v42, v10, vcc row_ror:8 row_mask:0xf bank_mask:0xf
  v_cndmask_b32_dpp v15, v43, v11, vcc row_ror:8 row_mask:0xf bank_mask:0xf
  v_mfma_f32_16x16x32_bf16 v[0:3], a[164:167], v[132:135], v[0:3]
  s_not_b64 vcc, s[58:59]
  v_cndmask_b32_dpp v44, v8, v40, vcc row_ror:8 row_mask:0xf bank_mask:0xf
  v_cndmask_b32_dpp v45, v9, v41, vcc row_ror:8 row_mask:0xf bank_mask:0xf
  v_cndmask_b32_dpp v46, v10, v42, vcc row_ror:8 row_mask:0xf bank_mask:0xf
  v_cndmask_b32_dpp v47, v11, v43, vcc row_ror:8 row_mask:0xf bank_mask:0xf
  v_mfma_f32_16x16x32_bf16 v[8:11], a[160:163], v[136:139], 0
  s_mov_b64 vcc, s[58:59]
  v_add_f32 v158, v212, v158
  v_add_f32 v159, v212, v159
  v_exp_f32 v158, v158
  v_exp_f32 v159, v159
  v_exp_f32 v196, v196
  v_exp_f32 v197, v197
  v_exp_f32 v198, v198
  v_exp_f32 v199, v199
  v_mfma_f32_16x16x32_bf16 v[8:11], a[164:167], v[140:143], v[8:11]
  v_cvt_pk_bf16_f32 v153, v158, v159
  v_cvt_pk_bf16_f32 v158, v196, v197
  v_cvt_pk_bf16_f32 v159, v198, v199
  v_mfma_f32_16x16x32_bf16 v[196:199], a[128:131], a[80:83], v[204:207]
  buffer_store_dwordx4 v[12:15], v251, s[16:19], s25 offen sc1
  v_cmp_nlt_f32_e64 s[52:53], v226, s44
  v_accvgpr_read_b32 v226, a200
  v_accvgpr_read_b32 v227, a201
  v_add_f32 v226, v226, v227
  v_rcp_f32 v236, v226
  v_mfma_f32_16x16x32_bf16 v[196:199], a[132:135], a[84:87], v[196:199]
  s_or_b64 s[46:47], s[46:47], s[52:53]
  v_mov_b32 v237, v236
  v_cmp_nlt_f32_e64 s[54:55], v226, s44
  v_pk_mul_f32 v[16:17], v[16:17], v[236:237]
  v_pk_mul_f32 v[18:19], v[18:19], v[236:237]
  v_pk_mul_f32 v[20:21], v[20:21], v[236:237]
  v_pk_mul_f32 v[22:23], v[22:23], v[236:237]
  v_cvt_pk_bf16_f32 v16, v16, v17
  v_cvt_pk_bf16_f32 v17, v18, v19
  v_cvt_pk_bf16_f32 v18, v20, v21
  v_cvt_pk_bf16_f32 v19, v22, v23
  v_pk_mul_f32 v[48:49], v[48:49], v[236:237]
  v_pk_mul_f32 v[50:51], v[50:51], v[236:237]
  v_pk_mul_f32 v[52:53], v[52:53], v[236:237]
  v_pk_mul_f32 v[54:55], v[54:55], v[236:237]
  v_cvt_pk_bf16_f32 v48, v48, v49
  v_cvt_pk_bf16_f32 v49, v50, v51
  v_cvt_pk_bf16_f32 v50, v52, v53
  v_cvt_pk_bf16_f32 v51, v54, v55
  v_mfma_f32_16x16x32_bf16 v[196:199], a[136:139], a[88:91], v[196:199]
  v_accvgpr_read_b32 v226, a204
  v_accvgpr_read_b32 v227, a205
  v_add_f32 v226, v226, v227
  v_rcp_f32 v238, v226
  v_cndmask_b32_dpp v20, v48, v16, vcc row_ror:8 row_mask:0xf bank_mask:0xf
  v_cndmask_b32_dpp v21, v49, v17, vcc row_ror:8 row_mask:0xf bank_mask:0xf
  v_cndmask_b32_dpp v22, v50, v18, vcc row_ror:8 row_mask:0xf bank_mask:0xf
  v_cndmask_b32_dpp v23, v51, v19, vcc row_ror:8 row_mask:0xf bank_mask:0xf
  v_mfma_f32_16x16x32_bf16 v[196:199], a[140:143], a[92:95], v[196:199]
  s_not_b64 vcc, s[58:59]
  v_mov_b32 v239, v238
  v_cndmask_b32_dpp v52, v16, v48, vcc row_ror:8 row_mask:0xf bank_mask:0xf
  v_cndmask_b32_dpp v53, v17, v49, vcc row_ror:8 row_mask:0xf bank_mask:0xf
  v_cndmask_b32_dpp v54, v18, v50, vcc row_ror:8 row_mask:0xf bank_mask:0xf
  v_cndmask_b32_dpp v55, v19, v51, vcc row_ror:8 row_mask:0xf bank_mask:0xf
  v_pk_mul_f32 v[24:25], v[24:25], v[238:239]
  v_pk_mul_f32 v[26:27], v[26:27], v[238:239]
  v_pk_mul_f32 v[28:29], v[28:29], v[238:239]
  v_pk_mul_f32 v[30:31], v[30:31], v[238:239]
  v_cvt_pk_bf16_f32 v24, v24, v25
  v_cvt_pk_bf16_f32 v25, v26, v27
  v_cvt_pk_bf16_f32 v26, v28, v29
  v_cvt_pk_bf16_f32 v27, v30, v31
  v_pk_mul_f32 v[56:57], v[56:57], v[238:239]
  v_pk_mul_f32 v[58:59], v[58:59], v[238:239]
  v_pk_mul_f32 v[60:61], v[60:61], v[238:239]
  v_pk_mul_f32 v[62:63], v[62:63], v[238:239]
  v_cvt_pk_bf16_f32 v56, v56, v57
  v_cvt_pk_bf16_f32 v57, v58, v59
  v_cvt_pk_bf16_f32 v58, v60, v61
  v_cvt_pk_bf16_f32 v59, v62, v63
  v_mfma_f32_16x16x32_bf16 v[16:19], a[160:163], v[144:147], 0
  s_mov_b64 vcc, s[58:59]
  v_cndmask_b32_dpp v28, v56, v24, vcc row_ror:8 row_mask:0xf bank_mask:0xf
  v_cndmask_b32_dpp v29, v57, v25, vcc row_ror:8 row_mask:0xf bank_mask:0xf
  v_cndmask_b32_dpp v30, v58, v26, vcc row_ror:8 row_mask:0xf bank_mask:0xf
  v_cndmask_b32_dpp v31, v59, v27, vcc row_ror:8 row_mask:0xf bank_mask:0xf
  v_mfma_f32_16x16x32_bf16 v[16:19], a[164:167], v[148:151], v[16:19]
  s_not_b64 vcc, s[58:59]
  v_cndmask_b32_dpp v60, v24, v56, vcc row_ror:8 row_mask:0xf bank_mask:0xf
  v_cndmask_b32_dpp v61, v25, v57, vcc row_ror:8 row_mask:0xf bank_mask:0xf
  v_cndmask_b32_dpp v62, v26, v58, vcc row_ror:8 row_mask:0xf bank_mask:0xf
  v_cndmask_b32_dpp v63, v27, v59, vcc row_ror:8 row_mask:0xf bank_mask:0xf
  v_mfma_f32_16x16x32_bf16 v[24:27], a[160:163], v[152:155], 0
  v_exp_f32 v192, v192
  v_exp_f32 v193, v193
  v_exp_f32 v194, v194
  v_exp_f32 v195, v195
  v_mfma_f32_16x16x32_bf16 v[24:27], a[164:167], v[156:159], v[24:27]
  s_mov_b64 vcc, s[58:59]
  ds_read_b64_tr_b16 a[160:161], v242 offset:1024
  ds_read_b64_tr_b16 a[162:163], v242 offset:3072
  v_cvt_pk_bf16_f32 v160, v192, v193
  v_cvt_pk_bf16_f32 v161, v194, v195
  v_mfma_f32_16x16x32_bf16 v[192:195], a[128:131], a[96:99], v[208:211]
  ds_read_b64_tr_b16 a[164:165], v242 offset:5120
  ds_read_b64_tr_b16 a[166:167], v242 offset:7168
  v_mfma_f32_16x16x32_bf16 v[192:195], a[132:135], a[100:103], v[192:195]
  s_or_b64 s[46:47], s[46:47], s[54:55]
  v_accvgpr_write_b32 a192, 0
  v_accvgpr_write_b32 a193, 0
  v_mfma_f32_16x16x32_bf16 v[192:195], a[136:139], a[104:107], v[192:195]
  v_exp_f32 v196, v196
  v_mfma_f32_16x16x32_bf16 v[192:195], a[140:143], a[108:111], v[192:195]
  v_exp_f32 v197, v197
  v_mfma_f32_16x16x32_bf16 v[4:7], a[168:171], v[128:131], 0
  v_exp_f32 v198, v198
  v_mfma_f32_16x16x32_bf16 v[4:7], a[172:175], v[132:135], v[4:7]
  v_exp_f32 v199, v199
  v_mfma_f32_16x16x32_bf16 v[12:15], a[168:171], v[136:139], 0
  buffer_load_dwordx4 v245, s[12:15], s33 offen offset:2048 nt lds
  v_cvt_pk_bf16_f32 v168, v196, v197
  v_mfma_f32_16x16x32_bf16 v[12:15], a[172:175], v[140:143], v[12:15]
  s_add_u32 m0, s36, 0
  v_cvt_pk_bf16_f32 v169, v198, v199
  v_accvgpr_write_b32 a52, v20
  v_smfmac_f32_16x16x64_bf16 a[192:195], a[208:211], v[128:135], v248
  v_accvgpr_write_b32 a53, v21
  v_accvgpr_write_b32 a54, v22
  v_mfma_f32_16x16x32_bf16 v[196:199], a[128:131], a[112:115], v[212:215]
  ds_read_b128 a[128:131], v240 offset:24576
  v_accvgpr_write_b32 a55, v23
  v_mfma_f32_16x16x32_bf16 v[196:199], a[132:135], a[116:119], v[196:199]
  ds_read_b128 a[132:135], v241 offset:24576
  v_accvgpr_write_b32 a56, v28
  v_mfma_f32_16x16x32_bf16 v[196:199], a[136:139], a[120:123], v[196:199]
  ds_read_b128 a[136:139], v240 offset:26624
  v_accvgpr_write_b32 a57, v29
  v_mfma_f32_16x16x32_bf16 v[196:199], a[140:143], a[124:127], v[196:199]
  ds_read_b128 a[140:143], v241 offset:26624
  v_accvgpr_write_b32 a58, v30
  v_mfma_f32_16x16x32_bf16 v[20:23], a[168:171], v[144:147], 0
  v_accvgpr_write_b32 a59, v31
  v_accvgpr_write_b32 a196, 0
  v_mfma_f32_16x16x32_bf16 v[20:23], a[172:175], v[148:151], v[20:23]
  v_exp_f32 v192, v192
  v_mfma_f32_16x16x32_bf16 v[28:31], a[168:171], v[152:155], 0
  v_exp_f32 v193, v193
  v_exp_f32 v194, v194
  v_exp_f32 v195, v195
  v_mfma_f32_16x16x32_bf16 v[28:31], a[172:175], v[156:159], v[28:31]
  ds_read_b64_tr_b16 a[168:169], v242 offset:1032
  ds_read_b64_tr_b16 a[170:171], v242 offset:3080
  v_cvt_pk_bf16_f32 v176, v192, v193
  v_cvt_pk_bf16_f32 v177, v194, v195
  v_mfma_f32_16x16x32_bf16 v[192:195], a[144:147], a[64:67], v[200:203]
  s_waitcnt lgkmcnt(4)
  ds_read_b64_tr_b16 a[172:173], v242 offset:5128
  ds_read_b64_tr_b16 a[174:175], v242 offset:7176
  v_mfma_f32_16x16x32_bf16 v[192:195], a[148:151], a[68:71], v[192:195]
  buffer_load_dwordx4 v245, s[4:7], s39 offen nt lds
  v_accvgpr_write_b32 a197, 0
  v_mfma_f32_16x16x32_bf16 v[192:195], a[152:155], a[72:75], v[192:195]
  s_add_u32 m0, s37, 24576
  v_exp_f32 v196, v196
  v_mfma_f32_16x16x32_bf16 v[192:195], a[156:159], a[76:79], v[192:195]
  v_exp_f32 v197, v197
  v_mfma_f32_16x16x32_bf16 v[32:35], a[176:179], v[128:131], 0
  v_exp_f32 v198, v198
  v_mfma_f32_16x16x32_bf16 v[32:35], a[180:183], v[132:135], v[32:35]
  v_exp_f32 v199, v199
  v_mfma_f32_16x16x32_bf16 v[40:43], a[176:179], v[136:139], 0
  v_cvt_pk_bf16_f32 v184, v196, v197
  v_cvt_pk_bf16_f32 v185, v198, v199
  v_mfma_f32_16x16x32_bf16 v[40:43], a[180:183], v[140:143], v[40:43]
  v_exp_f32 v192, v192
  v_smfmac_f32_16x16x64_bf16 a[196:199], a[208:211], v[136:143], v248
  v_exp_f32 v193, v193
  v_mfma_f32_16x16x32_bf16 v[196:199], a[144:147], a[80:83], v[204:207]
  v_exp_f32 v194, v194
  v_mfma_f32_16x16x32_bf16 v[196:199], a[148:151], a[84:87], v[196:199]
  v_exp_f32 v195, v195
  v_mfma_f32_16x16x32_bf16 v[196:199], a[152:155], a[88:91], v[196:199]
  buffer_load_dwordx4 v246, s[8:11], s40 offen nt lds
  v_cvt_pk_bf16_f32 v162, v192, v193
  v_mfma_f32_16x16x32_bf16 v[196:199], a[156:159], a[92:95], v[196:199]
  s_add_u32 m0, s36, -1024
  v_cvt_pk_bf16_f32 v163, v194, v195
  v_accvgpr_write_b32 a60, v36
  v_mfma_f32_16x16x32_bf16 v[48:51], a[176:179], v[144:147], 0
  v_accvgpr_write_b32 a61, v37
  v_accvgpr_write_b32 a62, v38
  v_mfma_f32_16x16x32_bf16 v[48:51], a[180:183], v[148:151], v[48:51]
  v_accvgpr_write_b32 a63, v39
  v_accvgpr_write_b32 a212, v44
  v_mfma_f32_16x16x32_bf16 v[56:59], a[176:179], v[152:155], 0
  ds_read_b64_tr_b16 a[176:177], v243 offset:1024
  ds_read_b64_tr_b16 a[178:179], v243 offset:3072
  v_mfma_f32_16x16x32_bf16 v[56:59], a[180:183], v[156:159], v[56:59]
  ds_read_b64_tr_b16 a[180:181], v243 offset:5120
  ds_read_b64_tr_b16 a[182:183], v243 offset:7168
  v_mfma_f32_16x16x32_bf16 v[192:195], a[144:147], a[96:99], v[208:211]
  v_accvgpr_write_b32 a213, v45
  v_accvgpr_write_b32 a214, v46
  v_mfma_f32_16x16x32_bf16 v[192:195], a[148:151], a[100:103], v[192:195]
  v_accvgpr_write_b32 a215, v47
  v_accvgpr_write_b32 a200, 0
  v_mfma_f32_16x16x32_bf16 v[192:195], a[152:155], a[104:107], v[192:195]
  v_accvgpr_write_b32 a201, 0
  v_accvgpr_write_b32 a216, v52
  v_mfma_f32_16x16x32_bf16 v[192:195], a[156:159], a[108:111], v[192:195]
  v_exp_f32 v196, v196
  v_mfma_f32_16x16x32_bf16 v[36:39], a[184:187], v[128:131], 0
  v_exp_f32 v197, v197
  v_mfma_f32_16x16x32_bf16 v[36:39], a[188:191], v[132:135], v[36:39]
  v_exp_f32 v198, v198
  v_mfma_f32_16x16x32_bf16 v[44:47], a[184:187], v[136:139], 0
  v_exp_f32 v199, v199
  v_mfma_f32_16x16x32_bf16 v[44:47], a[188:191], v[140:143], v[44:47]
  buffer_load_dwordx4 v245, s[4:7], s39 offen offset:2048 nt lds
  v_cvt_pk_bf16_f32 v170, v196, v197
  v_smfmac_f32_16x16x64_bf16 a[200:203], a[208:211], v[144:151], v248
  s_add_u32 m0, s37, 56328
  v_cvt_pk_bf16_f32 v171, v198, v199
  v_accvgpr_write_b32 a217, v53
  v_accvgpr_write_b32 a218, v54
  v_accvgpr_write_b32 a219, v55
  v_pk_mul_f32 v[64:65], v[64:65], v[232:233]
  v_pk_mul_f32 v[66:67], v[66:67], v[232:233]
  v_pk_mul_f32 v[68:69], v[68:69], v[232:233]
  v_pk_mul_f32 v[70:71], v[70:71], v[232:233]
  v_mfma_f32_16x16x32_bf16 v[196:199], a[144:147], a[112:115], v[212:215]
  ds_read_b128 a[144:147], v240 offset:28672
  v_accvgpr_write_b32 a220, v60
  v_accvgpr_write_b32 a221, v61
  v_accvgpr_write_b32 a222, v62
  v_pk_mul_f32 v[96:97], v[96:97], v[232:233]
  v_pk_mul_f32 v[98:99], v[98:99], v[232:233]
  v_pk_mul_f32 v[100:101], v[100:101], v[232:233]
  v_pk_mul_f32 v[102:103], v[102:103], v[232:233]
  v_mfma_f32_16x16x32_bf16 v[196:199], a[148:151], a[116:119], v[196:199]
  ds_read_b128 a[148:151], v241 offset:28672
  v_accvgpr_write_b32 a223, v63
  v_exp_f32 v192, v192
  v_pk_mul_f32 v[72:73], v[72:73], v[234:235]
  v_pk_mul_f32 v[74:75], v[74:75], v[234:235]
  v_pk_mul_f32 v[76:77], v[76:77], v[234:235]
  v_pk_mul_f32 v[78:79], v[78:79], v[234:235]
  v_mfma_f32_16x16x32_bf16 v[196:199], a[152:155], a[120:123], v[196:199]
  v_exp_f32 v193, v193
  v_exp_f32 v194, v194
  v_pk_mul_f32 v[104:105], v[104:105], v[234:235]
  v_pk_mul_f32 v[106:107], v[106:107], v[234:235]
  v_pk_mul_f32 v[108:109], v[108:109], v[234:235]
  v_pk_mul_f32 v[110:111], v[110:111], v[234:235]
  v_mfma_f32_16x16x32_bf16 v[196:199], a[156:159], a[124:127], v[196:199]
  v_exp_f32 v195, v195
  v_mfma_f32_16x16x32_bf16 v[52:55], a[184:187], v[144:147], 0
  ds_read_b128 a[152:155], v240 offset:30720
  ds_read_b128 a[156:159], v241 offset:30720
  v_mfma_f32_16x16x32_bf16 v[52:55], a[188:191], v[148:151], v[52:55]
  v_cvt_pk_bf16_f32 v178, v192, v193
  v_cvt_pk_bf16_f32 v179, v194, v195
  v_mfma_f32_16x16x32_bf16 v[60:63], a[184:187], v[152:155], 0
  ds_read_b64_tr_b16 a[184:185], v243 offset:1032
  ds_read_b64_tr_b16 a[186:187], v243 offset:3080
  v_mfma_f32_16x16x32_bf16 v[60:63], a[188:191], v[156:159], v[60:63]
  ds_read_b64_tr_b16 a[188:189], v243 offset:5128
  ds_read_b64_tr_b16 a[190:191], v243 offset:7176
  v_mfma_f32_16x16x32_bf16 v[192:195], a[128:131], a[64:67], v[200:203]
  s_waitcnt lgkmcnt(6)
  buffer_load_dwordx4 v246, s[8:11], s40 offen offset:1024 nt lds
  v_cvt_pk_bf16_f32 v64, v64, v65
  v_cvt_pk_bf16_f32 v65, v66, v67
  v_cvt_pk_bf16_f32 v66, v68, v69
  v_pk_mul_f32 v[80:81], v[80:81], v[236:237]
  v_pk_mul_f32 v[82:83], v[82:83], v[236:237]
  v_pk_mul_f32 v[84:85], v[84:85], v[236:237]
  v_pk_mul_f32 v[86:87], v[86:87], v[236:237]
  v_mfma_f32_16x16x32_bf16 v[192:195], a[132:135], a[68:71], v[192:195]
  s_add_u32 m0, s36, 1920
  v_cvt_pk_bf16_f32 v67, v70, v71
  v_cvt_pk_bf16_f32 v96, v96, v97
  v_cvt_pk_bf16_f32 v97, v98, v99
  v_cvt_pk_bf16_f32 v98, v100, v101
  v_cvt_pk_bf16_f32 v99, v102, v103
  v_pk_mul_f32 v[112:113], v[112:113], v[236:237]
  v_pk_mul_f32 v[114:115], v[114:115], v[236:237]
  v_pk_mul_f32 v[116:117], v[116:117], v[236:237]
  v_pk_mul_f32 v[118:119], v[118:119], v[236:237]
  v_mfma_f32_16x16x32_bf16 v[192:195], a[136:139], a[72:75], v[192:195]
  v_cndmask_b32_dpp v68, v96, v64, vcc row_ror:8 row_mask:0xf bank_mask:0xf
  v_cndmask_b32_dpp v69, v97, v65, vcc row_ror:8 row_mask:0xf bank_mask:0xf
  v_cndmask_b32_dpp v70, v98, v66, vcc row_ror:8 row_mask:0xf bank_mask:0xf
  v_cndmask_b32_dpp v71, v99, v67, vcc row_ror:8 row_mask:0xf bank_mask:0xf
  v_pk_mul_f32 v[88:89], v[88:89], v[238:239]
  v_pk_mul_f32 v[90:91], v[90:91], v[238:239]
  v_pk_mul_f32 v[92:93], v[92:93], v[238:239]
  v_pk_mul_f32 v[94:95], v[94:95], v[238:239]
  v_mfma_f32_16x16x32_bf16 v[192:195], a[140:143], a[76:79], v[192:195]
  s_not_b64 vcc, s[58:59]
  v_cvt_pk_bf16_f32 v72, v72, v73
  v_cvt_pk_bf16_f32 v73, v74, v75
  v_cvt_pk_bf16_f32 v74, v76, v77
  v_cvt_pk_bf16_f32 v75, v78, v79
  v_cndmask_b32_dpp v100, v64, v96, vcc row_ror:8 row_mask:0xf bank_mask:0xf
  v_cndmask_b32_dpp v101, v65, v97, vcc row_ror:8 row_mask:0xf bank_mask:0xf
  v_cndmask_b32_dpp v102, v66, v98, vcc row_ror:8 row_mask:0xf bank_mask:0xf
  v_cndmask_b32_dpp v103, v67, v99, vcc row_ror:8 row_mask:0xf bank_mask:0xf
  v_cvt_pk_bf16_f32 v104, v104, v105
  v_cvt_pk_bf16_f32 v105, v106, v107
  v_cvt_pk_bf16_f32 v106, v108, v109
  v_cvt_pk_bf16_f32 v107, v110, v111
  v_pk_mul_f32 v[120:121], v[120:121], v[238:239]
  v_pk_mul_f32 v[122:123], v[122:123], v[238:239]
  v_pk_mul_f32 v[124:125], v[124:125], v[238:239]
  v_pk_mul_f32 v[126:127], v[126:127], v[238:239]
  v_mfma_f32_16x16x32_bf16 v[64:67], a[160:163], v[128:131], 0
  s_mov_b64 vcc, s[58:59]
  buffer_store_dwordx4 v[68:71], v251, s[16:19], s24 offen offset:128 sc1
  v_cndmask_b32_dpp v76, v104, v72, vcc row_ror:8 row_mask:0xf bank_mask:0xf
  v_cndmask_b32_dpp v77, v105, v73, vcc row_ror:8 row_mask:0xf bank_mask:0xf
  v_cndmask_b32_dpp v78, v106, v74, vcc row_ror:8 row_mask:0xf bank_mask:0xf
  v_cndmask_b32_dpp v79, v107, v75, vcc row_ror:8 row_mask:0xf bank_mask:0xf
  v_mfma_f32_16x16x32_bf16 v[64:67], a[164:167], v[132:135], v[64:67]
  s_not_b64 vcc, s[58:59]
  v_cndmask_b32_dpp v108, v72, v104, vcc row_ror:8 row_mask:0xf bank_mask:0xf
  v_cndmask_b32_dpp v109, v73, v105, vcc row_ror:8 row_mask:0xf bank_mask:0xf
  v_cndmask_b32_dpp v110, v74, v106, vcc row_ror:8 row_mask:0xf bank_mask:0xf
  v_cndmask_b32_dpp v111, v75, v107, vcc row_ror:8 row_mask:0xf bank_mask:0xf
  v_mfma_f32_16x16x32_bf16 v[72:75], a[160:163], v[136:139], 0
  s_mov_b64 vcc, s[58:59]
  v_accvgpr_write_b32 a204, 0
  v_accvgpr_write_b32 a205, 0
  v_mfma_f32_16x16x32_bf16 v[72:75], a[164:167], v[140:143], v[72:75]
  v_exp_f32 v196, v196
  v_exp_f32 v197, v197
  v_exp_f32 v198, v198
  v_exp_f32 v199, v199
  v_smfmac_f32_16x16x64_bf16 a[204:207], a[208:211], v[152:159], v248
  v_cvt_pk_bf16_f32 v186, v196, v197
  v_cvt_pk_bf16_f32 v187, v198, v199
  v_mfma_f32_16x16x32_bf16 v[196:199], a[128:131], a[80:83], v[204:207]
  v_cvt_pk_bf16_f32 v80, v80, v81
  v_cvt_pk_bf16_f32 v81, v82, v83
  v_mfma_f32_16x16x32_bf16 v[196:199], a[132:135], a[84:87], v[196:199]
  v_cvt_pk_bf16_f32 v82, v84, v85
  v_cvt_pk_bf16_f32 v83, v86, v87
  v_cvt_pk_bf16_f32 v112, v112, v113
  v_cvt_pk_bf16_f32 v113, v114, v115
  v_cvt_pk_bf16_f32 v114, v116, v117
  v_cvt_pk_bf16_f32 v115, v118, v119
  v_mfma_f32_16x16x32_bf16 v[196:199], a[136:139], a[88:91], v[196:199]
  v_cndmask_b32_dpp v84, v112, v80, vcc row_ror:8 row_mask:0xf bank_mask:0xf
  v_cndmask_b32_dpp v85, v113, v81, vcc row_ror:8 row_mask:0xf bank_mask:0xf
  v_cndmask_b32_dpp v86, v114, v82, vcc row_ror:8 row_mask:0xf bank_mask:0xf
  v_cndmask_b32_dpp v87, v115, v83, vcc row_ror:8 row_mask:0xf bank_mask:0xf
  v_mfma_f32_16x16x32_bf16 v[196:199], a[140:143], a[92:95], v[196:199]
  s_not_b64 vcc, s[58:59]
  v_cvt_pk_bf16_f32 v88, v88, v89
  v_cvt_pk_bf16_f32 v89, v90, v91
  v_cvt_pk_bf16_f32 v90, v92, v93
  v_cvt_pk_bf16_f32 v91, v94, v95
  v_cndmask_b32_dpp v116, v80, v112, vcc row_ror:8 row_mask:0xf bank_mask:0xf
  v_cndmask_b32_dpp v117, v81, v113, vcc row_ror:8 row_mask:0xf bank_mask:0xf
  v_cndmask_b32_dpp v118, v82, v114, vcc row_ror:8 row_mask:0xf bank_mask:0xf
  v_cndmask_b32_dpp v119, v83, v115, vcc row_ror:8 row_mask:0xf bank_mask:0xf
  v_cvt_pk_bf16_f32 v120, v120, v121
  v_cvt_pk_bf16_f32 v121, v122, v123
  v_cvt_pk_bf16_f32 v122, v124, v125
  v_cvt_pk_bf16_f32 v123, v126, v127
  v_mfma_f32_16x16x32_bf16 v[80:83], a[160:163], v[144:147], 0
  s_mov_b64 vcc, s[58:59]
  v_cndmask_b32_dpp v92, v120, v88, vcc row_ror:8 row_mask:0xf bank_mask:0xf
  v_cndmask_b32_dpp v93, v121, v89, vcc row_ror:8 row_mask:0xf bank_mask:0xf
  v_cndmask_b32_dpp v94, v122, v90, vcc row_ror:8 row_mask:0xf bank_mask:0xf
  v_cndmask_b32_dpp v95, v123, v91, vcc row_ror:8 row_mask:0xf bank_mask:0xf
  v_mfma_f32_16x16x32_bf16 v[80:83], a[164:167], v[148:151], v[80:83]
  s_not_b64 vcc, s[58:59]
  buffer_load_dwordx4 v245, s[4:7], s39 offen offset:128 nt lds
  v_cndmask_b32_dpp v124, v88, v120, vcc row_ror:8 row_mask:0xf bank_mask:0xf
  v_cndmask_b32_dpp v125, v89, v121, vcc row_ror:8 row_mask:0xf bank_mask:0xf
  v_cndmask_b32_dpp v126, v90, v122, vcc row_ror:8 row_mask:0xf bank_mask:0xf
  v_cndmask_b32_dpp v127, v91, v123, vcc row_ror:8 row_mask:0xf bank_mask:0xf
  v_mfma_f32_16x16x32_bf16 v[88:91], a[160:163], v[152:155], 0
  s_add_u32 m0, s37, 25472
  v_exp_f32 v192, v192
  v_exp_f32 v193, v193
  v_exp_f32 v194, v194
  v_exp_f32 v195, v195
  v_mfma_f32_16x16x32_bf16 v[88:91], a[164:167], v[156:159], v[88:91]
  s_mov_b64 vcc, s[58:59]
  v_cvt_pk_bf16_f32 v164, v192, v193
  v_cvt_pk_bf16_f32 v165, v194, v195
  v_mfma_f32_16x16x32_bf16 v[192:195], a[128:131], a[96:99], v[208:211]
  v_accvgpr_write_b32 a224, v76
  v_accvgpr_write_b32 a225, v77
  v_mfma_f32_16x16x32_bf16 v[192:195], a[132:135], a[100:103], v[192:195]
  v_accvgpr_write_b32 a226, v78
  v_accvgpr_write_b32 a227, v79
  v_mfma_f32_16x16x32_bf16 v[192:195], a[136:139], a[104:107], v[192:195]
  v_exp_f32 v196, v196
  v_mfma_f32_16x16x32_bf16 v[192:195], a[140:143], a[108:111], v[192:195]
  s_waitcnt vmcnt(22) lgkmcnt(0)
  v_exp_f32 v197, v197
  v_mfma_f32_16x16x32_bf16 v[68:71], a[168:171], v[128:131], 0
  s_barrier
  v_exp_f32 v198, v198
  v_mfma_f32_16x16x32_bf16 v[68:71], a[172:175], v[132:135], v[68:71]
  v_exp_f32 v199, v199
  v_mfma_f32_16x16x32_bf16 v[76:79], a[168:171], v[136:139], 0
  ds_read_b64_tr_b16 a[160:161], v242 offset:8192
  ds_read_b64_tr_b16 a[162:163], v242 offset:10240
  v_mfma_f32_16x16x32_bf16 v[76:79], a[172:175], v[140:143], v[76:79]
  ds_read_b64_tr_b16 a[164:165], v242 offset:12288
  ds_read_b64_tr_b16 a[166:167], v242 offset:14336
  v_cvt_pk_bf16_f32 v172, v196, v197
  v_cvt_pk_bf16_f32 v173, v198, v199
  v_mfma_f32_16x16x32_bf16 v[196:199], a[128:131], a[112:115], v[212:215]
L_stub7:
  s_cmp_eq_u32 s99, 1
  s_cbranch_scc1 L_ret1
  ds_read_b128 a[128:131], v240 offset:32768
  buffer_load_dwordx4 v246, s[8:11], s40 offen offset:128 nt lds
  v_mfma_f32_16x16x32_bf16 v[196:199], a[132:135], a[116:119], v[196:199]
  s_add_u32 m0, s36, 896
  ds_read_b128 a[132:135], v241 offset:32768
  v_accvgpr_write_b32 a228, v84
  v_mfma_f32_16x16x32_bf16 v[196:199], a[136:139], a[120:123], v[196:199]
  ds_read_b128 a[136:139], v240 offset:34816
  v_accvgpr_write_b32 a229, v85
  v_mfma_f32_16x16x32_bf16 v[196:199], a[140:143], a[124:127], v[196:199]
  ds_read_b128 a[140:143], v241 offset:34816
  v_accvgpr_write_b32 a230, v86
  v_accvgpr_write_b32 a231, v87
  v_mfma_f32_16x16x32_bf16 v[84:87], a[168:171], v[144:147], 0
  v_accvgpr_write_b32 a232, v92
  v_accvgpr_write_b32 a233, v93
  v_mfma_f32_16x16x32_bf16 v[84:87], a[172:175], v[148:151], v[84:87]
  v_accvgpr_write_b32 a234, v94
  v_accvgpr_write_b32 a235, v95
  v_mfma_f32_16x16x32_bf16 v[92:95], a[168:171], v[152:155], 0
  v_exp_f32 v192, v192
  v_exp_f32 v193, v193
  v_exp_f32 v194, v194
  v_exp_f32 v195, v195
  v_mfma_f32_16x16x32_bf16 v[92:95], a[172:175], v[156:159], v[92:95]
  ds_read_b64_tr_b16 a[168:169], v242 offset:8200
  ds_read_b64_tr_b16 a[170:171], v242 offset:10248
  v_cvt_pk_bf16_f32 v180, v192, v193
  v_cvt_pk_bf16_f32 v181, v194, v195
  v_mfma_f32_16x16x32_bf16 v[192:195], a[144:147], a[64:67], v[200:203]
  v_exp_f32 v196, v196
  v_mfma_f32_16x16x32_bf16 v[192:195], a[148:151], a[68:71], v[192:195]
  v_exp_f32 v197, v197
  v_mfma_f32_16x16x32_bf16 v[192:195], a[152:155], a[72:75], v[192:195]
  v_exp_f32 v198, v198
  v_mfma_f32_16x16x32_bf16 v[192:195], a[156:159], a[76:79], v[192:195]
  v_exp_f32 v199, v199
  v_mfma_f32_16x16x32_bf16 v[96:99], a[176:179], v[128:131], 0
  ds_read_b64_tr_b16 a[172:173], v242 offset:12296
  ds_read_b64_tr_b16 a[174:175], v242 offset:14344
  v_mfma_f32_16x16x32_bf16 v[96:99], a[180:183], v[132:135], v[96:99]
  buffer_load_dwordx4 v245, s[4:7], s39 offen offset:2176 nt lds
  v_cvt_pk_bf16_f32 v188, v196, v197
  v_mfma_f32_16x16x32_bf16 v[104:107], a[176:179], v[136:139], 0
  s_add_u32 m0, s37, 57224
  v_cvt_pk_bf16_f32 v189, v198, v199
  v_accvgpr_write_b32 a236, v100
  v_mfma_f32_16x16x32_bf16 v[104:107], a[180:183], v[140:143], v[104:107]
  s_add_u32 s39, s21, 81920
  v_exp_f32 v192, v192
  v_mfma_f32_16x16x32_bf16 v[196:199], a[144:147], a[80:83], v[204:207]
  v_exp_f32 v193, v193
  v_mfma_f32_16x16x32_bf16 v[196:199], a[148:151], a[84:87], v[196:199]
  v_exp_f32 v194, v194
  v_mfma_f32_16x16x32_bf16 v[196:199], a[152:155], a[88:91], v[196:199]
  v_exp_f32 v195, v195
  v_mfma_f32_16x16x32_bf16 v[196:199], a[156:159], a[92:95], v[196:199]
  v_cvt_pk_bf16_f32 v166, v192, v193
  v_cvt_pk_bf16_f32 v167, v194, v195
  v_mfma_f32_16x16x32_bf16 v[112:115], a[176:179], v[144:147], 0
  v_accvgpr_write_b32 a237, v101
  v_accvgpr_write_b32 a238, v102
  v_mfma_f32_16x16x32_bf16 v[112:115], a[180:183], v[148:151], v[112:115]
  v_accvgpr_write_b32 a239, v103
  v_accvgpr_write_b32 a240, v108
  v_mfma_f32_16x16x32_bf16 v[120:123], a[176:179], v[152:155], 0
  ds_read_b64_tr_b16 a[176:177], v243 offset:8192
  ds_read_b64_tr_b16 a[178:179], v243 offset:10240
  v_mfma_f32_16x16x32_bf16 v[120:123], a[180:183], v[156:159], v[120:123]
  ds_read_b64_tr_b16 a[180:181], v243 offset:12288
  ds_read_b64_tr_b16 a[182:183], v243 offset:14336
  v_mfma_f32_16x16x32_bf16 v[192:195], a[144:147], a[96:99], v[208:211]
  buffer_load_dwordx4 v246, s[8:11], s40 offen offset:1152 nt lds
  v_accvgpr_write_b32 a241, v109
  v_mfma_f32_16x16x32_bf16 v[192:195], a[148:151], a[100:103], v[192:195]
  s_add_u32 m0, s36, 16384
  v_accvgpr_write_b32 a242, v110
  v_accvgpr_write_b32 a243, v111
  v_mfma_f32_16x16x32_bf16 v[192:195], a[152:155], a[104:107], v[192:195]
  v_exp_f32 v196, v196
  v_mfma_f32_16x16x32_bf16 v[192:195], a[156:159], a[108:111], v[192:195]
  s_add_u32 s40, s21, 65536
  v_exp_f32 v197, v197
  v_mfma_f32_16x16x32_bf16 v[100:103], a[184:187], v[128:131], 0
  v_exp_f32 v198, v198
  v_mfma_f32_16x16x32_bf16 v[100:103], a[188:191], v[132:135], v[100:103]
  v_exp_f32 v199, v199
  v_mfma_f32_16x16x32_bf16 v[108:111], a[184:187], v[136:139], 0
  v_cvt_pk_bf16_f32 v174, v196, v197
  v_cvt_pk_bf16_f32 v175, v198, v199
  v_mfma_f32_16x16x32_bf16 v[108:111], a[188:191], v[140:143], v[108:111]
  v_accvgpr_write_b32 a244, v116
  v_accvgpr_write_b32 a245, v117
  v_mfma_f32_16x16x32_bf16 v[196:199], a[144:147], a[112:115], v[212:215]
  s_waitcnt vmcnt(23)
  ds_read_b128 a[144:147], v240 offset:36864
  v_accvgpr_write_b32 a246, v118
  v_mfma_f32_16x16x32_bf16 v[196:199], a[148:151], a[116:119], v[196:199]
  ds_read_b128 a[148:151], v241 offset:36864
  v_accvgpr_write_b32 a247, v119
  v_mfma_f32_16x16x32_bf16 v[196:199], a[152:155], a[120:123], v[196:199]
  ds_read_b128 a[152:155], v240 offset:38912
  buffer_load_dwordx4 v245, s[4:7], s39 offen nt lds
  v_mfma_f32_16x16x32_bf16 v[196:199], a[156:159], a[124:127], v[196:199]
  s_add_u32 m0, s37, 0
  ds_read_b128 a[156:159], v241 offset:38912
  v_accvgpr_write_b32 a248, v124
  v_mfma_f32_16x16x32_bf16 v[116:119], a[184:187], v[144:147], 0
  v_accvgpr_write_b32 a249, v125
  v_accvgpr_write_b32 a250, v126
  v_mfma_f32_16x16x32_bf16 v[116:119], a[188:191], v[148:151], v[116:119]
  v_accvgpr_write_b32 a251, v127
  v_cmp_nlt_f32_e64 s[56:57], v226, s44
  v_mfma_f32_16x16x32_bf16 v[124:127], a[184:187], v[152:155], 0
  s_waitcnt lgkmcnt(4)
  v_exp_f32 v192, v192
  v_exp_f32 v193, v193
  v_exp_f32 v194, v194
  v_exp_f32 v195, v195
  v_mfma_f32_16x16x32_bf16 v[124:127], a[188:191], v[156:159], v[124:127]
  s_or_b64 s[46:47], s[46:47], s[56:57]
  ds_read_b64_tr_b16 a[184:185], v243 offset:8200
  ds_read_b64_tr_b16 a[186:187], v243 offset:10248
  v_cvt_pk_bf16_f32 v182, v192, v193
  v_cvt_pk_bf16_f32 v183, v194, v195
  v_mfma_f32_16x16x32_bf16 v[192:195], a[128:131], a[64:67], v[200:203]
  ds_read_b128 v[216:219], v249 offset:2048
  ds_read_b64_tr_b16 a[188:189], v243 offset:12296
  v_mfma_f32_16x16x32_bf16 v[192:195], a[132:135], a[68:71], v[192:195]
  v_exp_f32 v196, v196
  v_mfma_f32_16x16x32_bf16 v[192:195], a[136:139], a[72:75], v[192:195]
  v_exp_f32 v197, v197
  v_mfma_f32_16x16x32_bf16 v[192:195], a[140:143], a[76:79], v[192:195]
  v_exp_f32 v198, v198
  v_mfma_f32_16x16x32_bf16 v[0:3], a[160:163], v[160:163], v[0:3]
  v_exp_f32 v199, v199
  v_mfma_f32_16x16x32_bf16 v[0:3], a[164:167], v[164:167], v[0:3]
  buffer_store_dwordx4 a[52:55], v251, s[16:19], s26 offen sc1
  v_mfma_f32_16x16x32_bf16 v[8:11], a[160:163], v[168:171], v[8:11]
  ds_read_b64_tr_b16 a[190:191], v243 offset:14344
  v_cvt_pk_bf16_f32 v190, v196, v197
  v_mfma_f32_16x16x32_bf16 v[8:11], a[164:167], v[172:175], v[8:11]
  v_cvt_pk_bf16_f32 v191, v198, v199
  v_mfma_f32_16x16x32_bf16 v[196:199], a[128:131], a[80:83], v[204:207]
  v_exp_f32 v192, v192
  v_mfma_f32_16x16x32_bf16 v[196:199], a[132:135], a[84:87], v[196:199]
  v_exp_f32 v193, v193
  v_mfma_f32_16x16x32_bf16 v[196:199], a[136:139], a[88:91], v[196:199]
  v_exp_f32 v194, v194
  v_mfma_f32_16x16x32_bf16 v[196:199], a[140:143], a[92:95], v[196:199]
  v_exp_f32 v195, v195
  v_mfma_f32_16x16x32_bf16 v[16:19], a[160:163], v[176:179], v[16:19]
  s_waitcnt lgkmcnt(1)
  v_lshlrev_b32 v224, 16, v216
  v_cvt_pk_bf16_f32 v128, v192, v193
  v_mfma_f32_16x16x32_bf16 v[16:19], a[164:167], v[180:183], v[16:19]
  v_cvt_pk_bf16_f32 v129, v194, v195
  v_and_b32 v225, 0xffff0000, v216
  v_mfma_f32_16x16x32_bf16 v[24:27], a[160:163], v[184:187], v[24:27]
  ds_read_b64_tr_b16 a[160:161], v242 offset:9216
  ds_read_b64_tr_b16 a[162:163], v242 offset:11264
  v_mfma_f32_16x16x32_bf16 v[24:27], a[164:167], v[188:191], v[24:27]
  ds_read_b64_tr_b16 a[164:165], v242 offset:13312
  ds_read_b64_tr_b16 a[166:167], v242 offset:15360
  v_mfma_f32_16x16x32_bf16 v[192:195], a[128:131], a[96:99], v[208:211]
  buffer_load_dwordx4 v246, s[8:11], s40 offen nt lds
  v_lshlrev_b32 v226, 16, v217
  v_mfma_f32_16x16x32_bf16 v[192:195], a[132:135], a[100:103], v[192:195]
  s_add_u32 m0, s36, 15360
  v_and_b32 v227, 0xffff0000, v217
  v_lshlrev_b32 v228, 16, v218
  v_mfma_f32_16x16x32_bf16 v[192:195], a[136:139], a[104:107], v[192:195]
  v_exp_f32 v196, v196
  v_mfma_f32_16x16x32_bf16 v[192:195], a[140:143], a[108:111], v[192:195]
  v_exp_f32 v197, v197
  v_mfma_f32_16x16x32_bf16 v[4:7], a[168:171], v[160:163], v[4:7]
  v_exp_f32 v198, v198
  v_mfma_f32_16x16x32_bf16 v[4:7], a[172:175], v[164:167], v[4:7]
  v_exp_f32 v199, v199
  v_mfma_f32_16x16x32_bf16 v[12:15], a[168:171], v[168:171], v[12:15]
  v_cvt_pk_bf16_f32 v136, v196, v197
  v_cvt_pk_bf16_f32 v137, v198, v199
  v_mfma_f32_16x16x32_bf16 v[12:15], a[172:175], v[172:175], v[12:15]
  v_and_b32 v229, 0xffff0000, v218
  v_lshlrev_b32 v230, 16, v219
  v_smfmac_f32_16x16x64_bf16 a[192:195], a[208:211], v[160:167], v248
  v_exp_f32 v192, v192
  v_mfma_f32_16x16x32_bf16 v[196:199], a[128:131], a[112:115], v[212:215]
  v_exp_f32 v193, v193
  v_mfma_f32_16x16x32_bf16 v[196:199], a[132:135], a[116:119], v[196:199]
  v_exp_f32 v194, v194
  v_mfma_f32_16x16x32_bf16 v[196:199], a[136:139], a[120:123], v[196:199]
  v_exp_f32 v195, v195
  v_mfma_f32_16x16x32_bf16 v[196:199], a[140:143], a[124:127], v[196:199]
  ds_read_b128 a[128:131], v240 offset:40960
  ds_read_b128 a[132:135], v241 offset:40960
  v_mfma_f32_16x16x32_bf16 v[20:23], a[168:171], v[176:179], v[20:23]
  ds_read_b128 a[136:139], v240 offset:43008
  ds_read_b128 a[140:143], v241 offset:43008
  v_mfma_f32_16x16x32_bf16 v[20:23], a[172:175], v[180:183], v[20:23]
  buffer_load_dwordx4 v245, s[4:7], s39 offen offset:2048 nt lds
  v_and_b32 v231, 0xffff0000, v219
  v_mfma_f32_16x16x32_bf16 v[28:31], a[168:171], v[184:187], v[28:31]
  s_add_u32 m0, s37, 31752
  ds_read_b64_tr_b16 a[168:169], v242 offset:9224
  ds_read_b64_tr_b16 a[170:171], v242 offset:11272
  v_cvt_pk_bf16_f32 v144, v192, v193
  v_cvt_pk_bf16_f32 v145, v194, v195
  v_pk_mul_f32 v[224:225], v[224:225], s[42:43]
  v_pk_mul_f32 v[226:227], v[226:227], s[42:43]
  v_pk_mul_f32 v[228:229], v[228:229], s[42:43]
  v_pk_mul_f32 v[230:231], v[230:231], s[42:43]
  v_mfma_f32_16x16x32_bf16 v[28:31], a[172:175], v[188:191], v[28:31]
  v_exp_f32 v196, v196
  v_mfma_f32_16x16x32_bf16 v[192:195], a[144:147], a[64:67], v[200:203]
  v_exp_f32 v197, v197
  v_mfma_f32_16x16x32_bf16 v[192:195], a[148:151], a[68:71], v[192:195]
  v_exp_f32 v198, v198
  v_mfma_f32_16x16x32_bf16 v[192:195], a[152:155], a[72:75], v[192:195]
  v_exp_f32 v199, v199
  v_mfma_f32_16x16x32_bf16 v[192:195], a[156:159], a[76:79], v[192:195]
  ds_read_b64_tr_b16 a[172:173], v242 offset:13320
  ds_read_b64_tr_b16 a[174:175], v242 offset:15368
  v_mfma_f32_16x16x32_bf16 v[32:35], a[176:179], v[160:163], v[32:35]
  v_cvt_pk_bf16_f32 v152, v196, v197
  v_cvt_pk_bf16_f32 v153, v198, v199
  v_mfma_f32_16x16x32_bf16 v[32:35], a[180:183], v[164:167], v[32:35]
  v_cvt_pk_bf16_f32 v216, v224, v225
  v_cvt_pk_bf16_f32 v217, v226, v227
  v_mfma_f32_16x16x32_bf16 v[40:43], a[176:179], v[168:171], v[40:43]
  v_exp_f32 v192, v192
  v_mfma_f32_16x16x32_bf16 v[40:43], a[180:183], v[172:175], v[40:43]
  v_exp_f32 v193, v193
  v_smfmac_f32_16x16x64_bf16 a[196:199], a[208:211], v[168:175], v248
  v_exp_f32 v194, v194
  v_mfma_f32_16x16x32_bf16 v[196:199], a[144:147], a[80:83], v[204:207]
  v_exp_f32 v195, v195
  v_mfma_f32_16x16x32_bf16 v[196:199], a[148:151], a[84:87], v[196:199]
  buffer_load_dwordx4 v246, s[8:11], s40 offen offset:1024 nt lds
  v_cvt_pk_bf16_f32 v218, v228, v229
  v_mfma_f32_16x16x32_bf16 v[196:199], a[152:155], a[88:91], v[196:199]
  s_add_u32 m0, s36, 18304
  v_cvt_pk_bf16_f32 v130, v192, v193
  v_cvt_pk_bf16_f32 v131, v194, v195
  v_mfma_f32_16x16x32_bf16 v[196:199], a[156:159], a[92:95], v[196:199]
  v_cvt_pk_bf16_f32 v219, v230, v231
  v_accvgpr_write_b32 a0, v216
  v_mfma_f32_16x16x32_bf16 v[48:51], a[176:179], v[176:179], v[48:51]
  v_accvgpr_write_b32 a1, v217
  v_accvgpr_write_b32 a2, v218
  v_mfma_f32_16x16x32_bf16 v[48:51], a[180:183], v[180:183], v[48:51]
  v_accvgpr_write_b32 a3, v219
  v_mfma_f32_16x16x32_bf16 v[56:59], a[176:179], v[184:187], v[56:59]
  ds_read_b128 v[220:223], v250 offset:2048
  ds_read_b64_tr_b16 a[176:177], v243 offset:9216
  v_mfma_f32_16x16x32_bf16 v[56:59], a[180:183], v[188:191], v[56:59]
  v_exp_f32 v196, v196
  v_mfma_f32_16x16x32_bf16 v[192:195], a[144:147], a[96:99], v[208:211]
  v_exp_f32 v197, v197
  v_mfma_f32_16x16x32_bf16 v[192:195], a[148:151], a[100:103], v[192:195]
  v_exp_f32 v198, v198
  v_mfma_f32_16x16x32_bf16 v[192:195], a[152:155], a[104:107], v[192:195]
  v_exp_f32 v199, v199
  v_mfma_f32_16x16x32_bf16 v[192:195], a[156:159], a[108:111], v[192:195]
  ds_read_b64_tr_b16 a[178:179], v243 offset:11264
  ds_read_b64_tr_b16 a[180:181], v243 offset:13312
  v_mfma_f32_16x16x32_bf16 v[36:39], a[184:187], v[160:163], v[36:39]
  s_waitcnt lgkmcnt(4)
  ds_read_b64_tr_b16 a[182:183], v243 offset:15360
  buffer_load_dwordx4 v245, s[4:7], s39 offen offset:128 nt lds
  v_mfma_f32_16x16x32_bf16 v[36:39], a[188:191], v[164:167], v[36:39]
  s_add_u32 m0, s37, 896
  v_cvt_pk_bf16_f32 v138, v196, v197
  v_cvt_pk_bf16_f32 v139, v198, v199
  v_mfma_f32_16x16x32_bf16 v[44:47], a[184:187], v[168:171], v[44:47]
  v_exp_f32 v192, v192
  v_mfma_f32_16x16x32_bf16 v[44:47], a[188:191], v[172:175], v[44:47]
  s_waitcnt lgkmcnt(3)
  v_lshlrev_b32 v224, 16, v220
  v_and_b32 v225, 0xffff0000, v220
  v_smfmac_f32_16x16x64_bf16 a[200:203], a[208:211], v[176:183], v248
  v_exp_f32 v193, v193
  v_mfma_f32_16x16x32_bf16 v[196:199], a[144:147], a[112:115], v[212:215]
  v_exp_f32 v194, v194
  v_mfma_f32_16x16x32_bf16 v[196:199], a[148:151], a[116:119], v[196:199]
  v_exp_f32 v195, v195
  v_mfma_f32_16x16x32_bf16 v[196:199], a[152:155], a[120:123], v[196:199]
  ds_read_b128 a[144:147], v240 offset:45056
  ds_read_b128 a[148:151], v241 offset:45056
  v_mfma_f32_16x16x32_bf16 v[196:199], a[156:159], a[124:127], v[196:199]
  ds_read_b128 a[152:155], v240 offset:47104
  ds_read_b128 a[156:159], v241 offset:47104
  v_mfma_f32_16x16x32_bf16 v[52:55], a[184:187], v[176:179], v[52:55]
  buffer_store_dwordx4 a[56:59], v251, s[16:19], s27 offen sc1
  v_mfma_f32_16x16x32_bf16 v[52:55], a[188:191], v[180:183], v[52:55]
  v_cvt_pk_bf16_f32 v146, v192, v193
  v_cvt_pk_bf16_f32 v147, v194, v195
  v_mfma_f32_16x16x32_bf16 v[60:63], a[184:187], v[184:187], v[60:63]
  ds_read_b64_tr_b16 a[184:185], v243 offset:9224
  ds_read_b64_tr_b16 a[186:187], v243 offset:11272
  v_mfma_f32_16x16x32_bf16 v[60:63], a[188:191], v[188:191], v[60:63]
  ds_read_b64_tr_b16 a[188:189], v243 offset:13320
  ds_read_b64_tr_b16 a[190:191], v243 offset:15368
  v_mfma_f32_16x16x32_bf16 v[192:195], a[128:131], a[64:67], v[200:203]
  v_lshlrev_b32 v226, 16, v221
  v_and_b32 v227, 0xffff0000, v221
  v_mfma_f32_16x16x32_bf16 v[192:195], a[132:135], a[68:71], v[192:195]
  v_lshlrev_b32 v228, 16, v222
  v_and_b32 v229, 0xffff0000, v222
  v_mfma_f32_16x16x32_bf16 v[192:195], a[136:139], a[72:75], v[192:195]
  v_exp_f32 v196, v196
  v_mfma_f32_16x16x32_bf16 v[192:195], a[140:143], a[76:79], v[192:195]
  v_exp_f32 v197, v197
  v_mfma_f32_16x16x32_bf16 v[64:67], a[160:163], v[160:163], v[64:67]
  v_exp_f32 v198, v198
  v_mfma_f32_16x16x32_bf16 v[64:67], a[164:167], v[164:167], v[64:67]
  v_exp_f32 v199, v199
  v_mfma_f32_16x16x32_bf16 v[72:75], a[160:163], v[168:171], v[72:75]
  buffer_load_dwordx4 v246, s[8:11], s40 offen offset:128 nt lds
  v_cvt_pk_bf16_f32 v154, v196, v197
  v_mfma_f32_16x16x32_bf16 v[72:75], a[164:167], v[172:175], v[72:75]
  s_add_u32 m0, s36, 17280
  v_cvt_pk_bf16_f32 v155, v198, v199
  v_lshlrev_b32 v230, 16, v223
  v_smfmac_f32_16x16x64_bf16 a[204:207], a[208:211], v[184:191], v248
  v_exp_f32 v192, v192
  v_mfma_f32_16x16x32_bf16 v[196:199], a[128:131], a[80:83], v[204:207]
  v_exp_f32 v193, v193
  v_mfma_f32_16x16x32_bf16 v[196:199], a[132:135], a[84:87], v[196:199]
  v_and_b32 v231, 0xffff0000, v223
  v_cvt_pk_bf16_f32 v132, v192, v193
  v_mfma_f32_16x16x32_bf16 v[196:199], a[136:139], a[88:91], v[196:199]
  v_exp_f32 v194, v194
  v_exp_f32 v195, v195
  v_pk_mul_f32 v[224:225], v[224:225], s[42:43]
  v_pk_mul_f32 v[226:227], v[226:227], s[42:43]
  v_pk_mul_f32 v[228:229], v[228:229], s[42:43]
  v_pk_mul_f32 v[230:231], v[230:231], s[42:43]
  v_mfma_f32_16x16x32_bf16 v[196:199], a[140:143], a[92:95], v[196:199]
  v_cvt_pk_bf16_f32 v133, v194, v195
  v_cvt_pk_bf16_f32 v220, v224, v225
  v_mfma_f32_16x16x32_bf16 v[80:83], a[160:163], v[176:179], v[80:83]
  v_cvt_pk_bf16_f32 v221, v226, v227
  v_cvt_pk_bf16_f32 v222, v228, v229
  v_mfma_f32_16x16x32_bf16 v[80:83], a[164:167], v[180:183], v[80:83]
  v_cvt_pk_bf16_f32 v223, v230, v231
  v_accvgpr_write_b32 a4, v220
  v_mfma_f32_16x16x32_bf16 v[88:91], a[160:163], v[184:187], v[88:91]
  v_exp_f32 v196, v196
  v_mfma_f32_16x16x32_bf16 v[88:91], a[164:167], v[188:191], v[88:91]
  v_exp_f32 v197, v197
  v_mfma_f32_16x16x32_bf16 v[192:195], a[128:131], a[96:99], v[208:211]
  v_exp_f32 v198, v198
  v_mfma_f32_16x16x32_bf16 v[192:195], a[132:135], a[100:103], v[192:195]
  v_exp_f32 v199, v199
  v_mfma_f32_16x16x32_bf16 v[192:195], a[136:139], a[104:107], v[192:195]
  buffer_load_dwordx4 v245, s[4:7], s39 offen offset:2176 nt lds
  v_cvt_pk_bf16_f32 v140, v196, v197
  v_mfma_f32_16x16x32_bf16 v[192:195], a[140:143], a[108:111], v[192:195]
  s_waitcnt vmcnt(22) lgkmcnt(0)
  v_cvt_pk_bf16_f32 v141, v198, v199
  v_accvgpr_write_b32 a5, v221
  v_mfma_f32_16x16x32_bf16 v[68:71], a[168:171], v[160:163], v[68:71]
  s_barrier
  ds_read_b64_tr_b16 a[160:161], v242 offset:16384
  ds_read_b64_tr_b16 a[162:163], v242 offset:18432
  v_mfma_f32_16x16x32_bf16 v[68:71], a[172:175], v[164:167], v[68:71]
  s_add_u32 m0, s37, 32648
  v_exp_f32 v192, v192
  v_mfma_f32_16x16x32_bf16 v[76:79], a[168:171], v[168:171], v[76:79]
  s_waitcnt vmcnt(21)
  v_exp_f32 v193, v193
  v_mfma_f32_16x16x32_bf16 v[76:79], a[172:175], v[172:175], v[76:79]
  s_add_u32 s39, s21, 98304
  v_exp_f32 v194, v194
  v_mfma_f32_16x16x32_bf16 v[196:199], a[128:131], a[112:115], v[212:215]
  v_exp_f32 v195, v195
  v_mfma_f32_16x16x32_bf16 v[196:199], a[132:135], a[116:119], v[196:199]
  ds_read_b128 a[128:131], v240 offset:49152
  ds_read_b128 a[132:135], v241 offset:49152
  v_mfma_f32_16x16x32_bf16 v[196:199], a[136:139], a[120:123], v[196:199]
  ds_read_b128 a[136:139], v240 offset:51200
  ds_read_b64_tr_b16 a[164:165], v242 offset:20480
  v_mfma_f32_16x16x32_bf16 v[196:199], a[140:143], a[124:127], v[196:199]
  ds_read_b128 a[140:143], v241 offset:51200
  ds_read_b64_tr_b16 a[166:167], v242 offset:22528
  v_mfma_f32_16x16x32_bf16 v[84:87], a[168:171], v[176:179], v[84:87]
  buffer_load_dwordx4 v246, s[8:11], s40 offen offset:1152 nt lds
  v_cvt_pk_bf16_f32 v148, v192, v193
  v_mfma_f32_16x16x32_bf16 v[84:87], a[172:175], v[180:183], v[84:87]
  s_add_u32 m0, s38, 1920
  ds_read_b128 v[216:219], v249 offset:4096
  v_cvt_pk_bf16_f32 v149, v194, v195
  v_mfma_f32_16x16x32_bf16 v[92:95], a[168:171], v[184:187], v[92:95]
  v_exp_f32 v196, v196
  v_mfma_f32_16x16x32_bf16 v[92:95], a[172:175], v[188:191], v[92:95]
  s_add_u32 s40, s21, 81920
  v_exp_f32 v197, v197
  v_mfma_f32_16x16x32_bf16 v[192:195], a[144:147], a[64:67], v[200:203]
  v_exp_f32 v198, v198
  v_mfma_f32_16x16x32_bf16 v[192:195], a[148:151], a[68:71], v[192:195]
  v_exp_f32 v199, v199
  v_mfma_f32_16x16x32_bf16 v[192:195], a[152:155], a[72:75], v[192:195]
  ds_read_b64_tr_b16 a[168:169], v242 offset:16392
  ds_read_b64_tr_b16 a[170:171], v242 offset:18440
  v_mfma_f32_16x16x32_bf16 v[192:195], a[156:159], a[76:79], v[192:195]
  ds_read_b64_tr_b16 a[172:173], v242 offset:20488
  ds_read_b64_tr_b16 a[174:175], v242 offset:22536
  v_mfma_f32_16x16x32_bf16 v[96:99], a[176:179], v[160:163], v[96:99]
  v_accvgpr_write_b32 a6, v222
  v_cvt_pk_bf16_f32 v156, v196, v197
  v_mfma_f32_16x16x32_bf16 v[96:99], a[180:183], v[164:167], v[96:99]
  v_cvt_pk_bf16_f32 v157, v198, v199
  v_accvgpr_write_b32 a7, v223
  v_mfma_f32_16x16x32_bf16 v[104:107], a[176:179], v[168:171], v[104:107]
  s_waitcnt lgkmcnt(4)
  buffer_load_dwordx4 v245, s[12:15], s33 offen offset:128 nt lds
  v_lshlrev_b32 v224, 16, v216
  v_mfma_f32_16x16x32_bf16 v[104:107], a[180:183], v[172:175], v[104:107]
  s_add_u32 m0, s38, 896
  v_and_b32 v225, 0xffff0000, v216
  v_lshlrev_b32 v226, 16, v217
  v_mfma_f32_16x16x32_bf16 v[196:199], a[144:147], a[80:83], v[204:207]
  v_exp_f32 v192, v192
  v_mfma_f32_16x16x32_bf16 v[196:199], a[148:151], a[84:87], v[196:199]
  v_exp_f32 v193, v193
  v_mfma_f32_16x16x32_bf16 v[196:199], a[152:155], a[88:91], v[196:199]
  v_exp_f32 v194, v194
  v_mfma_f32_16x16x32_bf16 v[196:199], a[156:159], a[92:95], v[196:199]
  v_exp_f32 v195, v195
  v_mfma_f32_16x16x32_bf16 v[112:115], a[176:179], v[176:179], v[112:115]
  v_cvt_pk_bf16_f32 v134, v192, v193
  v_cvt_pk_bf16_f32 v135, v194, v195
  v_mfma_f32_16x16x32_bf16 v[112:115], a[180:183], v[180:183], v[112:115]
  v_and_b32 v227, 0xffff0000, v217
  v_lshlrev_b32 v228, 16, v218
  v_mfma_f32_16x16x32_bf16 v[120:123], a[176:179], v[184:187], v[120:123]
  v_exp_f32 v196, v196
  v_mfma_f32_16x16x32_bf16 v[120:123], a[180:183], v[188:191], v[120:123]
  v_exp_f32 v197, v197
  v_mfma_f32_16x16x32_bf16 v[192:195], a[144:147], a[96:99], v[208:211]
  v_exp_f32 v198, v198
  v_mfma_f32_16x16x32_bf16 v[192:195], a[148:151], a[100:103], v[192:195]
  v_exp_f32 v199, v199
  v_mfma_f32_16x16x32_bf16 v[192:195], a[152:155], a[104:107], v[192:195]
  ds_read_b64_tr_b16 a[176:177], v243 offset:16384
  ds_read_b64_tr_b16 a[178:179], v243 offset:18432
  v_mfma_f32_16x16x32_bf16 v[192:195], a[156:159], a[108:111], v[192:195]
  ds_read_b64_tr_b16 a[180:181], v243 offset:20480
  ds_read_b64_tr_b16 a[182:183], v243 offset:22528
  v_mfma_f32_16x16x32_bf16 v[100:103], a[184:187], v[160:163], v[100:103]
  buffer_load_dwordx4 v245, s[12:15], s33 offen offset:2176 nt lds
  v_cvt_pk_bf16_f32 v142, v196, v197
  v_mfma_f32_16x16x32_bf16 v[100:103], a[188:191], v[164:167], v[100:103]
  s_add_u32 m0, s36, 32768
  v_cvt_pk_bf16_f32 v143, v198, v199
  v_and_b32 v229, 0xffff0000, v218
  v_mfma_f32_16x16x32_bf16 v[108:111], a[184:187], v[168:171], v[108:111]
  v_lshlrev_b32 v230, 16, v219
  v_and_b32 v231, 0xffff0000, v219
  v_mfma_f32_16x16x32_bf16 v[108:111], a[188:191], v[172:175], v[108:111]
  v_exp_f32 v192, v192
  v_exp_f32 v193, v193
  v_pk_mul_f32 v[224:225], v[224:225], s[42:43]
  v_pk_mul_f32 v[226:227], v[226:227], s[42:43]
  v_pk_mul_f32 v[228:229], v[228:229], s[42:43]
  v_pk_mul_f32 v[230:231], v[230:231], s[42:43]
  v_mfma_f32_16x16x32_bf16 v[196:199], a[144:147], a[112:115], v[212:215]
  v_exp_f32 v194, v194
  v_mfma_f32_16x16x32_bf16 v[196:199], a[148:151], a[116:119], v[196:199]
  v_exp_f32 v195, v195
  v_mfma_f32_16x16x32_bf16 v[196:199], a[152:155], a[120:123], v[196:199]
  buffer_store_dwordx4 a[60:63], v251, s[16:19], s24 offen offset:2048 sc1
  v_mfma_f32_16x16x32_bf16 v[196:199], a[156:159], a[124:127], v[196:199]
  ds_read_b128 a[144:147], v240 offset:53248
  ds_read_b128 a[148:151], v241 offset:53248
  v_mfma_f32_16x16x32_bf16 v[116:119], a[184:187], v[176:179], v[116:119]
  ds_read_b128 a[152:155], v240 offset:55296
  ds_read_b128 a[156:159], v241 offset:55296
  v_mfma_f32_16x16x32_bf16 v[116:119], a[188:191], v[180:183], v[116:119]
  v_cvt_pk_bf16_f32 v150, v192, v193
  v_cvt_pk_bf16_f32 v151, v194, v195
  v_mfma_f32_16x16x32_bf16 v[124:127], a[184:187], v[184:187], v[124:127]
  v_exp_f32 v196, v196
  v_mfma_f32_16x16x32_bf16 v[124:127], a[188:191], v[188:191], v[124:127]
  v_exp_f32 v197, v197
  v_mfma_f32_16x16x32_bf16 v[192:195], a[128:131], a[64:67], v[200:203]
  v_exp_f32 v198, v198
  v_mfma_f32_16x16x32_bf16 v[192:195], a[132:135], a[68:71], v[192:195]
  v_exp_f32 v199, v199
  v_mfma_f32_16x16x32_bf16 v[192:195], a[136:139], a[72:75], v[192:195]
  ds_read_b64_tr_b16 a[184:185], v243 offset:16392
  ds_read_b64_tr_b16 a[186:187], v243 offset:18440
  v_mfma_f32_16x16x32_bf16 v[192:195], a[140:143], a[76:79], v[192:195]
  ds_read_b64_tr_b16 a[188:189], v243 offset:20488
  ds_read_b64_tr_b16 a[190:191], v243 offset:22536
  v_mfma_f32_16x16x32_bf16 v[0:3], a[160:163], v[128:131], v[0:3]
  buffer_load_dwordx4 v245, s[4:7], s39 offen nt lds
  v_cvt_pk_bf16_f32 v158, v196, v197
  v_mfma_f32_16x16x32_bf16 v[0:3], a[164:167], v[132:135], v[0:3]
  s_add_u32 m0, s37, 8192
  v_cvt_pk_bf16_f32 v159, v198, v199
  v_cvt_pk_bf16_f32 v216, v224, v225
  v_mfma_f32_16x16x32_bf16 v[8:11], a[160:163], v[136:139], v[8:11]
  v_cvt_pk_bf16_f32 v217, v226, v227
  v_cvt_pk_bf16_f32 v218, v228, v229
  v_mfma_f32_16x16x32_bf16 v[8:11], a[164:167], v[140:143], v[8:11]
  v_exp_f32 v192, v192
  v_mfma_f32_16x16x32_bf16 v[196:199], a[128:131], a[80:83], v[204:207]
  v_exp_f32 v193, v193
  v_mfma_f32_16x16x32_bf16 v[196:199], a[132:135], a[84:87], v[196:199]
  v_exp_f32 v194, v194
  v_mfma_f32_16x16x32_bf16 v[196:199], a[136:139], a[88:91], v[196:199]
  v_exp_f32 v195, v195
  v_mfma_f32_16x16x32_bf16 v[196:199], a[140:143], a[92:95], v[196:199]
  v_cvt_pk_bf16_f32 v160, v192, v193
  v_cvt_pk_bf16_f32 v161, v194, v195
  v_mfma_f32_16x16x32_bf16 v[16:19], a[160:163], v[144:147], v[16:19]
  v_cvt_pk_bf16_f32 v219, v230, v231
  v_accvgpr_write_b32 a8, v216
  v_mfma_f32_16x16x32_bf16 v[16:19], a[164:167], v[148:151], v[16:19]
  ds_read_b128 v[220:223], v250 offset:4096
  v_accvgpr_write_b32 a9, v217
  v_mfma_f32_16x16x32_bf16 v[24:27], a[160:163], v[152:155], v[24:27]
  ds_read_b64_tr_b16 a[160:161], v242 offset:17408
  ds_read_b64_tr_b16 a[162:163], v242 offset:19456
  v_mfma_f32_16x16x32_bf16 v[24:27], a[164:167], v[156:159], v[24:27]
  ds_read_b64_tr_b16 a[164:165], v242 offset:21504
  ds_read_b64_tr_b16 a[166:167], v242 offset:23552
  v_mfma_f32_16x16x32_bf16 v[192:195], a[128:131], a[96:99], v[208:211]
  buffer_load_dwordx4 v246, s[8:11], s40 offen nt lds
  v_accvgpr_write_b32 a10, v218
  v_mfma_f32_16x16x32_bf16 v[192:195], a[132:135], a[100:103], v[192:195]
  s_add_u32 m0, s36, 31744
  v_exp_f32 v196, v196
  v_mfma_f32_16x16x32_bf16 v[192:195], a[136:139], a[104:107], v[192:195]
  v_exp_f32 v197, v197
  v_mfma_f32_16x16x32_bf16 v[192:195], a[140:143], a[108:111], v[192:195]
  s_waitcnt lgkmcnt(5)
  v_exp_f32 v198, v198
  v_mfma_f32_16x16x32_bf16 v[4:7], a[168:171], v[128:131], v[4:7]
  v_exp_f32 v199, v199
  v_mfma_f32_16x16x32_bf16 v[4:7], a[172:175], v[132:135], v[4:7]
  v_cvt_pk_bf16_f32 v168, v196, v197
  v_cvt_pk_bf16_f32 v169, v198, v199
  v_mfma_f32_16x16x32_bf16 v[12:15], a[168:171], v[136:139], v[12:15]
  s_waitcnt lgkmcnt(0)
  v_accvgpr_write_b32 a11, v219
  v_lshlrev_b32 v224, 16, v220
  v_mfma_f32_16x16x32_bf16 v[12:15], a[172:175], v[140:143], v[12:15]
  v_and_b32 v225, 0xffff0000, v220
  v_lshlrev_b32 v226, 16, v221
  v_smfmac_f32_16x16x64_bf16 a[192:195], a[208:211], v[128:135], v248
  v_exp_f32 v192, v192
  v_mfma_f32_16x16x32_bf16 v[196:199], a[128:131], a[112:115], v[212:215]
  v_exp_f32 v193, v193
  v_mfma_f32_16x16x32_bf16 v[196:199], a[132:135], a[116:119], v[196:199]
  v_exp_f32 v194, v194
  v_mfma_f32_16x16x32_bf16 v[196:199], a[136:139], a[120:123], v[196:199]
  v_exp_f32 v195, v195
  v_mfma_f32_16x16x32_bf16 v[196:199], a[140:143], a[124:127], v[196:199]
  ds_read_b128 a[128:131], v240 offset:57344
  ds_read_b128 a[132:135], v241 offset:57344
  v_mfma_f32_16x16x32_bf16 v[20:23], a[168:171], v[144:147], v[20:23]
  ds_read_b128 a[136:139], v240 offset:59392
  ds_read_b128 a[140:143], v241 offset:59392
  v_mfma_f32_16x16x32_bf16 v[20:23], a[172:175], v[148:151], v[20:23]
  buffer_load_dwordx4 v245, s[4:7], s39 offen offset:2048 nt lds
  v_cvt_pk_bf16_f32 v176, v192, v193
  v_mfma_f32_16x16x32_bf16 v[28:31], a[168:171], v[152:155], v[28:31]
  s_add_u32 m0, s37, 39944
  ds_read_b64_tr_b16 a[168:169], v242 offset:17416
  ds_read_b64_tr_b16 a[170:171], v242 offset:19464
  v_mfma_f32_16x16x32_bf16 v[28:31], a[172:175], v[156:159], v[28:31]
L_stub8:
  s_cmp_eq_u32 s99, 1
  s_cbranch_scc1 L_ret2
  ds_read_b64_tr_b16 a[172:173], v242 offset:21512
  ds_read_b64_tr_b16 a[174:175], v242 offset:23560
  v_cvt_pk_bf16_f32 v177, v194, v195
  v_mfma_f32_16x16x32_bf16 v[192:195], a[144:147], a[64:67], v[200:203]
  v_and_b32 v227, 0xffff0000, v221
  v_lshlrev_b32 v228, 16, v222
  v_mfma_f32_16x16x32_bf16 v[192:195], a[148:151], a[68:71], v[192:195]
  v_and_b32 v229, 0xffff0000, v222
  v_lshlrev_b32 v230, 16, v223
  v_mfma_f32_16x16x32_bf16 v[192:195], a[152:155], a[72:75], v[192:195]
  v_exp_f32 v196, v196
  v_mfma_f32_16x16x32_bf16 v[192:195], a[156:159], a[76:79], v[192:195]
  v_exp_f32 v197, v197
  v_mfma_f32_16x16x32_bf16 v[32:35], a[176:179], v[128:131], v[32:35]
  v_exp_f32 v198, v198
  v_mfma_f32_16x16x32_bf16 v[32:35], a[180:183], v[132:135], v[32:35]
  v_exp_f32 v199, v199
  v_mfma_f32_16x16x32_bf16 v[40:43], a[176:179], v[136:139], v[40:43]
  v_cvt_pk_bf16_f32 v184, v196, v197
  v_cvt_pk_bf16_f32 v185, v198, v199
  v_mfma_f32_16x16x32_bf16 v[40:43], a[180:183], v[140:143], v[40:43]
  buffer_load_dwordx4 v246, s[8:11], s40 offen offset:1024 nt lds
  v_and_b32 v231, 0xffff0000, v223
  v_smfmac_f32_16x16x64_bf16 a[196:199], a[208:211], v[136:143], v248
  s_add_u32 m0, s36, 34688
  v_exp_f32 v192, v192
  v_exp_f32 v193, v193
  v_pk_mul_f32 v[224:225], v[224:225], s[42:43]
  v_pk_mul_f32 v[226:227], v[226:227], s[42:43]
  v_pk_mul_f32 v[228:229], v[228:229], s[42:43]
  v_pk_mul_f32 v[230:231], v[230:231], s[42:43]
  v_mfma_f32_16x16x32_bf16 v[196:199], a[144:147], a[80:83], v[204:207]
  v_exp_f32 v194, v194
  v_mfma_f32_16x16x32_bf16 v[196:199], a[148:151], a[84:87], v[196:199]
  v_exp_f32 v195, v195
  v_mfma_f32_16x16x32_bf16 v[196:199], a[152:155], a[88:91], v[196:199]
  v_cvt_pk_bf16_f32 v162, v192, v193
  v_cvt_pk_bf16_f32 v163, v194, v195
  v_mfma_f32_16x16x32_bf16 v[196:199], a[156:159], a[92:95], v[196:199]
  v_cvt_pk_bf16_f32 v220, v224, v225
  v_cvt_pk_bf16_f32 v221, v226, v227
  v_mfma_f32_16x16x32_bf16 v[48:51], a[176:179], v[144:147], v[48:51]
  v_cvt_pk_bf16_f32 v222, v228, v229
  v_cvt_pk_bf16_f32 v223, v230, v231
  v_mfma_f32_16x16x32_bf16 v[48:51], a[180:183], v[148:151], v[48:51]
  v_accvgpr_write_b32 a12, v220
  v_accvgpr_write_b32 a13, v221
  v_mfma_f32_16x16x32_bf16 v[56:59], a[176:179], v[152:155], v[56:59]
  v_exp_f32 v196, v196
  v_mfma_f32_16x16x32_bf16 v[56:59], a[180:183], v[156:159], v[56:59]
  v_exp_f32 v197, v197
  v_mfma_f32_16x16x32_bf16 v[192:195], a[144:147], a[96:99], v[208:211]
  v_exp_f32 v198, v198
  v_mfma_f32_16x16x32_bf16 v[192:195], a[148:151], a[100:103], v[192:195]
  v_exp_f32 v199, v199
  v_mfma_f32_16x16x32_bf16 v[192:195], a[152:155], a[104:107], v[192:195]
  ds_read_b64_tr_b16 a[176:177], v243 offset:17408
  ds_read_b64_tr_b16 a[178:179], v243 offset:19456
  v_mfma_f32_16x16x32_bf16 v[192:195], a[156:159], a[108:111], v[192:195]
  ds_read_b64_tr_b16 a[180:181], v243 offset:21504
  ds_read_b64_tr_b16 a[182:183], v243 offset:23552
  v_mfma_f32_16x16x32_bf16 v[36:39], a[184:187], v[128:131], v[36:39]
  s_waitcnt vmcnt(26)
  buffer_store_dwordx4 a[212:215], v251, s[16:19], s25 offen offset:2048 sc1
  v_mfma_f32_16x16x32_bf16 v[36:39], a[188:191], v[132:135], v[36:39]
  v_cvt_pk_bf16_f32 v170, v196, v197
  v_cvt_pk_bf16_f32 v171, v198, v199
  v_mfma_f32_16x16x32_bf16 v[44:47], a[184:187], v[136:139], v[44:47]
  v_exp_f32 v192, v192
  v_mfma_f32_16x16x32_bf16 v[44:47], a[188:191], v[140:143], v[44:47]
  v_exp_f32 v193, v193
  v_smfmac_f32_16x16x64_bf16 a[200:203], a[208:211], v[144:151], v248
  v_exp_f32 v194, v194
  v_mfma_f32_16x16x32_bf16 v[196:199], a[144:147], a[112:115], v[212:215]
  v_exp_f32 v195, v195
  v_mfma_f32_16x16x32_bf16 v[196:199], a[148:151], a[116:119], v[196:199]
  ds_read_b128 a[144:147], v240 offset:61440
  ds_read_b128 a[148:151], v241 offset:61440
  v_mfma_f32_16x16x32_bf16 v[196:199], a[152:155], a[120:123], v[196:199]
  ds_read_b128 a[152:155], v240 offset:63488
  v_cvt_pk_bf16_f32 v178, v192, v193
  v_mfma_f32_16x16x32_bf16 v[196:199], a[156:159], a[124:127], v[196:199]
  ds_read_b128 v[216:219], v249 offset:0
  ds_read_b128 a[156:159], v241 offset:63488
  v_mfma_f32_16x16x32_bf16 v[52:55], a[184:187], v[144:147], v[52:55]
  v_cvt_pk_bf16_f32 v179, v194, v195
  v_accvgpr_write_b32 a14, v222
  v_mfma_f32_16x16x32_bf16 v[52:55], a[188:191], v[148:151], v[52:55]
  buffer_load_dwordx4 v245, s[4:7], s39 offen offset:128 nt lds
  v_accvgpr_write_b32 a15, v223
  v_mfma_f32_16x16x32_bf16 v[60:63], a[184:187], v[152:155], v[60:63]
  s_add_u32 m0, s37, 9088
  v_exp_f32 v196, v196
  v_mfma_f32_16x16x32_bf16 v[60:63], a[188:191], v[156:159], v[60:63]
  s_waitcnt lgkmcnt(5)
  v_exp_f32 v197, v197
  v_mfma_f32_16x16x32_bf16 v[192:195], a[128:131], a[64:67], v[200:203]
  v_exp_f32 v198, v198
  v_mfma_f32_16x16x32_bf16 v[192:195], a[132:135], a[68:71], v[192:195]
  v_exp_f32 v199, v199
  v_mfma_f32_16x16x32_bf16 v[192:195], a[136:139], a[72:75], v[192:195]
  ds_read_b64_tr_b16 a[184:185], v243 offset:17416
  ds_read_b64_tr_b16 a[186:187], v243 offset:19464
  v_mfma_f32_16x16x32_bf16 v[192:195], a[140:143], a[76:79], v[192:195]
  ds_read_b64_tr_b16 a[188:189], v243 offset:21512
  ds_read_b64_tr_b16 a[190:191], v243 offset:23560
  v_mfma_f32_16x16x32_bf16 v[64:67], a[160:163], v[128:131], v[64:67]
  v_cvt_pk_bf16_f32 v186, v196, v197
  v_cvt_pk_bf16_f32 v187, v198, v199
  v_mfma_f32_16x16x32_bf16 v[64:67], a[164:167], v[132:135], v[64:67]
  s_waitcnt lgkmcnt(4)
  v_lshlrev_b32 v224, 16, v216
  v_and_b32 v225, 0xffff0000, v216
  v_mfma_f32_16x16x32_bf16 v[72:75], a[160:163], v[136:139], v[72:75]
  v_lshlrev_b32 v226, 16, v217
  v_and_b32 v227, 0xffff0000, v217
  v_mfma_f32_16x16x32_bf16 v[72:75], a[164:167], v[140:143], v[72:75]
  v_exp_f32 v192, v192
  v_smfmac_f32_16x16x64_bf16 a[204:207], a[208:211], v[152:159], v248
  v_exp_f32 v193, v193
  v_mfma_f32_16x16x32_bf16 v[196:199], a[128:131], a[80:83], v[204:207]
  v_exp_f32 v194, v194
  v_mfma_f32_16x16x32_bf16 v[196:199], a[132:135], a[84:87], v[196:199]
  v_exp_f32 v195, v195
  v_mfma_f32_16x16x32_bf16 v[196:199], a[136:139], a[88:91], v[196:199]
  buffer_load_dwordx4 v246, s[8:11], s40 offen offset:128 nt lds
  v_cvt_pk_bf16_f32 v164, v192, v193
  v_mfma_f32_16x16x32_bf16 v[196:199], a[140:143], a[92:95], v[196:199]
  s_add_u32 m0, s36, 33664
  v_cvt_pk_bf16_f32 v165, v194, v195
  v_lshlrev_b32 v228, 16, v218
  v_mfma_f32_16x16x32_bf16 v[80:83], a[160:163], v[144:147], v[80:83]
  v_and_b32 v229, 0xffff0000, v218
  v_lshlrev_b32 v230, 16, v219
  v_mfma_f32_16x16x32_bf16 v[80:83], a[164:167], v[148:151], v[80:83]
  v_and_b32 v231, 0xffff0000, v219
  v_mfma_f32_16x16x32_bf16 v[88:91], a[160:163], v[152:155], v[88:91]
  v_exp_f32 v196, v196
  v_mfma_f32_16x16x32_bf16 v[88:91], a[164:167], v[156:159], v[88:91]
  v_exp_f32 v197, v197
  v_mfma_f32_16x16x32_bf16 v[192:195], a[128:131], a[96:99], v[208:211]
  v_exp_f32 v198, v198
  v_mfma_f32_16x16x32_bf16 v[192:195], a[132:135], a[100:103], v[192:195]
  v_exp_f32 v199, v199
  v_mfma_f32_16x16x32_bf16 v[192:195], a[136:139], a[104:107], v[192:195]
  v_cvt_pk_bf16_f32 v172, v196, v197
  v_cvt_pk_bf16_f32 v173, v198, v199
  v_mfma_f32_16x16x32_bf16 v[192:195], a[140:143], a[108:111], v[192:195]
  s_waitcnt vmcnt(20) lgkmcnt(0)
  v_mfma_f32_16x16x32_bf16 v[68:71], a[168:171], v[128:131], v[68:71]
  s_barrier
  buffer_load_dwordx4 v245, s[4:7], s39 offen offset:2176 nt lds
  ds_read_b64_tr_b16 a[160:161], v242 offset:24576
  v_mfma_f32_16x16x32_bf16 v[68:71], a[172:175], v[132:135], v[68:71]
  s_add_u32 m0, s38, 4096
  ds_read_b64_tr_b16 a[162:163], v242 offset:26624
  ds_read_b64_tr_b16 a[164:165], v242 offset:28672
  v_mfma_f32_16x16x32_bf16 v[76:79], a[168:171], v[136:139], v[76:79]
  v_exp_f32 v192, v192
  v_exp_f32 v193, v193
  v_pk_mul_f32 v[224:225], v[224:225], s[42:43]
  v_pk_mul_f32 v[226:227], v[226:227], s[42:43]
  v_pk_mul_f32 v[228:229], v[228:229], s[42:43]
  v_pk_mul_f32 v[230:231], v[230:231], s[42:43]
  v_mfma_f32_16x16x32_bf16 v[76:79], a[172:175], v[140:143], v[76:79]
  s_add_u32 s39, s21, 114688
  v_exp_f32 v194, v194
  v_mfma_f32_16x16x32_bf16 v[196:199], a[128:131], a[112:115], v[212:215]
  v_exp_f32 v195, v195
  v_mfma_f32_16x16x32_bf16 v[196:199], a[132:135], a[116:119], v[196:199]
  ds_read_b128 a[128:131], v240 offset:0
  ds_read_b128 a[132:135], v241 offset:0
  v_mfma_f32_16x16x32_bf16 v[196:199], a[136:139], a[120:123], v[196:199]
  ds_read_b128 a[136:139], v240 offset:2048
  ds_read_b64_tr_b16 a[166:167], v242 offset:30720
  v_mfma_f32_16x16x32_bf16 v[196:199], a[140:143], a[124:127], v[196:199]
  ds_read_b128 a[140:143], v241 offset:2048
  v_cvt_pk_bf16_f32 v180, v192, v193
  v_mfma_f32_16x16x32_bf16 v[84:87], a[168:171], v[144:147], v[84:87]
  v_cvt_pk_bf16_f32 v181, v194, v195
  v_cvt_pk_bf16_f32 v216, v224, v225
  v_mfma_f32_16x16x32_bf16 v[84:87], a[172:175], v[148:151], v[84:87]
  v_cvt_pk_bf16_f32 v217, v226, v227
  v_cvt_pk_bf16_f32 v218, v228, v229
  v_mfma_f32_16x16x32_bf16 v[92:95], a[168:171], v[152:155], v[92:95]
  v_exp_f32 v196, v196
  v_mfma_f32_16x16x32_bf16 v[92:95], a[172:175], v[156:159], v[92:95]
  v_exp_f32 v197, v197
  v_mfma_f32_16x16x32_bf16 v[192:195], a[144:147], a[64:67], v[200:203]
  v_exp_f32 v198, v198
  v_mfma_f32_16x16x32_bf16 v[192:195], a[148:151], a[68:71], v[192:195]
  v_exp_f32 v199, v199
  v_mfma_f32_16x16x32_bf16 v[192:195], a[152:155], a[72:75], v[192:195]
  buffer_load_dwordx4 v245, s[12:15], s34 offen nt lds
  ds_read_b64_tr_b16 a[168:169], v242 offset:24584
  v_mfma_f32_16x16x32_bf16 v[192:195], a[156:159], a[76:79], v[192:195]
  s_add_u32 m0, s38, 3072
  ds_read_b64_tr_b16 a[170:171], v242 offset:26632
  ds_read_b64_tr_b16 a[172:173], v242 offset:28680
  v_mfma_f32_16x16x32_bf16 v[96:99], a[176:179], v[128:131], v[96:99]
  ds_read_b64_tr_b16 a[174:175], v242 offset:30728
  v_cvt_pk_bf16_f32 v188, v196, v197
  v_mfma_f32_16x16x32_bf16 v[96:99], a[180:183], v[132:135], v[96:99]
  v_cvt_pk_bf16_f32 v189, v198, v199
  v_cvt_pk_bf16_f32 v219, v230, v231
  v_mfma_f32_16x16x32_bf16 v[104:107], a[176:179], v[136:139], v[104:107]
  v_exp_f32 v192, v192
  v_mfma_f32_16x16x32_bf16 v[104:107], a[180:183], v[140:143], v[104:107]
  v_exp_f32 v193, v193
  v_mfma_f32_16x16x32_bf16 v[196:199], a[144:147], a[80:83], v[204:207]
  v_exp_f32 v194, v194
  v_mfma_f32_16x16x32_bf16 v[196:199], a[148:151], a[84:87], v[196:199]
  v_exp_f32 v195, v195
  v_mfma_f32_16x16x32_bf16 v[196:199], a[152:155], a[88:91], v[196:199]
  ds_read_b128 v[220:223], v250 offset:0
  v_accvgpr_write_b32 a16, v216
  v_mfma_f32_16x16x32_bf16 v[196:199], a[156:159], a[92:95], v[196:199]
  v_cvt_pk_bf16_f32 v166, v192, v193
  v_cvt_pk_bf16_f32 v167, v194, v195
  v_mfma_f32_16x16x32_bf16 v[112:115], a[176:179], v[144:147], v[112:115]
  buffer_load_dwordx4 v245, s[12:15], s34 offen offset:2048 nt lds
  v_accvgpr_write_b32 a17, v217
  v_mfma_f32_16x16x32_bf16 v[112:115], a[180:183], v[148:151], v[112:115]
  s_add_u32 m0, s37, 40840
  v_accvgpr_write_b32 a18, v218
  v_accvgpr_write_b32 a19, v219
  v_mfma_f32_16x16x32_bf16 v[120:123], a[176:179], v[152:155], v[120:123]
  v_exp_f32 v196, v196
  v_mfma_f32_16x16x32_bf16 v[120:123], a[180:183], v[156:159], v[120:123]
  v_exp_f32 v197, v197
  v_mfma_f32_16x16x32_bf16 v[192:195], a[144:147], a[96:99], v[208:211]
  v_exp_f32 v198, v198
  v_mfma_f32_16x16x32_bf16 v[192:195], a[148:151], a[100:103], v[192:195]
  v_exp_f32 v199, v199
  v_mfma_f32_16x16x32_bf16 v[192:195], a[152:155], a[104:107], v[192:195]
  buffer_store_dwordx4 a[216:219], v251, s[16:19], s26 offen offset:2048 sc1
  v_mfma_f32_16x16x32_bf16 v[192:195], a[156:159], a[108:111], v[192:195]
  ds_read_b64_tr_b16 a[176:177], v243 offset:24576
  ds_read_b64_tr_b16 a[178:179], v243 offset:26624
  v_mfma_f32_16x16x32_bf16 v[100:103], a[184:187], v[128:131], v[100:103]
  ds_read_b64_tr_b16 a[180:181], v243 offset:28672
  ds_read_b64_tr_b16 a[182:183], v243 offset:30720
  v_mfma_f32_16x16x32_bf16 v[100:103], a[188:191], v[132:135], v[100:103]
  v_cvt_pk_bf16_f32 v174, v196, v197
  v_cvt_pk_bf16_f32 v175, v198, v199
  v_mfma_f32_16x16x32_bf16 v[108:111], a[184:187], v[136:139], v[108:111]
  s_waitcnt lgkmcnt(4)
  v_lshlrev_b32 v224, 16, v220
  v_and_b32 v225, 0xffff0000, v220
  v_mfma_f32_16x16x32_bf16 v[108:111], a[188:191], v[140:143], v[108:111]
  v_lshlrev_b32 v226, 16, v221
  v_and_b32 v227, 0xffff0000, v221
  v_mfma_f32_16x16x32_bf16 v[196:199], a[144:147], a[112:115], v[212:215]
  v_exp_f32 v192, v192
  v_mfma_f32_16x16x32_bf16 v[196:199], a[148:151], a[116:119], v[196:199]
  v_exp_f32 v193, v193
  v_mfma_f32_16x16x32_bf16 v[196:199], a[152:155], a[120:123], v[196:199]
  v_exp_f32 v194, v194
  v_mfma_f32_16x16x32_bf16 v[196:199], a[156:159], a[124:127], v[196:199]
  v_exp_f32 v195, v195
  v_mfma_f32_16x16x32_bf16 v[116:119], a[184:187], v[144:147], v[116:119]
  ds_read_b128 a[144:147], v240 offset:4096
  ds_read_b128 a[148:151], v241 offset:4096
  v_mfma_f32_16x16x32_bf16 v[116:119], a[188:191], v[148:151], v[116:119]
  ds_read_b128 a[152:155], v240 offset:6144
  ds_read_b128 a[156:159], v241 offset:6144
  v_mfma_f32_16x16x32_bf16 v[124:127], a[184:187], v[152:155], v[124:127]
  ds_read_b64_tr_b16 a[184:185], v243 offset:24584
  ds_read_b64_tr_b16 a[186:187], v243 offset:26632
  v_mfma_f32_16x16x32_bf16 v[124:127], a[188:191], v[156:159], v[124:127]
  ds_read_b64_tr_b16 a[188:189], v243 offset:28680
  ds_read_b64_tr_b16 a[190:191], v243 offset:30728
  v_cvt_pk_bf16_f32 v182, v192, v193
  v_cvt_pk_bf16_f32 v183, v194, v195
  v_mfma_f32_16x16x32_bf16 v[192:195], a[128:131], a[64:67], v[200:203]
  buffer_load_dwordx4 v246, s[8:11], s40 offen offset:1152 nt lds
  v_lshlrev_b32 v228, 16, v222
  v_mfma_f32_16x16x32_bf16 v[192:195], a[132:135], a[68:71], v[192:195]
  s_add_u32 m0, s36, 49152
  v_and_b32 v229, 0xffff0000, v222
  v_lshlrev_b32 v230, 16, v223
  v_mfma_f32_16x16x32_bf16 v[192:195], a[136:139], a[72:75], v[192:195]
  v_exp_f32 v196, v196
  v_mfma_f32_16x16x32_bf16 v[192:195], a[140:143], a[76:79], v[192:195]
  s_add_u32 s40, s21, 98304
  v_exp_f32 v197, v197
  v_mfma_f32_16x16x32_bf16 v[0:3], a[160:163], v[160:163], v[0:3]
  v_exp_f32 v198, v198
  v_mfma_f32_16x16x32_bf16 v[0:3], a[164:167], v[164:167], v[0:3]
  v_exp_f32 v199, v199
  v_mfma_f32_16x16x32_bf16 v[8:11], a[160:163], v[168:171], v[8:11]
  v_cvt_pk_bf16_f32 v190, v196, v197
  v_cvt_pk_bf16_f32 v191, v198, v199
  v_mfma_f32_16x16x32_bf16 v[8:11], a[164:167], v[172:175], v[8:11]
  v_exp_f32 v192, v192
  v_mfma_f32_16x16x32_bf16 v[196:199], a[128:131], a[80:83], v[204:207]
  v_exp_f32 v193, v193
  v_mfma_f32_16x16x32_bf16 v[196:199], a[132:135], a[84:87], v[196:199]
  v_and_b32 v231, 0xffff0000, v223
  v_cvt_pk_bf16_f32 v128, v192, v193
  v_mfma_f32_16x16x32_bf16 v[196:199], a[136:139], a[88:91], v[196:199]
  v_exp_f32 v194, v194
  v_exp_f32 v195, v195
  v_pk_mul_f32 v[224:225], v[224:225], s[42:43]
  v_pk_mul_f32 v[226:227], v[226:227], s[42:43]
  v_pk_mul_f32 v[228:229], v[228:229], s[42:43]
  v_pk_mul_f32 v[230:231], v[230:231], s[42:43]
  v_mfma_f32_16x16x32_bf16 v[196:199], a[140:143], a[92:95], v[196:199]
  buffer_load_dwordx4 v245, s[4:7], s39 offen nt lds
  v_cvt_pk_bf16_f32 v129, v194, v195
  v_mfma_f32_16x16x32_bf16 v[16:19], a[160:163], v[176:179], v[16:19]
  s_add_u32 m0, s37, 16384
  v_cvt_pk_bf16_f32 v220, v224, v225
  v_cvt_pk_bf16_f32 v221, v226, v227
  v_mfma_f32_16x16x32_bf16 v[16:19], a[164:167], v[180:183], v[16:19]
  v_cvt_pk_bf16_f32 v222, v228, v229
  v_cvt_pk_bf16_f32 v223, v230, v231
  v_mfma_f32_16x16x32_bf16 v[24:27], a[160:163], v[184:187], v[24:27]
  v_exp_f32 v196, v196
  v_mfma_f32_16x16x32_bf16 v[24:27], a[164:167], v[188:191], v[24:27]
  v_exp_f32 v197, v197
  v_mfma_f32_16x16x32_bf16 v[192:195], a[128:131], a[96:99], v[208:211]
  v_exp_f32 v198, v198
  v_mfma_f32_16x16x32_bf16 v[192:195], a[132:135], a[100:103], v[192:195]
  v_exp_f32 v199, v199
  v_mfma_f32_16x16x32_bf16 v[192:195], a[136:139], a[104:107], v[192:195]
  ds_read_b64_tr_b16 a[160:161], v242 offset:25600
  ds_read_b64_tr_b16 a[162:163], v242 offset:27648
  v_mfma_f32_16x16x32_bf16 v[192:195], a[140:143], a[108:111], v[192:195]
  s_waitcnt vmcnt(14)
  ds_read_b64_tr_b16 a[164:165], v242 offset:29696
  ds_read_b64_tr_b16 a[166:167], v242 offset:31744
  v_mfma_f32_16x16x32_bf16 v[4:7], a[168:171], v[160:163], v[4:7]
  v_cvt_pk_bf16_f32 v136, v196, v197
  v_cvt_pk_bf16_f32 v137, v198, v199
  v_mfma_f32_16x16x32_bf16 v[4:7], a[172:175], v[164:167], v[4:7]
  buffer_load_dwordx4 v246, s[8:11], s40 offen nt lds
  v_accvgpr_write_b32 a20, v220
  v_mfma_f32_16x16x32_bf16 v[12:15], a[168:171], v[168:171], v[12:15]
  s_add_u32 m0, s36, 48128
  v_exp_f32 v192, v192
  v_mfma_f32_16x16x32_bf16 v[12:15], a[172:175], v[172:175], v[12:15]
  v_exp_f32 v193, v193
  v_smfmac_f32_16x16x64_bf16 a[192:195], a[208:211], v[160:167], v248
  v_exp_f32 v194, v194
  v_mfma_f32_16x16x32_bf16 v[196:199], a[128:131], a[112:115], v[212:215]
  v_exp_f32 v195, v195
  v_mfma_f32_16x16x32_bf16 v[196:199], a[132:135], a[116:119], v[196:199]
  ds_read_b128 a[128:131], v240 offset:8192
  ds_read_b128 a[132:135], v241 offset:8192
  v_mfma_f32_16x16x32_bf16 v[196:199], a[136:139], a[120:123], v[196:199]
  ds_read_b128 v[216:219], v249 offset:2048
  ds_read_b128 a[136:139], v240 offset:10240
  v_mfma_f32_16x16x32_bf16 v[196:199], a[140:143], a[124:127], v[196:199]
  ds_read_b128 a[140:143], v241 offset:10240
  v_cvt_pk_bf16_f32 v144, v192, v193
  v_mfma_f32_16x16x32_bf16 v[20:23], a[168:171], v[176:179], v[20:23]
  v_cvt_pk_bf16_f32 v145, v194, v195
  v_accvgpr_write_b32 a21, v221
  v_mfma_f32_16x16x32_bf16 v[20:23], a[172:175], v[180:183], v[20:23]
  v_accvgpr_write_b32 a22, v222
  v_accvgpr_write_b32 a23, v223
  v_mfma_f32_16x16x32_bf16 v[28:31], a[168:171], v[184:187], v[28:31]
  v_exp_f32 v196, v196
  v_mfma_f32_16x16x32_bf16 v[28:31], a[172:175], v[188:191], v[28:31]
  s_waitcnt lgkmcnt(5)
  v_exp_f32 v197, v197
  v_mfma_f32_16x16x32_bf16 v[192:195], a[144:147], a[64:67], v[200:203]
  v_exp_f32 v198, v198
  v_mfma_f32_16x16x32_bf16 v[192:195], a[148:151], a[68:71], v[192:195]
  v_exp_f32 v199, v199
  v_mfma_f32_16x16x32_bf16 v[192:195], a[152:155], a[72:75], v[192:195]
  ds_read_b64_tr_b16 a[168:169], v242 offset:25608
  ds_read_b64_tr_b16 a[170:171], v242 offset:27656
  v_mfma_f32_16x16x32_bf16 v[192:195], a[156:159], a[76:79], v[192:195]
  ds_read_b64_tr_b16 a[172:173], v242 offset:29704
  ds_read_b64_tr_b16 a[174:175], v242 offset:31752
  v_mfma_f32_16x16x32_bf16 v[32:35], a[176:179], v[160:163], v[32:35]
  s_waitcnt lgkmcnt(4)
  buffer_load_dwordx4 v245, s[4:7], s39 offen offset:2048 nt lds
  v_cvt_pk_bf16_f32 v152, v196, v197
  v_mfma_f32_16x16x32_bf16 v[32:35], a[180:183], v[164:167], v[32:35]
  s_add_u32 m0, s37, 48136
  v_cvt_pk_bf16_f32 v153, v198, v199
  v_lshlrev_b32 v224, 16, v216
  v_mfma_f32_16x16x32_bf16 v[40:43], a[176:179], v[168:171], v[40:43]
  v_and_b32 v225, 0xffff0000, v216
  v_lshlrev_b32 v226, 16, v217
  v_mfma_f32_16x16x32_bf16 v[40:43], a[180:183], v[172:175], v[40:43]
  v_exp_f32 v192, v192
  v_smfmac_f32_16x16x64_bf16 a[196:199], a[208:211], v[168:175], v248
  v_exp_f32 v193, v193
  v_mfma_f32_16x16x32_bf16 v[196:199], a[144:147], a[80:83], v[204:207]
  v_exp_f32 v194, v194
  v_mfma_f32_16x16x32_bf16 v[196:199], a[148:151], a[84:87], v[196:199]
  v_exp_f32 v195, v195
  v_mfma_f32_16x16x32_bf16 v[196:199], a[152:155], a[88:91], v[196:199]
  v_and_b32 v227, 0xffff0000, v217
  v_cvt_pk_bf16_f32 v130, v192, v193
  v_mfma_f32_16x16x32_bf16 v[196:199], a[156:159], a[92:95], v[196:199]
  v_cvt_pk_bf16_f32 v131, v194, v195
  v_lshlrev_b32 v228, 16, v218
  v_mfma_f32_16x16x32_bf16 v[48:51], a[176:179], v[176:179], v[48:51]
  buffer_store_dwordx4 a[220:223], v251, s[16:19], s27 offen offset:2048 sc1
  v_mfma_f32_16x16x32_bf16 v[48:51], a[180:183], v[180:183], v[48:51]
  v_and_b32 v229, 0xffff0000, v218
  v_lshlrev_b32 v230, 16, v219
  v_mfma_f32_16x16x32_bf16 v[56:59], a[176:179], v[184:187], v[56:59]
  v_exp_f32 v196, v196
  v_mfma_f32_16x16x32_bf16 v[56:59], a[180:183], v[188:191], v[56:59]
  v_exp_f32 v197, v197
  v_mfma_f32_16x16x32_bf16 v[192:195], a[144:147], a[96:99], v[208:211]
  v_exp_f32 v198, v198
  v_mfma_f32_16x16x32_bf16 v[192:195], a[148:151], a[100:103], v[192:195]
  v_exp_f32 v199, v199
  v_mfma_f32_16x16x32_bf16 v[192:195], a[152:155], a[104:107], v[192:195]
  ds_read_b64_tr_b16 a[176:177], v243 offset:25600
  ds_read_b64_tr_b16 a[178:179], v243 offset:27648
  v_mfma_f32_16x16x32_bf16 v[192:195], a[156:159], a[108:111], v[192:195]
  ds_read_b64_tr_b16 a[180:181], v243 offset:29696
  ds_read_b64_tr_b16 a[182:183], v243 offset:31744
  v_mfma_f32_16x16x32_bf16 v[36:39], a[184:187], v[160:163], v[36:39]
  v_cvt_pk_bf16_f32 v138, v196, v197
  v_cvt_pk_bf16_f32 v139, v198, v199
  v_mfma_f32_16x16x32_bf16 v[36:39], a[188:191], v[164:167], v[36:39]
  v_and_b32 v231, 0xffff0000, v219
  v_mfma_f32_16x16x32_bf16 v[44:47], a[184:187], v[168:171], v[44:47]
  v_exp_f32 v192, v192
  v_exp_f32 v193, v193
  v_pk_mul_f32 v[224:225], v[224:225], s[42:43]
  v_pk_mul_f32 v[226:227], v[226:227], s[42:43]
  v_pk_mul_f32 v[228:229], v[228:229], s[42:43]
  v_pk_mul_f32 v[230:231], v[230:231], s[42:43]
  v_mfma_f32_16x16x32_bf16 v[44:47], a[188:191], v[172:175], v[44:47]
  v_exp_f32 v194, v194
  v_smfmac_f32_16x16x64_bf16 a[200:203], a[208:211], v[176:183], v248
  v_exp_f32 v195, v195
  v_mfma_f32_16x16x32_bf16 v[196:199], a[144:147], a[112:115], v[212:215]
  ds_read_b128 a[144:147], v240 offset:12288
  buffer_load_dwordx4 v246, s[8:11], s40 offen offset:1024 nt lds
  v_mfma_f32_16x16x32_bf16 v[196:199], a[148:151], a[116:119], v[196:199]
  s_add_u32 m0, s36, 51072
  ds_read_b128 a[148:151], v241 offset:12288
  v_cvt_pk_bf16_f32 v146, v192, v193
  v_mfma_f32_16x16x32_bf16 v[196:199], a[152:155], a[120:123], v[196:199]
  ds_read_b128 a[152:155], v240 offset:14336
  v_cvt_pk_bf16_f32 v147, v194, v195
  v_mfma_f32_16x16x32_bf16 v[196:199], a[156:159], a[124:127], v[196:199]
  ds_read_b128 a[156:159], v241 offset:14336
  v_cvt_pk_bf16_f32 v216, v224, v225
  v_mfma_f32_16x16x32_bf16 v[52:55], a[184:187], v[176:179], v[52:55]
  v_cvt_pk_bf16_f32 v217, v226, v227
  v_cvt_pk_bf16_f32 v218, v228, v229
  v_mfma_f32_16x16x32_bf16 v[52:55], a[188:191], v[180:183], v[52:55]
  v_cvt_pk_bf16_f32 v219, v230, v231
  v_accvgpr_write_b32 a24, v216
  v_mfma_f32_16x16x32_bf16 v[60:63], a[184:187], v[184:187], v[60:63]
  v_exp_f32 v196, v196
  v_mfma_f32_16x16x32_bf16 v[60:63], a[188:191], v[188:191], v[60:63]
  v_exp_f32 v197, v197
  v_mfma_f32_16x16x32_bf16 v[192:195], a[128:131], a[64:67], v[200:203]
  v_exp_f32 v198, v198
  v_mfma_f32_16x16x32_bf16 v[192:195], a[132:135], a[68:71], v[192:195]
  v_exp_f32 v199, v199
  v_mfma_f32_16x16x32_bf16 v[192:195], a[136:139], a[72:75], v[192:195]
  ds_read_b64_tr_b16 a[184:185], v243 offset:25608
  ds_read_b64_tr_b16 a[186:187], v243 offset:27656
  v_mfma_f32_16x16x32_bf16 v[192:195], a[140:143], a[76:79], v[192:195]
  ds_read_b64_tr_b16 a[188:189], v243 offset:29704
  ds_read_b64_tr_b16 a[190:191], v243 offset:31752
  v_mfma_f32_16x16x32_bf16 v[64:67], a[160:163], v[160:163], v[64:67]
  buffer_load_dwordx4 v245, s[4:7], s39 offen offset:128 nt lds
  v_cvt_pk_bf16_f32 v154, v196, v197
  v_mfma_f32_16x16x32_bf16 v[64:67], a[164:167], v[164:167], v[64:67]
  s_add_u32 m0, s38, -128
  v_cvt_pk_bf16_f32 v155, v198, v199
  v_accvgpr_write_b32 a25, v217
  v_mfma_f32_16x16x32_bf16 v[72:75], a[160:163], v[168:171], v[72:75]
  v_exp_f32 v192, v192
  v_mfma_f32_16x16x32_bf16 v[72:75], a[164:167], v[172:175], v[72:75]
  v_exp_f32 v193, v193
  v_smfmac_f32_16x16x64_bf16 a[204:207], a[208:211], v[184:191], v248
  ds_read_b128 v[220:223], v250 offset:2048
  v_cvt_pk_bf16_f32 v132, v192, v193
  v_mfma_f32_16x16x32_bf16 v[196:199], a[128:131], a[80:83], v[204:207]
  v_exp_f32 v194, v194
  v_mfma_f32_16x16x32_bf16 v[196:199], a[132:135], a[84:87], v[196:199]
  v_exp_f32 v195, v195
  v_mfma_f32_16x16x32_bf16 v[196:199], a[136:139], a[88:91], v[196:199]
  v_cvt_pk_bf16_f32 v133, v194, v195
  v_accvgpr_write_b32 a26, v218
  v_mfma_f32_16x16x32_bf16 v[196:199], a[140:143], a[92:95], v[196:199]
  v_accvgpr_write_b32 a27, v219
  v_mfma_f32_16x16x32_bf16 v[80:83], a[160:163], v[176:179], v[80:83]
  v_mfma_f32_16x16x32_bf16 v[80:83], a[164:167], v[180:183], v[80:83]
  buffer_load_dwordx4 v245, s[12:15], s34 offen offset:128 nt lds
  v_mfma_f32_16x16x32_bf16 v[88:91], a[160:163], v[184:187], v[88:91]
  s_add_u32 m0, s38, -1152
  v_mfma_f32_16x16x32_bf16 v[88:91], a[164:167], v[188:191], v[88:91]
  v_mfma_f32_16x16x32_bf16 v[192:195], a[128:131], a[96:99], v[208:211]
  s_waitcnt lgkmcnt(0)
  v_lshlrev_b32 v224, 16, v220
  v_and_b32 v225, 0xffff0000, v220
  v_mfma_f32_16x16x32_bf16 v[192:195], a[132:135], a[100:103], v[192:195]
  v_exp_f32 v196, v196
  v_mfma_f32_16x16x32_bf16 v[192:195], a[136:139], a[104:107], v[192:195]
  v_exp_f32 v197, v197
  v_mfma_f32_16x16x32_bf16 v[192:195], a[140:143], a[108:111], v[192:195]
  s_waitcnt vmcnt(22)
  v_exp_f32 v198, v198
  v_mfma_f32_16x16x32_bf16 v[68:71], a[168:171], v[160:163], v[68:71]
  s_barrier
  v_exp_f32 v199, v199
  v_mfma_f32_16x16x32_bf16 v[68:71], a[172:175], v[164:167], v[68:71]
  ds_read_b64_tr_b16 a[160:161], v242 offset:0
  ds_read_b64_tr_b16 a[162:163], v242 offset:2048
  v_mfma_f32_16x16x32_bf16 v[76:79], a[168:171], v[168:171], v[76:79]
  ds_read_b64_tr_b16 a[164:165], v242 offset:4096
  ds_read_b64_tr_b16 a[166:167], v242 offset:6144
  v_mfma_f32_16x16x32_bf16 v[76:79], a[172:175], v[172:175], v[76:79]
  buffer_load_dwordx4 v245, s[12:15], s34 offen offset:2176 nt lds
  v_cvt_pk_bf16_f32 v140, v196, v197
  v_cvt_pk_bf16_f32 v141, v198, v199
  v_mfma_f32_16x16x32_bf16 v[196:199], a[128:131], a[112:115], v[212:215]
  s_add_u32 m0, s37, 17280
  ds_read_b128 a[128:131], v240 offset:16384
  v_lshlrev_b32 v226, 16, v221
  v_mfma_f32_16x16x32_bf16 v[196:199], a[132:135], a[116:119], v[196:199]
  ds_read_b128 a[132:135], v241 offset:16384
  v_and_b32 v227, 0xffff0000, v221
  v_mfma_f32_16x16x32_bf16 v[196:199], a[136:139], a[120:123], v[196:199]
  v_exp_f32 v192, v192
  v_mfma_f32_16x16x32_bf16 v[196:199], a[140:143], a[124:127], v[196:199]
  v_exp_f32 v193, v193
  v_mfma_f32_16x16x32_bf16 v[84:87], a[168:171], v[176:179], v[84:87]
  v_exp_f32 v194, v194
  v_mfma_f32_16x16x32_bf16 v[84:87], a[172:175], v[180:183], v[84:87]
  v_exp_f32 v195, v195
  v_mfma_f32_16x16x32_bf16 v[92:95], a[168:171], v[184:187], v[92:95]
  ds_read_b128 a[136:139], v240 offset:18432
  ds_read_b128 a[140:143], v241 offset:18432
  v_mfma_f32_16x16x32_bf16 v[92:95], a[172:175], v[188:191], v[92:95]
  ds_read_b64_tr_b16 a[168:169], v242 offset:8
  ds_read_b64_tr_b16 a[170:171], v242 offset:2056
  v_cvt_pk_bf16_f32 v148, v192, v193
  v_cvt_pk_bf16_f32 v149, v194, v195
  v_mfma_f32_16x16x32_bf16 v[192:195], a[144:147], a[64:67], v[200:203]
  ds_read_b64_tr_b16 a[172:173], v242 offset:4104
  ds_read_b64_tr_b16 a[174:175], v242 offset:6152
  v_lshlrev_b32 v228, 16, v222
  v_mfma_f32_16x16x32_bf16 v[192:195], a[148:151], a[68:71], v[192:195]
  buffer_load_dwordx4 v246, s[8:11], s40 offen offset:128 nt lds
  v_and_b32 v229, 0xffff0000, v222
  v_mfma_f32_16x16x32_bf16 v[192:195], a[152:155], a[72:75], v[192:195]
  s_add_u32 m0, s36, 50048
  v_lshlrev_b32 v230, 16, v223
  v_and_b32 v231, 0xffff0000, v223
  v_mfma_f32_16x16x32_bf16 v[192:195], a[156:159], a[76:79], v[192:195]
  v_exp_f32 v196, v196
  v_exp_f32 v197, v197
  v_pk_mul_f32 v[224:225], v[224:225], s[42:43]
  v_pk_mul_f32 v[226:227], v[226:227], s[42:43]
  v_pk_mul_f32 v[228:229], v[228:229], s[42:43]
  v_pk_mul_f32 v[230:231], v[230:231], s[42:43]
  v_mfma_f32_16x16x32_bf16 v[96:99], a[176:179], v[160:163], v[96:99]
  v_exp_f32 v198, v198
  v_mfma_f32_16x16x32_bf16 v[96:99], a[180:183], v[164:167], v[96:99]
  v_exp_f32 v199, v199
  v_mfma_f32_16x16x32_bf16 v[104:107], a[176:179], v[168:171], v[104:107]
  v_cvt_pk_bf16_f32 v156, v196, v197
  v_cvt_pk_bf16_f32 v157, v198, v199
  v_mfma_f32_16x16x32_bf16 v[104:107], a[180:183], v[172:175], v[104:107]
  v_exp_f32 v192, v192
  v_mfma_f32_16x16x32_bf16 v[196:199], a[144:147], a[80:83], v[204:207]
L_stub9:
  s_cmp_eq_u32 s99, 1
  s_cbranch_scc1 L_ret2
  v_exp_f32 v193, v193
  v_mfma_f32_16x16x32_bf16 v[196:199], a[148:151], a[84:87], v[196:199]
  v_exp_f32 v194, v194
  v_mfma_f32_16x16x32_bf16 v[196:199], a[152:155], a[88:91], v[196:199]
  v_exp_f32 v195, v195
  v_mfma_f32_16x16x32_bf16 v[196:199], a[156:159], a[92:95], v[196:199]
  buffer_store_dwordx4 a[224:227], v251, s[16:19], s25 offen offset:128 sc1
  v_mfma_f32_16x16x32_bf16 v[112:115], a[176:179], v[176:179], v[112:115]
  v_cvt_pk_bf16_f32 v134, v192, v193
  v_cvt_pk_bf16_f32 v135, v194, v195
  v_mfma_f32_16x16x32_bf16 v[112:115], a[180:183], v[180:183], v[112:115]
  v_cvt_pk_bf16_f32 v220, v224, v225
  v_cvt_pk_bf16_f32 v221, v226, v227
  v_mfma_f32_16x16x32_bf16 v[120:123], a[176:179], v[184:187], v[120:123]
  v_exp_f32 v196, v196
  v_mfma_f32_16x16x32_bf16 v[120:123], a[180:183], v[188:191], v[120:123]
  v_exp_f32 v197, v197
  v_mfma_f32_16x16x32_bf16 v[192:195], a[144:147], a[96:99], v[208:211]
  s_waitcnt vmcnt(12)
  v_exp_f32 v198, v198
  v_mfma_f32_16x16x32_bf16 v[192:195], a[148:151], a[100:103], v[192:195]
  v_exp_f32 v199, v199
  v_mfma_f32_16x16x32_bf16 v[192:195], a[152:155], a[104:107], v[192:195]
  ds_read_b64_tr_b16 a[176:177], v243 offset:0
  ds_read_b64_tr_b16 a[178:179], v243 offset:2048
  v_mfma_f32_16x16x32_bf16 v[192:195], a[156:159], a[108:111], v[192:195]
  ds_read_b64_tr_b16 a[180:181], v243 offset:4096
  ds_read_b64_tr_b16 a[182:183], v243 offset:6144
  v_mfma_f32_16x16x32_bf16 v[100:103], a[184:187], v[160:163], v[100:103]
  v_cvt_pk_bf16_f32 v142, v196, v197
  v_cvt_pk_bf16_f32 v143, v198, v199
  v_mfma_f32_16x16x32_bf16 v[100:103], a[188:191], v[164:167], v[100:103]
  buffer_load_dwordx4 v245, s[4:7], s39 offen offset:2176 nt lds
  v_cvt_pk_bf16_f32 v222, v228, v229
  v_mfma_f32_16x16x32_bf16 v[108:111], a[184:187], v[168:171], v[108:111]
  s_add_u32 m0, s37, 49032
  v_cvt_pk_bf16_f32 v223, v230, v231
  v_accvgpr_write_b32 a28, v220
  v_mfma_f32_16x16x32_bf16 v[108:111], a[188:191], v[172:175], v[108:111]
  s_add_u32 s39, s22, 0
  v_exp_f32 v192, v192
  v_mfma_f32_16x16x32_bf16 v[196:199], a[144:147], a[112:115], v[212:215]
  ds_read_b128 v[216:219], v249 offset:4096
  ds_read_b128 a[144:147], v240 offset:20480
  v_mfma_f32_16x16x32_bf16 v[196:199], a[148:151], a[116:119], v[196:199]
  v_exp_f32 v193, v193
  v_mfma_f32_16x16x32_bf16 v[196:199], a[152:155], a[120:123], v[196:199]
  v_exp_f32 v194, v194
  v_mfma_f32_16x16x32_bf16 v[196:199], a[156:159], a[124:127], v[196:199]
  v_exp_f32 v195, v195
  v_mfma_f32_16x16x32_bf16 v[116:119], a[184:187], v[176:179], v[116:119]
  ds_read_b128 a[148:151], v241 offset:20480
  ds_read_b128 a[152:155], v240 offset:22528
  v_mfma_f32_16x16x32_bf16 v[116:119], a[188:191], v[180:183], v[116:119]
  ds_read_b128 a[156:159], v241 offset:22528
  v_cvt_pk_bf16_f32 v150, v192, v193
  v_mfma_f32_16x16x32_bf16 v[124:127], a[184:187], v[184:187], v[124:127]
  ds_read_b64_tr_b16 a[184:185], v243 offset:8
  ds_read_b64_tr_b16 a[186:187], v243 offset:2056
  v_mfma_f32_16x16x32_bf16 v[124:127], a[188:191], v[188:191], v[124:127]
  s_waitcnt lgkmcnt(5)
  ds_read_b64_tr_b16 a[188:189], v243 offset:4104
  ds_read_b64_tr_b16 a[190:191], v243 offset:6152
  v_cvt_pk_bf16_f32 v151, v194, v195
  v_mfma_f32_16x16x32_bf16 v[192:195], a[128:131], a[64:67], v[200:203]
  buffer_load_dwordx4 v246, s[8:11], s40 offen offset:1152 nt lds
  v_accvgpr_write_b32 a29, v221
  v_mfma_f32_16x16x32_bf16 v[192:195], a[132:135], a[68:71], v[192:195]
  s_add_u32 m0, s36, 0
  v_accvgpr_write_b32 a30, v222
  v_accvgpr_write_b32 a31, v223
  v_mfma_f32_16x16x32_bf16 v[192:195], a[136:139], a[72:75], v[192:195]
  v_exp_f32 v196, v196
  v_mfma_f32_16x16x32_bf16 v[192:195], a[140:143], a[76:79], v[192:195]
  s_add_u32 s40, s21, 114688
  v_exp_f32 v197, v197
  v_mfma_f32_16x16x32_bf16 v[0:3], a[160:163], v[128:131], v[0:3]
  v_exp_f32 v198, v198
  v_mfma_f32_16x16x32_bf16 v[0:3], a[164:167], v[132:135], v[0:3]
  v_exp_f32 v199, v199
  v_mfma_f32_16x16x32_bf16 v[8:11], a[160:163], v[136:139], v[8:11]
  v_lshlrev_b32 v224, 16, v216
  v_cvt_pk_bf16_f32 v158, v196, v197
  v_mfma_f32_16x16x32_bf16 v[8:11], a[164:167], v[140:143], v[8:11]
  v_cvt_pk_bf16_f32 v159, v198, v199
  v_and_b32 v225, 0xffff0000, v216
  v_mfma_f32_16x16x32_bf16 v[196:199], a[128:131], a[80:83], v[204:207]
  v_lshlrev_b32 v226, 16, v217
  v_and_b32 v227, 0xffff0000, v217
  v_mfma_f32_16x16x32_bf16 v[196:199], a[132:135], a[84:87], v[196:199]
  v_exp_f32 v192, v192
  v_mfma_f32_16x16x32_bf16 v[196:199], a[136:139], a[88:91], v[196:199]
  v_exp_f32 v193, v193
  v_mfma_f32_16x16x32_bf16 v[196:199], a[140:143], a[92:95], v[196:199]
  v_exp_f32 v194, v194
  v_mfma_f32_16x16x32_bf16 v[16:19], a[160:163], v[144:147], v[16:19]
  v_exp_f32 v195, v195
  v_mfma_f32_16x16x32_bf16 v[16:19], a[164:167], v[148:151], v[16:19]
  buffer_load_dwordx4 v245, s[4:7], s39 offen nt lds
  v_cvt_pk_bf16_f32 v160, v192, v193
  v_mfma_f32_16x16x32_bf16 v[24:27], a[160:163], v[152:155], v[24:27]
  s_add_u32 m0, s38, 2048
  ds_read_b64_tr_b16 a[160:161], v242 offset:1024
  ds_read_b64_tr_b16 a[162:163], v242 offset:3072
  v_mfma_f32_16x16x32_bf16 v[24:27], a[164:167], v[156:159], v[24:27]
  ds_read_b64_tr_b16 a[164:165], v242 offset:5120
  ds_read_b64_tr_b16 a[166:167], v242 offset:7168
  v_cvt_pk_bf16_f32 v161, v194, v195
  v_mfma_f32_16x16x32_bf16 v[192:195], a[128:131], a[96:99], v[208:211]
  v_lshlrev_b32 v228, 16, v218
  v_and_b32 v229, 0xffff0000, v218
  v_mfma_f32_16x16x32_bf16 v[192:195], a[132:135], a[100:103], v[192:195]
  v_lshlrev_b32 v230, 16, v219
  v_and_b32 v231, 0xffff0000, v219
  v_mfma_f32_16x16x32_bf16 v[192:195], a[136:139], a[104:107], v[192:195]
  v_exp_f32 v196, v196
  v_exp_f32 v197, v197
  v_pk_mul_f32 v[224:225], v[224:225], s[42:43]
  v_pk_mul_f32 v[226:227], v[226:227], s[42:43]
  v_pk_mul_f32 v[228:229], v[228:229], s[42:43]
  v_pk_mul_f32 v[230:231], v[230:231], s[42:43]
  v_mfma_f32_16x16x32_bf16 v[192:195], a[140:143], a[108:111], v[192:195]
  v_exp_f32 v198, v198
  v_mfma_f32_16x16x32_bf16 v[4:7], a[168:171], v[128:131], v[4:7]
  v_exp_f32 v199, v199
  v_mfma_f32_16x16x32_bf16 v[4:7], a[172:175], v[132:135], v[4:7]
  v_cvt_pk_bf16_f32 v168, v196, v197
  v_cvt_pk_bf16_f32 v169, v198, v199
  v_mfma_f32_16x16x32_bf16 v[12:15], a[168:171], v[136:139], v[12:15]
  v_cvt_pk_bf16_f32 v216, v224, v225
  v_cvt_pk_bf16_f32 v217, v226, v227
  v_mfma_f32_16x16x32_bf16 v[12:15], a[172:175], v[140:143], v[12:15]
  v_exp_f32 v192, v192
  v_smfmac_f32_16x16x64_bf16 a[192:195], a[208:211], v[128:135], v248
  v_exp_f32 v193, v193
  v_mfma_f32_16x16x32_bf16 v[196:199], a[128:131], a[112:115], v[212:215]
  v_exp_f32 v194, v194
  v_mfma_f32_16x16x32_bf16 v[196:199], a[132:135], a[116:119], v[196:199]
  v_exp_f32 v195, v195
  v_mfma_f32_16x16x32_bf16 v[196:199], a[136:139], a[120:123], v[196:199]
  buffer_load_dwordx4 v245, s[12:15], s35 offen nt lds
  ds_read_b128 a[128:131], v240 offset:24576
  v_mfma_f32_16x16x32_bf16 v[196:199], a[140:143], a[124:127], v[196:199]
  s_add_u32 m0, s38, 1024
  ds_read_b128 a[132:135], v241 offset:24576
  ds_read_b128 a[136:139], v240 offset:26624
  v_mfma_f32_16x16x32_bf16 v[20:23], a[168:171], v[144:147], v[20:23]
  ds_read_b128 a[140:143], v241 offset:26624
  v_cvt_pk_bf16_f32 v176, v192, v193
  v_mfma_f32_16x16x32_bf16 v[20:23], a[172:175], v[148:151], v[20:23]
  v_cvt_pk_bf16_f32 v177, v194, v195
  v_cvt_pk_bf16_f32 v218, v228, v229
  v_mfma_f32_16x16x32_bf16 v[28:31], a[168:171], v[152:155], v[28:31]
  v_exp_f32 v196, v196
  v_mfma_f32_16x16x32_bf16 v[28:31], a[172:175], v[156:159], v[28:31]
  v_exp_f32 v197, v197
  v_mfma_f32_16x16x32_bf16 v[192:195], a[144:147], a[64:67], v[200:203]
  s_waitcnt lgkmcnt(4)
  v_exp_f32 v198, v198
  v_mfma_f32_16x16x32_bf16 v[192:195], a[148:151], a[68:71], v[192:195]
  v_exp_f32 v199, v199
  v_mfma_f32_16x16x32_bf16 v[192:195], a[152:155], a[72:75], v[192:195]
  ds_read_b64_tr_b16 a[168:169], v242 offset:1032
  ds_read_b64_tr_b16 a[170:171], v242 offset:3080
  v_mfma_f32_16x16x32_bf16 v[192:195], a[156:159], a[76:79], v[192:195]
  ds_read_b64_tr_b16 a[172:173], v242 offset:5128
  ds_read_b64_tr_b16 a[174:175], v242 offset:7176
  v_mfma_f32_16x16x32_bf16 v[32:35], a[176:179], v[128:131], v[32:35]
  buffer_load_dwordx4 v245, s[12:15], s35 offen offset:2048 nt lds
  v_cvt_pk_bf16_f32 v184, v196, v197
  v_mfma_f32_16x16x32_bf16 v[32:35], a[180:183], v[132:135], v[32:35]
  s_add_u32 m0, s37, 24576
  v_cvt_pk_bf16_f32 v185, v198, v199
  v_cvt_pk_bf16_f32 v219, v230, v231
  v_mfma_f32_16x16x32_bf16 v[40:43], a[176:179], v[136:139], v[40:43]
  v_accvgpr_write_b32 a32, v216
  v_accvgpr_write_b32 a33, v217
  v_mfma_f32_16x16x32_bf16 v[40:43], a[180:183], v[140:143], v[40:43]
  ds_read_b128 v[220:223], v250 offset:4096
  v_accvgpr_write_b32 a34, v218
  v_smfmac_f32_16x16x64_bf16 a[196:199], a[208:211], v[136:143], v248
  v_exp_f32 v192, v192
  v_mfma_f32_16x16x32_bf16 v[196:199], a[144:147], a[80:83], v[204:207]
  v_exp_f32 v193, v193
  v_mfma_f32_16x16x32_bf16 v[196:199], a[148:151], a[84:87], v[196:199]
  v_exp_f32 v194, v194
  v_mfma_f32_16x16x32_bf16 v[196:199], a[152:155], a[88:91], v[196:199]
  v_exp_f32 v195, v195
  v_mfma_f32_16x16x32_bf16 v[196:199], a[156:159], a[92:95], v[196:199]
  buffer_store_dwordx4 a[228:231], v251, s[16:19], s26 offen offset:128 sc1
  v_mfma_f32_16x16x32_bf16 v[48:51], a[176:179], v[144:147], v[48:51]
  v_cvt_pk_bf16_f32 v162, v192, v193
  v_cvt_pk_bf16_f32 v163, v194, v195
  v_mfma_f32_16x16x32_bf16 v[48:51], a[180:183], v[148:151], v[48:51]
  v_accvgpr_write_b32 a35, v219
  v_mfma_f32_16x16x32_bf16 v[56:59], a[176:179], v[152:155], v[56:59]
  ds_read_b64_tr_b16 a[176:177], v243 offset:1024
  ds_read_b64_tr_b16 a[178:179], v243 offset:3072
  v_mfma_f32_16x16x32_bf16 v[56:59], a[180:183], v[156:159], v[56:59]
  ds_read_b64_tr_b16 a[180:181], v243 offset:5120
  ds_read_b64_tr_b16 a[182:183], v243 offset:7168
  v_mfma_f32_16x16x32_bf16 v[192:195], a[144:147], a[96:99], v[208:211]
  s_waitcnt lgkmcnt(4)
  v_lshlrev_b32 v224, 16, v220
  v_and_b32 v225, 0xffff0000, v220
  v_mfma_f32_16x16x32_bf16 v[192:195], a[148:151], a[100:103], v[192:195]
  v_exp_f32 v196, v196
  v_mfma_f32_16x16x32_bf16 v[192:195], a[152:155], a[104:107], v[192:195]
  v_exp_f32 v197, v197
  v_mfma_f32_16x16x32_bf16 v[192:195], a[156:159], a[108:111], v[192:195]
  v_exp_f32 v198, v198
  v_mfma_f32_16x16x32_bf16 v[36:39], a[184:187], v[128:131], v[36:39]
  v_exp_f32 v199, v199
  v_mfma_f32_16x16x32_bf16 v[36:39], a[188:191], v[132:135], v[36:39]
  buffer_load_dwordx4 v246, s[8:11], s40 offen nt lds
  v_cvt_pk_bf16_f32 v170, v196, v197
  v_mfma_f32_16x16x32_bf16 v[44:47], a[184:187], v[136:139], v[44:47]
  s_add_u32 m0, s36, -1024
  v_cvt_pk_bf16_f32 v171, v198, v199
  v_lshlrev_b32 v226, 16, v221
  v_mfma_f32_16x16x32_bf16 v[44:47], a[188:191], v[140:143], v[44:47]
  v_and_b32 v227, 0xffff0000, v221
  v_lshlrev_b32 v228, 16, v222
  v_smfmac_f32_16x16x64_bf16 a[200:203], a[208:211], v[144:151], v248
  v_exp_f32 v192, v192
  v_mfma_f32_16x16x32_bf16 v[196:199], a[144:147], a[112:115], v[212:215]
  v_exp_f32 v193, v193
  v_mfma_f32_16x16x32_bf16 v[196:199], a[148:151], a[116:119], v[196:199]
  v_exp_f32 v194, v194
  v_mfma_f32_16x16x32_bf16 v[196:199], a[152:155], a[120:123], v[196:199]
  v_exp_f32 v195, v195
  v_mfma_f32_16x16x32_bf16 v[196:199], a[156:159], a[124:127], v[196:199]
  ds_read_b128 a[144:147], v240 offset:28672
  ds_read_b128 a[148:151], v241 offset:28672
  v_mfma_f32_16x16x32_bf16 v[52:55], a[184:187], v[144:147], v[52:55]
  ds_read_b128 a[152:155], v240 offset:30720
  ds_read_b128 a[156:159], v241 offset:30720
  v_mfma_f32_16x16x32_bf16 v[52:55], a[188:191], v[148:151], v[52:55]
  v_cvt_pk_bf16_f32 v178, v192, v193
  v_cvt_pk_bf16_f32 v179, v194, v195
  v_mfma_f32_16x16x32_bf16 v[60:63], a[184:187], v[152:155], v[60:63]
  ds_read_b64_tr_b16 a[184:185], v243 offset:1032
  ds_read_b64_tr_b16 a[186:187], v243 offset:3080
  v_mfma_f32_16x16x32_bf16 v[60:63], a[188:191], v[156:159], v[60:63]
  ds_read_b64_tr_b16 a[188:189], v243 offset:5128
  ds_read_b64_tr_b16 a[190:191], v243 offset:7176
  v_mfma_f32_16x16x32_bf16 v[192:195], a[128:131], a[64:67], v[200:203]
  buffer_load_dwordx4 v245, s[4:7], s39 offen offset:2048 nt lds
  v_and_b32 v229, 0xffff0000, v222
  v_mfma_f32_16x16x32_bf16 v[192:195], a[132:135], a[68:71], v[192:195]
  s_add_u32 m0, s37, 56328
  v_lshlrev_b32 v230, 16, v223
  v_and_b32 v231, 0xffff0000, v223
  v_mfma_f32_16x16x32_bf16 v[192:195], a[136:139], a[72:75], v[192:195]
  v_exp_f32 v196, v196
  v_exp_f32 v197, v197
  v_pk_mul_f32 v[224:225], v[224:225], s[42:43]
  v_pk_mul_f32 v[226:227], v[226:227], s[42:43]
  v_pk_mul_f32 v[228:229], v[228:229], s[42:43]
  v_pk_mul_f32 v[230:231], v[230:231], s[42:43]
  v_mfma_f32_16x16x32_bf16 v[192:195], a[140:143], a[76:79], v[192:195]
  v_exp_f32 v198, v198
  v_mfma_f32_16x16x32_bf16 v[64:67], a[160:163], v[128:131], v[64:67]
  v_exp_f32 v199, v199
  v_mfma_f32_16x16x32_bf16 v[64:67], a[164:167], v[132:135], v[64:67]
  v_cvt_pk_bf16_f32 v186, v196, v197
  v_cvt_pk_bf16_f32 v187, v198, v199
  v_mfma_f32_16x16x32_bf16 v[72:75], a[160:163], v[136:139], v[72:75]
  v_cvt_pk_bf16_f32 v220, v224, v225
  v_cvt_pk_bf16_f32 v221, v226, v227
  v_mfma_f32_16x16x32_bf16 v[72:75], a[164:167], v[140:143], v[72:75]
  v_exp_f32 v192, v192
  v_smfmac_f32_16x16x64_bf16 a[204:207], a[208:211], v[152:159], v248
  v_exp_f32 v193, v193
  v_mfma_f32_16x16x32_bf16 v[196:199], a[128:131], a[80:83], v[204:207]
  v_exp_f32 v194, v194
  v_mfma_f32_16x16x32_bf16 v[196:199], a[132:135], a[84:87], v[196:199]
  v_exp_f32 v195, v195
  v_mfma_f32_16x16x32_bf16 v[196:199], a[136:139], a[88:91], v[196:199]
  buffer_load_dwordx4 v246, s[8:11], s40 offen offset:1024 nt lds
  v_cvt_pk_bf16_f32 v164, v192, v193
  v_mfma_f32_16x16x32_bf16 v[196:199], a[140:143], a[92:95], v[196:199]
  s_add_u32 m0, s36, 1920
  v_cvt_pk_bf16_f32 v165, v194, v195
  v_cvt_pk_bf16_f32 v222, v228, v229
  v_mfma_f32_16x16x32_bf16 v[80:83], a[160:163], v[144:147], v[80:83]
  v_cvt_pk_bf16_f32 v223, v230, v231
  v_accvgpr_write_b32 a36, v220
  v_mfma_f32_16x16x32_bf16 v[80:83], a[164:167], v[148:151], v[80:83]
  s_waitcnt vmcnt(11)
  v_exp_f32 v196, v196
  v_mfma_f32_16x16x32_bf16 v[88:91], a[160:163], v[152:155], v[88:91]
  v_exp_f32 v197, v197
  v_mfma_f32_16x16x32_bf16 v[88:91], a[164:167], v[156:159], v[88:91]
  v_exp_f32 v198, v198
  v_mfma_f32_16x16x32_bf16 v[192:195], a[128:131], a[96:99], v[208:211]
  v_exp_f32 v199, v199
  v_mfma_f32_16x16x32_bf16 v[192:195], a[132:135], a[100:103], v[192:195]
  v_cvt_pk_bf16_f32 v172, v196, v197
  v_cvt_pk_bf16_f32 v173, v198, v199
  v_mfma_f32_16x16x32_bf16 v[192:195], a[136:139], a[104:107], v[192:195]
  v_accvgpr_write_b32 a37, v221
  v_accvgpr_write_b32 a38, v222
  v_mfma_f32_16x16x32_bf16 v[192:195], a[140:143], a[108:111], v[192:195]
  s_waitcnt vmcnt(19) lgkmcnt(0)
  v_accvgpr_write_b32 a39, v223
  v_mfma_f32_16x16x32_bf16 v[68:71], a[168:171], v[128:131], v[68:71]
  s_barrier
  ds_read_b64_tr_b16 a[160:161], v242 offset:8192
  ds_read_b64_tr_b16 a[162:163], v242 offset:10240
  v_mfma_f32_16x16x32_bf16 v[68:71], a[172:175], v[132:135], v[68:71]
  ds_read_b128 v[216:219], v249 offset:0
  ds_read_b64_tr_b16 a[164:165], v242 offset:12288
  v_mfma_f32_16x16x32_bf16 v[76:79], a[168:171], v[136:139], v[76:79]
  v_exp_f32 v192, v192
  v_mfma_f32_16x16x32_bf16 v[76:79], a[172:175], v[140:143], v[76:79]
  v_exp_f32 v193, v193
  v_mfma_f32_16x16x32_bf16 v[196:199], a[128:131], a[112:115], v[212:215]
  v_exp_f32 v194, v194
  v_mfma_f32_16x16x32_bf16 v[196:199], a[132:135], a[116:119], v[196:199]
  v_exp_f32 v195, v195
  v_mfma_f32_16x16x32_bf16 v[196:199], a[136:139], a[120:123], v[196:199]
  ds_read_b128 a[128:131], v240 offset:32768
  ds_read_b128 a[132:135], v241 offset:32768
  v_mfma_f32_16x16x32_bf16 v[196:199], a[140:143], a[124:127], v[196:199]
  ds_read_b128 a[136:139], v240 offset:34816
  ds_read_b128 a[140:143], v241 offset:34816
  v_mfma_f32_16x16x32_bf16 v[84:87], a[168:171], v[144:147], v[84:87]
  ds_read_b64_tr_b16 a[166:167], v242 offset:14336
  buffer_load_dwordx4 v245, s[4:7], s39 offen offset:128 nt lds
  v_mfma_f32_16x16x32_bf16 v[84:87], a[172:175], v[148:151], v[84:87]
  s_add_u32 m0, s37, 25472
  v_cvt_pk_bf16_f32 v180, v192, v193
  v_cvt_pk_bf16_f32 v181, v194, v195
  v_mfma_f32_16x16x32_bf16 v[92:95], a[168:171], v[152:155], v[92:95]
  ds_read_b64_tr_b16 a[168:169], v242 offset:8200
  ds_read_b64_tr_b16 a[170:171], v242 offset:10248
  v_mfma_f32_16x16x32_bf16 v[92:95], a[172:175], v[156:159], v[92:95]
  ds_read_b64_tr_b16 a[172:173], v242 offset:12296
  ds_read_b64_tr_b16 a[174:175], v242 offset:14344
  v_mfma_f32_16x16x32_bf16 v[192:195], a[144:147], a[64:67], v[200:203]
  s_waitcnt lgkmcnt(9)
  v_lshlrev_b32 v224, 16, v216
  v_and_b32 v225, 0xffff0000, v216
  v_mfma_f32_16x16x32_bf16 v[192:195], a[148:151], a[68:71], v[192:195]
  v_exp_f32 v196, v196
  v_mfma_f32_16x16x32_bf16 v[192:195], a[152:155], a[72:75], v[192:195]
  v_exp_f32 v197, v197
  v_mfma_f32_16x16x32_bf16 v[192:195], a[156:159], a[76:79], v[192:195]
  v_exp_f32 v198, v198
  v_mfma_f32_16x16x32_bf16 v[96:99], a[176:179], v[128:131], v[96:99]
  v_exp_f32 v199, v199
  v_mfma_f32_16x16x32_bf16 v[96:99], a[180:183], v[132:135], v[96:99]
  buffer_store_dwordx4 a[232:235], v251, s[16:19], s27 offen offset:128 sc1
  v_mfma_f32_16x16x32_bf16 v[104:107], a[176:179], v[136:139], v[104:107]
  v_cvt_pk_bf16_f32 v188, v196, v197
  v_cvt_pk_bf16_f32 v189, v198, v199
  v_mfma_f32_16x16x32_bf16 v[104:107], a[180:183], v[140:143], v[104:107]
  v_lshlrev_b32 v226, 16, v217
  v_and_b32 v227, 0xffff0000, v217
  v_mfma_f32_16x16x32_bf16 v[196:199], a[144:147], a[80:83], v[204:207]
  v_lshlrev_b32 v228, 16, v218
  v_and_b32 v229, 0xffff0000, v218
  v_mfma_f32_16x16x32_bf16 v[196:199], a[148:151], a[84:87], v[196:199]
  v_exp_f32 v192, v192
  v_mfma_f32_16x16x32_bf16 v[196:199], a[152:155], a[88:91], v[196:199]
  v_exp_f32 v193, v193
  v_mfma_f32_16x16x32_bf16 v[196:199], a[156:159], a[92:95], v[196:199]
  v_exp_f32 v194, v194
  v_mfma_f32_16x16x32_bf16 v[112:115], a[176:179], v[144:147], v[112:115]
  v_exp_f32 v195, v195
  v_mfma_f32_16x16x32_bf16 v[112:115], a[180:183], v[148:151], v[112:115]
  v_cvt_pk_bf16_f32 v166, v192, v193
  v_cvt_pk_bf16_f32 v167, v194, v195
  v_mfma_f32_16x16x32_bf16 v[120:123], a[176:179], v[152:155], v[120:123]
  ds_read_b64_tr_b16 a[176:177], v243 offset:8192
  ds_read_b64_tr_b16 a[178:179], v243 offset:10240
  v_mfma_f32_16x16x32_bf16 v[120:123], a[180:183], v[156:159], v[120:123]
  buffer_load_dwordx4 v246, s[8:11], s40 offen offset:128 nt lds
  ds_read_b64_tr_b16 a[180:181], v243 offset:12288
  v_mfma_f32_16x16x32_bf16 v[192:195], a[144:147], a[96:99], v[208:211]
  s_add_u32 m0, s36, 896
  ds_read_b64_tr_b16 a[182:183], v243 offset:14336
  v_lshlrev_b32 v230, 16, v219
  v_mfma_f32_16x16x32_bf16 v[192:195], a[148:151], a[100:103], v[192:195]
  v_exp_f32 v196, v196
  v_mfma_f32_16x16x32_bf16 v[192:195], a[152:155], a[104:107], v[192:195]
  v_exp_f32 v197, v197
  v_mfma_f32_16x16x32_bf16 v[192:195], a[156:159], a[108:111], v[192:195]
  v_and_b32 v231, 0xffff0000, v219
  v_cvt_pk_bf16_f32 v174, v196, v197
  v_mfma_f32_16x16x32_bf16 v[100:103], a[184:187], v[128:131], v[100:103]
  v_exp_f32 v198, v198
  v_exp_f32 v199, v199
  v_pk_mul_f32 v[224:225], v[224:225], s[42:43]
  v_pk_mul_f32 v[226:227], v[226:227], s[42:43]
  v_pk_mul_f32 v[228:229], v[228:229], s[42:43]
  v_pk_mul_f32 v[230:231], v[230:231], s[42:43]
  v_mfma_f32_16x16x32_bf16 v[100:103], a[188:191], v[132:135], v[100:103]
  v_cvt_pk_bf16_f32 v175, v198, v199
  v_cvt_pk_bf16_f32 v216, v224, v225
  v_mfma_f32_16x16x32_bf16 v[108:111], a[184:187], v[136:139], v[108:111]
  v_exp_f32 v192, v192
  v_mfma_f32_16x16x32_bf16 v[108:111], a[188:191], v[140:143], v[108:111]
  v_exp_f32 v193, v193
  v_mfma_f32_16x16x32_bf16 v[196:199], a[144:147], a[112:115], v[212:215]
  v_exp_f32 v194, v194
  v_mfma_f32_16x16x32_bf16 v[196:199], a[148:151], a[116:119], v[196:199]
  v_exp_f32 v195, v195
  v_mfma_f32_16x16x32_bf16 v[196:199], a[152:155], a[120:123], v[196:199]
  buffer_load_dwordx4 v245, s[4:7], s39 offen offset:2176 nt lds
  ds_read_b128 a[144:147], v240 offset:36864
  v_mfma_f32_16x16x32_bf16 v[196:199], a[156:159], a[124:127], v[196:199]
  s_add_u32 m0, s37, 57224
  ds_read_b128 a[148:151], v241 offset:36864
  ds_read_b128 a[152:155], v240 offset:38912
  v_mfma_f32_16x16x32_bf16 v[116:119], a[184:187], v[144:147], v[116:119]
  ds_read_b128 a[156:159], v241 offset:38912
  v_cvt_pk_bf16_f32 v182, v192, v193
  v_mfma_f32_16x16x32_bf16 v[116:119], a[188:191], v[148:151], v[116:119]
  s_add_u32 s39, s22, 16384
  v_cvt_pk_bf16_f32 v183, v194, v195
  v_cvt_pk_bf16_f32 v217, v226, v227
  v_mfma_f32_16x16x32_bf16 v[124:127], a[184:187], v[152:155], v[124:127]
  ds_read_b64_tr_b16 a[184:185], v243 offset:8200
  ds_read_b64_tr_b16 a[186:187], v243 offset:10248
  v_mfma_f32_16x16x32_bf16 v[124:127], a[188:191], v[156:159], v[124:127]
  s_waitcnt lgkmcnt(6)
  ds_read_b64_tr_b16 a[188:189], v243 offset:12296
  ds_read_b64_tr_b16 a[190:191], v243 offset:14344
  v_mfma_f32_16x16x32_bf16 v[192:195], a[128:131], a[64:67], v[200:203]
  v_cvt_pk_bf16_f32 v218, v228, v229
  v_cvt_pk_bf16_f32 v219, v230, v231
  v_mfma_f32_16x16x32_bf16 v[192:195], a[132:135], a[68:71], v[192:195]
  v_exp_f32 v196, v196
  v_mfma_f32_16x16x32_bf16 v[192:195], a[136:139], a[72:75], v[192:195]
  v_exp_f32 v197, v197
  v_mfma_f32_16x16x32_bf16 v[192:195], a[140:143], a[76:79], v[192:195]
  v_exp_f32 v198, v198
  v_mfma_f32_16x16x32_bf16 v[0:3], a[160:163], v[160:163], v[0:3]
  v_exp_f32 v199, v199
  v_mfma_f32_16x16x32_bf16 v[0:3], a[164:167], v[164:167], v[0:3]
  ds_read_b128 v[220:223], v250 offset:0
  buffer_load_dwordx4 v246, s[8:11], s40 offen offset:1152 nt lds
  v_mfma_f32_16x16x32_bf16 v[8:11], a[160:163], v[168:171], v[8:11]
  s_add_u32 m0, s38, 3968
  v_cvt_pk_bf16_f32 v190, v196, v197
  v_cvt_pk_bf16_f32 v191, v198, v199
  v_mfma_f32_16x16x32_bf16 v[8:11], a[164:167], v[172:175], v[8:11]
  s_add_u32 s40, s22, 0
  v_accvgpr_write_b32 a40, v216
  v_accvgpr_write_b32 a41, v217
  v_mfma_f32_16x16x32_bf16 v[196:199], a[128:131], a[80:83], v[204:207]
  v_exp_f32 v192, v192
  v_mfma_f32_16x16x32_bf16 v[196:199], a[132:135], a[84:87], v[196:199]
  v_exp_f32 v193, v193
  v_mfma_f32_16x16x32_bf16 v[196:199], a[136:139], a[88:91], v[196:199]
  v_exp_f32 v194, v194
  v_mfma_f32_16x16x32_bf16 v[196:199], a[140:143], a[92:95], v[196:199]
  v_exp_f32 v195, v195
  v_mfma_f32_16x16x32_bf16 v[16:19], a[160:163], v[176:179], v[16:19]
  v_accvgpr_write_b32 a42, v218
  v_cvt_pk_bf16_f32 v128, v192, v193
  v_mfma_f32_16x16x32_bf16 v[16:19], a[164:167], v[180:183], v[16:19]
  v_cvt_pk_bf16_f32 v129, v194, v195
  v_accvgpr_write_b32 a43, v219
  v_mfma_f32_16x16x32_bf16 v[24:27], a[160:163], v[184:187], v[24:27]
  ds_read_b64_tr_b16 a[160:161], v242 offset:9216
  ds_read_b64_tr_b16 a[162:163], v242 offset:11264
  v_mfma_f32_16x16x32_bf16 v[24:27], a[164:167], v[188:191], v[24:27]
  s_waitcnt lgkmcnt(2)
  buffer_load_dwordx4 v245, s[12:15], s35 offen offset:128 nt lds
  ds_read_b64_tr_b16 a[164:165], v242 offset:13312
  v_mfma_f32_16x16x32_bf16 v[192:195], a[128:131], a[96:99], v[208:211]
  s_add_u32 m0, s38, 2944
  ds_read_b64_tr_b16 a[166:167], v242 offset:15360
  v_lshlrev_b32 v224, 16, v220
  v_mfma_f32_16x16x32_bf16 v[192:195], a[132:135], a[100:103], v[192:195]
  v_and_b32 v225, 0xffff0000, v220
  v_lshlrev_b32 v226, 16, v221
  v_mfma_f32_16x16x32_bf16 v[192:195], a[136:139], a[104:107], v[192:195]
  v_exp_f32 v196, v196
  v_mfma_f32_16x16x32_bf16 v[192:195], a[140:143], a[108:111], v[192:195]
  v_exp_f32 v197, v197
  v_mfma_f32_16x16x32_bf16 v[4:7], a[168:171], v[160:163], v[4:7]
  v_exp_f32 v198, v198
  v_mfma_f32_16x16x32_bf16 v[4:7], a[172:175], v[164:167], v[4:7]
  v_exp_f32 v199, v199
  v_mfma_f32_16x16x32_bf16 v[12:15], a[168:171], v[168:171], v[12:15]
  v_cvt_pk_bf16_f32 v136, v196, v197
  v_cvt_pk_bf16_f32 v137, v198, v199
  v_mfma_f32_16x16x32_bf16 v[12:15], a[172:175], v[172:175], v[12:15]
  buffer_load_dwordx4 v245, s[12:15], s35 offen offset:2176 nt lds
  v_and_b32 v227, 0xffff0000, v221
  v_smfmac_f32_16x16x64_bf16 a[192:195], a[208:211], v[160:167], v248
  s_add_u32 m0, s36, 16384
  v_lshlrev_b32 v228, 16, v222
  v_and_b32 v229, 0xffff0000, v222
  v_mfma_f32_16x16x32_bf16 v[196:199], a[128:131], a[112:115], v[212:215]
  v_exp_f32 v192, v192
  v_mfma_f32_16x16x32_bf16 v[196:199], a[132:135], a[116:119], v[196:199]
  v_exp_f32 v193, v193
  v_mfma_f32_16x16x32_bf16 v[196:199], a[136:139], a[120:123], v[196:199]
  v_exp_f32 v194, v194
  v_mfma_f32_16x16x32_bf16 v[196:199], a[140:143], a[124:127], v[196:199]
  v_exp_f32 v195, v195
  v_mfma_f32_16x16x32_bf16 v[20:23], a[168:171], v[176:179], v[20:23]
  ds_read_b128 a[128:131], v240 offset:40960
  ds_read_b128 a[132:135], v241 offset:40960
  v_mfma_f32_16x16x32_bf16 v[20:23], a[172:175], v[180:183], v[20:23]
  buffer_store_dwordx4 a[236:239], v251, s[16:19], s24 offen offset:2176 sc1
  v_mfma_f32_16x16x32_bf16 v[28:31], a[168:171], v[184:187], v[28:31]
  ds_read_b128 a[136:139], v240 offset:43008
  ds_read_b128 a[140:143], v241 offset:43008
  v_mfma_f32_16x16x32_bf16 v[28:31], a[172:175], v[188:191], v[28:31]
  ds_read_b64_tr_b16 a[168:169], v242 offset:9224
  ds_read_b64_tr_b16 a[170:171], v242 offset:11272
  v_cvt_pk_bf16_f32 v144, v192, v193
  v_cvt_pk_bf16_f32 v145, v194, v195
  v_mfma_f32_16x16x32_bf16 v[192:195], a[144:147], a[64:67], v[200:203]
  ds_read_b64_tr_b16 a[172:173], v242 offset:13320
  ds_read_b64_tr_b16 a[174:175], v242 offset:15368
  v_mfma_f32_16x16x32_bf16 v[192:195], a[148:151], a[68:71], v[192:195]
  v_lshlrev_b32 v230, 16, v223
  v_and_b32 v231, 0xffff0000, v223
  v_mfma_f32_16x16x32_bf16 v[192:195], a[152:155], a[72:75], v[192:195]
  v_exp_f32 v196, v196
  v_exp_f32 v197, v197
  v_pk_mul_f32 v[224:225], v[224:225], s[42:43]
  v_pk_mul_f32 v[226:227], v[226:227], s[42:43]
  v_pk_mul_f32 v[228:229], v[228:229], s[42:43]
  v_pk_mul_f32 v[230:231], v[230:231], s[42:43]
  v_mfma_f32_16x16x32_bf16 v[192:195], a[156:159], a[76:79], v[192:195]
  v_exp_f32 v198, v198
  v_mfma_f32_16x16x32_bf16 v[32:35], a[176:179], v[160:163], v[32:35]
  v_exp_f32 v199, v199
  v_mfma_f32_16x16x32_bf16 v[32:35], a[180:183], v[164:167], v[32:35]
  v_cvt_pk_bf16_f32 v152, v196, v197
  v_cvt_pk_bf16_f32 v153, v198, v199
  v_mfma_f32_16x16x32_bf16 v[40:43], a[176:179], v[168:171], v[40:43]
  v_cvt_pk_bf16_f32 v220, v224, v225
  v_cvt_pk_bf16_f32 v221, v226, v227
  v_mfma_f32_16x16x32_bf16 v[40:43], a[180:183], v[172:175], v[40:43]
  v_exp_f32 v192, v192
  v_smfmac_f32_16x16x64_bf16 a[196:199], a[208:211], v[168:175], v248
  v_exp_f32 v193, v193
  v_mfma_f32_16x16x32_bf16 v[196:199], a[144:147], a[80:83], v[204:207]
  v_exp_f32 v194, v194
  v_mfma_f32_16x16x32_bf16 v[196:199], a[148:151], a[84:87], v[196:199]
  v_exp_f32 v195, v195
  v_mfma_f32_16x16x32_bf16 v[196:199], a[152:155], a[88:91], v[196:199]
  buffer_load_dwordx4 v245, s[4:7], s39 offen nt lds
  v_cvt_pk_bf16_f32 v130, v192, v193
  v_mfma_f32_16x16x32_bf16 v[196:199], a[156:159], a[92:95], v[196:199]
  s_add_u32 m0, s37, 0
  v_cvt_pk_bf16_f32 v131, v194, v195
  v_cvt_pk_bf16_f32 v222, v228, v229
  v_mfma_f32_16x16x32_bf16 v[48:51], a[176:179], v[176:179], v[48:51]
  s_waitcnt vmcnt(13)
  v_cvt_pk_bf16_f32 v223, v230, v231
  v_accvgpr_write_b32 a44, v220
  v_mfma_f32_16x16x32_bf16 v[48:51], a[180:183], v[180:183], v[48:51]
  v_exp_f32 v196, v196
  v_mfma_f32_16x16x32_bf16 v[56:59], a[176:179], v[184:187], v[56:59]
  v_exp_f32 v197, v197
  v_mfma_f32_16x16x32_bf16 v[56:59], a[180:183], v[188:191], v[56:59]
  v_exp_f32 v198, v198
  v_mfma_f32_16x16x32_bf16 v[192:195], a[144:147], a[96:99], v[208:211]
  v_exp_f32 v199, v199
  v_mfma_f32_16x16x32_bf16 v[192:195], a[148:151], a[100:103], v[192:195]
  ds_read_b64_tr_b16 a[176:177], v243 offset:9216
  ds_read_b64_tr_b16 a[178:179], v243 offset:11264
  v_mfma_f32_16x16x32_bf16 v[192:195], a[152:155], a[104:107], v[192:195]
  ds_read_b64_tr_b16 a[180:181], v243 offset:13312
  ds_read_b64_tr_b16 a[182:183], v243 offset:15360
  v_mfma_f32_16x16x32_bf16 v[192:195], a[156:159], a[108:111], v[192:195]
  v_cvt_pk_bf16_f32 v138, v196, v197
  v_cvt_pk_bf16_f32 v139, v198, v199
  v_mfma_f32_16x16x32_bf16 v[36:39], a[184:187], v[160:163], v[36:39]
L_stub10:
  s_cmp_eq_u32 s99, 1
  s_cbranch_scc1 L_ret2
  ds_read_b128 v[216:219], v249 offset:2048
  buffer_load_dwordx4 v246, s[8:11], s40 offen nt lds
  v_mfma_f32_16x16x32_bf16 v[36:39], a[188:191], v[164:167], v[36:39]
  s_add_u32 m0, s36, 15360
  v_accvgpr_write_b32 a45, v221
  v_accvgpr_write_b32 a46, v222
  v_mfma_f32_16x16x32_bf16 v[44:47], a[184:187], v[168:171], v[44:47]
  v_exp_f32 v192, v192
  v_mfma_f32_16x16x32_bf16 v[44:47], a[188:191], v[172:175], v[44:47]
  v_exp_f32 v193, v193
  v_smfmac_f32_16x16x64_bf16 a[200:203], a[208:211], v[176:183], v248
  v_exp_f32 v194, v194
  v_mfma_f32_16x16x32_bf16 v[196:199], a[144:147], a[112:115], v[212:215]
  v_exp_f32 v195, v195
  v_mfma_f32_16x16x32_bf16 v[196:199], a[148:151], a[116:119], v[196:199]
  ds_read_b128 a[144:147], v240 offset:45056
  ds_read_b128 a[148:151], v241 offset:45056
  v_mfma_f32_16x16x32_bf16 v[196:199], a[152:155], a[120:123], v[196:199]
  ds_read_b128 a[152:155], v240 offset:47104
  v_cvt_pk_bf16_f32 v146, v192, v193
  v_mfma_f32_16x16x32_bf16 v[196:199], a[156:159], a[124:127], v[196:199]
  ds_read_b128 a[156:159], v241 offset:47104
  v_cvt_pk_bf16_f32 v147, v194, v195
  v_mfma_f32_16x16x32_bf16 v[52:55], a[184:187], v[176:179], v[52:55]
  s_waitcnt lgkmcnt(4)
  v_accvgpr_write_b32 a47, v223
  v_lshlrev_b32 v224, 16, v216
  v_mfma_f32_16x16x32_bf16 v[52:55], a[188:191], v[180:183], v[52:55]
  buffer_load_dwordx4 v245, s[4:7], s39 offen offset:2048 nt lds
  v_and_b32 v225, 0xffff0000, v216
  v_mfma_f32_16x16x32_bf16 v[60:63], a[184:187], v[184:187], v[60:63]
  s_add_u32 m0, s37, 31752
  ds_read_b64_tr_b16 a[184:185], v243 offset:9224
  ds_read_b64_tr_b16 a[186:187], v243 offset:11272
  v_mfma_f32_16x16x32_bf16 v[60:63], a[188:191], v[188:191], v[60:63]
  ds_read_b64_tr_b16 a[188:189], v243 offset:13320
  ds_read_b64_tr_b16 a[190:191], v243 offset:15368
  v_mfma_f32_16x16x32_bf16 v[192:195], a[128:131], a[64:67], v[200:203]
  v_lshlrev_b32 v226, 16, v217
  v_and_b32 v227, 0xffff0000, v217
  v_mfma_f32_16x16x32_bf16 v[192:195], a[132:135], a[68:71], v[192:195]
  v_exp_f32 v196, v196
  v_mfma_f32_16x16x32_bf16 v[192:195], a[136:139], a[72:75], v[192:195]
  v_exp_f32 v197, v197
  v_mfma_f32_16x16x32_bf16 v[192:195], a[140:143], a[76:79], v[192:195]
  v_exp_f32 v198, v198
  v_mfma_f32_16x16x32_bf16 v[64:67], a[160:163], v[160:163], v[64:67]
  v_exp_f32 v199, v199
  v_mfma_f32_16x16x32_bf16 v[64:67], a[164:167], v[164:167], v[64:67]
  v_cvt_pk_bf16_f32 v154, v196, v197
  v_cvt_pk_bf16_f32 v155, v198, v199
  v_mfma_f32_16x16x32_bf16 v[72:75], a[160:163], v[168:171], v[72:75]
  v_lshlrev_b32 v228, 16, v218
  v_and_b32 v229, 0xffff0000, v218
  v_mfma_f32_16x16x32_bf16 v[72:75], a[164:167], v[172:175], v[72:75]
  v_exp_f32 v192, v192
  v_smfmac_f32_16x16x64_bf16 a[204:207], a[208:211], v[184:191], v248
  v_exp_f32 v193, v193
  v_mfma_f32_16x16x32_bf16 v[196:199], a[128:131], a[80:83], v[204:207]
  v_exp_f32 v194, v194
  v_mfma_f32_16x16x32_bf16 v[196:199], a[132:135], a[84:87], v[196:199]
  v_exp_f32 v195, v195
  v_mfma_f32_16x16x32_bf16 v[196:199], a[136:139], a[88:91], v[196:199]
  buffer_load_dwordx4 v246, s[8:11], s40 offen offset:1024 nt lds
  v_lshlrev_b32 v230, 16, v219
  v_mfma_f32_16x16x32_bf16 v[196:199], a[140:143], a[92:95], v[196:199]
  s_add_u32 m0, s36, 18304
  v_cvt_pk_bf16_f32 v132, v192, v193
  v_cvt_pk_bf16_f32 v133, v194, v195
  v_mfma_f32_16x16x32_bf16 v[80:83], a[160:163], v[176:179], v[80:83]
  v_and_b32 v231, 0xffff0000, v219
  v_mfma_f32_16x16x32_bf16 v[80:83], a[164:167], v[180:183], v[80:83]
  v_mfma_f32_16x16x32_bf16 v[88:91], a[160:163], v[184:187], v[88:91]
  v_mfma_f32_16x16x32_bf16 v[88:91], a[164:167], v[188:191], v[88:91]
  v_exp_f32 v196, v196
  v_exp_f32 v197, v197
  v_pk_mul_f32 v[224:225], v[224:225], s[42:43]
  v_pk_mul_f32 v[226:227], v[226:227], s[42:43]
  v_pk_mul_f32 v[228:229], v[228:229], s[42:43]
  v_pk_mul_f32 v[230:231], v[230:231], s[42:43]
  v_mfma_f32_16x16x32_bf16 v[192:195], a[128:131], a[96:99], v[208:211]
  v_exp_f32 v198, v198
  v_mfma_f32_16x16x32_bf16 v[192:195], a[132:135], a[100:103], v[192:195]
  v_exp_f32 v199, v199
  v_mfma_f32_16x16x32_bf16 v[192:195], a[136:139], a[104:107], v[192:195]
  v_cvt_pk_bf16_f32 v140, v196, v197
  v_cvt_pk_bf16_f32 v141, v198, v199
  v_mfma_f32_16x16x32_bf16 v[192:195], a[140:143], a[108:111], v[192:195]
  s_waitcnt vmcnt(19) lgkmcnt(0)
  v_cvt_pk_bf16_f32 v216, v224, v225
  v_cvt_pk_bf16_f32 v217, v226, v227
  v_mfma_f32_16x16x32_bf16 v[68:71], a[168:171], v[160:163], v[68:71]
  s_barrier
  ds_read_b64_tr_b16 a[160:161], v242 offset:16384
  ds_read_b64_tr_b16 a[162:163], v242 offset:18432
  v_mfma_f32_16x16x32_bf16 v[68:71], a[172:175], v[164:167], v[68:71]
  v_exp_f32 v192, v192
  v_mfma_f32_16x16x32_bf16 v[76:79], a[168:171], v[168:171], v[76:79]
  v_exp_f32 v193, v193
  v_mfma_f32_16x16x32_bf16 v[76:79], a[172:175], v[172:175], v[76:79]
  v_exp_f32 v194, v194
  v_mfma_f32_16x16x32_bf16 v[196:199], a[128:131], a[112:115], v[212:215]
  v_exp_f32 v195, v195
  v_mfma_f32_16x16x32_bf16 v[196:199], a[132:135], a[116:119], v[196:199]
  buffer_store_dwordx4 a[240:243], v251, s[16:19], s25 offen offset:2176 sc1
  v_mfma_f32_16x16x32_bf16 v[196:199], a[136:139], a[120:123], v[196:199]
  ds_read_b128 a[128:131], v240 offset:49152
  ds_read_b128 a[132:135], v241 offset:49152
  v_mfma_f32_16x16x32_bf16 v[196:199], a[140:143], a[124:127], v[196:199]
  ds_read_b128 a[136:139], v240 offset:51200
  ds_read_b128 a[140:143], v241 offset:51200
  v_mfma_f32_16x16x32_bf16 v[84:87], a[168:171], v[176:179], v[84:87]
  ds_read_b64_tr_b16 a[164:165], v242 offset:20480
  ds_read_b64_tr_b16 a[166:167], v242 offset:22528
  v_mfma_f32_16x16x32_bf16 v[84:87], a[172:175], v[180:183], v[84:87]
  v_cvt_pk_bf16_f32 v148, v192, v193
  v_cvt_pk_bf16_f32 v149, v194, v195
  v_mfma_f32_16x16x32_bf16 v[92:95], a[168:171], v[184:187], v[92:95]
  ds_read_b64_tr_b16 a[168:169], v242 offset:16392
  ds_read_b64_tr_b16 a[170:171], v242 offset:18440
  v_mfma_f32_16x16x32_bf16 v[92:95], a[172:175], v[188:191], v[92:95]
  ds_read_b64_tr_b16 a[172:173], v242 offset:20488
  ds_read_b64_tr_b16 a[174:175], v242 offset:22536
  v_mfma_f32_16x16x32_bf16 v[192:195], a[144:147], a[64:67], v[200:203]
  v_cvt_pk_bf16_f32 v218, v228, v229
  v_cvt_pk_bf16_f32 v219, v230, v231
  v_mfma_f32_16x16x32_bf16 v[192:195], a[148:151], a[68:71], v[192:195]
  v_exp_f32 v196, v196
  v_mfma_f32_16x16x32_bf16 v[192:195], a[152:155], a[72:75], v[192:195]
  ds_read_b128 v[220:223], v250 offset:2048
  v_accvgpr_write_b32 a48, v216
  v_mfma_f32_16x16x32_bf16 v[192:195], a[156:159], a[76:79], v[192:195]
  v_exp_f32 v197, v197
  v_mfma_f32_16x16x32_bf16 v[96:99], a[176:179], v[160:163], v[96:99]
  v_exp_f32 v198, v198
  v_mfma_f32_16x16x32_bf16 v[96:99], a[180:183], v[164:167], v[96:99]
  v_exp_f32 v199, v199
  v_mfma_f32_16x16x32_bf16 v[104:107], a[176:179], v[168:171], v[104:107]
  buffer_load_dwordx4 v245, s[4:7], s39 offen offset:128 nt lds
  v_cvt_pk_bf16_f32 v156, v196, v197
  v_mfma_f32_16x16x32_bf16 v[104:107], a[180:183], v[172:175], v[104:107]
  s_add_u32 m0, s37, 896
  v_cvt_pk_bf16_f32 v157, v198, v199
  v_accvgpr_write_b32 a49, v217
  v_mfma_f32_16x16x32_bf16 v[196:199], a[144:147], a[80:83], v[204:207]
  v_accvgpr_write_b32 a50, v218
  v_accvgpr_write_b32 a51, v219
  v_mfma_f32_16x16x32_bf16 v[196:199], a[148:151], a[84:87], v[196:199]
  v_exp_f32 v192, v192
  v_mfma_f32_16x16x32_bf16 v[196:199], a[152:155], a[88:91], v[196:199]
  v_exp_f32 v193, v193
  v_mfma_f32_16x16x32_bf16 v[196:199], a[156:159], a[92:95], v[196:199]
  v_exp_f32 v194, v194
  v_mfma_f32_16x16x32_bf16 v[112:115], a[176:179], v[176:179], v[112:115]
  v_exp_f32 v195, v195
  v_mfma_f32_16x16x32_bf16 v[112:115], a[180:183], v[180:183], v[112:115]
  v_cvt_pk_bf16_f32 v134, v192, v193
  v_cvt_pk_bf16_f32 v135, v194, v195
  v_mfma_f32_16x16x32_bf16 v[120:123], a[176:179], v[184:187], v[120:123]
  ds_read_b64_tr_b16 a[176:177], v243 offset:16384
  ds_read_b64_tr_b16 a[178:179], v243 offset:18432
  v_mfma_f32_16x16x32_bf16 v[120:123], a[180:183], v[188:191], v[120:123]
  ds_read_b64_tr_b16 a[180:181], v243 offset:20480
  ds_read_b64_tr_b16 a[182:183], v243 offset:22528
  v_mfma_f32_16x16x32_bf16 v[192:195], a[144:147], a[96:99], v[208:211]
  s_waitcnt lgkmcnt(4)
  buffer_load_dwordx4 v246, s[8:11], s40 offen offset:128 nt lds
  v_lshlrev_b32 v224, 16, v220
  v_mfma_f32_16x16x32_bf16 v[192:195], a[148:151], a[100:103], v[192:195]
  s_add_u32 m0, s36, 17280
  v_and_b32 v225, 0xffff0000, v220
  v_lshlrev_b32 v226, 16, v221
  v_mfma_f32_16x16x32_bf16 v[192:195], a[152:155], a[104:107], v[192:195]
  v_exp_f32 v196, v196
  v_mfma_f32_16x16x32_bf16 v[192:195], a[156:159], a[108:111], v[192:195]
  v_exp_f32 v197, v197
  v_mfma_f32_16x16x32_bf16 v[100:103], a[184:187], v[160:163], v[100:103]
  v_exp_f32 v198, v198
  v_mfma_f32_16x16x32_bf16 v[100:103], a[188:191], v[164:167], v[100:103]
  v_exp_f32 v199, v199
  v_mfma_f32_16x16x32_bf16 v[108:111], a[184:187], v[168:171], v[108:111]
  v_cvt_pk_bf16_f32 v142, v196, v197
  v_cvt_pk_bf16_f32 v143, v198, v199
  v_mfma_f32_16x16x32_bf16 v[108:111], a[188:191], v[172:175], v[108:111]
  v_and_b32 v227, 0xffff0000, v221
  v_lshlrev_b32 v228, 16, v222
  v_mfma_f32_16x16x32_bf16 v[196:199], a[144:147], a[112:115], v[212:215]
  ds_read_b128 a[144:147], v240 offset:53248
  v_and_b32 v229, 0xffff0000, v222
  v_mfma_f32_16x16x32_bf16 v[196:199], a[148:151], a[116:119], v[196:199]
  v_exp_f32 v192, v192
  v_mfma_f32_16x16x32_bf16 v[196:199], a[152:155], a[120:123], v[196:199]
  v_exp_f32 v193, v193
  v_mfma_f32_16x16x32_bf16 v[196:199], a[156:159], a[124:127], v[196:199]
  v_exp_f32 v194, v194
  v_mfma_f32_16x16x32_bf16 v[116:119], a[184:187], v[176:179], v[116:119]
  v_exp_f32 v195, v195
  v_mfma_f32_16x16x32_bf16 v[116:119], a[188:191], v[180:183], v[116:119]
  ds_read_b128 a[148:151], v241 offset:53248
  ds_read_b128 a[152:155], v240 offset:55296
  v_mfma_f32_16x16x32_bf16 v[124:127], a[184:187], v[184:187], v[124:127]
  ds_read_b128 a[156:159], v241 offset:55296
  ds_read_b64_tr_b16 a[184:185], v243 offset:16392
  v_mfma_f32_16x16x32_bf16 v[124:127], a[188:191], v[188:191], v[124:127]
  ds_read_b64_tr_b16 a[186:187], v243 offset:18440
  ds_read_b64_tr_b16 a[188:189], v243 offset:20488
  v_cvt_pk_bf16_f32 v150, v192, v193
  v_cvt_pk_bf16_f32 v151, v194, v195
  v_mfma_f32_16x16x32_bf16 v[192:195], a[128:131], a[64:67], v[200:203]
  ds_read_b64_tr_b16 a[190:191], v243 offset:22536
  buffer_load_dwordx4 v245, s[4:7], s39 offen offset:2176 nt lds
  v_lshlrev_b32 v230, 16, v223
  v_mfma_f32_16x16x32_bf16 v[192:195], a[132:135], a[68:71], v[192:195]
  s_add_u32 m0, s37, 32648
  v_and_b32 v231, 0xffff0000, v223
  v_mfma_f32_16x16x32_bf16 v[192:195], a[136:139], a[72:75], v[192:195]
  v_exp_f32 v196, v196
  v_exp_f32 v197, v197
  v_pk_mul_f32 v[224:225], v[224:225], s[42:43]
  v_pk_mul_f32 v[226:227], v[226:227], s[42:43]
  v_pk_mul_f32 v[228:229], v[228:229], s[42:43]
  v_pk_mul_f32 v[230:231], v[230:231], s[42:43]
  v_mfma_f32_16x16x32_bf16 v[192:195], a[140:143], a[76:79], v[192:195]
  s_add_u32 s39, s22, 32768
  v_exp_f32 v198, v198
  v_mfma_f32_16x16x32_bf16 v[0:3], a[160:163], v[128:131], v[0:3]
  v_exp_f32 v199, v199
  v_mfma_f32_16x16x32_bf16 v[0:3], a[164:167], v[132:135], v[0:3]
  v_cvt_pk_bf16_f32 v158, v196, v197
  v_cvt_pk_bf16_f32 v159, v198, v199
  v_mfma_f32_16x16x32_bf16 v[8:11], a[160:163], v[136:139], v[8:11]
  v_cvt_pk_bf16_f32 v220, v224, v225
  v_cvt_pk_bf16_f32 v221, v226, v227
  v_mfma_f32_16x16x32_bf16 v[8:11], a[164:167], v[140:143], v[8:11]
  v_exp_f32 v192, v192
  v_mfma_f32_16x16x32_bf16 v[196:199], a[128:131], a[80:83], v[204:207]
  v_exp_f32 v193, v193
  v_mfma_f32_16x16x32_bf16 v[196:199], a[132:135], a[84:87], v[196:199]
  v_exp_f32 v194, v194
  v_mfma_f32_16x16x32_bf16 v[196:199], a[136:139], a[88:91], v[196:199]
  v_exp_f32 v195, v195
  v_mfma_f32_16x16x32_bf16 v[196:199], a[140:143], a[92:95], v[196:199]
  s_waitcnt vmcnt(9)
  buffer_load_dwordx4 v246, s[8:11], s40 offen offset:1152 nt lds
  v_cvt_pk_bf16_f32 v160, v192, v193
  v_mfma_f32_16x16x32_bf16 v[16:19], a[160:163], v[144:147], v[16:19]
  s_add_u32 m0, s36, 32768
  v_cvt_pk_bf16_f32 v161, v194, v195
  v_cvt_pk_bf16_f32 v222, v228, v229
  v_mfma_f32_16x16x32_bf16 v[16:19], a[164:167], v[148:151], v[16:19]
  s_add_u32 s40, s22, 16384
  v_cvt_pk_bf16_f32 v223, v230, v231
  v_accvgpr_write_b32 a52, v220
  v_mfma_f32_16x16x32_bf16 v[24:27], a[160:163], v[152:155], v[24:27]
  v_exp_f32 v196, v196
  v_mfma_f32_16x16x32_bf16 v[24:27], a[164:167], v[156:159], v[24:27]
  v_exp_f32 v197, v197
  v_mfma_f32_16x16x32_bf16 v[192:195], a[128:131], a[96:99], v[208:211]
  v_exp_f32 v198, v198
  v_mfma_f32_16x16x32_bf16 v[192:195], a[132:135], a[100:103], v[192:195]
  v_exp_f32 v199, v199
  v_mfma_f32_16x16x32_bf16 v[192:195], a[136:139], a[104:107], v[192:195]
  ds_read_b64_tr_b16 a[160:161], v242 offset:17408
  ds_read_b64_tr_b16 a[162:163], v242 offset:19456
  v_mfma_f32_16x16x32_bf16 v[192:195], a[140:143], a[108:111], v[192:195]
  ds_read_b128 v[216:219], v249 offset:4096
  ds_read_b64_tr_b16 a[164:165], v242 offset:21504
  v_mfma_f32_16x16x32_bf16 v[4:7], a[168:171], v[128:131], v[4:7]
  ds_read_b64_tr_b16 a[166:167], v242 offset:23552
  v_cvt_pk_bf16_f32 v168, v196, v197
  v_mfma_f32_16x16x32_bf16 v[4:7], a[172:175], v[132:135], v[4:7]
  buffer_store_dwordx4 a[244:247], v251, s[16:19], s26 offen offset:2176 sc1
  v_mfma_f32_16x16x32_bf16 v[12:15], a[168:171], v[136:139], v[12:15]
  v_cvt_pk_bf16_f32 v169, v198, v199
  v_accvgpr_write_b32 a53, v221
  v_mfma_f32_16x16x32_bf16 v[12:15], a[172:175], v[140:143], v[12:15]
  v_accvgpr_write_b32 a54, v222
  v_accvgpr_write_b32 a55, v223
  v_smfmac_f32_16x16x64_bf16 a[192:195], a[208:211], v[128:135], v248
  v_exp_f32 v192, v192
  v_mfma_f32_16x16x32_bf16 v[196:199], a[128:131], a[112:115], v[212:215]
  v_exp_f32 v193, v193
  v_mfma_f32_16x16x32_bf16 v[196:199], a[132:135], a[116:119], v[196:199]
  v_exp_f32 v194, v194
  v_mfma_f32_16x16x32_bf16 v[196:199], a[136:139], a[120:123], v[196:199]
  v_exp_f32 v195, v195
  v_mfma_f32_16x16x32_bf16 v[196:199], a[140:143], a[124:127], v[196:199]
  ds_read_b128 a[128:131], v240 offset:57344
  ds_read_b128 a[132:135], v241 offset:57344
  v_mfma_f32_16x16x32_bf16 v[20:23], a[168:171], v[144:147], v[20:23]
  ds_read_b128 a[136:139], v240 offset:59392
  ds_read_b128 a[140:143], v241 offset:59392
  v_mfma_f32_16x16x32_bf16 v[20:23], a[172:175], v[148:151], v[20:23]
  v_cvt_pk_bf16_f32 v176, v192, v193
  v_cvt_pk_bf16_f32 v177, v194, v195
  v_mfma_f32_16x16x32_bf16 v[28:31], a[168:171], v[152:155], v[28:31]
  ds_read_b64_tr_b16 a[168:169], v242 offset:17416
  ds_read_b64_tr_b16 a[170:171], v242 offset:19464
  v_mfma_f32_16x16x32_bf16 v[28:31], a[172:175], v[156:159], v[28:31]
  s_waitcnt lgkmcnt(6)
  ds_read_b64_tr_b16 a[172:173], v242 offset:21512
  ds_read_b64_tr_b16 a[174:175], v242 offset:23560
  v_mfma_f32_16x16x32_bf16 v[192:195], a[144:147], a[64:67], v[200:203]
  buffer_load_dwordx4 v245, s[4:7], s39 offen nt lds
  v_lshlrev_b32 v224, 16, v216
  v_mfma_f32_16x16x32_bf16 v[192:195], a[148:151], a[68:71], v[192:195]
  s_add_u32 m0, s37, 8192
  v_and_b32 v225, 0xffff0000, v216
  v_lshlrev_b32 v226, 16, v217
  v_mfma_f32_16x16x32_bf16 v[192:195], a[152:155], a[72:75], v[192:195]
  v_exp_f32 v196, v196
  v_mfma_f32_16x16x32_bf16 v[192:195], a[156:159], a[76:79], v[192:195]
  v_exp_f32 v197, v197
  v_mfma_f32_16x16x32_bf16 v[32:35], a[176:179], v[128:131], v[32:35]
  v_exp_f32 v198, v198
  v_mfma_f32_16x16x32_bf16 v[32:35], a[180:183], v[132:135], v[32:35]
  v_exp_f32 v199, v199
  v_mfma_f32_16x16x32_bf16 v[40:43], a[176:179], v[136:139], v[40:43]
  v_and_b32 v227, 0xffff0000, v217
  v_cvt_pk_bf16_f32 v184, v196, v197
  v_mfma_f32_16x16x32_bf16 v[40:43], a[180:183], v[140:143], v[40:43]
  v_cvt_pk_bf16_f32 v185, v198, v199
  v_lshlrev_b32 v228, 16, v218
  v_smfmac_f32_16x16x64_bf16 a[196:199], a[208:211], v[136:143], v248
  v_and_b32 v229, 0xffff0000, v218
  v_lshlrev_b32 v230, 16, v219
  v_mfma_f32_16x16x32_bf16 v[196:199], a[144:147], a[80:83], v[204:207]
  v_exp_f32 v192, v192
  v_mfma_f32_16x16x32_bf16 v[196:199], a[148:151], a[84:87], v[196:199]
  v_exp_f32 v193, v193
  v_mfma_f32_16x16x32_bf16 v[196:199], a[152:155], a[88:91], v[196:199]
  v_exp_f32 v194, v194
  v_mfma_f32_16x16x32_bf16 v[196:199], a[156:159], a[92:95], v[196:199]
  v_exp_f32 v195, v195
  v_mfma_f32_16x16x32_bf16 v[48:51], a[176:179], v[144:147], v[48:51]
  buffer_load_dwordx4 v246, s[8:11], s40 offen nt lds
  v_cvt_pk_bf16_f32 v162, v192, v193
  v_mfma_f32_16x16x32_bf16 v[48:51], a[180:183], v[148:151], v[48:51]
  s_add_u32 m0, s36, 31744
  v_cvt_pk_bf16_f32 v163, v194, v195
  v_and_b32 v231, 0xffff0000, v219
  v_mfma_f32_16x16x32_bf16 v[56:59], a[176:179], v[152:155], v[56:59]
  v_exp_f32 v196, v196
  v_exp_f32 v197, v197
  v_pk_mul_f32 v[224:225], v[224:225], s[42:43]
  v_pk_mul_f32 v[226:227], v[226:227], s[42:43]
  v_pk_mul_f32 v[228:229], v[228:229], s[42:43]
  v_pk_mul_f32 v[230:231], v[230:231], s[42:43]
  v_mfma_f32_16x16x32_bf16 v[56:59], a[180:183], v[156:159], v[56:59]
  v_exp_f32 v198, v198
  v_mfma_f32_16x16x32_bf16 v[192:195], a[144:147], a[96:99], v[208:211]
  v_exp_f32 v199, v199
  v_mfma_f32_16x16x32_bf16 v[192:195], a[148:151], a[100:103], v[192:195]
  ds_read_b64_tr_b16 a[176:177], v243 offset:17408
  ds_read_b64_tr_b16 a[178:179], v243 offset:19456
  v_mfma_f32_16x16x32_bf16 v[192:195], a[152:155], a[104:107], v[192:195]
  ds_read_b64_tr_b16 a[180:181], v243 offset:21504
  ds_read_b64_tr_b16 a[182:183], v243 offset:23552
  v_mfma_f32_16x16x32_bf16 v[192:195], a[156:159], a[108:111], v[192:195]
  v_cvt_pk_bf16_f32 v170, v196, v197
  v_cvt_pk_bf16_f32 v171, v198, v199
  v_mfma_f32_16x16x32_bf16 v[36:39], a[184:187], v[128:131], v[36:39]
  v_cvt_pk_bf16_f32 v216, v224, v225
  v_cvt_pk_bf16_f32 v217, v226, v227
  v_mfma_f32_16x16x32_bf16 v[36:39], a[188:191], v[132:135], v[36:39]
  v_cvt_pk_bf16_f32 v218, v228, v229
  v_cvt_pk_bf16_f32 v219, v230, v231
  v_mfma_f32_16x16x32_bf16 v[44:47], a[184:187], v[136:139], v[44:47]
  v_exp_f32 v192, v192
  v_mfma_f32_16x16x32_bf16 v[44:47], a[188:191], v[140:143], v[44:47]
  v_exp_f32 v193, v193
  v_smfmac_f32_16x16x64_bf16 a[200:203], a[208:211], v[144:151], v248
  v_exp_f32 v194, v194
  v_mfma_f32_16x16x32_bf16 v[196:199], a[144:147], a[112:115], v[212:215]
  v_exp_f32 v195, v195
  v_mfma_f32_16x16x32_bf16 v[196:199], a[148:151], a[116:119], v[196:199]
  ds_read_b128 a[144:147], v240 offset:61440
  ds_read_b128 a[148:151], v241 offset:61440
  v_mfma_f32_16x16x32_bf16 v[196:199], a[152:155], a[120:123], v[196:199]
  ds_read_b128 a[152:155], v240 offset:63488
  buffer_load_dwordx4 v245, s[4:7], s39 offen offset:2048 nt lds
  v_mfma_f32_16x16x32_bf16 v[196:199], a[156:159], a[124:127], v[196:199]
  s_add_u32 m0, s37, 39944
  ds_read_b128 a[156:159], v241 offset:63488
  v_cvt_pk_bf16_f32 v178, v192, v193
  v_mfma_f32_16x16x32_bf16 v[52:55], a[184:187], v[144:147], v[52:55]
  v_cvt_pk_bf16_f32 v179, v194, v195
  v_accvgpr_write_b32 a56, v216
  v_mfma_f32_16x16x32_bf16 v[52:55], a[188:191], v[148:151], v[52:55]
  v_accvgpr_write_b32 a57, v217
  v_accvgpr_write_b32 a58, v218
  v_mfma_f32_16x16x32_bf16 v[60:63], a[184:187], v[152:155], v[60:63]
  v_exp_f32 v196, v196
  v_mfma_f32_16x16x32_bf16 v[60:63], a[188:191], v[156:159], v[60:63]
  s_waitcnt lgkmcnt(4)
  v_exp_f32 v197, v197
  v_mfma_f32_16x16x32_bf16 v[192:195], a[128:131], a[64:67], v[200:203]
  ds_read_b128 v[220:223], v250 offset:4096
  ds_read_b64_tr_b16 a[184:185], v243 offset:17416
  v_mfma_f32_16x16x32_bf16 v[192:195], a[132:135], a[68:71], v[192:195]
  v_exp_f32 v198, v198
  v_mfma_f32_16x16x32_bf16 v[192:195], a[136:139], a[72:75], v[192:195]
  v_exp_f32 v199, v199
  v_mfma_f32_16x16x32_bf16 v[192:195], a[140:143], a[76:79], v[192:195]
  ds_read_b64_tr_b16 a[186:187], v243 offset:19464
  ds_read_b64_tr_b16 a[188:189], v243 offset:21512
  v_mfma_f32_16x16x32_bf16 v[64:67], a[160:163], v[128:131], v[64:67]
  ds_read_b64_tr_b16 a[190:191], v243 offset:23560
  buffer_load_dwordx4 v246, s[8:11], s40 offen offset:1024 nt lds
  v_mfma_f32_16x16x32_bf16 v[64:67], a[164:167], v[132:135], v[64:67]
  s_add_u32 m0, s36, 34688
  v_cvt_pk_bf16_f32 v186, v196, v197
  v_cvt_pk_bf16_f32 v187, v198, v199
  v_mfma_f32_16x16x32_bf16 v[72:75], a[160:163], v[136:139], v[72:75]
  v_exp_f32 v192, v192
  v_mfma_f32_16x16x32_bf16 v[72:75], a[164:167], v[140:143], v[72:75]
  v_exp_f32 v193, v193
  v_smfmac_f32_16x16x64_bf16 a[204:207], a[208:211], v[152:159], v248
  v_accvgpr_write_b32 a59, v219
  v_cvt_pk_bf16_f32 v164, v192, v193
  v_mfma_f32_16x16x32_bf16 v[196:199], a[128:131], a[80:83], v[204:207]
  s_waitcnt lgkmcnt(3)
  v_lshlrev_b32 v224, 16, v220
  v_and_b32 v225, 0xffff0000, v220
  v_mfma_f32_16x16x32_bf16 v[196:199], a[132:135], a[84:87], v[196:199]
  v_exp_f32 v194, v194
  v_mfma_f32_16x16x32_bf16 v[196:199], a[136:139], a[88:91], v[196:199]
  v_exp_f32 v195, v195
  v_mfma_f32_16x16x32_bf16 v[196:199], a[140:143], a[92:95], v[196:199]
  v_cvt_pk_bf16_f32 v165, v194, v195
  v_lshlrev_b32 v226, 16, v221
  v_mfma_f32_16x16x32_bf16 v[80:83], a[160:163], v[144:147], v[80:83]
  v_and_b32 v227, 0xffff0000, v221
  v_lshlrev_b32 v228, 16, v222
  v_mfma_f32_16x16x32_bf16 v[80:83], a[164:167], v[148:151], v[80:83]
  buffer_load_dwordx4 v245, s[4:7], s39 offen offset:128 nt lds
  v_and_b32 v229, 0xffff0000, v222
  v_mfma_f32_16x16x32_bf16 v[88:91], a[160:163], v[152:155], v[88:91]
  s_add_u32 m0, s37, 9088
  v_exp_f32 v196, v196
  v_mfma_f32_16x16x32_bf16 v[88:91], a[164:167], v[156:159], v[88:91]
  v_exp_f32 v197, v197
  v_mfma_f32_16x16x32_bf16 v[192:195], a[128:131], a[96:99], v[208:211]
  v_exp_f32 v198, v198
  v_mfma_f32_16x16x32_bf16 v[192:195], a[132:135], a[100:103], v[192:195]
  v_exp_f32 v199, v199
  v_mfma_f32_16x16x32_bf16 v[192:195], a[136:139], a[104:107], v[192:195]
  buffer_store_dwordx4 a[248:251], v251, s[16:19], s27 offen offset:2176 sc1
  v_mfma_f32_16x16x32_bf16 v[192:195], a[140:143], a[108:111], v[192:195]
  s_waitcnt vmcnt(19) lgkmcnt(0)
  v_cvt_pk_bf16_f32 v172, v196, v197
  v_cvt_pk_bf16_f32 v173, v198, v199
  v_mfma_f32_16x16x32_bf16 v[68:71], a[168:171], v[128:131], v[68:71]
  s_barrier
  ds_read_b64_tr_b16 a[160:161], v242 offset:24576
  ds_read_b64_tr_b16 a[162:163], v242 offset:26624
  v_mfma_f32_16x16x32_bf16 v[68:71], a[172:175], v[132:135], v[68:71]
  ds_read_b64_tr_b16 a[164:165], v242 offset:28672
  ds_read_b64_tr_b16 a[166:167], v242 offset:30720
  v_mfma_f32_16x16x32_bf16 v[76:79], a[168:171], v[136:139], v[76:79]
  v_lshlrev_b32 v230, 16, v223
  v_and_b32 v231, 0xffff0000, v223
  v_mfma_f32_16x16x32_bf16 v[76:79], a[172:175], v[140:143], v[76:79]
  v_exp_f32 v192, v192
  v_mfma_f32_16x16x32_bf16 v[196:199], a[128:131], a[112:115], v[212:215]
  v_exp_f32 v193, v193
  v_exp_f32 v194, v194
  v_pk_mul_f32 v[224:225], v[224:225], s[42:43]
  v_pk_mul_f32 v[226:227], v[226:227], s[42:43]
  v_pk_mul_f32 v[228:229], v[228:229], s[42:43]
  v_pk_mul_f32 v[230:231], v[230:231], s[42:43]
  v_mfma_f32_16x16x32_bf16 v[196:199], a[132:135], a[116:119], v[196:199]
  v_exp_f32 v195, v195
  v_mfma_f32_16x16x32_bf16 v[196:199], a[136:139], a[120:123], v[196:199]
  ds_read_b128 a[128:131], v240 offset:0
  ds_read_b128 a[132:135], v241 offset:0
  v_mfma_f32_16x16x32_bf16 v[196:199], a[140:143], a[124:127], v[196:199]
  ds_read_b128 a[136:139], v240 offset:2048
  ds_read_b128 a[140:143], v241 offset:2048
  v_mfma_f32_16x16x32_bf16 v[84:87], a[168:171], v[144:147], v[84:87]
  buffer_load_dwordx4 v246, s[8:11], s40 offen offset:128 nt lds
  v_cvt_pk_bf16_f32 v180, v192, v193
  v_mfma_f32_16x16x32_bf16 v[84:87], a[172:175], v[148:151], v[84:87]
  s_add_u32 m0, s36, 33664
  v_cvt_pk_bf16_f32 v181, v194, v195
  v_cvt_pk_bf16_f32 v220, v224, v225
  v_mfma_f32_16x16x32_bf16 v[92:95], a[168:171], v[152:155], v[92:95]
  v_exp_f32 v196, v196
  v_mfma_f32_16x16x32_bf16 v[92:95], a[172:175], v[156:159], v[92:95]
  v_exp_f32 v197, v197
  v_mfma_f32_16x16x32_bf16 v[192:195], a[144:147], a[64:67], v[200:203]
  v_exp_f32 v198, v198
  v_mfma_f32_16x16x32_bf16 v[192:195], a[148:151], a[68:71], v[192:195]
  v_exp_f32 v199, v199
  v_mfma_f32_16x16x32_bf16 v[192:195], a[152:155], a[72:75], v[192:195]
  ds_read_b64_tr_b16 a[168:169], v242 offset:24584
  ds_read_b64_tr_b16 a[170:171], v242 offset:26632
  v_mfma_f32_16x16x32_bf16 v[192:195], a[156:159], a[76:79], v[192:195]
  ds_read_b64_tr_b16 a[172:173], v242 offset:28680
  ds_read_b64_tr_b16 a[174:175], v242 offset:30728
  v_mfma_f32_16x16x32_bf16 v[96:99], a[176:179], v[128:131], v[96:99]
  v_cvt_pk_bf16_f32 v188, v196, v197
  v_cvt_pk_bf16_f32 v189, v198, v199
  v_mfma_f32_16x16x32_bf16 v[96:99], a[180:183], v[132:135], v[96:99]
  v_cvt_pk_bf16_f32 v221, v226, v227
  v_cvt_pk_bf16_f32 v222, v228, v229
  v_mfma_f32_16x16x32_bf16 v[104:107], a[176:179], v[136:139], v[104:107]
  v_exp_f32 v192, v192
  v_mfma_f32_16x16x32_bf16 v[104:107], a[180:183], v[140:143], v[104:107]
  v_exp_f32 v193, v193
  v_mfma_f32_16x16x32_bf16 v[196:199], a[144:147], a[80:83], v[204:207]
  v_exp_f32 v194, v194
  v_mfma_f32_16x16x32_bf16 v[196:199], a[148:151], a[84:87], v[196:199]
  v_exp_f32 v195, v195
  v_mfma_f32_16x16x32_bf16 v[196:199], a[152:155], a[88:91], v[196:199]
  buffer_load_dwordx4 v245, s[4:7], s39 offen offset:2176 nt lds
  v_cvt_pk_bf16_f32 v166, v192, v193
  v_mfma_f32_16x16x32_bf16 v[196:199], a[156:159], a[92:95], v[196:199]
  s_add_u32 m0, s37, 40840
  v_cvt_pk_bf16_f32 v167, v194, v195
  v_cvt_pk_bf16_f32 v223, v230, v231
  v_mfma_f32_16x16x32_bf16 v[112:115], a[176:179], v[144:147], v[112:115]
  v_accvgpr_write_b32 a60, v220
  v_accvgpr_write_b32 a61, v221
  v_mfma_f32_16x16x32_bf16 v[112:115], a[180:183], v[148:151], v[112:115]
  s_add_u32 s39, s22, 49152
  v_exp_f32 v196, v196
  v_mfma_f32_16x16x32_bf16 v[120:123], a[176:179], v[152:155], v[120:123]
  v_exp_f32 v197, v197
  v_mfma_f32_16x16x32_bf16 v[120:123], a[180:183], v[156:159], v[120:123]
  v_exp_f32 v198, v198
  v_mfma_f32_16x16x32_bf16 v[192:195], a[144:147], a[96:99], v[208:211]
  v_exp_f32 v199, v199
  v_mfma_f32_16x16x32_bf16 v[192:195], a[148:151], a[100:103], v[192:195]
  ds_read_b64_tr_b16 a[176:177], v243 offset:24576
  ds_read_b64_tr_b16 a[178:179], v243 offset:26624
  v_mfma_f32_16x16x32_bf16 v[192:195], a[152:155], a[104:107], v[192:195]
  ds_read_b64_tr_b16 a[180:181], v243 offset:28672
  ds_read_b64_tr_b16 a[182:183], v243 offset:30720
  v_mfma_f32_16x16x32_bf16 v[192:195], a[156:159], a[108:111], v[192:195]
  v_cvt_pk_bf16_f32 v174, v196, v197
  v_cvt_pk_bf16_f32 v175, v198, v199
  v_mfma_f32_16x16x32_bf16 v[100:103], a[184:187], v[128:131], v[100:103]
  buffer_load_dwordx4 v246, s[8:11], s40 offen offset:1152 nt lds
  v_accvgpr_write_b32 a62, v222
  v_mfma_f32_16x16x32_bf16 v[100:103], a[188:191], v[132:135], v[100:103]
  s_add_u32 m0, s36, 49152
  v_accvgpr_write_b32 a63, v223
  v_mfma_f32_16x16x32_bf16 v[108:111], a[184:187], v[136:139], v[108:111]
  v_exp_f32 v192, v192
  v_mfma_f32_16x16x32_bf16 v[108:111], a[188:191], v[140:143], v[108:111]
  s_add_u32 s40, s22, 32768
  v_exp_f32 v193, v193
  v_mfma_f32_16x16x32_bf16 v[196:199], a[144:147], a[112:115], v[212:215]
  v_exp_f32 v194, v194
  v_mfma_f32_16x16x32_bf16 v[196:199], a[148:151], a[116:119], v[196:199]
  v_exp_f32 v195, v195
  v_mfma_f32_16x16x32_bf16 v[196:199], a[152:155], a[120:123], v[196:199]
  ds_read_b128 a[144:147], v240 offset:4096
  ds_read_b128 a[148:151], v241 offset:4096
  v_mfma_f32_16x16x32_bf16 v[196:199], a[156:159], a[124:127], v[196:199]
  ds_read_b128 a[152:155], v240 offset:6144
  ds_read_b128 a[156:159], v241 offset:6144
  v_mfma_f32_16x16x32_bf16 v[116:119], a[184:187], v[144:147], v[116:119]
  v_cvt_pk_bf16_f32 v182, v192, v193
  v_cvt_pk_bf16_f32 v183, v194, v195
  v_mfma_f32_16x16x32_bf16 v[116:119], a[188:191], v[148:151], v[116:119]
  v_mfma_f32_16x16x32_bf16 v[124:127], a[184:187], v[152:155], v[124:127]
  ds_read_b64_tr_b16 a[184:185], v243 offset:24584
  ds_read_b64_tr_b16 a[186:187], v243 offset:26632
  v_mfma_f32_16x16x32_bf16 v[124:127], a[188:191], v[156:159], v[124:127]
  s_waitcnt lgkmcnt(6)
  v_exp_f32 v196, v196
  v_mfma_f32_16x16x32_bf16 v[132:135], a[128:131], a[0:3], 0
L_stub11:
  s_cmp_eq_u32 s99, 1
  s_cbranch_scc1 L_ret2
  v_exp_f32 v197, v197
  v_mfma_f32_16x16x32_bf16 v[132:135], a[132:135], a[4:7], v[132:135]
  v_exp_f32 v198, v198
  v_mfma_f32_16x16x32_bf16 v[132:135], a[136:139], a[8:11], v[132:135]
  v_exp_f32 v199, v199
  v_mfma_f32_16x16x32_bf16 v[132:135], a[140:143], a[12:15], v[132:135]
  ds_read_b64_tr_b16 a[188:189], v243 offset:28680
  ds_read_b64_tr_b16 a[190:191], v243 offset:30728
  v_mfma_f32_16x16x32_bf16 v[0:3], a[160:163], v[160:163], v[0:3]
  buffer_load_dwordx4 v245, s[4:7], s39 offen nt lds
  v_cvt_pk_bf16_f32 v190, v196, v197
  v_mfma_f32_16x16x32_bf16 v[0:3], a[164:167], v[164:167], v[0:3]
  s_add_u32 m0, s37, 16384
  v_cvt_pk_bf16_f32 v191, v198, v199
  v_max3_f32 v224, v132, v133, v134
  v_mfma_f32_16x16x32_bf16 v[8:11], a[160:163], v[168:171], v[8:11]
  v_max_f32 v224, v224, v135
  v_mov_b32 v225, v224
  v_mfma_f32_16x16x32_bf16 v[8:11], a[164:167], v[172:175], v[8:11]
  v_mfma_f32_16x16x32_bf16 v[140:143], a[128:131], a[16:19], 0
  v_permlane32_swap_b32 v224, v225
  v_max_f32 v224, v224, v225
  v_mfma_f32_16x16x32_bf16 v[140:143], a[132:135], a[20:23], v[140:143]
  v_mov_b32 v225, v224
  v_mfma_f32_16x16x32_bf16 v[140:143], a[136:139], a[24:27], v[140:143]
  v_mfma_f32_16x16x32_bf16 v[140:143], a[140:143], a[28:31], v[140:143]
  v_permlane16_swap_b32 v224, v225
  v_min_f32_e64 v200, -v224, -v225
  v_mfma_f32_16x16x32_bf16 v[16:19], a[160:163], v[176:179], v[16:19]
  v_min_f32_e64 v201, -v224, -v225
  v_min_f32_e64 v202, -v224, -v225
  v_mfma_f32_16x16x32_bf16 v[16:19], a[164:167], v[180:183], v[16:19]
  v_min_f32_e64 v203, -v224, -v225
  v_add_f32 v132, v200, v132
  v_mfma_f32_16x16x32_bf16 v[24:27], a[160:163], v[184:187], v[24:27]
  ds_read_b64_tr_b16 a[160:161], v242 offset:25600
  ds_read_b64_tr_b16 a[162:163], v242 offset:27648
  v_mfma_f32_16x16x32_bf16 v[24:27], a[164:167], v[188:191], v[24:27]
  ds_read_b64_tr_b16 a[164:165], v242 offset:29696
  ds_read_b64_tr_b16 a[166:167], v242 offset:31744
  v_smfmac_f32_16x16x64_bf16 a[192:195], a[208:211], v[160:167], v248
  buffer_load_dwordx4 v246, s[8:11], s40 offen nt lds
  v_max3_f32 v224, v140, v141, v142
  v_smfmac_f32_16x16x64_bf16 a[196:199], a[208:211], v[168:175], v248
  s_add_u32 m0, s36, 48128
  v_max_f32 v224, v224, v143
  v_mov_b32 v225, v224
  v_mfma_f32_16x16x32_bf16 v[148:151], a[128:131], a[32:35], 0
  v_add_f32 v133, v200, v133
  v_permlane32_swap_b32 v224, v225
  v_mfma_f32_16x16x32_bf16 v[148:151], a[132:135], a[36:39], v[148:151]
  v_max_f32 v224, v224, v225
  v_mov_b32 v225, v224
  v_mfma_f32_16x16x32_bf16 v[148:151], a[136:139], a[40:43], v[148:151]
  v_exp_f32 v132, v132
  v_mfma_f32_16x16x32_bf16 v[148:151], a[140:143], a[44:47], v[148:151]
  v_permlane16_swap_b32 v224, v225
  v_min_f32_e64 v204, -v224, -v225
  v_mfma_f32_16x16x32_bf16 v[4:7], a[168:171], v[160:163], v[4:7]
  v_min_f32_e64 v205, -v224, -v225
  v_min_f32_e64 v206, -v224, -v225
  v_mfma_f32_16x16x32_bf16 v[4:7], a[172:175], v[164:167], v[4:7]
  v_min_f32_e64 v207, -v224, -v225
  v_accvgpr_read_b32 v226, a192
  v_mfma_f32_16x16x32_bf16 v[12:15], a[168:171], v[168:171], v[12:15]
  v_max3_f32 v224, v148, v149, v150
  v_max_f32 v224, v224, v151
  v_mfma_f32_16x16x32_bf16 v[12:15], a[172:175], v[172:175], v[12:15]
  v_mov_b32 v225, v224
  v_accvgpr_read_b32 v227, a193
  v_smfmac_f32_16x16x64_bf16 a[200:203], a[208:211], v[176:183], v248
  buffer_load_dwordx4 v245, s[4:7], s39 offen offset:2048 nt lds
  v_permlane32_swap_b32 v224, v225
  v_smfmac_f32_16x16x64_bf16 a[204:207], a[208:211], v[184:191], v248
  s_add_u32 m0, s37, 48136
  v_max_f32 v224, v224, v225
  v_mov_b32 v225, v224
  v_mfma_f32_16x16x32_bf16 v[156:159], a[128:131], a[48:51], 0
  ds_read_b128 a[128:131], v240 offset:8192
  v_permlane16_swap_b32 v224, v225
  v_mfma_f32_16x16x32_bf16 v[156:159], a[132:135], a[52:55], v[156:159]
  ds_read_b128 a[132:135], v241 offset:8192
  v_min3_f32 v208, -v224, -v225, s63
  v_mfma_f32_16x16x32_bf16 v[156:159], a[136:139], a[56:59], v[156:159]
  ds_read_b128 a[136:139], v240 offset:10240
  v_min3_f32 v209, -v224, -v225, s63
  v_mfma_f32_16x16x32_bf16 v[156:159], a[140:143], a[60:63], v[156:159]
  ds_read_b128 a[140:143], v241 offset:10240
  v_min3_f32 v210, -v224, -v225, s63
  v_mfma_f32_16x16x32_bf16 v[20:23], a[168:171], v[176:179], v[20:23]
  v_min3_f32 v211, -v224, -v225, s63
  v_add_f32 v226, v226, v227
  v_mfma_f32_16x16x32_bf16 v[20:23], a[172:175], v[180:183], v[20:23]
  v_exp_f32 v133, v133
  v_mfma_f32_16x16x32_bf16 v[28:31], a[168:171], v[184:187], v[28:31]
  ds_read_b64_tr_b16 a[168:169], v242 offset:25608
  ds_read_b64_tr_b16 a[170:171], v242 offset:27656
  v_mfma_f32_16x16x32_bf16 v[28:31], a[172:175], v[188:191], v[28:31]
  s_waitcnt lgkmcnt(5)
  ds_read_b64_tr_b16 a[172:173], v242 offset:29704
  ds_read_b64_tr_b16 a[174:175], v242 offset:31752
  v_mfma_f32_16x16x32_bf16 v[192:195], a[144:147], a[0:3], v[200:203]
  buffer_load_dwordx4 v246, s[8:11], s40 offen offset:1024 nt lds
  v_max3_f32 v224, v156, v157, v158
  v_mfma_f32_16x16x32_bf16 v[192:195], a[148:151], a[4:7], v[192:195]
  s_add_u32 m0, s36, 51072
  v_max_f32 v224, v224, v159
  v_mov_b32 v225, v224
  v_mfma_f32_16x16x32_bf16 v[192:195], a[152:155], a[8:11], v[192:195]
  v_cvt_pk_bf16_f32 v128, v132, v133
  v_permlane32_swap_b32 v224, v225
  v_mfma_f32_16x16x32_bf16 v[192:195], a[156:159], a[12:15], v[192:195]
  v_max_f32 v224, v224, v225
  v_mov_b32 v225, v224
  v_mfma_f32_16x16x32_bf16 v[32:35], a[176:179], v[160:163], v[32:35]
  v_rcp_f32 v232, v226
  v_mfma_f32_16x16x32_bf16 v[32:35], a[180:183], v[164:167], v[32:35]
  v_permlane16_swap_b32 v224, v225
  v_min3_f32 v212, -v224, -v225, s63
  v_mfma_f32_16x16x32_bf16 v[40:43], a[176:179], v[168:171], v[40:43]
  v_exp_f32 v192, v192
  v_mfma_f32_16x16x32_bf16 v[40:43], a[180:183], v[172:175], v[40:43]
  v_exp_f32 v193, v193
  v_mfma_f32_16x16x32_bf16 v[196:199], a[144:147], a[16:19], v[204:207]
  v_exp_f32 v194, v194
  v_mfma_f32_16x16x32_bf16 v[196:199], a[148:151], a[20:23], v[196:199]
  v_exp_f32 v195, v195
  v_mfma_f32_16x16x32_bf16 v[196:199], a[152:155], a[24:27], v[196:199]
  buffer_load_dwordx4 v245, s[4:7], s39 offen offset:128 nt lds
  v_cvt_pk_bf16_f32 v130, v192, v193
  v_mfma_f32_16x16x32_bf16 v[196:199], a[156:159], a[28:31], v[196:199]
  s_add_u32 m0, s37, 17280
  v_cvt_pk_bf16_f32 v131, v194, v195
  v_min3_f32 v213, -v224, -v225, s63
  v_mfma_f32_16x16x32_bf16 v[48:51], a[176:179], v[176:179], v[48:51]
  v_min3_f32 v214, -v224, -v225, s63
  v_min3_f32 v215, -v224, -v225, s63
  v_mfma_f32_16x16x32_bf16 v[48:51], a[180:183], v[180:183], v[48:51]
  v_add_f32 v140, v204, v140
  v_add_f32 v141, v204, v141
  v_mfma_f32_16x16x32_bf16 v[56:59], a[176:179], v[184:187], v[56:59]
  v_exp_f32 v196, v196
  v_mfma_f32_16x16x32_bf16 v[56:59], a[180:183], v[188:191], v[56:59]
  v_exp_f32 v197, v197
  v_mfma_f32_16x16x32_bf16 v[192:195], a[144:147], a[32:35], v[208:211]
  v_exp_f32 v198, v198
  v_mfma_f32_16x16x32_bf16 v[192:195], a[148:151], a[36:39], v[192:195]
  v_exp_f32 v199, v199
  v_mfma_f32_16x16x32_bf16 v[192:195], a[152:155], a[40:43], v[192:195]
  ds_read_b64_tr_b16 a[176:177], v243 offset:25600
  ds_read_b64_tr_b16 a[178:179], v243 offset:27648
  v_mfma_f32_16x16x32_bf16 v[192:195], a[156:159], a[44:47], v[192:195]
  ds_read_b64_tr_b16 a[180:181], v243 offset:29696
  ds_read_b64_tr_b16 a[182:183], v243 offset:31744
  v_mfma_f32_16x16x32_bf16 v[36:39], a[184:187], v[160:163], v[36:39]
  buffer_load_dwordx4 v246, s[8:11], s40 offen offset:128 nt lds
  v_cvt_pk_bf16_f32 v138, v196, v197
  v_mfma_f32_16x16x32_bf16 v[36:39], a[188:191], v[164:167], v[36:39]
  s_add_u32 m0, s36, 50048
  v_cvt_pk_bf16_f32 v139, v198, v199
  v_mov_b32 v233, v232
  v_mfma_f32_16x16x32_bf16 v[44:47], a[184:187], v[168:171], v[44:47]
  v_exp_f32 v192, v192
  v_mfma_f32_16x16x32_bf16 v[44:47], a[188:191], v[172:175], v[44:47]
  v_exp_f32 v193, v193
  v_mfma_f32_16x16x32_bf16 v[196:199], a[144:147], a[48:51], v[212:215]
  v_exp_f32 v194, v194
  v_mfma_f32_16x16x32_bf16 v[196:199], a[148:151], a[52:55], v[196:199]
  v_exp_f32 v195, v195
  v_mfma_f32_16x16x32_bf16 v[196:199], a[152:155], a[56:59], v[196:199]
  ds_read_b128 a[144:147], v240 offset:12288
  ds_read_b128 a[148:151], v241 offset:12288
  v_mfma_f32_16x16x32_bf16 v[196:199], a[156:159], a[60:63], v[196:199]
  ds_read_b128 a[152:155], v240 offset:14336
  ds_read_b128 a[156:159], v241 offset:14336
  v_mfma_f32_16x16x32_bf16 v[52:55], a[184:187], v[176:179], v[52:55]
  v_cvt_pk_bf16_f32 v146, v192, v193
  v_cvt_pk_bf16_f32 v147, v194, v195
  v_mfma_f32_16x16x32_bf16 v[52:55], a[188:191], v[180:183], v[52:55]
  v_exp_f32 v140, v140
  v_mfma_f32_16x16x32_bf16 v[60:63], a[184:187], v[184:187], v[60:63]
  v_exp_f32 v196, v196
  v_mfma_f32_16x16x32_bf16 v[60:63], a[188:191], v[188:191], v[60:63]
  v_exp_f32 v197, v197
  v_mfma_f32_16x16x32_bf16 v[192:195], a[128:131], a[0:3], v[200:203]
  s_waitcnt lgkmcnt(4)
  v_exp_f32 v198, v198
  v_mfma_f32_16x16x32_bf16 v[192:195], a[132:135], a[4:7], v[192:195]
  v_exp_f32 v199, v199
  v_mfma_f32_16x16x32_bf16 v[192:195], a[136:139], a[8:11], v[192:195]
  ds_read_b64_tr_b16 a[184:185], v243 offset:25608
  ds_read_b64_tr_b16 a[186:187], v243 offset:27656
  v_mfma_f32_16x16x32_bf16 v[192:195], a[140:143], a[12:15], v[192:195]
  ds_read_b64_tr_b16 a[188:189], v243 offset:29704
  ds_read_b64_tr_b16 a[190:191], v243 offset:31752
  v_mfma_f32_16x16x32_bf16 v[64:67], a[160:163], v[160:163], v[64:67]
  buffer_load_dwordx4 v245, s[4:7], s39 offen offset:2176 nt lds
  v_cvt_pk_bf16_f32 v154, v196, v197
  v_mfma_f32_16x16x32_bf16 v[64:67], a[164:167], v[164:167], v[64:67]
  s_add_u32 m0, s37, 49032
  v_cvt_pk_bf16_f32 v155, v198, v199
  v_add_f32 v148, v208, v148
  v_mfma_f32_16x16x32_bf16 v[72:75], a[160:163], v[168:171], v[72:75]
  v_exp_f32 v192, v192
  v_mfma_f32_16x16x32_bf16 v[72:75], a[164:167], v[172:175], v[72:75]
  s_add_u32 s39, s22, 65536
  v_exp_f32 v193, v193
  v_mfma_f32_16x16x32_bf16 v[196:199], a[128:131], a[16:19], v[204:207]
  v_exp_f32 v194, v194
  v_mfma_f32_16x16x32_bf16 v[196:199], a[132:135], a[20:23], v[196:199]
  v_exp_f32 v195, v195
  v_mfma_f32_16x16x32_bf16 v[196:199], a[136:139], a[24:27], v[196:199]
  v_cvt_pk_bf16_f32 v132, v192, v193
  v_cvt_pk_bf16_f32 v133, v194, v195
  v_mfma_f32_16x16x32_bf16 v[196:199], a[140:143], a[28:31], v[196:199]
  v_exp_f32 v141, v141
  v_mfma_f32_16x16x32_bf16 v[80:83], a[160:163], v[176:179], v[80:83]
  v_cvt_pk_bf16_f32 v136, v140, v141
  v_add_f32 v149, v208, v149
  v_exp_f32 v148, v148
  v_pk_mul_f32 v[0:1], v[0:1], v[232:233]
  v_pk_mul_f32 v[2:3], v[2:3], v[232:233]
  v_pk_mul_f32 v[4:5], v[4:5], v[232:233]
  v_pk_mul_f32 v[6:7], v[6:7], v[232:233]
  v_mfma_f32_16x16x32_bf16 v[80:83], a[164:167], v[180:183], v[80:83]
  v_cvt_pk_bf16_f32 v0, v0, v1
  v_cvt_pk_bf16_f32 v1, v2, v3
  v_cvt_pk_bf16_f32 v2, v4, v5
  v_cvt_pk_bf16_f32 v3, v6, v7
  v_pk_mul_f32 v[32:33], v[32:33], v[232:233]
  v_pk_mul_f32 v[34:35], v[34:35], v[232:233]
  v_pk_mul_f32 v[36:37], v[36:37], v[232:233]
  v_pk_mul_f32 v[38:39], v[38:39], v[232:233]
  v_mfma_f32_16x16x32_bf16 v[88:91], a[160:163], v[184:187], v[88:91]
  buffer_load_dwordx4 v246, s[8:11], s40 offen offset:1152 nt lds
  v_cvt_pk_bf16_f32 v32, v32, v33
  v_mfma_f32_16x16x32_bf16 v[88:91], a[164:167], v[188:191], v[88:91]
  s_add_u32 m0, s36, 0
  v_cvt_pk_bf16_f32 v33, v34, v35
  v_cvt_pk_bf16_f32 v34, v36, v37
  v_mfma_f32_16x16x32_bf16 v[192:195], a[128:131], a[32:35], v[208:211]
  v_cvt_pk_bf16_f32 v35, v38, v39
  v_cndmask_b32_dpp v4, v32, v0, vcc row_ror:8 row_mask:0xf bank_mask:0xf
  v_mfma_f32_16x16x32_bf16 v[192:195], a[132:135], a[36:39], v[192:195]
  s_add_u32 s40, s22, 49152
  v_exp_f32 v196, v196
  v_mfma_f32_16x16x32_bf16 v[192:195], a[136:139], a[40:43], v[192:195]
  v_exp_f32 v197, v197
  v_mfma_f32_16x16x32_bf16 v[192:195], a[140:143], a[44:47], v[192:195]
  s_waitcnt vmcnt(18) lgkmcnt(0)
  v_exp_f32 v198, v198
  v_mfma_f32_16x16x32_bf16 v[68:71], a[168:171], v[160:163], v[68:71]
  s_barrier
  v_exp_f32 v199, v199
  v_mfma_f32_16x16x32_bf16 v[68:71], a[172:175], v[164:167], v[68:71]
  ds_read_b64_tr_b16 a[160:161], v242 offset:0
  ds_read_b64_tr_b16 a[162:163], v242 offset:2048
  v_mfma_f32_16x16x32_bf16 v[76:79], a[168:171], v[168:171], v[76:79]
  ds_read_b64_tr_b16 a[164:165], v242 offset:4096
  ds_read_b64_tr_b16 a[166:167], v242 offset:6144
  v_mfma_f32_16x16x32_bf16 v[76:79], a[172:175], v[172:175], v[76:79]
  v_cndmask_b32_dpp v5, v33, v1, vcc row_ror:8 row_mask:0xf bank_mask:0xf
  v_cndmask_b32_dpp v6, v34, v2, vcc row_ror:8 row_mask:0xf bank_mask:0xf
  v_cndmask_b32_dpp v7, v35, v3, vcc row_ror:8 row_mask:0xf bank_mask:0xf
  v_cvt_pk_bf16_f32 v140, v196, v197
  v_cvt_pk_bf16_f32 v141, v198, v199
  v_mfma_f32_16x16x32_bf16 v[196:199], a[128:131], a[48:51], v[212:215]
  s_not_b64 vcc, s[58:59]
  buffer_store_dwordx4 v[4:7], v251, s[16:19], s28 offen sc1
  v_mfma_f32_16x16x32_bf16 v[196:199], a[132:135], a[52:55], v[196:199]
  v_exp_f32 v149, v149
  v_mfma_f32_16x16x32_bf16 v[196:199], a[136:139], a[56:59], v[196:199]
  v_exp_f32 v192, v192
  v_mfma_f32_16x16x32_bf16 v[196:199], a[140:143], a[60:63], v[196:199]
  v_exp_f32 v193, v193
  v_mfma_f32_16x16x32_bf16 v[84:87], a[168:171], v[176:179], v[84:87]
  v_exp_f32 v194, v194
  v_mfma_f32_16x16x32_bf16 v[84:87], a[172:175], v[180:183], v[84:87]
  v_exp_f32 v195, v195
  v_mfma_f32_16x16x32_bf16 v[92:95], a[168:171], v[184:187], v[92:95]
  ds_read_b128 a[128:131], v240 offset:16384
  ds_read_b128 a[132:135], v241 offset:16384
  v_mfma_f32_16x16x32_bf16 v[92:95], a[172:175], v[188:191], v[92:95]
  ds_read_b128 a[136:139], v240 offset:18432
  ds_read_b128 a[140:143], v241 offset:18432
  v_cvt_pk_bf16_f32 v144, v148, v149
  v_cvt_pk_bf16_f32 v148, v192, v193
  v_cvt_pk_bf16_f32 v149, v194, v195
  v_mfma_f32_16x16x32_bf16 v[192:195], a[144:147], a[0:3], v[200:203]
  ds_read_b64_tr_b16 a[168:169], v242 offset:8
  ds_read_b64_tr_b16 a[170:171], v242 offset:2056
  v_mfma_f32_16x16x32_bf16 v[192:195], a[148:151], a[4:7], v[192:195]
  ds_read_b64_tr_b16 a[172:173], v242 offset:4104
  ds_read_b64_tr_b16 a[174:175], v242 offset:6152
  v_mfma_f32_16x16x32_bf16 v[192:195], a[152:155], a[8:11], v[192:195]
  buffer_load_dwordx4 v245, s[4:7], s39 offen nt lds
  v_add_f32 v156, v212, v156
  v_mfma_f32_16x16x32_bf16 v[192:195], a[156:159], a[12:15], v[192:195]
  s_add_u32 m0, s37, 24576
  v_add_f32 v157, v212, v157
  v_add_f32 v134, v200, v134
  v_mfma_f32_16x16x32_bf16 v[96:99], a[176:179], v[160:163], v[96:99]
  v_exp_f32 v156, v156
  v_mfma_f32_16x16x32_bf16 v[96:99], a[180:183], v[164:167], v[96:99]
  v_exp_f32 v157, v157
  v_mfma_f32_16x16x32_bf16 v[104:107], a[176:179], v[168:171], v[104:107]
  v_exp_f32 v196, v196
  v_exp_f32 v197, v197
  v_exp_f32 v198, v198
  v_exp_f32 v199, v199
  v_mfma_f32_16x16x32_bf16 v[104:107], a[180:183], v[172:175], v[104:107]
  v_cvt_pk_bf16_f32 v152, v156, v157
  v_cvt_pk_bf16_f32 v156, v196, v197
  v_cvt_pk_bf16_f32 v157, v198, v199
  v_mfma_f32_16x16x32_bf16 v[196:199], a[144:147], a[16:19], v[204:207]
  v_add_f32 v135, v200, v135
  v_add_f32 v142, v204, v142
  v_mfma_f32_16x16x32_bf16 v[196:199], a[148:151], a[20:23], v[196:199]
  v_exp_f32 v134, v134
  v_mfma_f32_16x16x32_bf16 v[196:199], a[152:155], a[24:27], v[196:199]
  v_exp_f32 v135, v135
  v_mfma_f32_16x16x32_bf16 v[196:199], a[156:159], a[28:31], v[196:199]
  v_exp_f32 v192, v192
  v_mfma_f32_16x16x32_bf16 v[112:115], a[176:179], v[176:179], v[112:115]
  v_exp_f32 v193, v193
  v_mfma_f32_16x16x32_bf16 v[112:115], a[180:183], v[180:183], v[112:115]
  v_exp_f32 v194, v194
  v_mfma_f32_16x16x32_bf16 v[120:123], a[176:179], v[184:187], v[120:123]
  v_exp_f32 v195, v195
  v_mfma_f32_16x16x32_bf16 v[120:123], a[180:183], v[188:191], v[120:123]
  ds_read_b64_tr_b16 a[176:177], v243 offset:0
  ds_read_b64_tr_b16 a[178:179], v243 offset:2048
  v_cvt_pk_bf16_f32 v129, v134, v135
  v_cvt_pk_bf16_f32 v134, v192, v193
  v_cvt_pk_bf16_f32 v135, v194, v195
  v_mfma_f32_16x16x32_bf16 v[192:195], a[144:147], a[32:35], v[208:211]
  ds_read_b64_tr_b16 a[180:181], v243 offset:4096
  ds_read_b64_tr_b16 a[182:183], v243 offset:6144
  v_mfma_f32_16x16x32_bf16 v[192:195], a[148:151], a[36:39], v[192:195]
  buffer_load_dwordx4 v246, s[8:11], s40 offen nt lds
  v_add_f32 v143, v204, v143
  v_mfma_f32_16x16x32_bf16 v[192:195], a[152:155], a[40:43], v[192:195]
  s_add_u32 m0, s36, -1024
  v_exp_f32 v142, v142
  v_mfma_f32_16x16x32_bf16 v[192:195], a[156:159], a[44:47], v[192:195]
  v_exp_f32 v143, v143
  v_mfma_f32_16x16x32_bf16 v[100:103], a[184:187], v[160:163], v[100:103]
  v_exp_f32 v196, v196
  v_mfma_f32_16x16x32_bf16 v[100:103], a[188:191], v[164:167], v[100:103]
  v_exp_f32 v197, v197
  v_mfma_f32_16x16x32_bf16 v[108:111], a[184:187], v[168:171], v[108:111]
  v_exp_f32 v198, v198
  v_exp_f32 v199, v199
  v_mfma_f32_16x16x32_bf16 v[108:111], a[188:191], v[172:175], v[108:111]
  v_cvt_pk_bf16_f32 v137, v142, v143
  v_cvt_pk_bf16_f32 v142, v196, v197
  v_cvt_pk_bf16_f32 v143, v198, v199
  v_mfma_f32_16x16x32_bf16 v[196:199], a[144:147], a[48:51], v[212:215]
  ds_read_b128 a[144:147], v240 offset:20480
  v_cmp_nlt_f32_e64 s[48:49], v226, s44
  v_mfma_f32_16x16x32_bf16 v[196:199], a[148:151], a[52:55], v[196:199]
  ds_read_b128 a[148:151], v241 offset:20480
  v_accvgpr_read_b32 v226, a196
  v_mfma_f32_16x16x32_bf16 v[196:199], a[152:155], a[56:59], v[196:199]
  ds_read_b128 a[152:155], v240 offset:22528
  v_accvgpr_read_b32 v227, a197
  v_mfma_f32_16x16x32_bf16 v[196:199], a[156:159], a[60:63], v[196:199]
  ds_read_b128 a[156:159], v241 offset:22528
  buffer_load_dwordx4 v245, s[4:7], s39 offen offset:2048 nt lds
  v_add_f32 v226, v226, v227
  v_rcp_f32 v234, v226
  v_mfma_f32_16x16x32_bf16 v[116:119], a[184:187], v[176:179], v[116:119]
  s_add_u32 m0, s37, 56328
  v_mov_b32 v235, v234
  v_cndmask_b32_dpp v36, v0, v32, vcc row_ror:8 row_mask:0xf bank_mask:0xf
  v_cndmask_b32_dpp v37, v1, v33, vcc row_ror:8 row_mask:0xf bank_mask:0xf
  v_cndmask_b32_dpp v38, v2, v34, vcc row_ror:8 row_mask:0xf bank_mask:0xf
  v_cndmask_b32_dpp v39, v3, v35, vcc row_ror:8 row_mask:0xf bank_mask:0xf
  v_pk_mul_f32 v[8:9], v[8:9], v[234:235]
  v_pk_mul_f32 v[10:11], v[10:11], v[234:235]
  v_pk_mul_f32 v[12:13], v[12:13], v[234:235]
  v_pk_mul_f32 v[14:15], v[14:15], v[234:235]
  v_cvt_pk_bf16_f32 v8, v8, v9
  v_cvt_pk_bf16_f32 v9, v10, v11
  v_cvt_pk_bf16_f32 v10, v12, v13
  v_cvt_pk_bf16_f32 v11, v14, v15
  v_pk_mul_f32 v[40:41], v[40:41], v[234:235]
  v_pk_mul_f32 v[42:43], v[42:43], v[234:235]
  v_pk_mul_f32 v[44:45], v[44:45], v[234:235]
  v_pk_mul_f32 v[46:47], v[46:47], v[234:235]
  v_cvt_pk_bf16_f32 v40, v40, v41
  v_cvt_pk_bf16_f32 v41, v42, v43
  v_cvt_pk_bf16_f32 v42, v44, v45
  v_cvt_pk_bf16_f32 v43, v46, v47
  v_mfma_f32_16x16x32_bf16 v[116:119], a[188:191], v[180:183], v[116:119]
  s_mov_b64 vcc, s[58:59]
  v_cndmask_b32_dpp v12, v40, v8, vcc row_ror:8 row_mask:0xf bank_mask:0xf
  v_cndmask_b32_dpp v13, v41, v9, vcc row_ror:8 row_mask:0xf bank_mask:0xf
  v_cndmask_b32_dpp v14, v42, v10, vcc row_ror:8 row_mask:0xf bank_mask:0xf
  v_cndmask_b32_dpp v15, v43, v11, vcc row_ror:8 row_mask:0xf bank_mask:0xf
  v_mfma_f32_16x16x32_bf16 v[124:127], a[184:187], v[184:187], v[124:127]
  s_not_b64 vcc, s[58:59]
  buffer_store_dwordx4 v[12:15], v251, s[16:19], s29 offen sc1
  v_add_f32 v150, v208, v150
  v_add_f32 v151, v208, v151
  v_exp_f32 v150, v150
  v_exp_f32 v151, v151
  v_exp_f32 v192, v192
  v_exp_f32 v193, v193
  v_exp_f32 v194, v194
  v_exp_f32 v195, v195
  v_mfma_f32_16x16x32_bf16 v[124:127], a[188:191], v[188:191], v[124:127]
  s_waitcnt lgkmcnt(3)
  ds_read_b64_tr_b16 a[184:185], v243 offset:8
  ds_read_b64_tr_b16 a[186:187], v243 offset:2056
  v_cvt_pk_bf16_f32 v145, v150, v151
  v_cvt_pk_bf16_f32 v150, v192, v193
  v_cvt_pk_bf16_f32 v151, v194, v195
  v_mfma_f32_16x16x32_bf16 v[192:195], a[128:131], a[0:3], v[200:203]
  ds_read_b64_tr_b16 a[188:189], v243 offset:4104
  ds_read_b64_tr_b16 a[190:191], v243 offset:6152
  v_mfma_f32_16x16x32_bf16 v[192:195], a[132:135], a[4:7], v[192:195]
  v_cndmask_b32_dpp v44, v8, v40, vcc row_ror:8 row_mask:0xf bank_mask:0xf
  v_cndmask_b32_dpp v45, v9, v41, vcc row_ror:8 row_mask:0xf bank_mask:0xf
  v_mfma_f32_16x16x32_bf16 v[192:195], a[136:139], a[8:11], v[192:195]
  v_cndmask_b32_dpp v46, v10, v42, vcc row_ror:8 row_mask:0xf bank_mask:0xf
  v_cndmask_b32_dpp v47, v11, v43, vcc row_ror:8 row_mask:0xf bank_mask:0xf
  v_mfma_f32_16x16x32_bf16 v[192:195], a[140:143], a[12:15], v[192:195]
  s_mov_b64 vcc, s[58:59]
  v_add_f32 v158, v212, v158
  v_add_f32 v159, v212, v159
  v_mfma_f32_16x16x32_bf16 v[0:3], a[160:163], v[128:131], 0
  v_exp_f32 v158, v158
  v_mfma_f32_16x16x32_bf16 v[0:3], a[164:167], v[132:135], v[0:3]
  v_exp_f32 v159, v159
  v_mfma_f32_16x16x32_bf16 v[8:11], a[160:163], v[136:139], 0
  v_exp_f32 v196, v196
  v_exp_f32 v197, v197
  v_exp_f32 v198, v198
  v_exp_f32 v199, v199
  v_mfma_f32_16x16x32_bf16 v[8:11], a[164:167], v[140:143], v[8:11]
  v_cvt_pk_bf16_f32 v153, v158, v159
  v_cvt_pk_bf16_f32 v158, v196, v197
  v_cvt_pk_bf16_f32 v159, v198, v199
  v_mfma_f32_16x16x32_bf16 v[196:199], a[128:131], a[16:19], v[204:207]
  buffer_load_dwordx4 v246, s[8:11], s40 offen offset:1024 nt lds
  v_cmp_nlt_f32_e64 s[52:53], v226, s44
  v_accvgpr_read_b32 v226, a200
  v_accvgpr_read_b32 v227, a201
  v_add_f32 v226, v226, v227
  v_rcp_f32 v236, v226
  v_mfma_f32_16x16x32_bf16 v[196:199], a[132:135], a[20:23], v[196:199]
  s_add_u32 m0, s36, 1920
  v_mov_b32 v237, v236
  v_cmp_nlt_f32_e64 s[54:55], v226, s44
  v_pk_mul_f32 v[16:17], v[16:17], v[236:237]
  v_pk_mul_f32 v[18:19], v[18:19], v[236:237]
  v_pk_mul_f32 v[20:21], v[20:21], v[236:237]
  v_pk_mul_f32 v[22:23], v[22:23], v[236:237]
  v_cvt_pk_bf16_f32 v16, v16, v17
  v_cvt_pk_bf16_f32 v17, v18, v19
  v_cvt_pk_bf16_f32 v18, v20, v21
  v_cvt_pk_bf16_f32 v19, v22, v23
  v_pk_mul_f32 v[48:49], v[48:49], v[236:237]
  v_pk_mul_f32 v[50:51], v[50:51], v[236:237]
  v_pk_mul_f32 v[52:53], v[52:53], v[236:237]
  v_pk_mul_f32 v[54:55], v[54:55], v[236:237]
  v_cvt_pk_bf16_f32 v48, v48, v49
  v_cvt_pk_bf16_f32 v49, v50, v51
  v_cvt_pk_bf16_f32 v50, v52, v53
  v_cvt_pk_bf16_f32 v51, v54, v55
  v_mfma_f32_16x16x32_bf16 v[196:199], a[136:139], a[24:27], v[196:199]
  v_accvgpr_read_b32 v226, a204
  v_accvgpr_read_b32 v227, a205
  v_add_f32 v226, v226, v227
  v_rcp_f32 v238, v226
  v_cndmask_b32_dpp v20, v48, v16, vcc row_ror:8 row_mask:0xf bank_mask:0xf
  v_cndmask_b32_dpp v21, v49, v17, vcc row_ror:8 row_mask:0xf bank_mask:0xf
  v_cndmask_b32_dpp v22, v50, v18, vcc row_ror:8 row_mask:0xf bank_mask:0xf
  v_cndmask_b32_dpp v23, v51, v19, vcc row_ror:8 row_mask:0xf bank_mask:0xf
  v_mfma_f32_16x16x32_bf16 v[196:199], a[140:143], a[28:31], v[196:199]
  s_not_b64 vcc, s[58:59]
  v_mov_b32 v239, v238
  v_cndmask_b32_dpp v52, v16, v48, vcc row_ror:8 row_mask:0xf bank_mask:0xf
  v_cndmask_b32_dpp v53, v17, v49, vcc row_ror:8 row_mask:0xf bank_mask:0xf
  v_cndmask_b32_dpp v54, v18, v50, vcc row_ror:8 row_mask:0xf bank_mask:0xf
  v_cndmask_b32_dpp v55, v19, v51, vcc row_ror:8 row_mask:0xf bank_mask:0xf
  v_pk_mul_f32 v[24:25], v[24:25], v[238:239]
  v_pk_mul_f32 v[26:27], v[26:27], v[238:239]
  v_pk_mul_f32 v[28:29], v[28:29], v[238:239]
  v_pk_mul_f32 v[30:31], v[30:31], v[238:239]
  v_cvt_pk_bf16_f32 v24, v24, v25
  v_cvt_pk_bf16_f32 v25, v26, v27
  v_cvt_pk_bf16_f32 v26, v28, v29
  v_cvt_pk_bf16_f32 v27, v30, v31
  v_pk_mul_f32 v[56:57], v[56:57], v[238:239]
  v_pk_mul_f32 v[58:59], v[58:59], v[238:239]
  v_pk_mul_f32 v[60:61], v[60:61], v[238:239]
  v_pk_mul_f32 v[62:63], v[62:63], v[238:239]
  v_cvt_pk_bf16_f32 v56, v56, v57
  v_cvt_pk_bf16_f32 v57, v58, v59
  v_cvt_pk_bf16_f32 v58, v60, v61
  v_cvt_pk_bf16_f32 v59, v62, v63
  v_mfma_f32_16x16x32_bf16 v[16:19], a[160:163], v[144:147], 0
  s_mov_b64 vcc, s[58:59]
  v_cndmask_b32_dpp v28, v56, v24, vcc row_ror:8 row_mask:0xf bank_mask:0xf
  v_cndmask_b32_dpp v29, v57, v25, vcc row_ror:8 row_mask:0xf bank_mask:0xf
  v_cndmask_b32_dpp v30, v58, v26, vcc row_ror:8 row_mask:0xf bank_mask:0xf
  v_cndmask_b32_dpp v31, v59, v27, vcc row_ror:8 row_mask:0xf bank_mask:0xf
  v_mfma_f32_16x16x32_bf16 v[16:19], a[164:167], v[148:151], v[16:19]
  s_not_b64 vcc, s[58:59]
  v_cndmask_b32_dpp v60, v24, v56, vcc row_ror:8 row_mask:0xf bank_mask:0xf
  v_cndmask_b32_dpp v61, v25, v57, vcc row_ror:8 row_mask:0xf bank_mask:0xf
  v_cndmask_b32_dpp v62, v26, v58, vcc row_ror:8 row_mask:0xf bank_mask:0xf
  v_cndmask_b32_dpp v63, v27, v59, vcc row_ror:8 row_mask:0xf bank_mask:0xf
  v_mfma_f32_16x16x32_bf16 v[24:27], a[160:163], v[152:155], 0
  v_exp_f32 v192, v192
  v_exp_f32 v193, v193
  v_exp_f32 v194, v194
  v_exp_f32 v195, v195
  v_mfma_f32_16x16x32_bf16 v[24:27], a[164:167], v[156:159], v[24:27]
  s_mov_b64 vcc, s[58:59]
  ds_read_b64_tr_b16 a[160:161], v242 offset:1024
  ds_read_b64_tr_b16 a[162:163], v242 offset:3072
  v_cvt_pk_bf16_f32 v160, v192, v193
  v_cvt_pk_bf16_f32 v161, v194, v195
  v_mfma_f32_16x16x32_bf16 v[192:195], a[128:131], a[32:35], v[208:211]
  ds_read_b64_tr_b16 a[164:165], v242 offset:5120
  ds_read_b64_tr_b16 a[166:167], v242 offset:7168
  v_mfma_f32_16x16x32_bf16 v[192:195], a[132:135], a[36:39], v[192:195]
  s_or_b64 s[48:49], s[48:49], s[52:53]
  v_accvgpr_write_b32 a192, 0
  v_accvgpr_write_b32 a193, 0
  v_mfma_f32_16x16x32_bf16 v[192:195], a[136:139], a[40:43], v[192:195]
  v_exp_f32 v196, v196
  v_mfma_f32_16x16x32_bf16 v[192:195], a[140:143], a[44:47], v[192:195]
  s_or_b64 s[48:49], s[48:49], s[54:55]
  v_exp_f32 v197, v197
  v_mfma_f32_16x16x32_bf16 v[4:7], a[168:171], v[128:131], 0
  v_exp_f32 v198, v198
  v_mfma_f32_16x16x32_bf16 v[4:7], a[172:175], v[132:135], v[4:7]
  v_exp_f32 v199, v199
  v_mfma_f32_16x16x32_bf16 v[12:15], a[168:171], v[136:139], 0
  buffer_load_dwordx4 v245, s[4:7], s39 offen offset:128 nt lds
  v_cvt_pk_bf16_f32 v168, v196, v197
  v_mfma_f32_16x16x32_bf16 v[12:15], a[172:175], v[140:143], v[12:15]
  s_add_u32 m0, s37, 25472
  v_cvt_pk_bf16_f32 v169, v198, v199
  v_accvgpr_write_b32 a124, v20
  v_smfmac_f32_16x16x64_bf16 a[192:195], a[208:211], v[128:135], v248
  v_accvgpr_write_b32 a125, v21
  v_accvgpr_write_b32 a126, v22
  v_mfma_f32_16x16x32_bf16 v[196:199], a[128:131], a[48:51], v[212:215]
  ds_read_b128 a[128:131], v240 offset:24576
  v_accvgpr_write_b32 a127, v23
  v_mfma_f32_16x16x32_bf16 v[196:199], a[132:135], a[52:55], v[196:199]
  ds_read_b128 a[132:135], v241 offset:24576
  v_accvgpr_write_b32 a212, v28
  v_mfma_f32_16x16x32_bf16 v[196:199], a[136:139], a[56:59], v[196:199]
  ds_read_b128 a[136:139], v240 offset:26624
  v_accvgpr_write_b32 a213, v29
  v_mfma_f32_16x16x32_bf16 v[196:199], a[140:143], a[60:63], v[196:199]
  ds_read_b128 a[140:143], v241 offset:26624
  v_accvgpr_write_b32 a214, v30
  v_mfma_f32_16x16x32_bf16 v[20:23], a[168:171], v[144:147], 0
  v_accvgpr_write_b32 a215, v31
  v_accvgpr_write_b32 a196, 0
  v_mfma_f32_16x16x32_bf16 v[20:23], a[172:175], v[148:151], v[20:23]
  v_exp_f32 v192, v192
  v_mfma_f32_16x16x32_bf16 v[28:31], a[168:171], v[152:155], 0
  v_exp_f32 v193, v193
  v_exp_f32 v194, v194
  v_exp_f32 v195, v195
  v_mfma_f32_16x16x32_bf16 v[28:31], a[172:175], v[156:159], v[28:31]
  ds_read_b64_tr_b16 a[168:169], v242 offset:1032
  ds_read_b64_tr_b16 a[170:171], v242 offset:3080
  v_cvt_pk_bf16_f32 v176, v192, v193
  v_cvt_pk_bf16_f32 v177, v194, v195
  v_mfma_f32_16x16x32_bf16 v[192:195], a[144:147], a[0:3], v[200:203]
  s_waitcnt lgkmcnt(4)
  ds_read_b64_tr_b16 a[172:173], v242 offset:5128
  ds_read_b64_tr_b16 a[174:175], v242 offset:7176
  v_mfma_f32_16x16x32_bf16 v[192:195], a[148:151], a[4:7], v[192:195]
  buffer_store_dwordx4 v[36:39], v251, s[16:19], s28 offen offset:2048 sc1
  v_mfma_f32_16x16x32_bf16 v[192:195], a[152:155], a[8:11], v[192:195]
L_stub12:
  s_cmp_eq_u32 s99, 1
  s_cbranch_scc1 L_ret3
  v_accvgpr_write_b32 a197, 0
  v_accvgpr_write_b32 a216, v44
  v_mfma_f32_16x16x32_bf16 v[192:195], a[156:159], a[12:15], v[192:195]
  v_exp_f32 v196, v196
  v_mfma_f32_16x16x32_bf16 v[32:35], a[176:179], v[128:131], 0
  v_exp_f32 v197, v197
  v_mfma_f32_16x16x32_bf16 v[32:35], a[180:183], v[132:135], v[32:35]
  v_exp_f32 v198, v198
  v_mfma_f32_16x16x32_bf16 v[40:43], a[176:179], v[136:139], 0
  v_exp_f32 v199, v199
  v_mfma_f32_16x16x32_bf16 v[40:43], a[180:183], v[140:143], v[40:43]
  v_cvt_pk_bf16_f32 v184, v196, v197
  v_cvt_pk_bf16_f32 v185, v198, v199
  v_smfmac_f32_16x16x64_bf16 a[196:199], a[208:211], v[136:143], v248
  v_exp_f32 v192, v192
  v_mfma_f32_16x16x32_bf16 v[196:199], a[144:147], a[16:19], v[204:207]
  v_exp_f32 v193, v193
  v_mfma_f32_16x16x32_bf16 v[196:199], a[148:151], a[20:23], v[196:199]
  v_exp_f32 v194, v194
  v_mfma_f32_16x16x32_bf16 v[196:199], a[152:155], a[24:27], v[196:199]
  v_exp_f32 v195, v195
  v_mfma_f32_16x16x32_bf16 v[196:199], a[156:159], a[28:31], v[196:199]
  buffer_load_dwordx4 v246, s[8:11], s40 offen offset:128 nt lds
  v_cvt_pk_bf16_f32 v162, v192, v193
  v_mfma_f32_16x16x32_bf16 v[48:51], a[176:179], v[144:147], 0
  s_add_u32 m0, s36, 896
  v_cvt_pk_bf16_f32 v163, v194, v195
  v_accvgpr_write_b32 a217, v45
  v_mfma_f32_16x16x32_bf16 v[48:51], a[180:183], v[148:151], v[48:51]
  v_accvgpr_write_b32 a218, v46
  v_accvgpr_write_b32 a219, v47
  v_mfma_f32_16x16x32_bf16 v[56:59], a[176:179], v[152:155], 0
  ds_read_b64_tr_b16 a[176:177], v243 offset:1024
  ds_read_b64_tr_b16 a[178:179], v243 offset:3072
  v_mfma_f32_16x16x32_bf16 v[56:59], a[180:183], v[156:159], v[56:59]
  ds_read_b64_tr_b16 a[180:181], v243 offset:5120
  ds_read_b64_tr_b16 a[182:183], v243 offset:7168
  v_mfma_f32_16x16x32_bf16 v[192:195], a[144:147], a[32:35], v[208:211]
  v_accvgpr_write_b32 a200, 0
  v_accvgpr_write_b32 a201, 0
  v_mfma_f32_16x16x32_bf16 v[192:195], a[148:151], a[36:39], v[192:195]
  v_exp_f32 v196, v196
  v_mfma_f32_16x16x32_bf16 v[192:195], a[152:155], a[40:43], v[192:195]
  v_exp_f32 v197, v197
  v_mfma_f32_16x16x32_bf16 v[192:195], a[156:159], a[44:47], v[192:195]
  v_exp_f32 v198, v198
  v_mfma_f32_16x16x32_bf16 v[36:39], a[184:187], v[128:131], 0
  v_exp_f32 v199, v199
  v_mfma_f32_16x16x32_bf16 v[36:39], a[188:191], v[132:135], v[36:39]
  buffer_load_dwordx4 v245, s[4:7], s39 offen offset:2176 nt lds
  v_cvt_pk_bf16_f32 v170, v196, v197
  v_mfma_f32_16x16x32_bf16 v[44:47], a[184:187], v[136:139], 0
  s_add_u32 m0, s37, 57224
  v_cvt_pk_bf16_f32 v171, v198, v199
  v_accvgpr_write_b32 a220, v52
  v_mfma_f32_16x16x32_bf16 v[44:47], a[188:191], v[140:143], v[44:47]
  s_add_u32 s39, s22, 81920
  v_accvgpr_write_b32 a221, v53
  v_accvgpr_write_b32 a222, v54
  v_smfmac_f32_16x16x64_bf16 a[200:203], a[208:211], v[144:151], v248
  v_accvgpr_write_b32 a223, v55
  v_accvgpr_write_b32 a224, v60
  v_accvgpr_write_b32 a225, v61
  v_accvgpr_write_b32 a226, v62
  v_pk_mul_f32 v[64:65], v[64:65], v[232:233]
  v_pk_mul_f32 v[66:67], v[66:67], v[232:233]
  v_pk_mul_f32 v[68:69], v[68:69], v[232:233]
  v_pk_mul_f32 v[70:71], v[70:71], v[232:233]
  v_mfma_f32_16x16x32_bf16 v[196:199], a[144:147], a[48:51], v[212:215]
  ds_read_b128 a[144:147], v240 offset:28672
  v_accvgpr_write_b32 a227, v63
  v_exp_f32 v192, v192
  v_pk_mul_f32 v[96:97], v[96:97], v[232:233]
  v_pk_mul_f32 v[98:99], v[98:99], v[232:233]
  v_pk_mul_f32 v[100:101], v[100:101], v[232:233]
  v_pk_mul_f32 v[102:103], v[102:103], v[232:233]
  v_mfma_f32_16x16x32_bf16 v[196:199], a[148:151], a[52:55], v[196:199]
  v_exp_f32 v193, v193
  v_exp_f32 v194, v194
  v_pk_mul_f32 v[72:73], v[72:73], v[234:235]
  v_pk_mul_f32 v[74:75], v[74:75], v[234:235]
  v_pk_mul_f32 v[76:77], v[76:77], v[234:235]
  v_pk_mul_f32 v[78:79], v[78:79], v[234:235]
  v_mfma_f32_16x16x32_bf16 v[196:199], a[152:155], a[56:59], v[196:199]
  v_exp_f32 v195, v195
  v_cvt_pk_bf16_f32 v178, v192, v193
  v_cvt_pk_bf16_f32 v64, v64, v65
  v_pk_mul_f32 v[104:105], v[104:105], v[234:235]
  v_pk_mul_f32 v[106:107], v[106:107], v[234:235]
  v_pk_mul_f32 v[108:109], v[108:109], v[234:235]
  v_pk_mul_f32 v[110:111], v[110:111], v[234:235]
  v_mfma_f32_16x16x32_bf16 v[196:199], a[156:159], a[60:63], v[196:199]
  ds_read_b128 a[148:151], v241 offset:28672
  ds_read_b128 a[152:155], v240 offset:30720
  v_mfma_f32_16x16x32_bf16 v[52:55], a[184:187], v[144:147], 0
  ds_read_b128 a[156:159], v241 offset:30720
  v_cvt_pk_bf16_f32 v179, v194, v195
  v_mfma_f32_16x16x32_bf16 v[52:55], a[188:191], v[148:151], v[52:55]
  v_cvt_pk_bf16_f32 v65, v66, v67
  v_cvt_pk_bf16_f32 v66, v68, v69
  v_mfma_f32_16x16x32_bf16 v[60:63], a[184:187], v[152:155], 0
  ds_read_b64_tr_b16 a[184:185], v243 offset:1032
  ds_read_b64_tr_b16 a[186:187], v243 offset:3080
  v_mfma_f32_16x16x32_bf16 v[60:63], a[188:191], v[156:159], v[60:63]
  ds_read_b64_tr_b16 a[188:189], v243 offset:5128
  ds_read_b64_tr_b16 a[190:191], v243 offset:7176
  v_mfma_f32_16x16x32_bf16 v[192:195], a[128:131], a[0:3], v[200:203]
  s_waitcnt lgkmcnt(7)
  buffer_load_dwordx4 v246, s[8:11], s40 offen offset:1152 nt lds
  v_cvt_pk_bf16_f32 v67, v70, v71
  v_cvt_pk_bf16_f32 v96, v96, v97
  v_cvt_pk_bf16_f32 v97, v98, v99
  v_pk_mul_f32 v[80:81], v[80:81], v[236:237]
  v_pk_mul_f32 v[82:83], v[82:83], v[236:237]
  v_pk_mul_f32 v[84:85], v[84:85], v[236:237]
  v_pk_mul_f32 v[86:87], v[86:87], v[236:237]
  v_mfma_f32_16x16x32_bf16 v[192:195], a[132:135], a[4:7], v[192:195]
  s_add_u32 m0, s36, 16384
  v_cvt_pk_bf16_f32 v98, v100, v101
  v_cvt_pk_bf16_f32 v99, v102, v103
  v_cndmask_b32_dpp v68, v96, v64, vcc row_ror:8 row_mask:0xf bank_mask:0xf
  v_cndmask_b32_dpp v69, v97, v65, vcc row_ror:8 row_mask:0xf bank_mask:0xf
  v_pk_mul_f32 v[112:113], v[112:113], v[236:237]
  v_pk_mul_f32 v[114:115], v[114:115], v[236:237]
  v_pk_mul_f32 v[116:117], v[116:117], v[236:237]
  v_pk_mul_f32 v[118:119], v[118:119], v[236:237]
  v_mfma_f32_16x16x32_bf16 v[192:195], a[136:139], a[8:11], v[192:195]
  s_add_u32 s40, s22, 65536
  v_cndmask_b32_dpp v70, v98, v66, vcc row_ror:8 row_mask:0xf bank_mask:0xf
  v_cndmask_b32_dpp v71, v99, v67, vcc row_ror:8 row_mask:0xf bank_mask:0xf
  v_cvt_pk_bf16_f32 v72, v72, v73
  v_cvt_pk_bf16_f32 v73, v74, v75
  v_pk_mul_f32 v[88:89], v[88:89], v[238:239]
  v_pk_mul_f32 v[90:91], v[90:91], v[238:239]
  v_pk_mul_f32 v[92:93], v[92:93], v[238:239]
  v_pk_mul_f32 v[94:95], v[94:95], v[238:239]
  v_mfma_f32_16x16x32_bf16 v[192:195], a[140:143], a[12:15], v[192:195]
  s_not_b64 vcc, s[58:59]
  buffer_store_dwordx4 v[68:71], v251, s[16:19], s28 offen offset:128 sc1
  v_cvt_pk_bf16_f32 v74, v76, v77
  v_cvt_pk_bf16_f32 v75, v78, v79
  v_cndmask_b32_dpp v100, v64, v96, vcc row_ror:8 row_mask:0xf bank_mask:0xf
  v_cndmask_b32_dpp v101, v65, v97, vcc row_ror:8 row_mask:0xf bank_mask:0xf
  v_cndmask_b32_dpp v102, v66, v98, vcc row_ror:8 row_mask:0xf bank_mask:0xf
  v_cndmask_b32_dpp v103, v67, v99, vcc row_ror:8 row_mask:0xf bank_mask:0xf
  v_cvt_pk_bf16_f32 v104, v104, v105
  v_cvt_pk_bf16_f32 v105, v106, v107
  v_cvt_pk_bf16_f32 v106, v108, v109
  v_cvt_pk_bf16_f32 v107, v110, v111
  v_pk_mul_f32 v[120:121], v[120:121], v[238:239]
  v_pk_mul_f32 v[122:123], v[122:123], v[238:239]
  v_pk_mul_f32 v[124:125], v[124:125], v[238:239]
  v_pk_mul_f32 v[126:127], v[126:127], v[238:239]
  v_mfma_f32_16x16x32_bf16 v[64:67], a[160:163], v[128:131], 0
  s_mov_b64 vcc, s[58:59]
  v_cndmask_b32_dpp v76, v104, v72, vcc row_ror:8 row_mask:0xf bank_mask:0xf
  v_cndmask_b32_dpp v77, v105, v73, vcc row_ror:8 row_mask:0xf bank_mask:0xf
  v_cndmask_b32_dpp v78, v106, v74, vcc row_ror:8 row_mask:0xf bank_mask:0xf
  v_cndmask_b32_dpp v79, v107, v75, vcc row_ror:8 row_mask:0xf bank_mask:0xf
  v_mfma_f32_16x16x32_bf16 v[64:67], a[164:167], v[132:135], v[64:67]
  s_not_b64 vcc, s[58:59]
  v_cndmask_b32_dpp v108, v72, v104, vcc row_ror:8 row_mask:0xf bank_mask:0xf
  v_cndmask_b32_dpp v109, v73, v105, vcc row_ror:8 row_mask:0xf bank_mask:0xf
  v_cndmask_b32_dpp v110, v74, v106, vcc row_ror:8 row_mask:0xf bank_mask:0xf
  v_cndmask_b32_dpp v111, v75, v107, vcc row_ror:8 row_mask:0xf bank_mask:0xf
  v_mfma_f32_16x16x32_bf16 v[72:75], a[160:163], v[136:139], 0
  s_mov_b64 vcc, s[58:59]
  v_accvgpr_write_b32 a204, 0
  v_accvgpr_write_b32 a205, 0
  v_mfma_f32_16x16x32_bf16 v[72:75], a[164:167], v[140:143], v[72:75]
  v_exp_f32 v196, v196
  v_exp_f32 v197, v197
  v_exp_f32 v198, v198
  v_exp_f32 v199, v199
  v_smfmac_f32_16x16x64_bf16 a[204:207], a[208:211], v[152:159], v248
  v_cvt_pk_bf16_f32 v186, v196, v197
  v_cvt_pk_bf16_f32 v187, v198, v199
  v_mfma_f32_16x16x32_bf16 v[196:199], a[128:131], a[16:19], v[204:207]
  v_cvt_pk_bf16_f32 v80, v80, v81
  v_cvt_pk_bf16_f32 v81, v82, v83
  v_mfma_f32_16x16x32_bf16 v[196:199], a[132:135], a[20:23], v[196:199]
  v_cvt_pk_bf16_f32 v82, v84, v85
  v_cvt_pk_bf16_f32 v83, v86, v87
  v_cvt_pk_bf16_f32 v112, v112, v113
  v_cvt_pk_bf16_f32 v113, v114, v115
  v_cvt_pk_bf16_f32 v114, v116, v117
  v_cvt_pk_bf16_f32 v115, v118, v119
  v_mfma_f32_16x16x32_bf16 v[196:199], a[136:139], a[24:27], v[196:199]
  v_cndmask_b32_dpp v84, v112, v80, vcc row_ror:8 row_mask:0xf bank_mask:0xf
  v_cndmask_b32_dpp v85, v113, v81, vcc row_ror:8 row_mask:0xf bank_mask:0xf
  v_cndmask_b32_dpp v86, v114, v82, vcc row_ror:8 row_mask:0xf bank_mask:0xf
  v_cndmask_b32_dpp v87, v115, v83, vcc row_ror:8 row_mask:0xf bank_mask:0xf
  v_mfma_f32_16x16x32_bf16 v[196:199], a[140:143], a[28:31], v[196:199]
  s_not_b64 vcc, s[58:59]
  v_cvt_pk_bf16_f32 v88, v88, v89
  v_cvt_pk_bf16_f32 v89, v90, v91
  v_cvt_pk_bf16_f32 v90, v92, v93
  v_cvt_pk_bf16_f32 v91, v94, v95
  v_cndmask_b32_dpp v116, v80, v112, vcc row_ror:8 row_mask:0xf bank_mask:0xf
  v_cndmask_b32_dpp v117, v81, v113, vcc row_ror:8 row_mask:0xf bank_mask:0xf
  v_cndmask_b32_dpp v118, v82, v114, vcc row_ror:8 row_mask:0xf bank_mask:0xf
  v_cndmask_b32_dpp v119, v83, v115, vcc row_ror:8 row_mask:0xf bank_mask:0xf
  v_cvt_pk_bf16_f32 v120, v120, v121
  v_cvt_pk_bf16_f32 v121, v122, v123
  v_cvt_pk_bf16_f32 v122, v124, v125
  v_cvt_pk_bf16_f32 v123, v126, v127
  v_mfma_f32_16x16x32_bf16 v[80:83], a[160:163], v[144:147], 0
  s_mov_b64 vcc, s[58:59]
  v_cndmask_b32_dpp v92, v120, v88, vcc row_ror:8 row_mask:0xf bank_mask:0xf
  v_cndmask_b32_dpp v93, v121, v89, vcc row_ror:8 row_mask:0xf bank_mask:0xf
  v_cndmask_b32_dpp v94, v122, v90, vcc row_ror:8 row_mask:0xf bank_mask:0xf
  v_cndmask_b32_dpp v95, v123, v91, vcc row_ror:8 row_mask:0xf bank_mask:0xf
  v_mfma_f32_16x16x32_bf16 v[80:83], a[164:167], v[148:151], v[80:83]
  s_not_b64 vcc, s[58:59]
  v_cndmask_b32_dpp v124, v88, v120, vcc row_ror:8 row_mask:0xf bank_mask:0xf
  v_cndmask_b32_dpp v125, v89, v121, vcc row_ror:8 row_mask:0xf bank_mask:0xf
  v_cndmask_b32_dpp v126, v90, v122, vcc row_ror:8 row_mask:0xf bank_mask:0xf
  v_cndmask_b32_dpp v127, v91, v123, vcc row_ror:8 row_mask:0xf bank_mask:0xf
  v_mfma_f32_16x16x32_bf16 v[88:91], a[160:163], v[152:155], 0
  v_exp_f32 v192, v192
  v_exp_f32 v193, v193
  v_exp_f32 v194, v194
  v_exp_f32 v195, v195
  v_mfma_f32_16x16x32_bf16 v[88:91], a[164:167], v[156:159], v[88:91]
  s_mov_b64 vcc, s[58:59]
  v_cvt_pk_bf16_f32 v164, v192, v193
  v_cvt_pk_bf16_f32 v165, v194, v195
  v_mfma_f32_16x16x32_bf16 v[192:195], a[128:131], a[32:35], v[208:211]
  v_accvgpr_write_b32 a228, v76
  v_accvgpr_write_b32 a229, v77
  v_mfma_f32_16x16x32_bf16 v[192:195], a[132:135], a[36:39], v[192:195]
  v_accvgpr_write_b32 a230, v78
  v_accvgpr_write_b32 a231, v79
  v_mfma_f32_16x16x32_bf16 v[192:195], a[136:139], a[40:43], v[192:195]
  v_exp_f32 v196, v196
  v_mfma_f32_16x16x32_bf16 v[192:195], a[140:143], a[44:47], v[192:195]
  s_waitcnt vmcnt(20) lgkmcnt(0)
  v_exp_f32 v197, v197
  v_mfma_f32_16x16x32_bf16 v[68:71], a[168:171], v[128:131], 0
  s_barrier
  v_exp_f32 v198, v198
  v_mfma_f32_16x16x32_bf16 v[68:71], a[172:175], v[132:135], v[68:71]
  v_exp_f32 v199, v199
  v_mfma_f32_16x16x32_bf16 v[76:79], a[168:171], v[136:139], 0
  ds_read_b64_tr_b16 a[160:161], v242 offset:8192
  ds_read_b64_tr_b16 a[162:163], v242 offset:10240
  v_mfma_f32_16x16x32_bf16 v[76:79], a[172:175], v[140:143], v[76:79]
  ds_read_b64_tr_b16 a[164:165], v242 offset:12288
  ds_read_b64_tr_b16 a[166:167], v242 offset:14336
  v_cvt_pk_bf16_f32 v172, v196, v197
  v_cvt_pk_bf16_f32 v173, v198, v199
  v_mfma_f32_16x16x32_bf16 v[196:199], a[128:131], a[48:51], v[212:215]
  ds_read_b128 a[128:131], v240 offset:32768
  buffer_load_dwordx4 v245, s[4:7], s39 offen nt lds
  v_mfma_f32_16x16x32_bf16 v[196:199], a[132:135], a[52:55], v[196:199]
  s_add_u32 m0, s37, 0
  ds_read_b128 a[132:135], v241 offset:32768
  v_accvgpr_write_b32 a232, v84
  v_mfma_f32_16x16x32_bf16 v[196:199], a[136:139], a[56:59], v[196:199]
  ds_read_b128 a[136:139], v240 offset:34816
  v_accvgpr_write_b32 a233, v85
  v_mfma_f32_16x16x32_bf16 v[196:199], a[140:143], a[60:63], v[196:199]
  ds_read_b128 a[140:143], v241 offset:34816
  v_accvgpr_write_b32 a234, v86
  v_accvgpr_write_b32 a235, v87
  v_mfma_f32_16x16x32_bf16 v[84:87], a[168:171], v[144:147], 0
  v_accvgpr_write_b32 a236, v92
  v_accvgpr_write_b32 a237, v93
  v_mfma_f32_16x16x32_bf16 v[84:87], a[172:175], v[148:151], v[84:87]
  v_accvgpr_write_b32 a238, v94
  v_accvgpr_write_b32 a239, v95
  v_mfma_f32_16x16x32_bf16 v[92:95], a[168:171], v[152:155], 0
  v_exp_f32 v192, v192
  v_exp_f32 v193, v193
  v_exp_f32 v194, v194
  v_exp_f32 v195, v195
  v_mfma_f32_16x16x32_bf16 v[92:95], a[172:175], v[156:159], v[92:95]
  ds_read_b64_tr_b16 a[168:169], v242 offset:8200
  ds_read_b64_tr_b16 a[170:171], v242 offset:10248
  v_cvt_pk_bf16_f32 v180, v192, v193
  v_cvt_pk_bf16_f32 v181, v194, v195
  v_mfma_f32_16x16x32_bf16 v[192:195], a[144:147], a[0:3], v[200:203]
  v_exp_f32 v196, v196
  v_mfma_f32_16x16x32_bf16 v[192:195], a[148:151], a[4:7], v[192:195]
  v_exp_f32 v197, v197
  v_mfma_f32_16x16x32_bf16 v[192:195], a[152:155], a[8:11], v[192:195]
  v_exp_f32 v198, v198
  v_mfma_f32_16x16x32_bf16 v[192:195], a[156:159], a[12:15], v[192:195]
  v_exp_f32 v199, v199
  v_mfma_f32_16x16x32_bf16 v[96:99], a[176:179], v[128:131], 0
  ds_read_b64_tr_b16 a[172:173], v242 offset:12296
  ds_read_b64_tr_b16 a[174:175], v242 offset:14344
  v_mfma_f32_16x16x32_bf16 v[96:99], a[180:183], v[132:135], v[96:99]
  buffer_load_dwordx4 v246, s[8:11], s40 offen nt lds
  v_cvt_pk_bf16_f32 v188, v196, v197
  v_mfma_f32_16x16x32_bf16 v[104:107], a[176:179], v[136:139], 0
  s_add_u32 m0, s36, 15360
  v_cvt_pk_bf16_f32 v189, v198, v199
  v_accvgpr_write_b32 a240, v108
  v_mfma_f32_16x16x32_bf16 v[104:107], a[180:183], v[140:143], v[104:107]
  v_exp_f32 v192, v192
  v_mfma_f32_16x16x32_bf16 v[196:199], a[144:147], a[16:19], v[204:207]
  v_exp_f32 v193, v193
  v_mfma_f32_16x16x32_bf16 v[196:199], a[148:151], a[20:23], v[196:199]
  v_exp_f32 v194, v194
  v_mfma_f32_16x16x32_bf16 v[196:199], a[152:155], a[24:27], v[196:199]
  v_exp_f32 v195, v195
  v_mfma_f32_16x16x32_bf16 v[196:199], a[156:159], a[28:31], v[196:199]
  buffer_store_dwordx4 v[100:103], v251, s[16:19], s28 offen offset:2176 sc1
  v_mfma_f32_16x16x32_bf16 v[112:115], a[176:179], v[144:147], 0
  v_cvt_pk_bf16_f32 v166, v192, v193
  v_cvt_pk_bf16_f32 v167, v194, v195
  v_mfma_f32_16x16x32_bf16 v[112:115], a[180:183], v[148:151], v[112:115]
  v_accvgpr_write_b32 a241, v109
  v_accvgpr_write_b32 a242, v110
  v_mfma_f32_16x16x32_bf16 v[120:123], a[176:179], v[152:155], 0
  ds_read_b64_tr_b16 a[176:177], v243 offset:8192
  ds_read_b64_tr_b16 a[178:179], v243 offset:10240
  v_mfma_f32_16x16x32_bf16 v[120:123], a[180:183], v[156:159], v[120:123]
  ds_read_b64_tr_b16 a[180:181], v243 offset:12288
  ds_read_b64_tr_b16 a[182:183], v243 offset:14336
  v_mfma_f32_16x16x32_bf16 v[192:195], a[144:147], a[32:35], v[208:211]
  v_accvgpr_write_b32 a243, v111
  v_accvgpr_write_b32 a244, v116
  v_mfma_f32_16x16x32_bf16 v[192:195], a[148:151], a[36:39], v[192:195]
  v_exp_f32 v196, v196
  v_mfma_f32_16x16x32_bf16 v[192:195], a[152:155], a[40:43], v[192:195]
  v_exp_f32 v197, v197
  v_mfma_f32_16x16x32_bf16 v[192:195], a[156:159], a[44:47], v[192:195]
  v_exp_f32 v198, v198
  v_mfma_f32_16x16x32_bf16 v[100:103], a[184:187], v[128:131], 0
  v_exp_f32 v199, v199
  v_mfma_f32_16x16x32_bf16 v[100:103], a[188:191], v[132:135], v[100:103]
  buffer_load_dwordx4 v245, s[4:7], s39 offen offset:2048 nt lds
  v_cvt_pk_bf16_f32 v174, v196, v197
  v_mfma_f32_16x16x32_bf16 v[108:111], a[184:187], v[136:139], 0
  s_add_u32 m0, s37, 31752
  v_cvt_pk_bf16_f32 v175, v198, v199
  v_accvgpr_write_b32 a245, v117
  v_mfma_f32_16x16x32_bf16 v[108:111], a[188:191], v[140:143], v[108:111]
  v_accvgpr_write_b32 a246, v118
  v_accvgpr_write_b32 a247, v119
  v_mfma_f32_16x16x32_bf16 v[196:199], a[144:147], a[48:51], v[212:215]
  ds_read_b128 a[144:147], v240 offset:36864
  v_accvgpr_write_b32 a248, v124
  v_mfma_f32_16x16x32_bf16 v[196:199], a[148:151], a[52:55], v[196:199]
  ds_read_b128 a[148:151], v241 offset:36864
  v_accvgpr_write_b32 a249, v125
  v_mfma_f32_16x16x32_bf16 v[196:199], a[152:155], a[56:59], v[196:199]
  ds_read_b128 a[152:155], v240 offset:38912
  v_accvgpr_write_b32 a250, v126
  v_mfma_f32_16x16x32_bf16 v[196:199], a[156:159], a[60:63], v[196:199]
  ds_read_b128 a[156:159], v241 offset:38912
  v_accvgpr_write_b32 a251, v127
  v_mfma_f32_16x16x32_bf16 v[116:119], a[184:187], v[144:147], 0
  v_exp_f32 v192, v192
  v_mfma_f32_16x16x32_bf16 v[116:119], a[188:191], v[148:151], v[116:119]
  v_exp_f32 v193, v193
  v_mfma_f32_16x16x32_bf16 v[124:127], a[184:187], v[152:155], 0
  v_exp_f32 v194, v194
  v_exp_f32 v195, v195
  v_mfma_f32_16x16x32_bf16 v[124:127], a[188:191], v[156:159], v[124:127]
  s_waitcnt lgkmcnt(3)
  ds_read_b64_tr_b16 a[184:185], v243 offset:8200
  ds_read_b64_tr_b16 a[186:187], v243 offset:10248
  v_cvt_pk_bf16_f32 v182, v192, v193
  v_cvt_pk_bf16_f32 v183, v194, v195
  v_mfma_f32_16x16x32_bf16 v[192:195], a[128:131], a[0:3], v[200:203]
  v_exp_f32 v196, v196
  v_mfma_f32_16x16x32_bf16 v[192:195], a[132:135], a[4:7], v[192:195]
  v_exp_f32 v197, v197
  v_mfma_f32_16x16x32_bf16 v[192:195], a[136:139], a[8:11], v[192:195]
  v_exp_f32 v198, v198
  v_mfma_f32_16x16x32_bf16 v[192:195], a[140:143], a[12:15], v[192:195]
  v_exp_f32 v199, v199
  v_mfma_f32_16x16x32_bf16 v[0:3], a[160:163], v[160:163], v[0:3]
  ds_read_b64_tr_b16 a[188:189], v243 offset:12296
  ds_read_b64_tr_b16 a[190:191], v243 offset:14344
  v_mfma_f32_16x16x32_bf16 v[0:3], a[164:167], v[164:167], v[0:3]
  buffer_load_dwordx4 v246, s[8:11], s40 offen offset:1024 nt lds
  v_cvt_pk_bf16_f32 v190, v196, v197
  v_mfma_f32_16x16x32_bf16 v[8:11], a[160:163], v[168:171], v[8:11]
  s_add_u32 m0, s36, 18304
  v_cvt_pk_bf16_f32 v191, v198, v199
  v_cmp_nlt_f32_e64 s[56:57], v226, s44
  v_mfma_f32_16x16x32_bf16 v[8:11], a[164:167], v[172:175], v[8:11]
  s_or_b64 s[48:49], s[48:49], s[56:57]
  v_exp_f32 v192, v192
  v_mfma_f32_16x16x32_bf16 v[196:199], a[128:131], a[16:19], v[204:207]
  v_exp_f32 v193, v193
  v_mfma_f32_16x16x32_bf16 v[196:199], a[132:135], a[20:23], v[196:199]
  v_exp_f32 v194, v194
  v_mfma_f32_16x16x32_bf16 v[196:199], a[136:139], a[24:27], v[196:199]
  v_exp_f32 v195, v195
  v_mfma_f32_16x16x32_bf16 v[196:199], a[140:143], a[28:31], v[196:199]
  v_cvt_pk_bf16_f32 v128, v192, v193
  v_cvt_pk_bf16_f32 v129, v194, v195
  v_mfma_f32_16x16x32_bf16 v[16:19], a[160:163], v[176:179], v[16:19]
  v_mfma_f32_16x16x32_bf16 v[16:19], a[164:167], v[180:183], v[16:19]
  v_mfma_f32_16x16x32_bf16 v[24:27], a[160:163], v[184:187], v[24:27]
  ds_read_b64_tr_b16 a[160:161], v242 offset:9216
  ds_read_b64_tr_b16 a[162:163], v242 offset:11264
  v_mfma_f32_16x16x32_bf16 v[24:27], a[164:167], v[188:191], v[24:27]
  v_exp_f32 v196, v196
  v_mfma_f32_16x16x32_bf16 v[192:195], a[128:131], a[32:35], v[208:211]
  v_exp_f32 v197, v197
  v_mfma_f32_16x16x32_bf16 v[192:195], a[132:135], a[36:39], v[192:195]
  v_exp_f32 v198, v198
  v_mfma_f32_16x16x32_bf16 v[192:195], a[136:139], a[40:43], v[192:195]
  v_exp_f32 v199, v199
  v_mfma_f32_16x16x32_bf16 v[192:195], a[140:143], a[44:47], v[192:195]
  buffer_store_dwordx4 a[124:127], v251, s[16:19], s30 offen sc1
  v_mfma_f32_16x16x32_bf16 v[4:7], a[168:171], v[160:163], v[4:7]
  ds_read_b64_tr_b16 a[164:165], v242 offset:13312
  ds_read_b64_tr_b16 a[166:167], v242 offset:15360
  v_mfma_f32_16x16x32_bf16 v[4:7], a[172:175], v[164:167], v[4:7]
  v_cvt_pk_bf16_f32 v136, v196, v197
  v_cvt_pk_bf16_f32 v137, v198, v199
  v_mfma_f32_16x16x32_bf16 v[12:15], a[168:171], v[168:171], v[12:15]
  v_exp_f32 v192, v192
  v_mfma_f32_16x16x32_bf16 v[12:15], a[172:175], v[172:175], v[12:15]
  v_exp_f32 v193, v193
  v_smfmac_f32_16x16x64_bf16 a[192:195], a[208:211], v[160:167], v248
  v_exp_f32 v194, v194
  v_mfma_f32_16x16x32_bf16 v[196:199], a[128:131], a[48:51], v[212:215]
  v_exp_f32 v195, v195
  v_mfma_f32_16x16x32_bf16 v[196:199], a[132:135], a[52:55], v[196:199]
  ds_read_b128 a[128:131], v240 offset:40960
  ds_read_b128 a[132:135], v241 offset:40960
  v_mfma_f32_16x16x32_bf16 v[196:199], a[136:139], a[56:59], v[196:199]
  ds_read_b128 a[136:139], v240 offset:43008
  v_cvt_pk_bf16_f32 v144, v192, v193
  v_mfma_f32_16x16x32_bf16 v[196:199], a[140:143], a[60:63], v[196:199]
  ds_read_b128 a[140:143], v241 offset:43008
  v_cvt_pk_bf16_f32 v145, v194, v195
  v_mfma_f32_16x16x32_bf16 v[20:23], a[168:171], v[176:179], v[20:23]
  buffer_load_dwordx4 v245, s[4:7], s39 offen offset:128 nt lds
  v_mfma_f32_16x16x32_bf16 v[20:23], a[172:175], v[180:183], v[20:23]
  s_add_u32 m0, s37, 896
  v_mfma_f32_16x16x32_bf16 v[28:31], a[168:171], v[184:187], v[28:31]
  ds_read_b64_tr_b16 a[168:169], v242 offset:9224
  ds_read_b64_tr_b16 a[170:171], v242 offset:11272
  v_mfma_f32_16x16x32_bf16 v[28:31], a[172:175], v[188:191], v[28:31]
  v_exp_f32 v196, v196
  v_mfma_f32_16x16x32_bf16 v[192:195], a[144:147], a[0:3], v[200:203]
  s_waitcnt lgkmcnt(4)
  v_exp_f32 v197, v197
  v_mfma_f32_16x16x32_bf16 v[192:195], a[148:151], a[4:7], v[192:195]
  v_exp_f32 v198, v198
  v_mfma_f32_16x16x32_bf16 v[192:195], a[152:155], a[8:11], v[192:195]
  v_exp_f32 v199, v199
  v_mfma_f32_16x16x32_bf16 v[192:195], a[156:159], a[12:15], v[192:195]
  ds_read_b64_tr_b16 a[172:173], v242 offset:13320
  ds_read_b64_tr_b16 a[174:175], v242 offset:15368
  v_mfma_f32_16x16x32_bf16 v[32:35], a[176:179], v[160:163], v[32:35]
  v_cvt_pk_bf16_f32 v152, v196, v197
  v_cvt_pk_bf16_f32 v153, v198, v199
  v_mfma_f32_16x16x32_bf16 v[32:35], a[180:183], v[164:167], v[32:35]
  v_mfma_f32_16x16x32_bf16 v[40:43], a[176:179], v[168:171], v[40:43]
  buffer_load_dwordx4 v246, s[8:11], s40 offen offset:128 nt lds
  v_mfma_f32_16x16x32_bf16 v[40:43], a[180:183], v[172:175], v[40:43]
  s_add_u32 m0, s36, 17280
  v_exp_f32 v192, v192
  v_smfmac_f32_16x16x64_bf16 a[196:199], a[208:211], v[168:175], v248
  v_exp_f32 v193, v193
  v_mfma_f32_16x16x32_bf16 v[196:199], a[144:147], a[16:19], v[204:207]
  v_exp_f32 v194, v194
  v_mfma_f32_16x16x32_bf16 v[196:199], a[148:151], a[20:23], v[196:199]
  v_exp_f32 v195, v195
  v_mfma_f32_16x16x32_bf16 v[196:199], a[152:155], a[24:27], v[196:199]
  v_cvt_pk_bf16_f32 v130, v192, v193
  v_cvt_pk_bf16_f32 v131, v194, v195
  v_mfma_f32_16x16x32_bf16 v[196:199], a[156:159], a[28:31], v[196:199]
  v_mfma_f32_16x16x32_bf16 v[48:51], a[176:179], v[176:179], v[48:51]
  v_mfma_f32_16x16x32_bf16 v[48:51], a[180:183], v[180:183], v[48:51]
  v_mfma_f32_16x16x32_bf16 v[56:59], a[176:179], v[184:187], v[56:59]
  ds_read_b64_tr_b16 a[176:177], v243 offset:9216
  ds_read_b64_tr_b16 a[178:179], v243 offset:11264
  v_mfma_f32_16x16x32_bf16 v[56:59], a[180:183], v[188:191], v[56:59]
  ds_read_b64_tr_b16 a[180:181], v243 offset:13312
  ds_read_b64_tr_b16 a[182:183], v243 offset:15360
  v_mfma_f32_16x16x32_bf16 v[192:195], a[144:147], a[32:35], v[208:211]
  v_exp_f32 v196, v196
  v_mfma_f32_16x16x32_bf16 v[192:195], a[148:151], a[36:39], v[192:195]
  v_exp_f32 v197, v197
  v_mfma_f32_16x16x32_bf16 v[192:195], a[152:155], a[40:43], v[192:195]
  v_exp_f32 v198, v198
  v_mfma_f32_16x16x32_bf16 v[192:195], a[156:159], a[44:47], v[192:195]
  v_exp_f32 v199, v199
  v_mfma_f32_16x16x32_bf16 v[36:39], a[184:187], v[160:163], v[36:39]
  buffer_load_dwordx4 v245, s[4:7], s39 offen offset:2176 nt lds
  v_cvt_pk_bf16_f32 v138, v196, v197
  v_mfma_f32_16x16x32_bf16 v[36:39], a[188:191], v[164:167], v[36:39]
  s_add_u32 m0, s37, 32648
  v_cvt_pk_bf16_f32 v139, v198, v199
  v_mfma_f32_16x16x32_bf16 v[44:47], a[184:187], v[168:171], v[44:47]
  v_exp_f32 v192, v192
  v_mfma_f32_16x16x32_bf16 v[44:47], a[188:191], v[172:175], v[44:47]
  s_add_u32 s39, s22, 98304
  v_exp_f32 v193, v193
  v_smfmac_f32_16x16x64_bf16 a[200:203], a[208:211], v[176:183], v248
  v_exp_f32 v194, v194
  v_mfma_f32_16x16x32_bf16 v[196:199], a[144:147], a[48:51], v[212:215]
  v_exp_f32 v195, v195
  v_mfma_f32_16x16x32_bf16 v[196:199], a[148:151], a[52:55], v[196:199]
  buffer_store_dwordx4 a[212:215], v251, s[16:19], s31 offen sc1
  v_mfma_f32_16x16x32_bf16 v[196:199], a[152:155], a[56:59], v[196:199]
  ds_read_b128 a[144:147], v240 offset:45056
  ds_read_b128 a[148:151], v241 offset:45056
  v_mfma_f32_16x16x32_bf16 v[196:199], a[156:159], a[60:63], v[196:199]
  ds_read_b128 a[152:155], v240 offset:47104
  ds_read_b128 a[156:159], v241 offset:47104
  v_mfma_f32_16x16x32_bf16 v[52:55], a[184:187], v[176:179], v[52:55]
  v_cvt_pk_bf16_f32 v146, v192, v193
  v_cvt_pk_bf16_f32 v147, v194, v195
  v_mfma_f32_16x16x32_bf16 v[52:55], a[188:191], v[180:183], v[52:55]
  v_mfma_f32_16x16x32_bf16 v[60:63], a[184:187], v[184:187], v[60:63]
  ds_read_b64_tr_b16 a[184:185], v243 offset:9224
  ds_read_b64_tr_b16 a[186:187], v243 offset:11272
  v_mfma_f32_16x16x32_bf16 v[60:63], a[188:191], v[188:191], v[60:63]
  v_exp_f32 v196, v196
  v_mfma_f32_16x16x32_bf16 v[192:195], a[128:131], a[0:3], v[200:203]
  v_exp_f32 v197, v197
  v_mfma_f32_16x16x32_bf16 v[192:195], a[132:135], a[4:7], v[192:195]
  s_waitcnt lgkmcnt(4)
  v_exp_f32 v198, v198
  v_mfma_f32_16x16x32_bf16 v[192:195], a[136:139], a[8:11], v[192:195]
  v_exp_f32 v199, v199
  v_mfma_f32_16x16x32_bf16 v[192:195], a[140:143], a[12:15], v[192:195]
  ds_read_b64_tr_b16 a[188:189], v243 offset:13320
  ds_read_b64_tr_b16 a[190:191], v243 offset:15368
  v_mfma_f32_16x16x32_bf16 v[64:67], a[160:163], v[160:163], v[64:67]
  buffer_load_dwordx4 v246, s[8:11], s40 offen offset:1152 nt lds
  v_cvt_pk_bf16_f32 v154, v196, v197
  v_mfma_f32_16x16x32_bf16 v[64:67], a[164:167], v[164:167], v[64:67]
  s_add_u32 m0, s36, 32768
  v_cvt_pk_bf16_f32 v155, v198, v199
  v_mfma_f32_16x16x32_bf16 v[72:75], a[160:163], v[168:171], v[72:75]
  s_add_u32 s40, s22, 81920
  v_exp_f32 v192, v192
  v_mfma_f32_16x16x32_bf16 v[72:75], a[164:167], v[172:175], v[72:75]
  v_exp_f32 v193, v193
  v_smfmac_f32_16x16x64_bf16 a[204:207], a[208:211], v[184:191], v248
  v_exp_f32 v194, v194
  v_mfma_f32_16x16x32_bf16 v[196:199], a[128:131], a[16:19], v[204:207]
  v_exp_f32 v195, v195
  v_mfma_f32_16x16x32_bf16 v[196:199], a[132:135], a[20:23], v[196:199]
  v_cvt_pk_bf16_f32 v132, v192, v193
  v_cvt_pk_bf16_f32 v133, v194, v195
  v_mfma_f32_16x16x32_bf16 v[196:199], a[136:139], a[24:27], v[196:199]
  v_mfma_f32_16x16x32_bf16 v[196:199], a[140:143], a[28:31], v[196:199]
  v_mfma_f32_16x16x32_bf16 v[80:83], a[160:163], v[176:179], v[80:83]
  v_mfma_f32_16x16x32_bf16 v[80:83], a[164:167], v[180:183], v[80:83]
  v_mfma_f32_16x16x32_bf16 v[88:91], a[160:163], v[184:187], v[88:91]
  v_mfma_f32_16x16x32_bf16 v[88:91], a[164:167], v[188:191], v[88:91]
  v_mfma_f32_16x16x32_bf16 v[192:195], a[128:131], a[32:35], v[208:211]
  v_mfma_f32_16x16x32_bf16 v[192:195], a[132:135], a[36:39], v[192:195]
  v_mfma_f32_16x16x32_bf16 v[192:195], a[136:139], a[40:43], v[192:195]
  v_mfma_f32_16x16x32_bf16 v[192:195], a[140:143], a[44:47], v[192:195]
  s_waitcnt vmcnt(23) lgkmcnt(0)
  v_exp_f32 v196, v196
  v_mfma_f32_16x16x32_bf16 v[68:71], a[168:171], v[160:163], v[68:71]
  s_barrier
  v_exp_f32 v197, v197
  v_mfma_f32_16x16x32_bf16 v[68:71], a[172:175], v[164:167], v[68:71]
L_stub13:
  s_cmp_eq_u32 s99, 1
  s_cbranch_scc1 L_ret3
  v_exp_f32 v198, v198
  v_mfma_f32_16x16x32_bf16 v[76:79], a[168:171], v[168:171], v[76:79]
  v_exp_f32 v199, v199
  v_mfma_f32_16x16x32_bf16 v[76:79], a[172:175], v[172:175], v[76:79]
  ds_read_b64_tr_b16 a[160:161], v242 offset:16384
  ds_read_b64_tr_b16 a[162:163], v242 offset:18432
  v_cvt_pk_bf16_f32 v140, v196, v197
  v_cvt_pk_bf16_f32 v141, v198, v199
  v_mfma_f32_16x16x32_bf16 v[196:199], a[128:131], a[48:51], v[212:215]
  v_exp_f32 v192, v192
  v_mfma_f32_16x16x32_bf16 v[196:199], a[132:135], a[52:55], v[196:199]
  v_exp_f32 v193, v193
  v_mfma_f32_16x16x32_bf16 v[196:199], a[136:139], a[56:59], v[196:199]
  v_exp_f32 v194, v194
  v_mfma_f32_16x16x32_bf16 v[196:199], a[140:143], a[60:63], v[196:199]
  v_exp_f32 v195, v195
  v_mfma_f32_16x16x32_bf16 v[84:87], a[168:171], v[176:179], v[84:87]
  buffer_store_dwordx4 a[216:219], v251, s[16:19], s29 offen offset:2048 sc1
  v_mfma_f32_16x16x32_bf16 v[84:87], a[172:175], v[180:183], v[84:87]
  ds_read_b128 a[128:131], v240 offset:49152
  ds_read_b128 a[132:135], v241 offset:49152
  v_mfma_f32_16x16x32_bf16 v[92:95], a[168:171], v[184:187], v[92:95]
  ds_read_b128 a[136:139], v240 offset:51200
  ds_read_b128 a[140:143], v241 offset:51200
  v_mfma_f32_16x16x32_bf16 v[92:95], a[172:175], v[188:191], v[92:95]
  ds_read_b64_tr_b16 a[164:165], v242 offset:20480
  ds_read_b64_tr_b16 a[166:167], v242 offset:22528
  v_cvt_pk_bf16_f32 v148, v192, v193
  v_cvt_pk_bf16_f32 v149, v194, v195
  v_mfma_f32_16x16x32_bf16 v[192:195], a[144:147], a[0:3], v[200:203]
  v_exp_f32 v196, v196
  v_mfma_f32_16x16x32_bf16 v[192:195], a[148:151], a[4:7], v[192:195]
  v_exp_f32 v197, v197
  v_mfma_f32_16x16x32_bf16 v[192:195], a[152:155], a[8:11], v[192:195]
  v_exp_f32 v198, v198
  v_mfma_f32_16x16x32_bf16 v[192:195], a[156:159], a[12:15], v[192:195]
  v_exp_f32 v199, v199
  v_mfma_f32_16x16x32_bf16 v[96:99], a[176:179], v[160:163], v[96:99]
  ds_read_b64_tr_b16 a[168:169], v242 offset:16392
  ds_read_b64_tr_b16 a[170:171], v242 offset:18440
  v_mfma_f32_16x16x32_bf16 v[96:99], a[180:183], v[164:167], v[96:99]
  ds_read_b64_tr_b16 a[172:173], v242 offset:20488
  ds_read_b64_tr_b16 a[174:175], v242 offset:22536
  v_mfma_f32_16x16x32_bf16 v[104:107], a[176:179], v[168:171], v[104:107]
  buffer_load_dwordx4 v245, s[4:7], s39 offen nt lds
  v_cvt_pk_bf16_f32 v156, v196, v197
  v_mfma_f32_16x16x32_bf16 v[104:107], a[180:183], v[172:175], v[104:107]
  s_add_u32 m0, s37, 8192
  v_cvt_pk_bf16_f32 v157, v198, v199
  v_mfma_f32_16x16x32_bf16 v[196:199], a[144:147], a[16:19], v[204:207]
  v_exp_f32 v192, v192
  v_mfma_f32_16x16x32_bf16 v[196:199], a[148:151], a[20:23], v[196:199]
  v_exp_f32 v193, v193
  v_mfma_f32_16x16x32_bf16 v[196:199], a[152:155], a[24:27], v[196:199]
  v_exp_f32 v194, v194
  v_mfma_f32_16x16x32_bf16 v[196:199], a[156:159], a[28:31], v[196:199]
  v_exp_f32 v195, v195
  v_mfma_f32_16x16x32_bf16 v[112:115], a[176:179], v[176:179], v[112:115]
  v_cvt_pk_bf16_f32 v134, v192, v193
  v_cvt_pk_bf16_f32 v135, v194, v195
  v_mfma_f32_16x16x32_bf16 v[112:115], a[180:183], v[180:183], v[112:115]
  v_mfma_f32_16x16x32_bf16 v[120:123], a[176:179], v[184:187], v[120:123]
  ds_read_b64_tr_b16 a[176:177], v243 offset:16384
  ds_read_b64_tr_b16 a[178:179], v243 offset:18432
  v_mfma_f32_16x16x32_bf16 v[120:123], a[180:183], v[188:191], v[120:123]
  v_exp_f32 v196, v196
  v_mfma_f32_16x16x32_bf16 v[192:195], a[144:147], a[32:35], v[208:211]
  v_exp_f32 v197, v197
  v_mfma_f32_16x16x32_bf16 v[192:195], a[148:151], a[36:39], v[192:195]
  v_exp_f32 v198, v198
  v_mfma_f32_16x16x32_bf16 v[192:195], a[152:155], a[40:43], v[192:195]
  v_exp_f32 v199, v199
  v_mfma_f32_16x16x32_bf16 v[192:195], a[156:159], a[44:47], v[192:195]
  ds_read_b64_tr_b16 a[180:181], v243 offset:20480
  ds_read_b64_tr_b16 a[182:183], v243 offset:22528
  v_mfma_f32_16x16x32_bf16 v[100:103], a[184:187], v[160:163], v[100:103]
  buffer_load_dwordx4 v246, s[8:11], s40 offen nt lds
  v_cvt_pk_bf16_f32 v142, v196, v197
  v_mfma_f32_16x16x32_bf16 v[100:103], a[188:191], v[164:167], v[100:103]
  s_add_u32 m0, s36, 31744
  v_cvt_pk_bf16_f32 v143, v198, v199
  v_mfma_f32_16x16x32_bf16 v[108:111], a[184:187], v[168:171], v[108:111]
  v_exp_f32 v192, v192
  v_mfma_f32_16x16x32_bf16 v[108:111], a[188:191], v[172:175], v[108:111]
  v_exp_f32 v193, v193
  v_mfma_f32_16x16x32_bf16 v[196:199], a[144:147], a[48:51], v[212:215]
  v_exp_f32 v194, v194
  v_mfma_f32_16x16x32_bf16 v[196:199], a[148:151], a[52:55], v[196:199]
  v_exp_f32 v195, v195
  v_mfma_f32_16x16x32_bf16 v[196:199], a[152:155], a[56:59], v[196:199]
  ds_read_b128 a[144:147], v240 offset:53248
  ds_read_b128 a[148:151], v241 offset:53248
  v_mfma_f32_16x16x32_bf16 v[196:199], a[156:159], a[60:63], v[196:199]
  ds_read_b128 a[152:155], v240 offset:55296
  ds_read_b128 a[156:159], v241 offset:55296
  v_mfma_f32_16x16x32_bf16 v[116:119], a[184:187], v[176:179], v[116:119]
  v_cvt_pk_bf16_f32 v150, v192, v193
  v_cvt_pk_bf16_f32 v151, v194, v195
  v_mfma_f32_16x16x32_bf16 v[116:119], a[188:191], v[180:183], v[116:119]
  v_mfma_f32_16x16x32_bf16 v[124:127], a[184:187], v[184:187], v[124:127]
  ds_read_b64_tr_b16 a[184:185], v243 offset:16392
  ds_read_b64_tr_b16 a[186:187], v243 offset:18440
  v_mfma_f32_16x16x32_bf16 v[124:127], a[188:191], v[188:191], v[124:127]
  s_waitcnt lgkmcnt(6)
  v_exp_f32 v196, v196
  v_mfma_f32_16x16x32_bf16 v[192:195], a[128:131], a[0:3], v[200:203]
  v_exp_f32 v197, v197
  v_mfma_f32_16x16x32_bf16 v[192:195], a[132:135], a[4:7], v[192:195]
  v_exp_f32 v198, v198
  v_mfma_f32_16x16x32_bf16 v[192:195], a[136:139], a[8:11], v[192:195]
  v_exp_f32 v199, v199
  v_mfma_f32_16x16x32_bf16 v[192:195], a[140:143], a[12:15], v[192:195]
  buffer_store_dwordx4 a[220:223], v251, s[16:19], s30 offen offset:2048 sc1
  v_mfma_f32_16x16x32_bf16 v[0:3], a[160:163], v[128:131], v[0:3]
  ds_read_b64_tr_b16 a[188:189], v243 offset:20488
  ds_read_b64_tr_b16 a[190:191], v243 offset:22536
  v_mfma_f32_16x16x32_bf16 v[0:3], a[164:167], v[132:135], v[0:3]
  v_cvt_pk_bf16_f32 v158, v196, v197
  v_cvt_pk_bf16_f32 v159, v198, v199
  v_mfma_f32_16x16x32_bf16 v[8:11], a[160:163], v[136:139], v[8:11]
  v_exp_f32 v192, v192
  v_mfma_f32_16x16x32_bf16 v[8:11], a[164:167], v[140:143], v[8:11]
  v_exp_f32 v193, v193
  v_mfma_f32_16x16x32_bf16 v[196:199], a[128:131], a[16:19], v[204:207]
  v_exp_f32 v194, v194
  v_mfma_f32_16x16x32_bf16 v[196:199], a[132:135], a[20:23], v[196:199]
  v_exp_f32 v195, v195
  v_mfma_f32_16x16x32_bf16 v[196:199], a[136:139], a[24:27], v[196:199]
  v_cvt_pk_bf16_f32 v160, v192, v193
  v_cvt_pk_bf16_f32 v161, v194, v195
  v_mfma_f32_16x16x32_bf16 v[196:199], a[140:143], a[28:31], v[196:199]
  v_mfma_f32_16x16x32_bf16 v[16:19], a[160:163], v[144:147], v[16:19]
  v_mfma_f32_16x16x32_bf16 v[16:19], a[164:167], v[148:151], v[16:19]
  buffer_load_dwordx4 v245, s[4:7], s39 offen offset:2048 nt lds
  v_mfma_f32_16x16x32_bf16 v[24:27], a[160:163], v[152:155], v[24:27]
  s_add_u32 m0, s37, 39944
  ds_read_b64_tr_b16 a[160:161], v242 offset:17408
  ds_read_b64_tr_b16 a[162:163], v242 offset:19456
  v_mfma_f32_16x16x32_bf16 v[24:27], a[164:167], v[156:159], v[24:27]
  v_exp_f32 v196, v196
  v_mfma_f32_16x16x32_bf16 v[192:195], a[128:131], a[32:35], v[208:211]
  v_exp_f32 v197, v197
  v_mfma_f32_16x16x32_bf16 v[192:195], a[132:135], a[36:39], v[192:195]
  v_exp_f32 v198, v198
  v_mfma_f32_16x16x32_bf16 v[192:195], a[136:139], a[40:43], v[192:195]
  v_exp_f32 v199, v199
  v_mfma_f32_16x16x32_bf16 v[192:195], a[140:143], a[44:47], v[192:195]
  ds_read_b64_tr_b16 a[164:165], v242 offset:21504
  ds_read_b64_tr_b16 a[166:167], v242 offset:23552
  v_mfma_f32_16x16x32_bf16 v[4:7], a[168:171], v[128:131], v[4:7]
  v_cvt_pk_bf16_f32 v168, v196, v197
  v_cvt_pk_bf16_f32 v169, v198, v199
  v_mfma_f32_16x16x32_bf16 v[4:7], a[172:175], v[132:135], v[4:7]
  v_mfma_f32_16x16x32_bf16 v[12:15], a[168:171], v[136:139], v[12:15]
  v_mfma_f32_16x16x32_bf16 v[12:15], a[172:175], v[140:143], v[12:15]
  v_exp_f32 v192, v192
  v_smfmac_f32_16x16x64_bf16 a[192:195], a[208:211], v[128:135], v248
  v_exp_f32 v193, v193
  v_mfma_f32_16x16x32_bf16 v[196:199], a[128:131], a[48:51], v[212:215]
  v_exp_f32 v194, v194
  v_mfma_f32_16x16x32_bf16 v[196:199], a[132:135], a[52:55], v[196:199]
  v_exp_f32 v195, v195
  v_mfma_f32_16x16x32_bf16 v[196:199], a[136:139], a[56:59], v[196:199]
  ds_read_b128 a[128:131], v240 offset:57344
  ds_read_b128 a[132:135], v241 offset:57344
  v_mfma_f32_16x16x32_bf16 v[196:199], a[140:143], a[60:63], v[196:199]
  ds_read_b128 a[136:139], v240 offset:59392
  ds_read_b128 a[140:143], v241 offset:59392
  v_mfma_f32_16x16x32_bf16 v[20:23], a[168:171], v[144:147], v[20:23]
  buffer_load_dwordx4 v246, s[8:11], s40 offen offset:1024 nt lds
  v_cvt_pk_bf16_f32 v176, v192, v193
  v_mfma_f32_16x16x32_bf16 v[20:23], a[172:175], v[148:151], v[20:23]
  s_add_u32 m0, s36, 34688
  v_cvt_pk_bf16_f32 v177, v194, v195
  v_mfma_f32_16x16x32_bf16 v[28:31], a[168:171], v[152:155], v[28:31]
  v_exp_f32 v196, v196
  v_mfma_f32_16x16x32_bf16 v[28:31], a[172:175], v[156:159], v[28:31]
  s_waitcnt lgkmcnt(4)
  v_exp_f32 v197, v197
  v_mfma_f32_16x16x32_bf16 v[192:195], a[144:147], a[0:3], v[200:203]
  v_exp_f32 v198, v198
  v_mfma_f32_16x16x32_bf16 v[192:195], a[148:151], a[4:7], v[192:195]
  v_exp_f32 v199, v199
  v_mfma_f32_16x16x32_bf16 v[192:195], a[152:155], a[8:11], v[192:195]
  ds_read_b64_tr_b16 a[168:169], v242 offset:17416
  ds_read_b64_tr_b16 a[170:171], v242 offset:19464
  v_mfma_f32_16x16x32_bf16 v[192:195], a[156:159], a[12:15], v[192:195]
  ds_read_b64_tr_b16 a[172:173], v242 offset:21512
  ds_read_b64_tr_b16 a[174:175], v242 offset:23560
  v_mfma_f32_16x16x32_bf16 v[32:35], a[176:179], v[128:131], v[32:35]
  v_cvt_pk_bf16_f32 v184, v196, v197
  v_cvt_pk_bf16_f32 v185, v198, v199
  v_mfma_f32_16x16x32_bf16 v[32:35], a[180:183], v[132:135], v[32:35]
  v_mfma_f32_16x16x32_bf16 v[40:43], a[176:179], v[136:139], v[40:43]
  buffer_load_dwordx4 v245, s[4:7], s39 offen offset:128 nt lds
  v_mfma_f32_16x16x32_bf16 v[40:43], a[180:183], v[140:143], v[40:43]
  s_add_u32 m0, s37, 9088
  v_exp_f32 v192, v192
  v_smfmac_f32_16x16x64_bf16 a[196:199], a[208:211], v[136:143], v248
  v_exp_f32 v193, v193
  v_mfma_f32_16x16x32_bf16 v[196:199], a[144:147], a[16:19], v[204:207]
  v_exp_f32 v194, v194
  v_mfma_f32_16x16x32_bf16 v[196:199], a[148:151], a[20:23], v[196:199]
  v_exp_f32 v195, v195
  v_mfma_f32_16x16x32_bf16 v[196:199], a[152:155], a[24:27], v[196:199]
  buffer_store_dwordx4 a[224:227], v251, s[16:19], s31 offen offset:2048 sc1
  v_mfma_f32_16x16x32_bf16 v[196:199], a[156:159], a[28:31], v[196:199]
  v_cvt_pk_bf16_f32 v162, v192, v193
  v_cvt_pk_bf16_f32 v163, v194, v195
  v_mfma_f32_16x16x32_bf16 v[48:51], a[176:179], v[144:147], v[48:51]
  v_mfma_f32_16x16x32_bf16 v[48:51], a[180:183], v[148:151], v[48:51]
  v_mfma_f32_16x16x32_bf16 v[56:59], a[176:179], v[152:155], v[56:59]
  ds_read_b64_tr_b16 a[176:177], v243 offset:17408
  ds_read_b64_tr_b16 a[178:179], v243 offset:19456
  v_mfma_f32_16x16x32_bf16 v[56:59], a[180:183], v[156:159], v[56:59]
  v_exp_f32 v196, v196
  v_mfma_f32_16x16x32_bf16 v[192:195], a[144:147], a[32:35], v[208:211]
  v_exp_f32 v197, v197
  v_mfma_f32_16x16x32_bf16 v[192:195], a[148:151], a[36:39], v[192:195]
  v_exp_f32 v198, v198
  v_mfma_f32_16x16x32_bf16 v[192:195], a[152:155], a[40:43], v[192:195]
  v_exp_f32 v199, v199
  v_mfma_f32_16x16x32_bf16 v[192:195], a[156:159], a[44:47], v[192:195]
  ds_read_b64_tr_b16 a[180:181], v243 offset:21504
  ds_read_b64_tr_b16 a[182:183], v243 offset:23552
  v_mfma_f32_16x16x32_bf16 v[36:39], a[184:187], v[128:131], v[36:39]
  buffer_load_dwordx4 v246, s[8:11], s40 offen offset:128 nt lds
  v_cvt_pk_bf16_f32 v170, v196, v197
  v_mfma_f32_16x16x32_bf16 v[36:39], a[188:191], v[132:135], v[36:39]
  s_add_u32 m0, s36, 33664
  v_cvt_pk_bf16_f32 v171, v198, v199
  v_mfma_f32_16x16x32_bf16 v[44:47], a[184:187], v[136:139], v[44:47]
  v_exp_f32 v192, v192
  v_mfma_f32_16x16x32_bf16 v[44:47], a[188:191], v[140:143], v[44:47]
  v_exp_f32 v193, v193
  v_smfmac_f32_16x16x64_bf16 a[200:203], a[208:211], v[144:151], v248
  v_exp_f32 v194, v194
  v_mfma_f32_16x16x32_bf16 v[196:199], a[144:147], a[48:51], v[212:215]
  v_exp_f32 v195, v195
  v_mfma_f32_16x16x32_bf16 v[196:199], a[148:151], a[52:55], v[196:199]
  ds_read_b128 a[144:147], v240 offset:61440
  ds_read_b128 a[148:151], v241 offset:61440
  v_mfma_f32_16x16x32_bf16 v[196:199], a[152:155], a[56:59], v[196:199]
  ds_read_b128 a[152:155], v240 offset:63488
  v_cvt_pk_bf16_f32 v178, v192, v193
  v_mfma_f32_16x16x32_bf16 v[196:199], a[156:159], a[60:63], v[196:199]
  ds_read_b128 a[156:159], v241 offset:63488
  v_cvt_pk_bf16_f32 v179, v194, v195
  v_mfma_f32_16x16x32_bf16 v[52:55], a[184:187], v[144:147], v[52:55]
  v_mfma_f32_16x16x32_bf16 v[52:55], a[188:191], v[148:151], v[52:55]
  buffer_load_dwordx4 v245, s[4:7], s39 offen offset:2176 nt lds
  v_mfma_f32_16x16x32_bf16 v[60:63], a[184:187], v[152:155], v[60:63]
  s_add_u32 m0, s37, 40840
  ds_read_b64_tr_b16 a[184:185], v243 offset:17416
  ds_read_b64_tr_b16 a[186:187], v243 offset:19464
  v_mfma_f32_16x16x32_bf16 v[60:63], a[188:191], v[156:159], v[60:63]
  s_waitcnt lgkmcnt(6)
  v_exp_f32 v196, v196
  v_mfma_f32_16x16x32_bf16 v[192:195], a[128:131], a[0:3], v[200:203]
  s_add_u32 s39, s22, 114688
  v_exp_f32 v197, v197
  v_mfma_f32_16x16x32_bf16 v[192:195], a[132:135], a[4:7], v[192:195]
  v_exp_f32 v198, v198
  v_mfma_f32_16x16x32_bf16 v[192:195], a[136:139], a[8:11], v[192:195]
  v_exp_f32 v199, v199
  v_mfma_f32_16x16x32_bf16 v[192:195], a[140:143], a[12:15], v[192:195]
  ds_read_b64_tr_b16 a[188:189], v243 offset:21512
  ds_read_b64_tr_b16 a[190:191], v243 offset:23560
  v_mfma_f32_16x16x32_bf16 v[64:67], a[160:163], v[128:131], v[64:67]
  v_cvt_pk_bf16_f32 v186, v196, v197
  v_cvt_pk_bf16_f32 v187, v198, v199
  v_mfma_f32_16x16x32_bf16 v[64:67], a[164:167], v[132:135], v[64:67]
  v_mfma_f32_16x16x32_bf16 v[72:75], a[160:163], v[136:139], v[72:75]
  v_mfma_f32_16x16x32_bf16 v[72:75], a[164:167], v[140:143], v[72:75]
  v_exp_f32 v192, v192
  v_smfmac_f32_16x16x64_bf16 a[204:207], a[208:211], v[152:159], v248
  v_exp_f32 v193, v193
  v_mfma_f32_16x16x32_bf16 v[196:199], a[128:131], a[16:19], v[204:207]
  v_exp_f32 v194, v194
  v_mfma_f32_16x16x32_bf16 v[196:199], a[132:135], a[20:23], v[196:199]
  v_exp_f32 v195, v195
  v_mfma_f32_16x16x32_bf16 v[196:199], a[136:139], a[24:27], v[196:199]
  buffer_load_dwordx4 v246, s[8:11], s40 offen offset:1152 nt lds
  v_cvt_pk_bf16_f32 v164, v192, v193
  v_mfma_f32_16x16x32_bf16 v[196:199], a[140:143], a[28:31], v[196:199]
  s_add_u32 m0, s37, 16384
  v_cvt_pk_bf16_f32 v165, v194, v195
  v_mfma_f32_16x16x32_bf16 v[80:83], a[160:163], v[144:147], v[80:83]
  v_mfma_f32_16x16x32_bf16 v[80:83], a[164:167], v[148:151], v[80:83]
  s_add_u32 s40, s22, 98304
  v_mfma_f32_16x16x32_bf16 v[88:91], a[160:163], v[152:155], v[88:91]
  v_mfma_f32_16x16x32_bf16 v[88:91], a[164:167], v[156:159], v[88:91]
  buffer_store_dwordx4 a[228:231], v251, s[16:19], s29 offen offset:128 sc1
  v_mfma_f32_16x16x32_bf16 v[192:195], a[128:131], a[32:35], v[208:211]
  v_exp_f32 v196, v196
  v_mfma_f32_16x16x32_bf16 v[192:195], a[132:135], a[36:39], v[192:195]
  v_exp_f32 v197, v197
  v_mfma_f32_16x16x32_bf16 v[192:195], a[136:139], a[40:43], v[192:195]
  v_exp_f32 v198, v198
  v_mfma_f32_16x16x32_bf16 v[192:195], a[140:143], a[44:47], v[192:195]
  s_waitcnt vmcnt(24) lgkmcnt(0)
  v_exp_f32 v199, v199
  v_mfma_f32_16x16x32_bf16 v[68:71], a[168:171], v[128:131], v[68:71]
  s_barrier
  ds_read_b64_tr_b16 a[160:161], v242 offset:24576
  ds_read_b64_tr_b16 a[162:163], v242 offset:26624
  v_mfma_f32_16x16x32_bf16 v[68:71], a[172:175], v[132:135], v[68:71]
  ds_read_b64_tr_b16 a[164:165], v242 offset:28672
  ds_read_b64_tr_b16 a[166:167], v242 offset:30720
  v_mfma_f32_16x16x32_bf16 v[76:79], a[168:171], v[136:139], v[76:79]
  v_cvt_pk_bf16_f32 v172, v196, v197
  v_cvt_pk_bf16_f32 v173, v198, v199
  v_mfma_f32_16x16x32_bf16 v[76:79], a[172:175], v[140:143], v[76:79]
  v_exp_f32 v192, v192
  v_mfma_f32_16x16x32_bf16 v[196:199], a[128:131], a[48:51], v[212:215]
  v_exp_f32 v193, v193
  v_mfma_f32_16x16x32_bf16 v[196:199], a[132:135], a[52:55], v[196:199]
  v_exp_f32 v194, v194
  v_mfma_f32_16x16x32_bf16 v[196:199], a[136:139], a[56:59], v[196:199]
  v_exp_f32 v195, v195
  v_mfma_f32_16x16x32_bf16 v[196:199], a[140:143], a[60:63], v[196:199]
  ds_read_b128 a[128:131], v240 offset:0
  ds_read_b128 a[132:135], v241 offset:0
  v_mfma_f32_16x16x32_bf16 v[84:87], a[168:171], v[144:147], v[84:87]
  ds_read_b128 a[136:139], v240 offset:2048
  ds_read_b128 a[140:143], v241 offset:2048
  v_mfma_f32_16x16x32_bf16 v[84:87], a[172:175], v[148:151], v[84:87]
  buffer_load_dwordx4 v246, s[8:11], s40 offen nt lds
  v_cvt_pk_bf16_f32 v180, v192, v193
  v_mfma_f32_16x16x32_bf16 v[92:95], a[168:171], v[152:155], v[92:95]
  s_add_u32 m0, s37, 48136
  ds_read_b64_tr_b16 a[168:169], v242 offset:24584
  ds_read_b64_tr_b16 a[170:171], v242 offset:26632
  v_mfma_f32_16x16x32_bf16 v[92:95], a[172:175], v[156:159], v[92:95]
  ds_read_b64_tr_b16 a[172:173], v242 offset:28680
  ds_read_b64_tr_b16 a[174:175], v242 offset:30728
  v_cvt_pk_bf16_f32 v181, v194, v195
  v_mfma_f32_16x16x32_bf16 v[192:195], a[144:147], a[0:3], v[200:203]
  v_exp_f32 v196, v196
  v_mfma_f32_16x16x32_bf16 v[192:195], a[148:151], a[4:7], v[192:195]
  v_exp_f32 v197, v197
  v_mfma_f32_16x16x32_bf16 v[192:195], a[152:155], a[8:11], v[192:195]
  v_exp_f32 v198, v198
  v_mfma_f32_16x16x32_bf16 v[192:195], a[156:159], a[12:15], v[192:195]
  v_exp_f32 v199, v199
  v_mfma_f32_16x16x32_bf16 v[96:99], a[176:179], v[128:131], v[96:99]
  v_cvt_pk_bf16_f32 v188, v196, v197
  v_cvt_pk_bf16_f32 v189, v198, v199
  v_mfma_f32_16x16x32_bf16 v[96:99], a[180:183], v[132:135], v[96:99]
  v_mfma_f32_16x16x32_bf16 v[104:107], a[176:179], v[136:139], v[104:107]
  v_mfma_f32_16x16x32_bf16 v[104:107], a[180:183], v[140:143], v[104:107]
  buffer_load_dwordx4 v246, s[8:11], s40 offen offset:1024 nt lds
  v_mfma_f32_16x16x32_bf16 v[196:199], a[144:147], a[16:19], v[204:207]
  s_add_u32 m0, s37, 17280
  v_exp_f32 v192, v192
  v_mfma_f32_16x16x32_bf16 v[196:199], a[148:151], a[20:23], v[196:199]
  v_exp_f32 v193, v193
  v_mfma_f32_16x16x32_bf16 v[196:199], a[152:155], a[24:27], v[196:199]
  v_exp_f32 v194, v194
  v_mfma_f32_16x16x32_bf16 v[196:199], a[156:159], a[28:31], v[196:199]
  v_exp_f32 v195, v195
  v_mfma_f32_16x16x32_bf16 v[112:115], a[176:179], v[144:147], v[112:115]
  v_cvt_pk_bf16_f32 v166, v192, v193
  v_cvt_pk_bf16_f32 v167, v194, v195
  v_mfma_f32_16x16x32_bf16 v[112:115], a[180:183], v[148:151], v[112:115]
  v_mfma_f32_16x16x32_bf16 v[120:123], a[176:179], v[152:155], v[120:123]
  ds_read_b64_tr_b16 a[176:177], v243 offset:24576
  ds_read_b64_tr_b16 a[178:179], v243 offset:26624
  v_mfma_f32_16x16x32_bf16 v[120:123], a[180:183], v[156:159], v[120:123]
  v_exp_f32 v196, v196
  v_mfma_f32_16x16x32_bf16 v[192:195], a[144:147], a[32:35], v[208:211]
  v_exp_f32 v197, v197
  v_mfma_f32_16x16x32_bf16 v[192:195], a[148:151], a[36:39], v[192:195]
  v_exp_f32 v198, v198
  v_mfma_f32_16x16x32_bf16 v[192:195], a[152:155], a[40:43], v[192:195]
  v_exp_f32 v199, v199
  v_mfma_f32_16x16x32_bf16 v[192:195], a[156:159], a[44:47], v[192:195]
  ds_read_b64_tr_b16 a[180:181], v243 offset:28672
  ds_read_b64_tr_b16 a[182:183], v243 offset:30720
  v_mfma_f32_16x16x32_bf16 v[100:103], a[184:187], v[128:131], v[100:103]
  buffer_load_dwordx4 v246, s[8:11], s40 offen offset:128 nt lds
  v_cvt_pk_bf16_f32 v174, v196, v197
  v_mfma_f32_16x16x32_bf16 v[100:103], a[188:191], v[132:135], v[100:103]
  s_add_u32 m0, s37, 49032
  v_cvt_pk_bf16_f32 v175, v198, v199
  v_mfma_f32_16x16x32_bf16 v[108:111], a[184:187], v[136:139], v[108:111]
  v_exp_f32 v192, v192
  v_mfma_f32_16x16x32_bf16 v[108:111], a[188:191], v[140:143], v[108:111]
  v_exp_f32 v193, v193
  v_mfma_f32_16x16x32_bf16 v[196:199], a[144:147], a[48:51], v[212:215]
  v_exp_f32 v194, v194
  v_mfma_f32_16x16x32_bf16 v[196:199], a[148:151], a[52:55], v[196:199]
  v_exp_f32 v195, v195
  v_mfma_f32_16x16x32_bf16 v[196:199], a[152:155], a[56:59], v[196:199]
  buffer_store_dwordx4 a[232:235], v251, s[16:19], s30 offen offset:128 sc1
  v_mfma_f32_16x16x32_bf16 v[196:199], a[156:159], a[60:63], v[196:199]
  ds_read_b128 a[144:147], v240 offset:4096
  ds_read_b128 a[148:151], v241 offset:4096
  v_mfma_f32_16x16x32_bf16 v[116:119], a[184:187], v[144:147], v[116:119]
  ds_read_b128 a[152:155], v240 offset:6144
  ds_read_b128 a[156:159], v241 offset:6144
  v_mfma_f32_16x16x32_bf16 v[116:119], a[188:191], v[148:151], v[116:119]
  v_cvt_pk_bf16_f32 v182, v192, v193
  v_cvt_pk_bf16_f32 v183, v194, v195
  v_mfma_f32_16x16x32_bf16 v[124:127], a[184:187], v[152:155], v[124:127]
  v_exp_f32 v196, v196
  v_mfma_f32_16x16x32_bf16 v[124:127], a[188:191], v[156:159], v[124:127]
  s_waitcnt lgkmcnt(4)
  v_exp_f32 v197, v197
  v_mfma_f32_16x16x32_bf16 v[192:195], a[128:131], a[0:3], v[200:203]
  v_exp_f32 v198, v198
  v_mfma_f32_16x16x32_bf16 v[192:195], a[132:135], a[4:7], v[192:195]
  v_exp_f32 v199, v199
  v_mfma_f32_16x16x32_bf16 v[192:195], a[136:139], a[8:11], v[192:195]
  ds_read_b64_tr_b16 a[184:185], v243 offset:24584
  ds_read_b64_tr_b16 a[186:187], v243 offset:26632
  v_mfma_f32_16x16x32_bf16 v[192:195], a[140:143], a[12:15], v[192:195]
  ds_read_b64_tr_b16 a[188:189], v243 offset:28680
  ds_read_b64_tr_b16 a[190:191], v243 offset:30728
  v_mfma_f32_16x16x32_bf16 v[0:3], a[160:163], v[160:163], v[0:3]
  buffer_load_dwordx4 v246, s[8:11], s40 offen offset:1152 nt lds
  v_cvt_pk_bf16_f32 v190, v196, v197
  v_mfma_f32_16x16x32_bf16 v[0:3], a[164:167], v[164:167], v[0:3]
  s_add_u32 m0, s36, 49152
  v_cvt_pk_bf16_f32 v191, v198, v199
  v_mfma_f32_16x16x32_bf16 v[8:11], a[160:163], v[168:171], v[8:11]
  v_exp_f32 v192, v192
  v_mfma_f32_16x16x32_bf16 v[8:11], a[164:167], v[172:175], v[8:11]
  s_add_u32 s40, s22, 114688
  v_exp_f32 v193, v193
  v_mfma_f32_16x16x32_bf16 v[196:199], a[128:131], a[16:19], v[204:207]
  v_exp_f32 v194, v194
  v_mfma_f32_16x16x32_bf16 v[196:199], a[132:135], a[20:23], v[196:199]
  v_exp_f32 v195, v195
  v_mfma_f32_16x16x32_bf16 v[196:199], a[136:139], a[24:27], v[196:199]
  v_cvt_pk_bf16_f32 v128, v192, v193
  v_cvt_pk_bf16_f32 v129, v194, v195
  v_mfma_f32_16x16x32_bf16 v[196:199], a[140:143], a[28:31], v[196:199]
  v_mfma_f32_16x16x32_bf16 v[16:19], a[160:163], v[176:179], v[16:19]
  v_mfma_f32_16x16x32_bf16 v[16:19], a[164:167], v[180:183], v[16:19]
  v_mfma_f32_16x16x32_bf16 v[24:27], a[160:163], v[184:187], v[24:27]
  ds_read_b64_tr_b16 a[160:161], v242 offset:25600
  ds_read_b64_tr_b16 a[162:163], v242 offset:27648
  v_mfma_f32_16x16x32_bf16 v[24:27], a[164:167], v[188:191], v[24:27]
  ds_read_b64_tr_b16 a[164:165], v242 offset:29696
  ds_read_b64_tr_b16 a[166:167], v242 offset:31744
  v_mfma_f32_16x16x32_bf16 v[192:195], a[128:131], a[32:35], v[208:211]
  v_exp_f32 v196, v196
  v_mfma_f32_16x16x32_bf16 v[192:195], a[132:135], a[36:39], v[192:195]
  v_exp_f32 v197, v197
  v_mfma_f32_16x16x32_bf16 v[192:195], a[136:139], a[40:43], v[192:195]
  v_exp_f32 v198, v198
  v_mfma_f32_16x16x32_bf16 v[192:195], a[140:143], a[44:47], v[192:195]
  v_exp_f32 v199, v199
  v_mfma_f32_16x16x32_bf16 v[4:7], a[168:171], v[160:163], v[4:7]
  buffer_load_dwordx4 v245, s[4:7], s39 offen nt lds
  v_cvt_pk_bf16_f32 v136, v196, v197
  v_mfma_f32_16x16x32_bf16 v[4:7], a[172:175], v[164:167], v[4:7]
  s_add_u32 m0, s36, 48128
  v_cvt_pk_bf16_f32 v137, v198, v199
  v_mfma_f32_16x16x32_bf16 v[12:15], a[168:171], v[168:171], v[12:15]
  v_exp_f32 v192, v192
  v_mfma_f32_16x16x32_bf16 v[12:15], a[172:175], v[172:175], v[12:15]
  v_exp_f32 v193, v193
  v_smfmac_f32_16x16x64_bf16 a[192:195], a[208:211], v[160:167], v248
  v_exp_f32 v194, v194
  v_mfma_f32_16x16x32_bf16 v[196:199], a[128:131], a[48:51], v[212:215]
  v_exp_f32 v195, v195
  v_mfma_f32_16x16x32_bf16 v[196:199], a[132:135], a[52:55], v[196:199]
  ds_read_b128 a[128:131], v240 offset:8192
  ds_read_b128 a[132:135], v241 offset:8192
  v_mfma_f32_16x16x32_bf16 v[196:199], a[136:139], a[56:59], v[196:199]
  ds_read_b128 a[136:139], v240 offset:10240
  v_cvt_pk_bf16_f32 v144, v192, v193
  v_mfma_f32_16x16x32_bf16 v[196:199], a[140:143], a[60:63], v[196:199]
  ds_read_b128 a[140:143], v241 offset:10240
  v_cvt_pk_bf16_f32 v145, v194, v195
  v_mfma_f32_16x16x32_bf16 v[20:23], a[168:171], v[176:179], v[20:23]
  v_mfma_f32_16x16x32_bf16 v[20:23], a[172:175], v[180:183], v[20:23]
  buffer_store_dwordx4 a[236:239], v251, s[16:19], s31 offen offset:128 sc1
  v_mfma_f32_16x16x32_bf16 v[28:31], a[168:171], v[184:187], v[28:31]
  ds_read_b64_tr_b16 a[168:169], v242 offset:25608
  ds_read_b64_tr_b16 a[170:171], v242 offset:27656
  v_mfma_f32_16x16x32_bf16 v[28:31], a[172:175], v[188:191], v[28:31]
  s_waitcnt lgkmcnt(6)
  v_exp_f32 v196, v196
  v_mfma_f32_16x16x32_bf16 v[192:195], a[144:147], a[0:3], v[200:203]
  v_exp_f32 v197, v197
  v_mfma_f32_16x16x32_bf16 v[192:195], a[148:151], a[4:7], v[192:195]
  v_exp_f32 v198, v198
  v_mfma_f32_16x16x32_bf16 v[192:195], a[152:155], a[8:11], v[192:195]
  v_exp_f32 v199, v199
  v_mfma_f32_16x16x32_bf16 v[192:195], a[156:159], a[12:15], v[192:195]
  ds_read_b64_tr_b16 a[172:173], v242 offset:29704
  ds_read_b64_tr_b16 a[174:175], v242 offset:31752
  v_mfma_f32_16x16x32_bf16 v[32:35], a[176:179], v[160:163], v[32:35]
  v_cvt_pk_bf16_f32 v152, v196, v197
  v_cvt_pk_bf16_f32 v153, v198, v199
  v_mfma_f32_16x16x32_bf16 v[32:35], a[180:183], v[164:167], v[32:35]
  v_mfma_f32_16x16x32_bf16 v[40:43], a[176:179], v[168:171], v[40:43]
  v_mfma_f32_16x16x32_bf16 v[40:43], a[180:183], v[172:175], v[40:43]
  v_exp_f32 v192, v192
  v_smfmac_f32_16x16x64_bf16 a[196:199], a[208:211], v[168:175], v248
  v_exp_f32 v193, v193
  v_mfma_f32_16x16x32_bf16 v[196:199], a[144:147], a[16:19], v[204:207]
  v_exp_f32 v194, v194
  v_mfma_f32_16x16x32_bf16 v[196:199], a[148:151], a[20:23], v[196:199]
  v_exp_f32 v195, v195
  v_mfma_f32_16x16x32_bf16 v[196:199], a[152:155], a[24:27], v[196:199]
  buffer_load_dwordx4 v245, s[4:7], s39 offen offset:2048 nt lds
  v_cvt_pk_bf16_f32 v130, v192, v193
  v_mfma_f32_16x16x32_bf16 v[196:199], a[156:159], a[28:31], v[196:199]
  s_add_u32 m0, s36, 51072
  v_cvt_pk_bf16_f32 v131, v194, v195
  v_mfma_f32_16x16x32_bf16 v[48:51], a[176:179], v[176:179], v[48:51]
  v_mfma_f32_16x16x32_bf16 v[48:51], a[180:183], v[180:183], v[48:51]
  v_mfma_f32_16x16x32_bf16 v[56:59], a[176:179], v[184:187], v[56:59]
  ds_read_b64_tr_b16 a[176:177], v243 offset:25600
  ds_read_b64_tr_b16 a[178:179], v243 offset:27648
  v_mfma_f32_16x16x32_bf16 v[56:59], a[180:183], v[188:191], v[56:59]
  v_exp_f32 v196, v196
  v_mfma_f32_16x16x32_bf16 v[192:195], a[144:147], a[32:35], v[208:211]
  v_exp_f32 v197, v197
  v_mfma_f32_16x16x32_bf16 v[192:195], a[148:151], a[36:39], v[192:195]
  v_exp_f32 v198, v198
  v_mfma_f32_16x16x32_bf16 v[192:195], a[152:155], a[40:43], v[192:195]
  v_exp_f32 v199, v199
  v_mfma_f32_16x16x32_bf16 v[192:195], a[156:159], a[44:47], v[192:195]
  ds_read_b64_tr_b16 a[180:181], v243 offset:29696
  ds_read_b64_tr_b16 a[182:183], v243 offset:31744
  v_mfma_f32_16x16x32_bf16 v[36:39], a[184:187], v[160:163], v[36:39]
  buffer_load_dwordx4 v245, s[4:7], s39 offen offset:128 nt lds
  v_cvt_pk_bf16_f32 v138, v196, v197
  v_mfma_f32_16x16x32_bf16 v[36:39], a[188:191], v[164:167], v[36:39]
  s_add_u32 m0, s36, 50048
  v_cvt_pk_bf16_f32 v139, v198, v199
  v_mfma_f32_16x16x32_bf16 v[44:47], a[184:187], v[168:171], v[44:47]
  v_exp_f32 v192, v192
  v_mfma_f32_16x16x32_bf16 v[44:47], a[188:191], v[172:175], v[44:47]
  v_exp_f32 v193, v193
  v_smfmac_f32_16x16x64_bf16 a[200:203], a[208:211], v[176:183], v248
  v_exp_f32 v194, v194
  v_mfma_f32_16x16x32_bf16 v[196:199], a[144:147], a[48:51], v[212:215]
  v_exp_f32 v195, v195
  v_mfma_f32_16x16x32_bf16 v[196:199], a[148:151], a[52:55], v[196:199]
  ds_read_b128 a[144:147], v240 offset:12288
  ds_read_b128 a[148:151], v241 offset:12288
  v_mfma_f32_16x16x32_bf16 v[196:199], a[152:155], a[56:59], v[196:199]
  ds_read_b128 a[152:155], v240 offset:14336
  v_cvt_pk_bf16_f32 v146, v192, v193
  v_mfma_f32_16x16x32_bf16 v[196:199], a[156:159], a[60:63], v[196:199]
  ds_read_b128 a[156:159], v241 offset:14336
  v_cvt_pk_bf16_f32 v147, v194, v195
  v_mfma_f32_16x16x32_bf16 v[52:55], a[184:187], v[176:179], v[52:55]
  v_mfma_f32_16x16x32_bf16 v[52:55], a[188:191], v[180:183], v[52:55]
  buffer_load_dwordx4 v245, s[4:7], s39 offen offset:2176 nt lds
  v_mfma_f32_16x16x32_bf16 v[60:63], a[184:187], v[184:187], v[60:63]
  s_add_u32 m0, s37, 24576
  ds_read_b64_tr_b16 a[184:185], v243 offset:25608
  ds_read_b64_tr_b16 a[186:187], v243 offset:27656
  v_mfma_f32_16x16x32_bf16 v[60:63], a[188:191], v[188:191], v[60:63]
  s_waitcnt lgkmcnt(6)
  v_exp_f32 v196, v196
  v_mfma_f32_16x16x32_bf16 v[192:195], a[128:131], a[0:3], v[200:203]
  v_exp_f32 v197, v197
  v_mfma_f32_16x16x32_bf16 v[192:195], a[132:135], a[4:7], v[192:195]
  v_exp_f32 v198, v198
  v_mfma_f32_16x16x32_bf16 v[192:195], a[136:139], a[8:11], v[192:195]
  v_exp_f32 v199, v199
  v_mfma_f32_16x16x32_bf16 v[192:195], a[140:143], a[12:15], v[192:195]
  ds_read_b64_tr_b16 a[188:189], v243 offset:29704
  ds_read_b64_tr_b16 a[190:191], v243 offset:31752
  v_mfma_f32_16x16x32_bf16 v[64:67], a[160:163], v[160:163], v[64:67]
  buffer_store_dwordx4 a[240:243], v251, s[16:19], s29 offen offset:2176 sc1
  v_mfma_f32_16x16x32_bf16 v[64:67], a[164:167], v[164:167], v[64:67]
  v_cvt_pk_bf16_f32 v154, v196, v197
  v_cvt_pk_bf16_f32 v155, v198, v199
  v_mfma_f32_16x16x32_bf16 v[72:75], a[160:163], v[168:171], v[72:75]
L_stub14:
  s_cmp_eq_u32 s99, 1
  s_cbranch_scc1 L_ret3
  v_exp_f32 v192, v192
  v_mfma_f32_16x16x32_bf16 v[72:75], a[164:167], v[172:175], v[72:75]
  v_exp_f32 v193, v193
  v_smfmac_f32_16x16x64_bf16 a[204:207], a[208:211], v[184:191], v248
  v_exp_f32 v194, v194
  v_mfma_f32_16x16x32_bf16 v[196:199], a[128:131], a[16:19], v[204:207]
  v_exp_f32 v195, v195
  v_mfma_f32_16x16x32_bf16 v[196:199], a[132:135], a[20:23], v[196:199]
  v_cvt_pk_bf16_f32 v132, v192, v193
  v_cvt_pk_bf16_f32 v133, v194, v195
  v_mfma_f32_16x16x32_bf16 v[196:199], a[136:139], a[24:27], v[196:199]
  v_mfma_f32_16x16x32_bf16 v[196:199], a[140:143], a[28:31], v[196:199]
  v_mfma_f32_16x16x32_bf16 v[80:83], a[160:163], v[176:179], v[80:83]
  v_mfma_f32_16x16x32_bf16 v[80:83], a[164:167], v[180:183], v[80:83]
  v_mfma_f32_16x16x32_bf16 v[88:91], a[160:163], v[184:187], v[88:91]
  v_mfma_f32_16x16x32_bf16 v[88:91], a[164:167], v[188:191], v[88:91]
  v_mfma_f32_16x16x32_bf16 v[192:195], a[128:131], a[32:35], v[208:211]
  v_mfma_f32_16x16x32_bf16 v[192:195], a[132:135], a[36:39], v[192:195]
  v_mfma_f32_16x16x32_bf16 v[192:195], a[136:139], a[40:43], v[192:195]
  v_mfma_f32_16x16x32_bf16 v[192:195], a[140:143], a[44:47], v[192:195]
  s_waitcnt vmcnt(23) lgkmcnt(0)
  v_exp_f32 v196, v196
  v_mfma_f32_16x16x32_bf16 v[68:71], a[168:171], v[160:163], v[68:71]
  s_barrier
  v_exp_f32 v197, v197
  v_mfma_f32_16x16x32_bf16 v[68:71], a[172:175], v[164:167], v[68:71]
  v_exp_f32 v198, v198
  v_mfma_f32_16x16x32_bf16 v[76:79], a[168:171], v[168:171], v[76:79]
  v_exp_f32 v199, v199
  v_mfma_f32_16x16x32_bf16 v[76:79], a[172:175], v[172:175], v[76:79]
  buffer_load_dwordx4 v246, s[8:11], s40 offen nt lds
  ds_read_b64_tr_b16 a[160:161], v242 offset:0
  v_cvt_pk_bf16_f32 v140, v196, v197
  v_cvt_pk_bf16_f32 v141, v198, v199
  v_mfma_f32_16x16x32_bf16 v[196:199], a[128:131], a[48:51], v[212:215]
  s_add_u32 m0, s37, 56328
  v_exp_f32 v192, v192
  v_mfma_f32_16x16x32_bf16 v[196:199], a[132:135], a[52:55], v[196:199]
  v_exp_f32 v193, v193
  v_mfma_f32_16x16x32_bf16 v[196:199], a[136:139], a[56:59], v[196:199]
  v_exp_f32 v194, v194
  v_mfma_f32_16x16x32_bf16 v[196:199], a[140:143], a[60:63], v[196:199]
  v_exp_f32 v195, v195
  v_mfma_f32_16x16x32_bf16 v[84:87], a[168:171], v[176:179], v[84:87]
  ds_read_b128 a[128:131], v240 offset:16384
  ds_read_b128 a[132:135], v241 offset:16384
  v_mfma_f32_16x16x32_bf16 v[84:87], a[172:175], v[180:183], v[84:87]
  ds_read_b128 a[136:139], v240 offset:18432
  ds_read_b128 a[140:143], v241 offset:18432
  v_mfma_f32_16x16x32_bf16 v[92:95], a[168:171], v[184:187], v[92:95]
  ds_read_b64_tr_b16 a[162:163], v242 offset:2048
  ds_read_b64_tr_b16 a[164:165], v242 offset:4096
  v_mfma_f32_16x16x32_bf16 v[92:95], a[172:175], v[188:191], v[92:95]
  ds_read_b64_tr_b16 a[166:167], v242 offset:6144
  ds_read_b64_tr_b16 a[168:169], v242 offset:8
  v_cvt_pk_bf16_f32 v148, v192, v193
  v_cvt_pk_bf16_f32 v149, v194, v195
  v_mfma_f32_16x16x32_bf16 v[192:195], a[144:147], a[0:3], v[200:203]
  v_exp_f32 v196, v196
  v_mfma_f32_16x16x32_bf16 v[192:195], a[148:151], a[4:7], v[192:195]
  v_exp_f32 v197, v197
  v_mfma_f32_16x16x32_bf16 v[192:195], a[152:155], a[8:11], v[192:195]
  v_exp_f32 v198, v198
  v_mfma_f32_16x16x32_bf16 v[192:195], a[156:159], a[12:15], v[192:195]
  v_exp_f32 v199, v199
  v_mfma_f32_16x16x32_bf16 v[96:99], a[176:179], v[160:163], v[96:99]
  buffer_load_dwordx4 v246, s[8:11], s40 offen offset:1024 nt lds
  ds_read_b64_tr_b16 a[170:171], v242 offset:2056
  v_mfma_f32_16x16x32_bf16 v[96:99], a[180:183], v[164:167], v[96:99]
  s_add_u32 m0, s37, 25472
  ds_read_b64_tr_b16 a[172:173], v242 offset:4104
  ds_read_b64_tr_b16 a[174:175], v242 offset:6152
  v_mfma_f32_16x16x32_bf16 v[104:107], a[176:179], v[168:171], v[104:107]
  v_cvt_pk_bf16_f32 v156, v196, v197
  v_cvt_pk_bf16_f32 v157, v198, v199
  v_mfma_f32_16x16x32_bf16 v[104:107], a[180:183], v[172:175], v[104:107]
  v_exp_f32 v192, v192
  v_mfma_f32_16x16x32_bf16 v[196:199], a[144:147], a[16:19], v[204:207]
  v_exp_f32 v193, v193
  v_mfma_f32_16x16x32_bf16 v[196:199], a[148:151], a[20:23], v[196:199]
  v_exp_f32 v194, v194
  v_mfma_f32_16x16x32_bf16 v[196:199], a[152:155], a[24:27], v[196:199]
  v_exp_f32 v195, v195
  v_mfma_f32_16x16x32_bf16 v[196:199], a[156:159], a[28:31], v[196:199]
  buffer_store_dwordx4 a[244:247], v251, s[16:19], s30 offen offset:2176 sc1
  v_mfma_f32_16x16x32_bf16 v[112:115], a[176:179], v[176:179], v[112:115]
  buffer_load_dwordx4 v246, s[8:11], s40 offen offset:128 nt lds
  v_cvt_pk_bf16_f32 v134, v192, v193
  v_mfma_f32_16x16x32_bf16 v[112:115], a[180:183], v[180:183], v[112:115]
  s_add_u32 m0, s37, 57224
  v_cvt_pk_bf16_f32 v135, v194, v195
  v_mfma_f32_16x16x32_bf16 v[120:123], a[176:179], v[184:187], v[120:123]
  v_exp_f32 v196, v196
  v_mfma_f32_16x16x32_bf16 v[120:123], a[180:183], v[188:191], v[120:123]
  v_exp_f32 v197, v197
  v_mfma_f32_16x16x32_bf16 v[192:195], a[144:147], a[32:35], v[208:211]
  buffer_load_dwordx4 v246, s[8:11], s40 offen offset:1152 nt lds
  ds_read_b64_tr_b16 a[176:177], v243 offset:0
  v_mfma_f32_16x16x32_bf16 v[192:195], a[148:151], a[36:39], v[192:195]
  v_exp_f32 v198, v198
  v_mfma_f32_16x16x32_bf16 v[192:195], a[152:155], a[40:43], v[192:195]
  v_exp_f32 v199, v199
  v_mfma_f32_16x16x32_bf16 v[192:195], a[156:159], a[44:47], v[192:195]
  ds_read_b64_tr_b16 a[178:179], v243 offset:2048
  ds_read_b64_tr_b16 a[180:181], v243 offset:4096
  v_mfma_f32_16x16x32_bf16 v[100:103], a[184:187], v[160:163], v[100:103]
  ds_read_b64_tr_b16 a[182:183], v243 offset:6144
  v_cvt_pk_bf16_f32 v142, v196, v197
  v_mfma_f32_16x16x32_bf16 v[100:103], a[188:191], v[164:167], v[100:103]
  v_cvt_pk_bf16_f32 v143, v198, v199
  v_mfma_f32_16x16x32_bf16 v[108:111], a[184:187], v[168:171], v[108:111]
  v_exp_f32 v192, v192
  v_mfma_f32_16x16x32_bf16 v[108:111], a[188:191], v[172:175], v[108:111]
  v_exp_f32 v193, v193
  v_mfma_f32_16x16x32_bf16 v[196:199], a[144:147], a[48:51], v[212:215]
  v_exp_f32 v194, v194
  v_mfma_f32_16x16x32_bf16 v[196:199], a[148:151], a[52:55], v[196:199]
  v_exp_f32 v195, v195
  v_mfma_f32_16x16x32_bf16 v[196:199], a[152:155], a[56:59], v[196:199]
  ds_read_b128 a[144:147], v240 offset:20480
  ds_read_b128 a[148:151], v241 offset:20480
  v_mfma_f32_16x16x32_bf16 v[196:199], a[156:159], a[60:63], v[196:199]
  ds_read_b128 a[152:155], v240 offset:22528
  ds_read_b128 a[156:159], v241 offset:22528
  v_mfma_f32_16x16x32_bf16 v[116:119], a[184:187], v[176:179], v[116:119]
  v_cvt_pk_bf16_f32 v150, v192, v193
  v_cvt_pk_bf16_f32 v151, v194, v195
  v_mfma_f32_16x16x32_bf16 v[116:119], a[188:191], v[180:183], v[116:119]
  v_mfma_f32_16x16x32_bf16 v[124:127], a[184:187], v[184:187], v[124:127]
  ds_read_b64_tr_b16 a[184:185], v243 offset:8
  ds_read_b64_tr_b16 a[186:187], v243 offset:2056
  v_mfma_f32_16x16x32_bf16 v[124:127], a[188:191], v[188:191], v[124:127]
  s_waitcnt lgkmcnt(6)
  v_exp_f32 v196, v196
  v_mfma_f32_16x16x32_bf16 v[192:195], a[128:131], a[0:3], v[200:203]
  v_exp_f32 v197, v197
  v_mfma_f32_16x16x32_bf16 v[192:195], a[132:135], a[4:7], v[192:195]
  v_exp_f32 v198, v198
  v_mfma_f32_16x16x32_bf16 v[192:195], a[136:139], a[8:11], v[192:195]
  v_exp_f32 v199, v199
  v_mfma_f32_16x16x32_bf16 v[192:195], a[140:143], a[12:15], v[192:195]
  ds_read_b64_tr_b16 a[188:189], v243 offset:4104
  ds_read_b64_tr_b16 a[190:191], v243 offset:6152
  v_mfma_f32_16x16x32_bf16 v[0:3], a[160:163], v[128:131], v[0:3]
  v_cvt_pk_bf16_f32 v158, v196, v197
  v_cvt_pk_bf16_f32 v159, v198, v199
  v_mfma_f32_16x16x32_bf16 v[0:3], a[164:167], v[132:135], v[0:3]
  v_mfma_f32_16x16x32_bf16 v[8:11], a[160:163], v[136:139], v[8:11]
  v_mfma_f32_16x16x32_bf16 v[8:11], a[164:167], v[140:143], v[8:11]
  v_exp_f32 v192, v192
  v_mfma_f32_16x16x32_bf16 v[196:199], a[128:131], a[16:19], v[204:207]
  v_exp_f32 v193, v193
  v_mfma_f32_16x16x32_bf16 v[196:199], a[132:135], a[20:23], v[196:199]
  v_exp_f32 v194, v194
  v_mfma_f32_16x16x32_bf16 v[196:199], a[136:139], a[24:27], v[196:199]
  v_exp_f32 v195, v195
  v_mfma_f32_16x16x32_bf16 v[196:199], a[140:143], a[28:31], v[196:199]
  v_cvt_pk_bf16_f32 v160, v192, v193
  v_cvt_pk_bf16_f32 v161, v194, v195
  v_mfma_f32_16x16x32_bf16 v[16:19], a[160:163], v[144:147], v[16:19]
  v_mfma_f32_16x16x32_bf16 v[16:19], a[164:167], v[148:151], v[16:19]
  v_mfma_f32_16x16x32_bf16 v[24:27], a[160:163], v[152:155], v[24:27]
  ds_read_b64_tr_b16 a[160:161], v242 offset:1024
  ds_read_b64_tr_b16 a[162:163], v242 offset:3072
  v_mfma_f32_16x16x32_bf16 v[24:27], a[164:167], v[156:159], v[24:27]
  v_exp_f32 v196, v196
  v_mfma_f32_16x16x32_bf16 v[192:195], a[128:131], a[32:35], v[208:211]
  v_exp_f32 v197, v197
  v_mfma_f32_16x16x32_bf16 v[192:195], a[132:135], a[36:39], v[192:195]
  v_exp_f32 v198, v198
  v_mfma_f32_16x16x32_bf16 v[192:195], a[136:139], a[40:43], v[192:195]
  v_exp_f32 v199, v199
  v_mfma_f32_16x16x32_bf16 v[192:195], a[140:143], a[44:47], v[192:195]
  buffer_store_dwordx4 a[248:251], v251, s[16:19], s31 offen offset:2176 sc1
  v_mfma_f32_16x16x32_bf16 v[4:7], a[168:171], v[128:131], v[4:7]
  ds_read_b64_tr_b16 a[164:165], v242 offset:5120
  ds_read_b64_tr_b16 a[166:167], v242 offset:7168
  v_mfma_f32_16x16x32_bf16 v[4:7], a[172:175], v[132:135], v[4:7]
  v_cvt_pk_bf16_f32 v168, v196, v197
  v_cvt_pk_bf16_f32 v169, v198, v199
  v_mfma_f32_16x16x32_bf16 v[12:15], a[168:171], v[136:139], v[12:15]
  v_exp_f32 v192, v192
  v_mfma_f32_16x16x32_bf16 v[12:15], a[172:175], v[140:143], v[12:15]
  v_exp_f32 v193, v193
  v_smfmac_f32_16x16x64_bf16 a[192:195], a[208:211], v[128:135], v248
  v_exp_f32 v194, v194
  v_mfma_f32_16x16x32_bf16 v[196:199], a[128:131], a[48:51], v[212:215]
  v_exp_f32 v195, v195
  v_mfma_f32_16x16x32_bf16 v[196:199], a[132:135], a[52:55], v[196:199]
  ds_read_b128 a[128:131], v240 offset:24576
  ds_read_b128 a[132:135], v241 offset:24576
  v_mfma_f32_16x16x32_bf16 v[196:199], a[136:139], a[56:59], v[196:199]
  ds_read_b128 a[136:139], v240 offset:26624
  v_cvt_pk_bf16_f32 v176, v192, v193
  v_mfma_f32_16x16x32_bf16 v[196:199], a[140:143], a[60:63], v[196:199]
  ds_read_b128 a[140:143], v241 offset:26624
  v_cvt_pk_bf16_f32 v177, v194, v195
  v_mfma_f32_16x16x32_bf16 v[20:23], a[168:171], v[144:147], v[20:23]
  v_mfma_f32_16x16x32_bf16 v[20:23], a[172:175], v[148:151], v[20:23]
  v_mfma_f32_16x16x32_bf16 v[28:31], a[168:171], v[152:155], v[28:31]
  ds_read_b64_tr_b16 a[168:169], v242 offset:1032
  ds_read_b64_tr_b16 a[170:171], v242 offset:3080
  v_mfma_f32_16x16x32_bf16 v[28:31], a[172:175], v[156:159], v[28:31]
  s_waitcnt lgkmcnt(6)
  v_exp_f32 v196, v196
  v_mfma_f32_16x16x32_bf16 v[192:195], a[144:147], a[0:3], v[200:203]
  v_exp_f32 v197, v197
  v_mfma_f32_16x16x32_bf16 v[192:195], a[148:151], a[4:7], v[192:195]
  v_exp_f32 v198, v198
  v_mfma_f32_16x16x32_bf16 v[192:195], a[152:155], a[8:11], v[192:195]
  v_exp_f32 v199, v199
  v_mfma_f32_16x16x32_bf16 v[192:195], a[156:159], a[12:15], v[192:195]
  ds_read_b64_tr_b16 a[172:173], v242 offset:5128
  ds_read_b64_tr_b16 a[174:175], v242 offset:7176
  v_mfma_f32_16x16x32_bf16 v[32:35], a[176:179], v[128:131], v[32:35]
  v_cvt_pk_bf16_f32 v184, v196, v197
  v_cvt_pk_bf16_f32 v185, v198, v199
  v_mfma_f32_16x16x32_bf16 v[32:35], a[180:183], v[132:135], v[32:35]
  v_mfma_f32_16x16x32_bf16 v[40:43], a[176:179], v[136:139], v[40:43]
  v_mfma_f32_16x16x32_bf16 v[40:43], a[180:183], v[140:143], v[40:43]
  v_exp_f32 v192, v192
  v_smfmac_f32_16x16x64_bf16 a[196:199], a[208:211], v[136:143], v248
  v_exp_f32 v193, v193
  v_mfma_f32_16x16x32_bf16 v[196:199], a[144:147], a[16:19], v[204:207]
  v_exp_f32 v194, v194
  v_mfma_f32_16x16x32_bf16 v[196:199], a[148:151], a[20:23], v[196:199]
  v_exp_f32 v195, v195
  v_mfma_f32_16x16x32_bf16 v[196:199], a[152:155], a[24:27], v[196:199]
  v_cvt_pk_bf16_f32 v162, v192, v193
  v_cvt_pk_bf16_f32 v163, v194, v195
  v_mfma_f32_16x16x32_bf16 v[196:199], a[156:159], a[28:31], v[196:199]
  v_mfma_f32_16x16x32_bf16 v[48:51], a[176:179], v[144:147], v[48:51]
  v_mfma_f32_16x16x32_bf16 v[48:51], a[180:183], v[148:151], v[48:51]
  v_mfma_f32_16x16x32_bf16 v[56:59], a[176:179], v[152:155], v[56:59]
  ds_read_b64_tr_b16 a[176:177], v243 offset:1024
  ds_read_b64_tr_b16 a[178:179], v243 offset:3072
  v_mfma_f32_16x16x32_bf16 v[56:59], a[180:183], v[156:159], v[56:59]
  ds_read_b64_tr_b16 a[180:181], v243 offset:5120
  ds_read_b64_tr_b16 a[182:183], v243 offset:7168
  v_mfma_f32_16x16x32_bf16 v[192:195], a[144:147], a[32:35], v[208:211]
  v_exp_f32 v196, v196
  v_mfma_f32_16x16x32_bf16 v[192:195], a[148:151], a[36:39], v[192:195]
  v_exp_f32 v197, v197
  v_mfma_f32_16x16x32_bf16 v[192:195], a[152:155], a[40:43], v[192:195]
  v_exp_f32 v198, v198
  v_mfma_f32_16x16x32_bf16 v[192:195], a[156:159], a[44:47], v[192:195]
  v_exp_f32 v199, v199
  v_mfma_f32_16x16x32_bf16 v[36:39], a[184:187], v[128:131], v[36:39]
  v_cvt_pk_bf16_f32 v170, v196, v197
  v_cvt_pk_bf16_f32 v171, v198, v199
  v_mfma_f32_16x16x32_bf16 v[36:39], a[188:191], v[132:135], v[36:39]
  v_mfma_f32_16x16x32_bf16 v[44:47], a[184:187], v[136:139], v[44:47]
  v_mfma_f32_16x16x32_bf16 v[44:47], a[188:191], v[140:143], v[44:47]
  v_smfmac_f32_16x16x64_bf16 a[200:203], a[208:211], v[144:151], v248
  v_exp_f32 v192, v192
  v_mfma_f32_16x16x32_bf16 v[196:199], a[144:147], a[48:51], v[212:215]
  v_exp_f32 v193, v193
  v_mfma_f32_16x16x32_bf16 v[196:199], a[148:151], a[52:55], v[196:199]
  v_exp_f32 v194, v194
  v_mfma_f32_16x16x32_bf16 v[196:199], a[152:155], a[56:59], v[196:199]
  v_exp_f32 v195, v195
  v_mfma_f32_16x16x32_bf16 v[196:199], a[156:159], a[60:63], v[196:199]
  ds_read_b128 a[144:147], v240 offset:28672
  ds_read_b128 a[148:151], v241 offset:28672
  v_mfma_f32_16x16x32_bf16 v[52:55], a[184:187], v[144:147], v[52:55]
  ds_read_b128 a[152:155], v240 offset:30720
  ds_read_b128 a[156:159], v241 offset:30720
  v_mfma_f32_16x16x32_bf16 v[52:55], a[188:191], v[148:151], v[52:55]
  v_cvt_pk_bf16_f32 v178, v192, v193
  v_cvt_pk_bf16_f32 v179, v194, v195
  v_mfma_f32_16x16x32_bf16 v[60:63], a[184:187], v[152:155], v[60:63]
  v_exp_f32 v196, v196
  v_mfma_f32_16x16x32_bf16 v[60:63], a[188:191], v[156:159], v[60:63]
  s_waitcnt lgkmcnt(4)
  v_exp_f32 v197, v197
  v_mfma_f32_16x16x32_bf16 v[192:195], a[128:131], a[0:3], v[200:203]
  v_exp_f32 v198, v198
  v_mfma_f32_16x16x32_bf16 v[192:195], a[132:135], a[4:7], v[192:195]
  v_exp_f32 v199, v199
  v_mfma_f32_16x16x32_bf16 v[192:195], a[136:139], a[8:11], v[192:195]
  ds_read_b64_tr_b16 a[184:185], v243 offset:1032
  ds_read_b64_tr_b16 a[186:187], v243 offset:3080
  v_mfma_f32_16x16x32_bf16 v[192:195], a[140:143], a[12:15], v[192:195]
  ds_read_b64_tr_b16 a[188:189], v243 offset:5128
  ds_read_b64_tr_b16 a[190:191], v243 offset:7176
  v_mfma_f32_16x16x32_bf16 v[64:67], a[160:163], v[128:131], v[64:67]
  v_cvt_pk_bf16_f32 v186, v196, v197
  v_cvt_pk_bf16_f32 v187, v198, v199
  v_mfma_f32_16x16x32_bf16 v[64:67], a[164:167], v[132:135], v[64:67]
  v_mfma_f32_16x16x32_bf16 v[72:75], a[160:163], v[136:139], v[72:75]
  v_mfma_f32_16x16x32_bf16 v[72:75], a[164:167], v[140:143], v[72:75]
  v_exp_f32 v192, v192
  v_smfmac_f32_16x16x64_bf16 a[204:207], a[208:211], v[152:159], v248
  v_exp_f32 v193, v193
  v_mfma_f32_16x16x32_bf16 v[196:199], a[128:131], a[16:19], v[204:207]
  v_exp_f32 v194, v194
  v_mfma_f32_16x16x32_bf16 v[196:199], a[132:135], a[20:23], v[196:199]
  v_exp_f32 v195, v195
  v_mfma_f32_16x16x32_bf16 v[196:199], a[136:139], a[24:27], v[196:199]
  v_cvt_pk_bf16_f32 v164, v192, v193
  v_cvt_pk_bf16_f32 v165, v194, v195
  v_mfma_f32_16x16x32_bf16 v[196:199], a[140:143], a[28:31], v[196:199]
  v_mfma_f32_16x16x32_bf16 v[80:83], a[160:163], v[144:147], v[80:83]
  v_mfma_f32_16x16x32_bf16 v[80:83], a[164:167], v[148:151], v[80:83]
  v_mfma_f32_16x16x32_bf16 v[88:91], a[160:163], v[152:155], v[88:91]
  v_mfma_f32_16x16x32_bf16 v[88:91], a[164:167], v[156:159], v[88:91]
  v_mfma_f32_16x16x32_bf16 v[192:195], a[128:131], a[32:35], v[208:211]
  v_mfma_f32_16x16x32_bf16 v[192:195], a[132:135], a[36:39], v[192:195]
  v_mfma_f32_16x16x32_bf16 v[192:195], a[136:139], a[40:43], v[192:195]
  v_mfma_f32_16x16x32_bf16 v[192:195], a[140:143], a[44:47], v[192:195]
  s_waitcnt vmcnt(1)
  v_exp_f32 v196, v196
  v_mfma_f32_16x16x32_bf16 v[68:71], a[168:171], v[128:131], v[68:71]
  s_barrier
  v_exp_f32 v197, v197
  v_mfma_f32_16x16x32_bf16 v[68:71], a[172:175], v[132:135], v[68:71]
  v_exp_f32 v198, v198
  v_mfma_f32_16x16x32_bf16 v[76:79], a[168:171], v[136:139], v[76:79]
  v_exp_f32 v199, v199
  v_mfma_f32_16x16x32_bf16 v[76:79], a[172:175], v[140:143], v[76:79]
  ds_read_b64_tr_b16 a[160:161], v242 offset:8192
  ds_read_b64_tr_b16 a[162:163], v242 offset:10240
  v_cvt_pk_bf16_f32 v172, v196, v197
  v_cvt_pk_bf16_f32 v173, v198, v199
  v_mfma_f32_16x16x32_bf16 v[196:199], a[128:131], a[48:51], v[212:215]
  v_exp_f32 v192, v192
  v_mfma_f32_16x16x32_bf16 v[196:199], a[132:135], a[52:55], v[196:199]
  v_exp_f32 v193, v193
  v_mfma_f32_16x16x32_bf16 v[196:199], a[136:139], a[56:59], v[196:199]
  v_exp_f32 v194, v194
  v_mfma_f32_16x16x32_bf16 v[196:199], a[140:143], a[60:63], v[196:199]
  v_exp_f32 v195, v195
  v_mfma_f32_16x16x32_bf16 v[84:87], a[168:171], v[144:147], v[84:87]
  ds_read_b128 a[128:131], v240 offset:32768
  ds_read_b128 a[132:135], v241 offset:32768
  v_mfma_f32_16x16x32_bf16 v[84:87], a[172:175], v[148:151], v[84:87]
  ds_read_b128 a[136:139], v240 offset:34816
  ds_read_b128 a[140:143], v241 offset:34816
  v_mfma_f32_16x16x32_bf16 v[92:95], a[168:171], v[152:155], v[92:95]
  ds_read_b64_tr_b16 a[164:165], v242 offset:12288
  ds_read_b64_tr_b16 a[166:167], v242 offset:14336
  v_mfma_f32_16x16x32_bf16 v[92:95], a[172:175], v[156:159], v[92:95]
  s_waitcnt lgkmcnt(6)
  ds_read_b64_tr_b16 a[168:169], v242 offset:8200
  ds_read_b64_tr_b16 a[170:171], v242 offset:10248
  v_cvt_pk_bf16_f32 v180, v192, v193
  v_cvt_pk_bf16_f32 v181, v194, v195
  v_mfma_f32_16x16x32_bf16 v[192:195], a[144:147], a[0:3], v[200:203]
  v_exp_f32 v196, v196
  v_mfma_f32_16x16x32_bf16 v[192:195], a[148:151], a[4:7], v[192:195]
  v_exp_f32 v197, v197
  v_mfma_f32_16x16x32_bf16 v[192:195], a[152:155], a[8:11], v[192:195]
  v_exp_f32 v198, v198
  v_mfma_f32_16x16x32_bf16 v[192:195], a[156:159], a[12:15], v[192:195]
  v_exp_f32 v199, v199
  v_mfma_f32_16x16x32_bf16 v[96:99], a[176:179], v[128:131], v[96:99]
  ds_read_b64_tr_b16 a[172:173], v242 offset:12296
  ds_read_b64_tr_b16 a[174:175], v242 offset:14344
  v_mfma_f32_16x16x32_bf16 v[96:99], a[180:183], v[132:135], v[96:99]
  v_cvt_pk_bf16_f32 v188, v196, v197
  v_cvt_pk_bf16_f32 v189, v198, v199
  v_mfma_f32_16x16x32_bf16 v[104:107], a[176:179], v[136:139], v[104:107]
  v_exp_f32 v192, v192
  v_mfma_f32_16x16x32_bf16 v[104:107], a[180:183], v[140:143], v[104:107]
  v_exp_f32 v193, v193
  v_mfma_f32_16x16x32_bf16 v[196:199], a[144:147], a[16:19], v[204:207]
  v_exp_f32 v194, v194
  v_mfma_f32_16x16x32_bf16 v[196:199], a[148:151], a[20:23], v[196:199]
  v_exp_f32 v195, v195
  v_mfma_f32_16x16x32_bf16 v[196:199], a[152:155], a[24:27], v[196:199]
  v_cvt_pk_bf16_f32 v166, v192, v193
  v_cvt_pk_bf16_f32 v167, v194, v195
  v_mfma_f32_16x16x32_bf16 v[196:199], a[156:159], a[28:31], v[196:199]
  v_mfma_f32_16x16x32_bf16 v[112:115], a[176:179], v[144:147], v[112:115]
  v_mfma_f32_16x16x32_bf16 v[112:115], a[180:183], v[148:151], v[112:115]
  v_mfma_f32_16x16x32_bf16 v[120:123], a[176:179], v[152:155], v[120:123]
  ds_read_b64_tr_b16 a[176:177], v243 offset:8192
  ds_read_b64_tr_b16 a[178:179], v243 offset:10240
  v_mfma_f32_16x16x32_bf16 v[120:123], a[180:183], v[156:159], v[120:123]
  ds_read_b64_tr_b16 a[180:181], v243 offset:12288
  ds_read_b64_tr_b16 a[182:183], v243 offset:14336
  v_mfma_f32_16x16x32_bf16 v[192:195], a[144:147], a[32:35], v[208:211]
  v_exp_f32 v196, v196
  v_mfma_f32_16x16x32_bf16 v[192:195], a[148:151], a[36:39], v[192:195]
  v_exp_f32 v197, v197
  v_mfma_f32_16x16x32_bf16 v[192:195], a[152:155], a[40:43], v[192:195]
  v_exp_f32 v198, v198
  v_mfma_f32_16x16x32_bf16 v[192:195], a[156:159], a[44:47], v[192:195]
  v_exp_f32 v199, v199
  v_mfma_f32_16x16x32_bf16 v[100:103], a[184:187], v[128:131], v[100:103]
  v_cvt_pk_bf16_f32 v174, v196, v197
  v_cvt_pk_bf16_f32 v175, v198, v199
  v_mfma_f32_16x16x32_bf16 v[100:103], a[188:191], v[132:135], v[100:103]
  v_mfma_f32_16x16x32_bf16 v[108:111], a[184:187], v[136:139], v[108:111]
  v_mfma_f32_16x16x32_bf16 v[108:111], a[188:191], v[140:143], v[108:111]
  v_mfma_f32_16x16x32_bf16 v[196:199], a[144:147], a[48:51], v[212:215]
  v_exp_f32 v192, v192
  v_mfma_f32_16x16x32_bf16 v[196:199], a[148:151], a[52:55], v[196:199]
  v_exp_f32 v193, v193
  v_mfma_f32_16x16x32_bf16 v[196:199], a[152:155], a[56:59], v[196:199]
  v_exp_f32 v194, v194
  v_mfma_f32_16x16x32_bf16 v[196:199], a[156:159], a[60:63], v[196:199]
  v_exp_f32 v195, v195
  v_mfma_f32_16x16x32_bf16 v[116:119], a[184:187], v[144:147], v[116:119]
  ds_read_b128 a[144:147], v240 offset:36864
  ds_read_b128 a[148:151], v241 offset:36864
  v_mfma_f32_16x16x32_bf16 v[116:119], a[188:191], v[148:151], v[116:119]
  ds_read_b128 a[152:155], v240 offset:38912
  ds_read_b128 a[156:159], v241 offset:38912
  v_mfma_f32_16x16x32_bf16 v[124:127], a[184:187], v[152:155], v[124:127]
  ds_read_b64_tr_b16 a[184:185], v243 offset:8200
  ds_read_b64_tr_b16 a[186:187], v243 offset:10248
  v_mfma_f32_16x16x32_bf16 v[124:127], a[188:191], v[156:159], v[124:127]
  s_waitcnt lgkmcnt(6)
  ds_read_b64_tr_b16 a[188:189], v243 offset:12296
  ds_read_b64_tr_b16 a[190:191], v243 offset:14344
  v_cvt_pk_bf16_f32 v182, v192, v193
  v_cvt_pk_bf16_f32 v183, v194, v195
  v_mfma_f32_16x16x32_bf16 v[192:195], a[128:131], a[0:3], v[200:203]
  v_exp_f32 v196, v196
  v_mfma_f32_16x16x32_bf16 v[192:195], a[132:135], a[4:7], v[192:195]
  v_exp_f32 v197, v197
  v_mfma_f32_16x16x32_bf16 v[192:195], a[136:139], a[8:11], v[192:195]
  v_exp_f32 v198, v198
  v_mfma_f32_16x16x32_bf16 v[192:195], a[140:143], a[12:15], v[192:195]
  v_exp_f32 v199, v199
  v_mfma_f32_16x16x32_bf16 v[0:3], a[160:163], v[160:163], v[0:3]
  v_cvt_pk_bf16_f32 v190, v196, v197
  v_cvt_pk_bf16_f32 v191, v198, v199
  v_mfma_f32_16x16x32_bf16 v[0:3], a[164:167], v[164:167], v[0:3]
  v_mfma_f32_16x16x32_bf16 v[8:11], a[160:163], v[168:171], v[8:11]
  v_mfma_f32_16x16x32_bf16 v[8:11], a[164:167], v[172:175], v[8:11]
  v_mfma_f32_16x16x32_bf16 v[16:19], a[160:163], v[176:179], v[16:19]
  v_exp_f32 v192, v192
  v_mfma_f32_16x16x32_bf16 v[16:19], a[164:167], v[180:183], v[16:19]
  v_exp_f32 v193, v193
  v_mfma_f32_16x16x32_bf16 v[24:27], a[160:163], v[184:187], v[24:27]
  v_exp_f32 v194, v194
  v_mfma_f32_16x16x32_bf16 v[24:27], a[164:167], v[188:191], v[24:27]
  v_exp_f32 v195, v195
  v_mfma_f32_16x16x32_bf16 v[196:199], a[128:131], a[16:19], v[204:207]
  ds_read_b128 a[128:131], v240 offset:40960
  ds_read_b64_tr_b16 a[160:161], v242 offset:9216
  v_mfma_f32_16x16x32_bf16 v[196:199], a[132:135], a[20:23], v[196:199]
  ds_read_b128 a[132:135], v241 offset:40960
  ds_read_b64_tr_b16 a[162:163], v242 offset:11264
  v_mfma_f32_16x16x32_bf16 v[196:199], a[136:139], a[24:27], v[196:199]
  ds_read_b128 a[136:139], v240 offset:43008
  ds_read_b64_tr_b16 a[164:165], v242 offset:13312
  v_mfma_f32_16x16x32_bf16 v[196:199], a[140:143], a[28:31], v[196:199]
  ds_read_b128 a[140:143], v241 offset:43008
  ds_read_b64_tr_b16 a[166:167], v242 offset:15360
  v_mfma_f32_16x16x32_bf16 v[4:7], a[168:171], v[160:163], v[4:7]
  v_cvt_pk_bf16_f32 v128, v192, v193
  v_cvt_pk_bf16_f32 v129, v194, v195
  v_mfma_f32_16x16x32_bf16 v[4:7], a[172:175], v[164:167], v[4:7]
  v_mfma_f32_16x16x32_bf16 v[12:15], a[168:171], v[168:171], v[12:15]
  v_mfma_f32_16x16x32_bf16 v[12:15], a[172:175], v[172:175], v[12:15]
  v_exp_f32 v196, v196
  v_smfmac_f32_16x16x64_bf16 a[192:195], a[208:211], v[160:167], v248
  v_exp_f32 v197, v197
  v_mfma_f32_16x16x32_bf16 v[20:23], a[168:171], v[176:179], v[20:23]
  v_exp_f32 v198, v198
  v_mfma_f32_16x16x32_bf16 v[20:23], a[172:175], v[180:183], v[20:23]
  v_exp_f32 v199, v199
  v_mfma_f32_16x16x32_bf16 v[28:31], a[168:171], v[184:187], v[28:31]
  ds_read_b64_tr_b16 a[168:169], v242 offset:9224
  ds_read_b64_tr_b16 a[170:171], v242 offset:11272
  v_mfma_f32_16x16x32_bf16 v[28:31], a[172:175], v[188:191], v[28:31]
  s_waitcnt lgkmcnt(2)
  ds_read_b64_tr_b16 a[172:173], v242 offset:13320
  ds_read_b64_tr_b16 a[174:175], v242 offset:15368
  v_mfma_f32_16x16x32_bf16 v[192:195], a[144:147], a[0:3], v[200:203]
  v_cvt_pk_bf16_f32 v136, v196, v197
  v_cvt_pk_bf16_f32 v137, v198, v199
  v_mfma_f32_16x16x32_bf16 v[192:195], a[148:151], a[4:7], v[192:195]
  v_mfma_f32_16x16x32_bf16 v[192:195], a[152:155], a[8:11], v[192:195]
  v_mfma_f32_16x16x32_bf16 v[192:195], a[156:159], a[12:15], v[192:195]
  v_mfma_f32_16x16x32_bf16 v[32:35], a[176:179], v[160:163], v[32:35]
  v_mfma_f32_16x16x32_bf16 v[32:35], a[180:183], v[164:167], v[32:35]
  v_mfma_f32_16x16x32_bf16 v[40:43], a[176:179], v[168:171], v[40:43]
  v_mfma_f32_16x16x32_bf16 v[40:43], a[180:183], v[172:175], v[40:43]
  v_smfmac_f32_16x16x64_bf16 a[196:199], a[208:211], v[168:175], v248
  v_mfma_f32_16x16x32_bf16 v[48:51], a[176:179], v[176:179], v[48:51]
  v_mfma_f32_16x16x32_bf16 v[48:51], a[180:183], v[180:183], v[48:51]
  v_mfma_f32_16x16x32_bf16 v[56:59], a[176:179], v[184:187], v[56:59]
  v_exp_f32 v192, v192
  v_mfma_f32_16x16x32_bf16 v[56:59], a[180:183], v[188:191], v[56:59]
  v_exp_f32 v193, v193
  v_mfma_f32_16x16x32_bf16 v[196:199], a[144:147], a[16:19], v[204:207]
  v_exp_f32 v194, v194
  v_mfma_f32_16x16x32_bf16 v[196:199], a[148:151], a[20:23], v[196:199]
  v_exp_f32 v195, v195
  v_mfma_f32_16x16x32_bf16 v[196:199], a[152:155], a[24:27], v[196:199]
  ds_read_b128 a[144:147], v240 offset:45056
  ds_read_b128 a[148:151], v241 offset:45056
  v_mfma_f32_16x16x32_bf16 v[196:199], a[156:159], a[28:31], v[196:199]
  ds_read_b128 a[152:155], v240 offset:47104
  ds_read_b128 a[156:159], v241 offset:47104
  v_mfma_f32_16x16x32_bf16 v[36:39], a[184:187], v[160:163], v[36:39]
  ds_read_b64_tr_b16 a[176:177], v243 offset:9216
  ds_read_b64_tr_b16 a[178:179], v243 offset:11264
  v_mfma_f32_16x16x32_bf16 v[36:39], a[188:191], v[164:167], v[36:39]
  ds_read_b64_tr_b16 a[180:181], v243 offset:13312
  ds_read_b64_tr_b16 a[182:183], v243 offset:15360
  v_mfma_f32_16x16x32_bf16 v[44:47], a[184:187], v[168:171], v[44:47]
  v_cvt_pk_bf16_f32 v130, v192, v193
  v_cvt_pk_bf16_f32 v131, v194, v195
  v_mfma_f32_16x16x32_bf16 v[44:47], a[188:191], v[172:175], v[44:47]
  v_exp_f32 v196, v196
  v_smfmac_f32_16x16x64_bf16 a[200:203], a[208:211], v[176:183], v248
  v_exp_f32 v197, v197
  v_mfma_f32_16x16x32_bf16 v[52:55], a[184:187], v[176:179], v[52:55]
  v_exp_f32 v198, v198
  v_mfma_f32_16x16x32_bf16 v[52:55], a[188:191], v[180:183], v[52:55]
  v_exp_f32 v199, v199
  v_mfma_f32_16x16x32_bf16 v[60:63], a[184:187], v[184:187], v[60:63]
  ds_read_b64_tr_b16 a[184:185], v243 offset:9224
  ds_read_b64_tr_b16 a[186:187], v243 offset:11272
  v_mfma_f32_16x16x32_bf16 v[60:63], a[188:191], v[188:191], v[60:63]
  ds_read_b64_tr_b16 a[188:189], v243 offset:13320
  ds_read_b64_tr_b16 a[190:191], v243 offset:15368
  v_mfma_f32_16x16x32_bf16 v[192:195], a[128:131], a[0:3], v[200:203]
  v_cvt_pk_bf16_f32 v138, v196, v197
  v_cvt_pk_bf16_f32 v139, v198, v199
  v_mfma_f32_16x16x32_bf16 v[192:195], a[132:135], a[4:7], v[192:195]
  v_mfma_f32_16x16x32_bf16 v[192:195], a[136:139], a[8:11], v[192:195]
  v_mfma_f32_16x16x32_bf16 v[192:195], a[140:143], a[12:15], v[192:195]
  v_mfma_f32_16x16x32_bf16 v[64:67], a[160:163], v[160:163], v[64:67]
  v_mfma_f32_16x16x32_bf16 v[64:67], a[164:167], v[164:167], v[64:67]
  v_mfma_f32_16x16x32_bf16 v[72:75], a[160:163], v[168:171], v[72:75]
  v_mfma_f32_16x16x32_bf16 v[72:75], a[164:167], v[172:175], v[72:75]
  v_smfmac_f32_16x16x64_bf16 a[204:207], a[208:211], v[184:191], v248
  v_mfma_f32_16x16x32_bf16 v[80:83], a[160:163], v[176:179], v[80:83]
  v_mfma_f32_16x16x32_bf16 v[80:83], a[164:167], v[180:183], v[80:83]
  v_mfma_f32_16x16x32_bf16 v[88:91], a[160:163], v[184:187], v[88:91]
  v_exp_f32 v192, v192
  v_mfma_f32_16x16x32_bf16 v[88:91], a[164:167], v[188:191], v[88:91]
  v_exp_f32 v193, v193
  v_mfma_f32_16x16x32_bf16 v[196:199], a[128:131], a[16:19], v[204:207]
  v_exp_f32 v194, v194
  v_mfma_f32_16x16x32_bf16 v[196:199], a[132:135], a[20:23], v[196:199]
  v_exp_f32 v195, v195
  v_mfma_f32_16x16x32_bf16 v[196:199], a[136:139], a[24:27], v[196:199]
  ds_read_b128 a[128:131], v240 offset:49152
  ds_read_b128 a[132:135], v241 offset:49152
  v_mfma_f32_16x16x32_bf16 v[196:199], a[140:143], a[28:31], v[196:199]
  s_waitcnt lgkmcnt(2)
  ds_read_b128 a[136:139], v240 offset:51200
  ds_read_b128 a[140:143], v241 offset:51200
  v_mfma_f32_16x16x32_bf16 v[68:71], a[168:171], v[160:163], v[68:71]
  ds_read_b64_tr_b16 a[160:161], v242 offset:16384
  ds_read_b64_tr_b16 a[162:163], v242 offset:18432
  v_mfma_f32_16x16x32_bf16 v[68:71], a[172:175], v[164:167], v[68:71]
  ds_read_b64_tr_b16 a[164:165], v242 offset:20480
  ds_read_b64_tr_b16 a[166:167], v242 offset:22528
  v_mfma_f32_16x16x32_bf16 v[76:79], a[168:171], v[168:171], v[76:79]
  v_cvt_pk_bf16_f32 v132, v192, v193
  v_cvt_pk_bf16_f32 v133, v194, v195
  v_mfma_f32_16x16x32_bf16 v[76:79], a[172:175], v[172:175], v[76:79]
  v_exp_f32 v196, v196
  v_mfma_f32_16x16x32_bf16 v[84:87], a[168:171], v[176:179], v[84:87]
  v_exp_f32 v197, v197
  v_mfma_f32_16x16x32_bf16 v[84:87], a[172:175], v[180:183], v[84:87]
  v_exp_f32 v198, v198
  v_mfma_f32_16x16x32_bf16 v[92:95], a[168:171], v[184:187], v[92:95]
  v_exp_f32 v199, v199
  v_mfma_f32_16x16x32_bf16 v[92:95], a[172:175], v[188:191], v[92:95]
  ds_read_b64_tr_b16 a[168:169], v242 offset:16392
  ds_read_b64_tr_b16 a[170:171], v242 offset:18440
  v_mfma_f32_16x16x32_bf16 v[192:195], a[144:147], a[0:3], v[200:203]
  ds_read_b64_tr_b16 a[172:173], v242 offset:20488
  ds_read_b64_tr_b16 a[174:175], v242 offset:22536
  v_mfma_f32_16x16x32_bf16 v[192:195], a[148:151], a[4:7], v[192:195]
  v_cvt_pk_bf16_f32 v140, v196, v197
  v_cvt_pk_bf16_f32 v141, v198, v199
  v_mfma_f32_16x16x32_bf16 v[192:195], a[152:155], a[8:11], v[192:195]
L_stub15:
  s_cmp_eq_u32 s99, 1
  s_cbranch_scc1 L_ret3
  v_mfma_f32_16x16x32_bf16 v[192:195], a[156:159], a[12:15], v[192:195]
  v_mfma_f32_16x16x32_bf16 v[96:99], a[176:179], v[160:163], v[96:99]
  v_mfma_f32_16x16x32_bf16 v[96:99], a[180:183], v[164:167], v[96:99]
  v_mfma_f32_16x16x32_bf16 v[104:107], a[176:179], v[168:171], v[104:107]
  v_mfma_f32_16x16x32_bf16 v[104:107], a[180:183], v[172:175], v[104:107]
  v_mfma_f32_16x16x32_bf16 v[112:115], a[176:179], v[176:179], v[112:115]
  v_mfma_f32_16x16x32_bf16 v[112:115], a[180:183], v[180:183], v[112:115]
  v_mfma_f32_16x16x32_bf16 v[120:123], a[176:179], v[184:187], v[120:123]
  ds_read_b64_tr_b16 a[176:177], v243 offset:16384
  ds_read_b64_tr_b16 a[178:179], v243 offset:18432
  v_mfma_f32_16x16x32_bf16 v[120:123], a[180:183], v[188:191], v[120:123]
  v_exp_f32 v192, v192
  v_mfma_f32_16x16x32_bf16 v[196:199], a[144:147], a[16:19], v[204:207]
  v_exp_f32 v193, v193
  v_mfma_f32_16x16x32_bf16 v[196:199], a[148:151], a[20:23], v[196:199]
  v_exp_f32 v194, v194
  v_mfma_f32_16x16x32_bf16 v[196:199], a[152:155], a[24:27], v[196:199]
  v_exp_f32 v195, v195
  v_mfma_f32_16x16x32_bf16 v[196:199], a[156:159], a[28:31], v[196:199]
  ds_read_b128 a[144:147], v240 offset:53248
  ds_read_b128 a[148:151], v241 offset:53248
  v_mfma_f32_16x16x32_bf16 v[100:103], a[184:187], v[160:163], v[100:103]
  ds_read_b128 a[152:155], v240 offset:55296
  ds_read_b128 a[156:159], v241 offset:55296
  v_mfma_f32_16x16x32_bf16 v[100:103], a[188:191], v[164:167], v[100:103]
  ds_read_b64_tr_b16 a[180:181], v243 offset:20480
  ds_read_b64_tr_b16 a[182:183], v243 offset:22528
  v_mfma_f32_16x16x32_bf16 v[108:111], a[184:187], v[168:171], v[108:111]
  v_cvt_pk_bf16_f32 v134, v192, v193
  v_cvt_pk_bf16_f32 v135, v194, v195
  v_mfma_f32_16x16x32_bf16 v[108:111], a[188:191], v[172:175], v[108:111]
  v_exp_f32 v196, v196
  v_mfma_f32_16x16x32_bf16 v[116:119], a[184:187], v[176:179], v[116:119]
  v_exp_f32 v197, v197
  v_mfma_f32_16x16x32_bf16 v[116:119], a[188:191], v[180:183], v[116:119]
  v_exp_f32 v198, v198
  v_mfma_f32_16x16x32_bf16 v[124:127], a[184:187], v[184:187], v[124:127]
  v_exp_f32 v199, v199
  v_mfma_f32_16x16x32_bf16 v[124:127], a[188:191], v[188:191], v[124:127]
  s_waitcnt lgkmcnt(2)
  ds_read_b64_tr_b16 a[184:185], v243 offset:16392
  ds_read_b64_tr_b16 a[186:187], v243 offset:18440
  v_mfma_f32_16x16x32_bf16 v[192:195], a[128:131], a[0:3], v[200:203]
  ds_read_b64_tr_b16 a[188:189], v243 offset:20488
  ds_read_b64_tr_b16 a[190:191], v243 offset:22536
  v_mfma_f32_16x16x32_bf16 v[192:195], a[132:135], a[4:7], v[192:195]
  v_cvt_pk_bf16_f32 v142, v196, v197
  v_cvt_pk_bf16_f32 v143, v198, v199
  v_mfma_f32_16x16x32_bf16 v[192:195], a[136:139], a[8:11], v[192:195]
  v_mfma_f32_16x16x32_bf16 v[192:195], a[140:143], a[12:15], v[192:195]
  v_mfma_f32_16x16x32_bf16 v[0:3], a[160:163], v[128:131], v[0:3]
  v_mfma_f32_16x16x32_bf16 v[0:3], a[164:167], v[132:135], v[0:3]
  v_mfma_f32_16x16x32_bf16 v[8:11], a[160:163], v[136:139], v[8:11]
  ds_read_b64_tr_b16 a[160:161], v242 offset:17408
  ds_read_b64_tr_b16 a[162:163], v242 offset:19456
  v_mfma_f32_16x16x32_bf16 v[8:11], a[164:167], v[140:143], v[8:11]
  ds_read_b64_tr_b16 a[164:165], v242 offset:21504
  ds_read_b64_tr_b16 a[166:167], v242 offset:23552
  v_mfma_f32_16x16x32_bf16 v[196:199], a[128:131], a[16:19], v[204:207]
  v_exp_f32 v192, v192
  v_mfma_f32_16x16x32_bf16 v[196:199], a[132:135], a[20:23], v[196:199]
  v_exp_f32 v193, v193
  v_mfma_f32_16x16x32_bf16 v[196:199], a[136:139], a[24:27], v[196:199]
  v_exp_f32 v194, v194
  v_mfma_f32_16x16x32_bf16 v[196:199], a[140:143], a[28:31], v[196:199]
  v_exp_f32 v195, v195
  v_mfma_f32_16x16x32_bf16 v[4:7], a[168:171], v[128:131], v[4:7]
  ds_read_b128 a[128:131], v240 offset:57344
  ds_read_b128 a[132:135], v241 offset:57344
  v_mfma_f32_16x16x32_bf16 v[4:7], a[172:175], v[132:135], v[4:7]
  ds_read_b128 a[136:139], v240 offset:59392
  ds_read_b128 a[140:143], v241 offset:59392
  v_mfma_f32_16x16x32_bf16 v[12:15], a[168:171], v[136:139], v[12:15]
  ds_read_b64_tr_b16 a[168:169], v242 offset:17416
  ds_read_b64_tr_b16 a[170:171], v242 offset:19464
  v_mfma_f32_16x16x32_bf16 v[12:15], a[172:175], v[140:143], v[12:15]
  ds_read_b64_tr_b16 a[172:173], v242 offset:21512
  ds_read_b64_tr_b16 a[174:175], v242 offset:23560
  v_cvt_pk_bf16_f32 v160, v192, v193
  v_cvt_pk_bf16_f32 v161, v194, v195
  v_mfma_f32_16x16x32_bf16 v[192:195], a[144:147], a[0:3], v[200:203]
  v_exp_f32 v196, v196
  v_mfma_f32_16x16x32_bf16 v[192:195], a[148:151], a[4:7], v[192:195]
  v_exp_f32 v197, v197
  v_mfma_f32_16x16x32_bf16 v[192:195], a[152:155], a[8:11], v[192:195]
  v_exp_f32 v198, v198
  v_mfma_f32_16x16x32_bf16 v[192:195], a[156:159], a[12:15], v[192:195]
  v_exp_f32 v199, v199
  v_mfma_f32_16x16x32_bf16 v[32:35], a[176:179], v[128:131], v[32:35]
  s_waitcnt lgkmcnt(4)
  v_cvt_pk_bf16_f32 v168, v196, v197
  v_cvt_pk_bf16_f32 v169, v198, v199
  v_mfma_f32_16x16x32_bf16 v[32:35], a[180:183], v[132:135], v[32:35]
  v_mfma_f32_16x16x32_bf16 v[40:43], a[176:179], v[136:139], v[40:43]
  ds_read_b64_tr_b16 a[176:177], v243 offset:17408
  ds_read_b64_tr_b16 a[178:179], v243 offset:19456
  v_mfma_f32_16x16x32_bf16 v[40:43], a[180:183], v[140:143], v[40:43]
  v_exp_f32 v192, v192
  v_smfmac_f32_16x16x64_bf16 a[192:195], a[208:211], v[128:135], v248
  v_exp_f32 v193, v193
  v_mfma_f32_16x16x32_bf16 v[196:199], a[144:147], a[16:19], v[204:207]
  v_exp_f32 v194, v194
  v_mfma_f32_16x16x32_bf16 v[196:199], a[148:151], a[20:23], v[196:199]
  v_exp_f32 v195, v195
  v_mfma_f32_16x16x32_bf16 v[196:199], a[152:155], a[24:27], v[196:199]
  ds_read_b128 a[144:147], v240 offset:61440
  ds_read_b128 a[148:151], v241 offset:61440
  v_mfma_f32_16x16x32_bf16 v[196:199], a[156:159], a[28:31], v[196:199]
  ds_read_b128 a[152:155], v240 offset:63488
  ds_read_b128 a[156:159], v241 offset:63488
  v_mfma_f32_16x16x32_bf16 v[36:39], a[184:187], v[128:131], v[36:39]
  ds_read_b64_tr_b16 a[180:181], v243 offset:21504
  ds_read_b64_tr_b16 a[182:183], v243 offset:23552
  v_mfma_f32_16x16x32_bf16 v[36:39], a[188:191], v[132:135], v[36:39]
  v_cvt_pk_bf16_f32 v162, v192, v193
  v_cvt_pk_bf16_f32 v163, v194, v195
  v_mfma_f32_16x16x32_bf16 v[44:47], a[184:187], v[136:139], v[44:47]
  v_exp_f32 v196, v196
  v_mfma_f32_16x16x32_bf16 v[44:47], a[188:191], v[140:143], v[44:47]
  v_exp_f32 v197, v197
  v_mfma_f32_16x16x32_bf16 v[192:195], a[128:131], a[0:3], v[200:203]
  v_exp_f32 v198, v198
  v_mfma_f32_16x16x32_bf16 v[192:195], a[132:135], a[4:7], v[192:195]
  v_exp_f32 v199, v199
  v_mfma_f32_16x16x32_bf16 v[192:195], a[136:139], a[8:11], v[192:195]
  ds_read_b64_tr_b16 a[184:185], v243 offset:17416
  ds_read_b64_tr_b16 a[186:187], v243 offset:19464
  v_mfma_f32_16x16x32_bf16 v[192:195], a[140:143], a[12:15], v[192:195]
  ds_read_b64_tr_b16 a[188:189], v243 offset:21512
  ds_read_b64_tr_b16 a[190:191], v243 offset:23560
  v_mfma_f32_16x16x32_bf16 v[64:67], a[160:163], v[128:131], v[64:67]
  v_cvt_pk_bf16_f32 v170, v196, v197
  v_cvt_pk_bf16_f32 v171, v198, v199
  v_mfma_f32_16x16x32_bf16 v[64:67], a[164:167], v[132:135], v[64:67]
  v_mfma_f32_16x16x32_bf16 v[72:75], a[160:163], v[136:139], v[72:75]
  ds_read_b64_tr_b16 a[160:161], v242 offset:24576
  ds_read_b64_tr_b16 a[162:163], v242 offset:26624
  v_mfma_f32_16x16x32_bf16 v[72:75], a[164:167], v[140:143], v[72:75]
  v_exp_f32 v192, v192
  v_smfmac_f32_16x16x64_bf16 a[196:199], a[208:211], v[136:143], v248
  v_exp_f32 v193, v193
  v_mfma_f32_16x16x32_bf16 v[196:199], a[128:131], a[16:19], v[204:207]
  v_exp_f32 v194, v194
  v_mfma_f32_16x16x32_bf16 v[196:199], a[132:135], a[20:23], v[196:199]
  v_exp_f32 v195, v195
  v_mfma_f32_16x16x32_bf16 v[196:199], a[136:139], a[24:27], v[196:199]
  ds_read_b128 a[128:131], v240 offset:32768
  ds_read_b128 a[132:135], v241 offset:32768
  v_mfma_f32_16x16x32_bf16 v[196:199], a[140:143], a[28:31], v[196:199]
  s_waitcnt lgkmcnt(4)
  ds_read_b128 a[136:139], v240 offset:34816
  ds_read_b128 a[140:143], v241 offset:34816
  v_mfma_f32_16x16x32_bf16 v[68:71], a[168:171], v[128:131], v[68:71]
  ds_read_b64_tr_b16 a[164:165], v242 offset:28672
  ds_read_b64_tr_b16 a[166:167], v242 offset:30720
  v_mfma_f32_16x16x32_bf16 v[68:71], a[172:175], v[132:135], v[68:71]
  v_cvt_pk_bf16_f32 v164, v192, v193
  v_cvt_pk_bf16_f32 v165, v194, v195
  v_mfma_f32_16x16x32_bf16 v[76:79], a[168:171], v[136:139], v[76:79]
  v_exp_f32 v196, v196
  v_mfma_f32_16x16x32_bf16 v[76:79], a[172:175], v[140:143], v[76:79]
  v_exp_f32 v197, v197
  v_mfma_f32_16x16x32_bf16 v[192:195], a[144:147], a[0:3], v[200:203]
  v_exp_f32 v198, v198
  v_mfma_f32_16x16x32_bf16 v[192:195], a[148:151], a[4:7], v[192:195]
  v_exp_f32 v199, v199
  v_mfma_f32_16x16x32_bf16 v[192:195], a[152:155], a[8:11], v[192:195]
  ds_read_b64_tr_b16 a[168:169], v242 offset:24584
  ds_read_b64_tr_b16 a[170:171], v242 offset:26632
  v_mfma_f32_16x16x32_bf16 v[192:195], a[156:159], a[12:15], v[192:195]
  ds_read_b64_tr_b16 a[172:173], v242 offset:28680
  ds_read_b64_tr_b16 a[174:175], v242 offset:30728
  v_mfma_f32_16x16x32_bf16 v[96:99], a[176:179], v[128:131], v[96:99]
  v_cvt_pk_bf16_f32 v172, v196, v197
  v_cvt_pk_bf16_f32 v173, v198, v199
  v_mfma_f32_16x16x32_bf16 v[96:99], a[180:183], v[132:135], v[96:99]
  v_mfma_f32_16x16x32_bf16 v[104:107], a[176:179], v[136:139], v[104:107]
  ds_read_b64_tr_b16 a[176:177], v243 offset:24576
  ds_read_b64_tr_b16 a[178:179], v243 offset:26624
  v_mfma_f32_16x16x32_bf16 v[104:107], a[180:183], v[140:143], v[104:107]
  v_exp_f32 v192, v192
  v_mfma_f32_16x16x32_bf16 v[196:199], a[144:147], a[16:19], v[204:207]
  v_exp_f32 v193, v193
  v_mfma_f32_16x16x32_bf16 v[196:199], a[148:151], a[20:23], v[196:199]
  v_exp_f32 v194, v194
  v_mfma_f32_16x16x32_bf16 v[196:199], a[152:155], a[24:27], v[196:199]
  v_exp_f32 v195, v195
  v_mfma_f32_16x16x32_bf16 v[196:199], a[156:159], a[28:31], v[196:199]
  ds_read_b128 a[144:147], v240 offset:36864
  ds_read_b128 a[148:151], v241 offset:36864
  v_mfma_f32_16x16x32_bf16 v[100:103], a[184:187], v[128:131], v[100:103]
  ds_read_b128 a[152:155], v240 offset:38912
  ds_read_b128 a[156:159], v241 offset:38912
  v_mfma_f32_16x16x32_bf16 v[100:103], a[188:191], v[132:135], v[100:103]
  ds_read_b64_tr_b16 a[180:181], v243 offset:28672
  ds_read_b64_tr_b16 a[182:183], v243 offset:30720
  v_mfma_f32_16x16x32_bf16 v[108:111], a[184:187], v[136:139], v[108:111]
  ds_read_b64_tr_b16 a[184:185], v243 offset:24584
  ds_read_b64_tr_b16 a[186:187], v243 offset:26632
  v_mfma_f32_16x16x32_bf16 v[108:111], a[188:191], v[140:143], v[108:111]
  s_waitcnt lgkmcnt(8)
  ds_read_b64_tr_b16 a[188:189], v243 offset:28680
  ds_read_b64_tr_b16 a[190:191], v243 offset:30728
  v_cvt_pk_bf16_f32 v166, v192, v193
  v_cvt_pk_bf16_f32 v167, v194, v195
  v_mfma_f32_16x16x32_bf16 v[192:195], a[128:131], a[32:35], v[208:211]
  v_exp_f32 v196, v196
  v_mfma_f32_16x16x32_bf16 v[192:195], a[132:135], a[36:39], v[192:195]
  v_exp_f32 v197, v197
  v_mfma_f32_16x16x32_bf16 v[192:195], a[136:139], a[40:43], v[192:195]
  v_exp_f32 v198, v198
  v_mfma_f32_16x16x32_bf16 v[192:195], a[140:143], a[44:47], v[192:195]
  v_exp_f32 v199, v199
  v_mfma_f32_16x16x32_bf16 v[0:3], a[160:163], v[160:163], v[0:3]
  v_cvt_pk_bf16_f32 v174, v196, v197
  v_cvt_pk_bf16_f32 v175, v198, v199
  v_mfma_f32_16x16x32_bf16 v[0:3], a[164:167], v[164:167], v[0:3]
  v_mfma_f32_16x16x32_bf16 v[8:11], a[160:163], v[168:171], v[8:11]
  ds_read_b64_tr_b16 a[160:161], v242 offset:25600
  ds_read_b64_tr_b16 a[162:163], v242 offset:27648
  v_mfma_f32_16x16x32_bf16 v[8:11], a[164:167], v[172:175], v[8:11]
  v_exp_f32 v192, v192
  v_mfma_f32_16x16x32_bf16 v[196:199], a[128:131], a[48:51], v[212:215]
  v_exp_f32 v193, v193
  v_mfma_f32_16x16x32_bf16 v[196:199], a[132:135], a[52:55], v[196:199]
  v_exp_f32 v194, v194
  v_mfma_f32_16x16x32_bf16 v[196:199], a[136:139], a[56:59], v[196:199]
  v_exp_f32 v195, v195
  v_mfma_f32_16x16x32_bf16 v[196:199], a[140:143], a[60:63], v[196:199]
  ds_read_b128 a[128:131], v240 offset:40960
  ds_read_b128 a[132:135], v241 offset:40960
  v_mfma_f32_16x16x32_bf16 v[4:7], a[168:171], v[160:163], v[4:7]
  ds_read_b128 a[136:139], v240 offset:43008
  ds_read_b128 a[140:143], v241 offset:43008
  v_mfma_f32_16x16x32_bf16 v[4:7], a[172:175], v[164:167], v[4:7]
  ds_read_b64_tr_b16 a[164:165], v242 offset:29696
  ds_read_b64_tr_b16 a[166:167], v242 offset:31744
  v_mfma_f32_16x16x32_bf16 v[12:15], a[168:171], v[168:171], v[12:15]
  ds_read_b64_tr_b16 a[168:169], v242 offset:25608
  ds_read_b64_tr_b16 a[170:171], v242 offset:27656
  v_mfma_f32_16x16x32_bf16 v[12:15], a[172:175], v[172:175], v[12:15]
  ds_read_b64_tr_b16 a[172:173], v242 offset:29704
  ds_read_b64_tr_b16 a[174:175], v242 offset:31752
  v_smfmac_f32_16x16x64_bf16 a[192:195], a[208:211], v[160:167], v248
  v_cvt_pk_bf16_f32 v144, v192, v193
  v_cvt_pk_bf16_f32 v145, v194, v195
  v_smfmac_f32_16x16x64_bf16 a[196:199], a[208:211], v[168:175], v248
  s_waitcnt lgkmcnt(10)
  v_exp_f32 v196, v196
  v_mfma_f32_16x16x32_bf16 v[192:195], a[144:147], a[32:35], v[208:211]
  v_exp_f32 v197, v197
  v_mfma_f32_16x16x32_bf16 v[192:195], a[148:151], a[36:39], v[192:195]
  v_exp_f32 v198, v198
  v_mfma_f32_16x16x32_bf16 v[192:195], a[152:155], a[40:43], v[192:195]
  v_exp_f32 v199, v199
  v_mfma_f32_16x16x32_bf16 v[192:195], a[156:159], a[44:47], v[192:195]
  v_cvt_pk_bf16_f32 v152, v196, v197
  v_cvt_pk_bf16_f32 v153, v198, v199
  v_mfma_f32_16x16x32_bf16 v[32:35], a[176:179], v[160:163], v[32:35]
  v_accvgpr_read_b32 v226, a192
  v_accvgpr_read_b32 v227, a193
  v_mfma_f32_16x16x32_bf16 v[32:35], a[180:183], v[164:167], v[32:35]
  v_add_f32 v226, v226, v227
  v_cmp_nlt_f32_e64 s[50:51], v226, s44
  v_mfma_f32_16x16x32_bf16 v[40:43], a[176:179], v[168:171], v[40:43]
  v_exp_f32 v192, v192
  v_mfma_f32_16x16x32_bf16 v[40:43], a[180:183], v[172:175], v[40:43]
  v_exp_f32 v193, v193
  v_mfma_f32_16x16x32_bf16 v[196:199], a[144:147], a[48:51], v[212:215]
  v_exp_f32 v194, v194
  v_mfma_f32_16x16x32_bf16 v[196:199], a[148:151], a[52:55], v[196:199]
  v_exp_f32 v195, v195
  v_mfma_f32_16x16x32_bf16 v[196:199], a[152:155], a[56:59], v[196:199]
  ds_read_b128 a[144:147], v240 offset:45056
  ds_read_b128 a[148:151], v241 offset:45056
  v_mfma_f32_16x16x32_bf16 v[196:199], a[156:159], a[60:63], v[196:199]
  ds_read_b128 a[152:155], v240 offset:47104
  ds_read_b128 a[156:159], v241 offset:47104
  v_mfma_f32_16x16x32_bf16 v[36:39], a[184:187], v[160:163], v[36:39]
  ds_read_b64_tr_b16 a[176:177], v243 offset:25600
  ds_read_b64_tr_b16 a[178:179], v243 offset:27648
  v_mfma_f32_16x16x32_bf16 v[36:39], a[188:191], v[164:167], v[36:39]
  ds_read_b64_tr_b16 a[180:181], v243 offset:29696
  ds_read_b64_tr_b16 a[182:183], v243 offset:31744
  v_mfma_f32_16x16x32_bf16 v[44:47], a[184:187], v[168:171], v[44:47]
  ds_read_b64_tr_b16 a[184:185], v243 offset:25608
  ds_read_b64_tr_b16 a[186:187], v243 offset:27656
  v_mfma_f32_16x16x32_bf16 v[44:47], a[188:191], v[172:175], v[44:47]
  s_waitcnt lgkmcnt(10)
  ds_read_b64_tr_b16 a[188:189], v243 offset:29704
  ds_read_b64_tr_b16 a[190:191], v243 offset:31752
  v_cvt_pk_bf16_f32 v146, v192, v193
  v_cvt_pk_bf16_f32 v147, v194, v195
  v_mfma_f32_16x16x32_bf16 v[192:195], a[128:131], a[32:35], v[208:211]
  v_rcp_f32 v232, v226
  v_mfma_f32_16x16x32_bf16 v[192:195], a[132:135], a[36:39], v[192:195]
  v_mov_b32 v233, v232
  v_accvgpr_read_b32 v226, a196
  v_pk_mul_f32 v[0:1], v[0:1], v[232:233]
  v_pk_mul_f32 v[2:3], v[2:3], v[232:233]
  v_pk_mul_f32 v[4:5], v[4:5], v[232:233]
  v_pk_mul_f32 v[6:7], v[6:7], v[232:233]
  v_mfma_f32_16x16x32_bf16 v[192:195], a[136:139], a[40:43], v[192:195]
  v_cvt_pk_bf16_f32 v0, v0, v1
  v_cvt_pk_bf16_f32 v1, v2, v3
  v_cvt_pk_bf16_f32 v2, v4, v5
  v_cvt_pk_bf16_f32 v3, v6, v7
  v_pk_mul_f32 v[32:33], v[32:33], v[232:233]
  v_pk_mul_f32 v[34:35], v[34:35], v[232:233]
  v_pk_mul_f32 v[36:37], v[36:37], v[232:233]
  v_pk_mul_f32 v[38:39], v[38:39], v[232:233]
  v_mfma_f32_16x16x32_bf16 v[192:195], a[140:143], a[44:47], v[192:195]
  v_exp_f32 v196, v196
  v_mfma_f32_16x16x32_bf16 v[64:67], a[160:163], v[160:163], v[64:67]
  v_exp_f32 v197, v197
  v_mfma_f32_16x16x32_bf16 v[64:67], a[164:167], v[164:167], v[64:67]
  v_exp_f32 v198, v198
  v_mfma_f32_16x16x32_bf16 v[72:75], a[160:163], v[168:171], v[72:75]
  v_exp_f32 v199, v199
  v_cvt_pk_bf16_f32 v32, v32, v33
  v_cvt_pk_bf16_f32 v33, v34, v35
  v_mfma_f32_16x16x32_bf16 v[72:75], a[164:167], v[172:175], v[72:75]
  ds_read_b64_tr_b16 a[160:161], v242 offset:16384
  ds_read_b64_tr_b16 a[162:163], v242 offset:18432
  v_cvt_pk_bf16_f32 v154, v196, v197
  v_cvt_pk_bf16_f32 v155, v198, v199
  v_cvt_pk_bf16_f32 v34, v36, v37
  v_cvt_pk_bf16_f32 v35, v38, v39
  v_mfma_f32_16x16x32_bf16 v[196:199], a[128:131], a[48:51], v[212:215]
  ds_read_b128 a[128:131], v240 offset:49152
  ds_read_b64_tr_b16 a[164:165], v242 offset:20480
  v_accvgpr_read_b32 v227, a197
  v_add_f32 v226, v226, v227
  v_rcp_f32 v234, v226
  v_mfma_f32_16x16x32_bf16 v[196:199], a[132:135], a[52:55], v[196:199]
  ds_read_b128 a[132:135], v241 offset:49152
  ds_read_b64_tr_b16 a[166:167], v242 offset:22528
  v_mov_b32 v235, v234
  v_cndmask_b32_dpp v4, v32, v0, vcc row_ror:8 row_mask:0xf bank_mask:0xf
  v_cndmask_b32_dpp v5, v33, v1, vcc row_ror:8 row_mask:0xf bank_mask:0xf
  v_cndmask_b32_dpp v6, v34, v2, vcc row_ror:8 row_mask:0xf bank_mask:0xf
  v_cndmask_b32_dpp v7, v35, v3, vcc row_ror:8 row_mask:0xf bank_mask:0xf
  v_pk_mul_f32 v[8:9], v[8:9], v[234:235]
  v_pk_mul_f32 v[10:11], v[10:11], v[234:235]
  v_pk_mul_f32 v[12:13], v[12:13], v[234:235]
  v_pk_mul_f32 v[14:15], v[14:15], v[234:235]
  v_mfma_f32_16x16x32_bf16 v[196:199], a[136:139], a[56:59], v[196:199]
  s_not_b64 vcc, s[58:59]
  buffer_store_dwordx4 v[4:7], v251, s[16:19], s32 offen sc1
  ds_read_b128 a[136:139], v240 offset:51200
  v_cvt_pk_bf16_f32 v8, v8, v9
  v_cvt_pk_bf16_f32 v9, v10, v11
  v_pk_mul_f32 v[40:41], v[40:41], v[234:235]
  v_pk_mul_f32 v[42:43], v[42:43], v[234:235]
  v_pk_mul_f32 v[44:45], v[44:45], v[234:235]
  v_pk_mul_f32 v[46:47], v[46:47], v[234:235]
  v_mfma_f32_16x16x32_bf16 v[196:199], a[140:143], a[60:63], v[196:199]
  ds_read_b128 a[140:143], v241 offset:51200
  v_cvt_pk_bf16_f32 v10, v12, v13
  v_cvt_pk_bf16_f32 v11, v14, v15
  v_cndmask_b32_dpp v36, v0, v32, vcc row_ror:8 row_mask:0xf bank_mask:0xf
  v_cndmask_b32_dpp v37, v1, v33, vcc row_ror:8 row_mask:0xf bank_mask:0xf
  v_cndmask_b32_dpp v38, v2, v34, vcc row_ror:8 row_mask:0xf bank_mask:0xf
  v_cndmask_b32_dpp v39, v3, v35, vcc row_ror:8 row_mask:0xf bank_mask:0xf
  v_mfma_f32_16x16x32_bf16 v[68:71], a[168:171], v[160:163], v[68:71]
  s_mov_b64 vcc, s[58:59]
  v_cvt_pk_bf16_f32 v40, v40, v41
  v_cvt_pk_bf16_f32 v41, v42, v43
  v_mfma_f32_16x16x32_bf16 v[68:71], a[172:175], v[164:167], v[68:71]
  v_exp_f32 v192, v192
  v_mfma_f32_16x16x32_bf16 v[76:79], a[168:171], v[168:171], v[76:79]
  v_exp_f32 v193, v193
  v_exp_f32 v194, v194
  v_exp_f32 v195, v195
  v_mfma_f32_16x16x32_bf16 v[76:79], a[172:175], v[172:175], v[76:79]
  s_waitcnt lgkmcnt(4)
  ds_read_b64_tr_b16 a[168:169], v242 offset:16392
  ds_read_b64_tr_b16 a[170:171], v242 offset:18440
  v_cvt_pk_bf16_f32 v42, v44, v45
  v_cvt_pk_bf16_f32 v43, v46, v47
  v_cvt_pk_bf16_f32 v148, v192, v193
  v_cvt_pk_bf16_f32 v149, v194, v195
  v_mfma_f32_16x16x32_bf16 v[192:195], a[144:147], a[32:35], v[208:211]
  ds_read_b64_tr_b16 a[172:173], v242 offset:20488
  ds_read_b64_tr_b16 a[174:175], v242 offset:22536
  v_mfma_f32_16x16x32_bf16 v[192:195], a[148:151], a[36:39], v[192:195]
  v_cndmask_b32_dpp v12, v40, v8, vcc row_ror:8 row_mask:0xf bank_mask:0xf
  v_cndmask_b32_dpp v13, v41, v9, vcc row_ror:8 row_mask:0xf bank_mask:0xf
  v_cndmask_b32_dpp v14, v42, v10, vcc row_ror:8 row_mask:0xf bank_mask:0xf
  v_cndmask_b32_dpp v15, v43, v11, vcc row_ror:8 row_mask:0xf bank_mask:0xf
  v_mfma_f32_16x16x32_bf16 v[192:195], a[152:155], a[40:43], v[192:195]
  s_not_b64 vcc, s[58:59]
  v_cndmask_b32_dpp v44, v8, v40, vcc row_ror:8 row_mask:0xf bank_mask:0xf
  v_cndmask_b32_dpp v45, v9, v41, vcc row_ror:8 row_mask:0xf bank_mask:0xf
  v_mfma_f32_16x16x32_bf16 v[192:195], a[156:159], a[44:47], v[192:195]
  v_cndmask_b32_dpp v46, v10, v42, vcc row_ror:8 row_mask:0xf bank_mask:0xf
  v_cndmask_b32_dpp v47, v11, v43, vcc row_ror:8 row_mask:0xf bank_mask:0xf
  v_mfma_f32_16x16x32_bf16 v[96:99], a[176:179], v[160:163], v[96:99]
  s_mov_b64 vcc, s[58:59]
  v_exp_f32 v196, v196
  v_mfma_f32_16x16x32_bf16 v[96:99], a[180:183], v[164:167], v[96:99]
  v_exp_f32 v197, v197
  v_mfma_f32_16x16x32_bf16 v[104:107], a[176:179], v[168:171], v[104:107]
  v_exp_f32 v198, v198
  v_exp_f32 v199, v199
  v_mfma_f32_16x16x32_bf16 v[104:107], a[180:183], v[172:175], v[104:107]
  ds_read_b64_tr_b16 a[176:177], v243 offset:16384
  ds_read_b64_tr_b16 a[178:179], v243 offset:18432
  ds_read_b64_tr_b16 a[180:181], v243 offset:20480
  ds_read_b64_tr_b16 a[182:183], v243 offset:22528
  v_cvt_pk_bf16_f32 v156, v196, v197
  v_cvt_pk_bf16_f32 v157, v198, v199
  v_pk_mul_f32 v[64:65], v[64:65], v[232:233]
  v_pk_mul_f32 v[66:67], v[66:67], v[232:233]
  v_pk_mul_f32 v[68:69], v[68:69], v[232:233]
  v_pk_mul_f32 v[70:71], v[70:71], v[232:233]
  v_mfma_f32_16x16x32_bf16 v[196:199], a[144:147], a[48:51], v[212:215]
  buffer_store_dwordx4 v[36:39], v251, s[16:19], s32 offen offset:2048 sc1
  v_mfma_f32_16x16x32_bf16 v[196:199], a[148:151], a[52:55], v[196:199]
  v_exp_f32 v192, v192
  v_mfma_f32_16x16x32_bf16 v[196:199], a[152:155], a[56:59], v[196:199]
  v_exp_f32 v193, v193
  v_mfma_f32_16x16x32_bf16 v[196:199], a[156:159], a[60:63], v[196:199]
  v_exp_f32 v194, v194
  v_mfma_f32_16x16x32_bf16 v[100:103], a[184:187], v[160:163], v[100:103]
  v_exp_f32 v195, v195
  v_mfma_f32_16x16x32_bf16 v[100:103], a[188:191], v[164:167], v[100:103]
  ds_read_b128 a[144:147], v240 offset:53248
  ds_read_b128 a[148:151], v241 offset:53248
  ds_read_b128 a[152:155], v240 offset:55296
  ds_read_b128 a[156:159], v241 offset:55296
  v_pk_mul_f32 v[96:97], v[96:97], v[232:233]
  v_pk_mul_f32 v[98:99], v[98:99], v[232:233]
  s_nop 1
  v_pk_mul_f32 v[100:101], v[100:101], v[232:233]
  v_pk_mul_f32 v[102:103], v[102:103], v[232:233]
  v_mfma_f32_16x16x32_bf16 v[108:111], a[184:187], v[168:171], v[108:111]
  ds_read_b64_tr_b16 a[184:185], v243 offset:16392
  ds_read_b64_tr_b16 a[186:187], v243 offset:18440
  v_mfma_f32_16x16x32_bf16 v[108:111], a[188:191], v[172:175], v[108:111]
  ds_read_b64_tr_b16 a[188:189], v243 offset:20488
  ds_read_b64_tr_b16 a[190:191], v243 offset:22536
  v_cvt_pk_bf16_f32 v150, v192, v193
  v_cvt_pk_bf16_f32 v151, v194, v195
  v_pk_mul_f32 v[72:73], v[72:73], v[234:235]
  v_pk_mul_f32 v[74:75], v[74:75], v[234:235]
  v_pk_mul_f32 v[76:77], v[76:77], v[234:235]
  v_pk_mul_f32 v[78:79], v[78:79], v[234:235]
  v_mfma_f32_16x16x32_bf16 v[192:195], a[128:131], a[32:35], v[208:211]
  s_waitcnt lgkmcnt(8)
  v_cvt_pk_bf16_f32 v64, v64, v65
  v_cvt_pk_bf16_f32 v65, v66, v67
  v_mfma_f32_16x16x32_bf16 v[192:195], a[132:135], a[36:39], v[192:195]
  v_cvt_pk_bf16_f32 v66, v68, v69
  v_cvt_pk_bf16_f32 v67, v70, v71
  v_mfma_f32_16x16x32_bf16 v[192:195], a[136:139], a[40:43], v[192:195]
  v_exp_f32 v196, v196
  v_mfma_f32_16x16x32_bf16 v[192:195], a[140:143], a[44:47], v[192:195]
  v_exp_f32 v197, v197
  v_exp_f32 v198, v198
  v_pk_mul_f32 v[104:105], v[104:105], v[234:235]
  v_pk_mul_f32 v[106:107], v[106:107], v[234:235]
  v_pk_mul_f32 v[108:109], v[108:109], v[234:235]
  v_pk_mul_f32 v[110:111], v[110:111], v[234:235]
  v_mfma_f32_16x16x32_bf16 v[16:19], a[160:163], v[144:147], v[16:19]
  v_exp_f32 v199, v199
  v_mfma_f32_16x16x32_bf16 v[16:19], a[164:167], v[148:151], v[16:19]
  v_cvt_pk_bf16_f32 v158, v196, v197
  v_cvt_pk_bf16_f32 v159, v198, v199
  v_mfma_f32_16x16x32_bf16 v[24:27], a[160:163], v[152:155], v[24:27]
  buffer_store_dwordx4 v[12:15], v251, s[16:19], s33 offen sc1
  v_cvt_pk_bf16_f32 v96, v96, v97
  v_cvt_pk_bf16_f32 v97, v98, v99
  v_mfma_f32_16x16x32_bf16 v[24:27], a[164:167], v[156:159], v[24:27]
  ds_read_b64_tr_b16 a[160:161], v242 offset:17408
  ds_read_b64_tr_b16 a[162:163], v242 offset:19456
  v_cvt_pk_bf16_f32 v98, v100, v101
  v_cvt_pk_bf16_f32 v99, v102, v103
  v_mfma_f32_16x16x32_bf16 v[196:199], a[128:131], a[48:51], v[212:215]
  ds_read_b128 a[128:131], v240 offset:57344
  ds_read_b64_tr_b16 a[164:165], v242 offset:21504
  v_mfma_f32_16x16x32_bf16 v[196:199], a[132:135], a[52:55], v[196:199]
  ds_read_b128 a[132:135], v241 offset:57344
  ds_read_b64_tr_b16 a[166:167], v242 offset:23552
  v_cndmask_b32_dpp v68, v96, v64, vcc row_ror:8 row_mask:0xf bank_mask:0xf
  v_cndmask_b32_dpp v69, v97, v65, vcc row_ror:8 row_mask:0xf bank_mask:0xf
  v_cndmask_b32_dpp v70, v98, v66, vcc row_ror:8 row_mask:0xf bank_mask:0xf
  v_cndmask_b32_dpp v71, v99, v67, vcc row_ror:8 row_mask:0xf bank_mask:0xf
  v_mfma_f32_16x16x32_bf16 v[196:199], a[136:139], a[56:59], v[196:199]
  s_not_b64 vcc, s[58:59]
  ds_read_b128 a[136:139], v240 offset:59392
  v_cvt_pk_bf16_f32 v72, v72, v73
  v_cvt_pk_bf16_f32 v73, v74, v75
  v_mfma_f32_16x16x32_bf16 v[196:199], a[140:143], a[60:63], v[196:199]
  ds_read_b128 a[140:143], v241 offset:59392
  v_cvt_pk_bf16_f32 v74, v76, v77
  v_cvt_pk_bf16_f32 v75, v78, v79
  v_cndmask_b32_dpp v100, v64, v96, vcc row_ror:8 row_mask:0xf bank_mask:0xf
  v_cndmask_b32_dpp v101, v65, v97, vcc row_ror:8 row_mask:0xf bank_mask:0xf
  v_cndmask_b32_dpp v102, v66, v98, vcc row_ror:8 row_mask:0xf bank_mask:0xf
  v_cndmask_b32_dpp v103, v67, v99, vcc row_ror:8 row_mask:0xf bank_mask:0xf
  v_mfma_f32_16x16x32_bf16 v[20:23], a[168:171], v[144:147], v[20:23]
  s_mov_b64 vcc, s[58:59]
  v_cvt_pk_bf16_f32 v104, v104, v105
  v_cvt_pk_bf16_f32 v105, v106, v107
  v_mfma_f32_16x16x32_bf16 v[20:23], a[172:175], v[148:151], v[20:23]
  v_exp_f32 v192, v192
  v_mfma_f32_16x16x32_bf16 v[28:31], a[168:171], v[152:155], v[28:31]
  v_exp_f32 v193, v193
  v_exp_f32 v194, v194
  v_exp_f32 v195, v195
  v_mfma_f32_16x16x32_bf16 v[28:31], a[172:175], v[156:159], v[28:31]
  s_waitcnt lgkmcnt(4)
  ds_read_b64_tr_b16 a[168:169], v242 offset:17416
  ds_read_b64_tr_b16 a[170:171], v242 offset:19464
  v_cvt_pk_bf16_f32 v106, v108, v109
  v_cvt_pk_bf16_f32 v107, v110, v111
  v_cvt_pk_bf16_f32 v176, v192, v193
  v_cvt_pk_bf16_f32 v177, v194, v195
  v_mfma_f32_16x16x32_bf16 v[192:195], a[144:147], a[32:35], v[208:211]
  ds_read_b64_tr_b16 a[172:173], v242 offset:21512
  ds_read_b64_tr_b16 a[174:175], v242 offset:23560
  v_mfma_f32_16x16x32_bf16 v[192:195], a[148:151], a[36:39], v[192:195]
  v_cndmask_b32_dpp v76, v104, v72, vcc row_ror:8 row_mask:0xf bank_mask:0xf
  v_cndmask_b32_dpp v77, v105, v73, vcc row_ror:8 row_mask:0xf bank_mask:0xf
  v_cndmask_b32_dpp v78, v106, v74, vcc row_ror:8 row_mask:0xf bank_mask:0xf
  v_cndmask_b32_dpp v79, v107, v75, vcc row_ror:8 row_mask:0xf bank_mask:0xf
  v_mfma_f32_16x16x32_bf16 v[192:195], a[152:155], a[40:43], v[192:195]
  s_not_b64 vcc, s[58:59]
  v_cndmask_b32_dpp v108, v72, v104, vcc row_ror:8 row_mask:0xf bank_mask:0xf
  v_cndmask_b32_dpp v109, v73, v105, vcc row_ror:8 row_mask:0xf bank_mask:0xf
  v_mfma_f32_16x16x32_bf16 v[192:195], a[156:159], a[44:47], v[192:195]
  v_cndmask_b32_dpp v110, v74, v106, vcc row_ror:8 row_mask:0xf bank_mask:0xf
  v_cndmask_b32_dpp v111, v75, v107, vcc row_ror:8 row_mask:0xf bank_mask:0xf
  v_mfma_f32_16x16x32_bf16 v[48:51], a[176:179], v[144:147], v[48:51]
  buffer_store_dwordx4 v[44:47], v251, s[16:19], s33 offen offset:2048 sc1
  v_mfma_f32_16x16x32_bf16 v[48:51], a[180:183], v[148:151], v[48:51]
  s_mov_b64 vcc, s[58:59]
  v_exp_f32 v196, v196
  v_mfma_f32_16x16x32_bf16 v[56:59], a[176:179], v[152:155], v[56:59]
  v_exp_f32 v197, v197
  v_mfma_f32_16x16x32_bf16 v[56:59], a[180:183], v[156:159], v[56:59]
  v_exp_f32 v198, v198
  v_exp_f32 v199, v199
  v_smfmac_f32_16x16x64_bf16 a[200:203], a[208:211], v[144:151], v248
  ds_read_b64_tr_b16 a[176:177], v243 offset:17408
  ds_read_b64_tr_b16 a[178:179], v243 offset:19456
  v_cvt_pk_bf16_f32 v184, v196, v197
  v_cvt_pk_bf16_f32 v185, v198, v199
  v_mfma_f32_16x16x32_bf16 v[196:199], a[144:147], a[48:51], v[212:215]
  v_exp_f32 v192, v192
  v_mfma_f32_16x16x32_bf16 v[196:199], a[148:151], a[52:55], v[196:199]
  v_exp_f32 v193, v193
  v_mfma_f32_16x16x32_bf16 v[196:199], a[152:155], a[56:59], v[196:199]
  v_exp_f32 v194, v194
  v_mfma_f32_16x16x32_bf16 v[196:199], a[156:159], a[60:63], v[196:199]
  v_exp_f32 v195, v195
  v_mfma_f32_16x16x32_bf16 v[52:55], a[184:187], v[144:147], v[52:55]
  ds_read_b128 a[144:147], v240 offset:61440
  ds_read_b128 a[148:151], v241 offset:61440
  v_mfma_f32_16x16x32_bf16 v[52:55], a[188:191], v[148:151], v[52:55]
  ds_read_b128 a[152:155], v240 offset:63488
  ds_read_b128 a[156:159], v241 offset:63488
  v_mfma_f32_16x16x32_bf16 v[60:63], a[184:187], v[152:155], v[60:63]
  ds_read_b64_tr_b16 a[180:181], v243 offset:21504
  ds_read_b64_tr_b16 a[182:183], v243 offset:23552
  v_mfma_f32_16x16x32_bf16 v[60:63], a[188:191], v[156:159], v[60:63]
  ds_read_b64_tr_b16 a[184:185], v243 offset:17416
  ds_read_b64_tr_b16 a[186:187], v243 offset:19464
  v_cvt_pk_bf16_f32 v178, v192, v193
  v_cvt_pk_bf16_f32 v179, v194, v195
  v_mfma_f32_16x16x32_bf16 v[192:195], a[128:131], a[32:35], v[208:211]
  s_waitcnt lgkmcnt(8)
  v_exp_f32 v196, v196
  v_mfma_f32_16x16x32_bf16 v[192:195], a[132:135], a[36:39], v[192:195]
  buffer_store_dwordx4 v[68:71], v251, s[16:19], s32 offen offset:128 sc1
  v_mfma_f32_16x16x32_bf16 v[192:195], a[136:139], a[40:43], v[192:195]
  v_exp_f32 v197, v197
  v_mfma_f32_16x16x32_bf16 v[192:195], a[140:143], a[44:47], v[192:195]
  v_exp_f32 v198, v198
  v_mfma_f32_16x16x32_bf16 v[80:83], a[160:163], v[144:147], v[80:83]
  v_exp_f32 v199, v199
  v_mfma_f32_16x16x32_bf16 v[80:83], a[164:167], v[148:151], v[80:83]
  ds_read_b64_tr_b16 a[188:189], v243 offset:21512
  ds_read_b64_tr_b16 a[190:191], v243 offset:23560
  v_mfma_f32_16x16x32_bf16 v[88:91], a[160:163], v[152:155], v[88:91]
  ds_read_b64_tr_b16 a[160:161], v242 offset:24576
  ds_read_b64_tr_b16 a[162:163], v242 offset:26624
  v_mfma_f32_16x16x32_bf16 v[88:91], a[164:167], v[156:159], v[88:91]
  ds_read_b64_tr_b16 a[164:165], v242 offset:28672
  ds_read_b64_tr_b16 a[166:167], v242 offset:30720
  v_smfmac_f32_16x16x64_bf16 a[204:207], a[208:211], v[152:159], v248
  v_cvt_pk_bf16_f32 v186, v196, v197
  v_cvt_pk_bf16_f32 v187, v198, v199
  v_mfma_f32_16x16x32_bf16 v[196:199], a[128:131], a[48:51], v[212:215]
  v_exp_f32 v192, v192
  v_mfma_f32_16x16x32_bf16 v[196:199], a[132:135], a[52:55], v[196:199]
  v_exp_f32 v193, v193
  v_mfma_f32_16x16x32_bf16 v[196:199], a[136:139], a[56:59], v[196:199]
  v_exp_f32 v194, v194
  v_mfma_f32_16x16x32_bf16 v[196:199], a[140:143], a[60:63], v[196:199]
  v_exp_f32 v195, v195
  v_mfma_f32_16x16x32_bf16 v[84:87], a[168:171], v[144:147], v[84:87]
  v_cvt_pk_bf16_f32 v180, v192, v193
  v_cvt_pk_bf16_f32 v181, v194, v195
  v_mfma_f32_16x16x32_bf16 v[84:87], a[172:175], v[148:151], v[84:87]
  v_cmp_nlt_f32_e64 s[52:53], v226, s44
  v_mfma_f32_16x16x32_bf16 v[92:95], a[168:171], v[152:155], v[92:95]
  s_waitcnt lgkmcnt(0)
  buffer_store_dwordx4 v[100:103], v251, s[16:19], s32 offen offset:2176 sc1
  v_mfma_f32_16x16x32_bf16 v[92:95], a[172:175], v[156:159], v[92:95]
  s_or_b64 s[50:51], s[50:51], s[52:53]
  v_exp_f32 v196, v196
  v_mfma_f32_16x16x32_bf16 v[192:195], a[144:147], a[32:35], v[208:211]
  v_exp_f32 v197, v197
  v_mfma_f32_16x16x32_bf16 v[192:195], a[148:151], a[36:39], v[192:195]
  v_exp_f32 v198, v198
  v_mfma_f32_16x16x32_bf16 v[192:195], a[152:155], a[40:43], v[192:195]
  v_exp_f32 v199, v199
  v_mfma_f32_16x16x32_bf16 v[192:195], a[156:159], a[44:47], v[192:195]
  ds_read_b64_tr_b16 a[168:169], v242 offset:24584
  ds_read_b64_tr_b16 a[170:171], v242 offset:26632
  v_mfma_f32_16x16x32_bf16 v[112:115], a[176:179], v[144:147], v[112:115]
  ds_read_b64_tr_b16 a[172:173], v242 offset:28680
  ds_read_b64_tr_b16 a[174:175], v242 offset:30728
  v_mfma_f32_16x16x32_bf16 v[112:115], a[180:183], v[148:151], v[112:115]
  v_cvt_pk_bf16_f32 v188, v196, v197
  v_cvt_pk_bf16_f32 v189, v198, v199
  v_mfma_f32_16x16x32_bf16 v[120:123], a[176:179], v[152:155], v[120:123]
  v_exp_f32 v192, v192
  v_mfma_f32_16x16x32_bf16 v[120:123], a[180:183], v[156:159], v[120:123]
  v_exp_f32 v193, v193
  v_mfma_f32_16x16x32_bf16 v[196:199], a[144:147], a[48:51], v[212:215]
  v_exp_f32 v194, v194
  v_mfma_f32_16x16x32_bf16 v[196:199], a[148:151], a[52:55], v[196:199]
  v_exp_f32 v195, v195
  v_mfma_f32_16x16x32_bf16 v[196:199], a[152:155], a[56:59], v[196:199]
  ds_read_b64_tr_b16 a[176:177], v243 offset:24576
  ds_read_b64_tr_b16 a[178:179], v243 offset:26624
  v_mfma_f32_16x16x32_bf16 v[196:199], a[156:159], a[60:63], v[196:199]
  ds_read_b64_tr_b16 a[180:181], v243 offset:28672
  ds_read_b64_tr_b16 a[182:183], v243 offset:30720
  v_mfma_f32_16x16x32_bf16 v[116:119], a[184:187], v[144:147], v[116:119]
  buffer_store_dwordx4 v[76:79], v251, s[16:19], s33 offen offset:128 sc1
  v_mfma_f32_16x16x32_bf16 v[116:119], a[188:191], v[148:151], v[116:119]
  v_cvt_pk_bf16_f32 v182, v192, v193
  v_cvt_pk_bf16_f32 v183, v194, v195
  v_mfma_f32_16x16x32_bf16 v[124:127], a[184:187], v[152:155], v[124:127]
  v_exp_f32 v196, v196
  v_mfma_f32_16x16x32_bf16 v[124:127], a[188:191], v[156:159], v[124:127]
  v_exp_f32 v197, v197
  v_mfma_f32_16x16x32_bf16 v[16:19], a[160:163], v[176:179], v[16:19]
  v_exp_f32 v198, v198
  v_exp_f32 v199, v199
  v_mfma_f32_16x16x32_bf16 v[16:19], a[164:167], v[180:183], v[16:19]
  ds_read_b64_tr_b16 a[184:185], v243 offset:24584
  ds_read_b64_tr_b16 a[186:187], v243 offset:26632
  v_cvt_pk_bf16_f32 v190, v196, v197
  v_cvt_pk_bf16_f32 v191, v198, v199
  v_mfma_f32_16x16x32_bf16 v[24:27], a[160:163], v[184:187], v[24:27]
  ds_read_b64_tr_b16 a[188:189], v243 offset:28680
  ds_read_b64_tr_b16 a[190:191], v243 offset:30728
  v_mfma_f32_16x16x32_bf16 v[24:27], a[164:167], v[188:191], v[24:27]
  s_waitcnt lgkmcnt(4)
  ds_read_b64_tr_b16 a[160:161], v242 offset:25600
  ds_read_b64_tr_b16 a[162:163], v242 offset:27648
  v_mfma_f32_16x16x32_bf16 v[20:23], a[168:171], v[176:179], v[20:23]
  ds_read_b64_tr_b16 a[164:165], v242 offset:29696
  ds_read_b64_tr_b16 a[166:167], v242 offset:31744
  v_mfma_f32_16x16x32_bf16 v[20:23], a[172:175], v[180:183], v[20:23]
  v_mfma_f32_16x16x32_bf16 v[28:31], a[168:171], v[184:187], v[28:31]
  ds_read_b64_tr_b16 a[168:169], v242 offset:25608
  ds_read_b64_tr_b16 a[170:171], v242 offset:27656
  v_mfma_f32_16x16x32_bf16 v[28:31], a[172:175], v[188:191], v[28:31]
  ds_read_b64_tr_b16 a[172:173], v242 offset:29704
  ds_read_b64_tr_b16 a[174:175], v242 offset:31752
  v_smfmac_f32_16x16x64_bf16 a[200:203], a[208:211], v[176:183], v248
  v_smfmac_f32_16x16x64_bf16 a[204:207], a[208:211], v[184:191], v248
  v_mfma_f32_16x16x32_bf16 v[48:51], a[176:179], v[176:179], v[48:51]
  buffer_store_dwordx4 v[108:111], v251, s[16:19], s33 offen offset:2176 sc1
  v_mfma_f32_16x16x32_bf16 v[48:51], a[180:183], v[180:183], v[48:51]
  v_mfma_f32_16x16x32_bf16 v[56:59], a[176:179], v[184:187], v[56:59]
  ds_read_b64_tr_b16 a[176:177], v243 offset:25600
  ds_read_b64_tr_b16 a[178:179], v243 offset:27648
  v_mfma_f32_16x16x32_bf16 v[56:59], a[180:183], v[188:191], v[56:59]
  s_waitcnt lgkmcnt(4)
  ds_read_b64_tr_b16 a[180:181], v243 offset:29696
  ds_read_b64_tr_b16 a[182:183], v243 offset:31744
  v_mfma_f32_16x16x32_bf16 v[52:55], a[184:187], v[176:179], v[52:55]
  v_mfma_f32_16x16x32_bf16 v[52:55], a[188:191], v[180:183], v[52:55]
  v_accvgpr_read_b32 v226, a200
  v_accvgpr_read_b32 v227, a201
  v_mfma_f32_16x16x32_bf16 v[60:63], a[184:187], v[184:187], v[60:63]
  ds_read_b64_tr_b16 a[184:185], v243 offset:25608
  ds_read_b64_tr_b16 a[186:187], v243 offset:27656
  v_mfma_f32_16x16x32_bf16 v[60:63], a[188:191], v[188:191], v[60:63]
  ds_read_b64_tr_b16 a[188:189], v243 offset:29704
  ds_read_b64_tr_b16 a[190:191], v243 offset:31752
  v_mfma_f32_16x16x32_bf16 v[80:83], a[160:163], v[176:179], v[80:83]
  v_add_f32 v226, v226, v227
  v_rcp_f32 v236, v226
  v_mfma_f32_16x16x32_bf16 v[80:83], a[164:167], v[180:183], v[80:83]
  v_mov_b32 v237, v236
  v_cmp_nlt_f32_e64 s[54:55], v226, s44
  v_pk_mul_f32 v[16:17], v[16:17], v[236:237]
  v_pk_mul_f32 v[18:19], v[18:19], v[236:237]
  v_pk_mul_f32 v[20:21], v[20:21], v[236:237]
  v_pk_mul_f32 v[22:23], v[22:23], v[236:237]
  v_mfma_f32_16x16x32_bf16 v[88:91], a[160:163], v[184:187], v[88:91]
  v_cvt_pk_bf16_f32 v16, v16, v17
  v_cvt_pk_bf16_f32 v17, v18, v19
  v_mfma_f32_16x16x32_bf16 v[88:91], a[164:167], v[188:191], v[88:91]
  s_or_b64 s[50:51], s[50:51], s[54:55]
  v_cvt_pk_bf16_f32 v18, v20, v21
  v_cvt_pk_bf16_f32 v19, v22, v23
  v_accvgpr_read_b32 v226, a204
  v_accvgpr_read_b32 v227, a205
  v_pk_mul_f32 v[48:49], v[48:49], v[236:237]
  v_pk_mul_f32 v[50:51], v[50:51], v[236:237]
  v_pk_mul_f32 v[52:53], v[52:53], v[236:237]
  v_pk_mul_f32 v[54:55], v[54:55], v[236:237]
  v_mfma_f32_16x16x32_bf16 v[84:87], a[168:171], v[176:179], v[84:87]
  s_waitcnt lgkmcnt(4)
  v_cvt_pk_bf16_f32 v48, v48, v49
  v_cvt_pk_bf16_f32 v49, v50, v51
  v_mfma_f32_16x16x32_bf16 v[84:87], a[172:175], v[180:183], v[84:87]
  v_cvt_pk_bf16_f32 v50, v52, v53
  v_cvt_pk_bf16_f32 v51, v54, v55
  v_mfma_f32_16x16x32_bf16 v[92:95], a[168:171], v[184:187], v[92:95]
  v_add_f32 v226, v226, v227
  v_cndmask_b32_dpp v20, v48, v16, vcc row_ror:8 row_mask:0xf bank_mask:0xf
  v_mfma_f32_16x16x32_bf16 v[92:95], a[172:175], v[188:191], v[92:95]
  v_rcp_f32 v238, v226
  v_mfma_f32_16x16x32_bf16 v[112:115], a[176:179], v[176:179], v[112:115]
  v_mov_b32 v239, v238
  v_cndmask_b32_dpp v21, v49, v17, vcc row_ror:8 row_mask:0xf bank_mask:0xf
  v_mfma_f32_16x16x32_bf16 v[112:115], a[180:183], v[180:183], v[112:115]
  s_waitcnt lgkmcnt(0)
  v_cndmask_b32_dpp v22, v50, v18, vcc row_ror:8 row_mask:0xf bank_mask:0xf
  v_cndmask_b32_dpp v23, v51, v19, vcc row_ror:8 row_mask:0xf bank_mask:0xf
  v_cmp_nlt_f32_e64 s[56:57], v226, s44
  v_pk_mul_f32 v[24:25], v[24:25], v[238:239]
  v_pk_mul_f32 v[26:27], v[26:27], v[238:239]
  v_pk_mul_f32 v[28:29], v[28:29], v[238:239]
  v_pk_mul_f32 v[30:31], v[30:31], v[238:239]
  v_mfma_f32_16x16x32_bf16 v[120:123], a[176:179], v[184:187], v[120:123]
  s_not_b64 vcc, s[58:59]
  buffer_store_dwordx4 v[20:23], v251, s[16:19], s34 offen sc1
  v_cvt_pk_bf16_f32 v24, v24, v25
  v_cvt_pk_bf16_f32 v25, v26, v27
  v_mfma_f32_16x16x32_bf16 v[120:123], a[180:183], v[188:191], v[120:123]
  s_or_b64 s[50:51], s[50:51], s[56:57]
  v_cvt_pk_bf16_f32 v26, v28, v29
  v_cvt_pk_bf16_f32 v27, v30, v31
  v_cndmask_b32_dpp v52, v16, v48, vcc row_ror:8 row_mask:0xf bank_mask:0xf
  v_cndmask_b32_dpp v53, v17, v49, vcc row_ror:8 row_mask:0xf bank_mask:0xf
  v_cndmask_b32_dpp v54, v18, v50, vcc row_ror:8 row_mask:0xf bank_mask:0xf
  v_cndmask_b32_dpp v55, v19, v51, vcc row_ror:8 row_mask:0xf bank_mask:0xf
  v_mfma_f32_16x16x32_bf16 v[116:119], a[184:187], v[176:179], v[116:119]
  v_mfma_f32_16x16x32_bf16 v[116:119], a[188:191], v[180:183], v[116:119]
  s_mov_b64 vcc, s[58:59]
  v_mfma_f32_16x16x32_bf16 v[124:127], a[184:187], v[184:187], v[124:127]
  v_mfma_f32_16x16x32_bf16 v[124:127], a[188:191], v[188:191], v[124:127]
  buffer_store_dwordx4 v[52:55], v251, s[16:19], s34 offen offset:2048 sc1
  v_pk_mul_f32 v[56:57], v[56:57], v[238:239]
  v_pk_mul_f32 v[58:59], v[58:59], v[238:239]
  v_pk_mul_f32 v[60:61], v[60:61], v[238:239]
  v_pk_mul_f32 v[62:63], v[62:63], v[238:239]
  v_cvt_pk_bf16_f32 v56, v56, v57
  v_cvt_pk_bf16_f32 v57, v58, v59
  v_cvt_pk_bf16_f32 v58, v60, v61
  v_cvt_pk_bf16_f32 v59, v62, v63
  v_cndmask_b32_dpp v28, v56, v24, vcc row_ror:8 row_mask:0xf bank_mask:0xf
  v_cndmask_b32_dpp v29, v57, v25, vcc row_ror:8 row_mask:0xf bank_mask:0xf
  v_cndmask_b32_dpp v30, v58, v26, vcc row_ror:8 row_mask:0xf bank_mask:0xf
  v_cndmask_b32_dpp v31, v59, v27, vcc row_ror:8 row_mask:0xf bank_mask:0xf
  buffer_store_dwordx4 v[28:31], v251, s[16:19], s35 offen sc1
  s_not_b64 vcc, s[58:59]
  v_cndmask_b32_dpp v60, v24, v56, vcc row_ror:8 row_mask:0xf bank_mask:0xf
  v_cndmask_b32_dpp v61, v25, v57, vcc row_ror:8 row_mask:0xf bank_mask:0xf
  v_cndmask_b32_dpp v62, v26, v58, vcc row_ror:8 row_mask:0xf bank_mask:0xf
  v_cndmask_b32_dpp v63, v27, v59, vcc row_ror:8 row_mask:0xf bank_mask:0xf
  buffer_store_dwordx4 v[60:63], v251, s[16:19], s35 offen offset:2048 sc1
  v_pk_mul_f32 v[80:81], v[80:81], v[236:237]
  v_pk_mul_f32 v[82:83], v[82:83], v[236:237]
  v_pk_mul_f32 v[84:85], v[84:85], v[236:237]
  v_pk_mul_f32 v[86:87], v[86:87], v[236:237]
  v_cvt_pk_bf16_f32 v80, v80, v81
  v_cvt_pk_bf16_f32 v81, v82, v83
  v_cvt_pk_bf16_f32 v82, v84, v85
  v_cvt_pk_bf16_f32 v83, v86, v87
  v_pk_mul_f32 v[88:89], v[88:89], v[238:239]
  v_pk_mul_f32 v[90:91], v[90:91], v[238:239]
  v_pk_mul_f32 v[92:93], v[92:93], v[238:239]
  v_pk_mul_f32 v[94:95], v[94:95], v[238:239]
  v_cvt_pk_bf16_f32 v88, v88, v89
  v_cvt_pk_bf16_f32 v89, v90, v91
  v_cvt_pk_bf16_f32 v90, v92, v93
  v_cvt_pk_bf16_f32 v91, v94, v95
  v_pk_mul_f32 v[112:113], v[112:113], v[236:237]
  v_pk_mul_f32 v[114:115], v[114:115], v[236:237]
  v_pk_mul_f32 v[116:117], v[116:117], v[236:237]
  v_pk_mul_f32 v[118:119], v[118:119], v[236:237]
  v_cvt_pk_bf16_f32 v112, v112, v113
  v_cvt_pk_bf16_f32 v113, v114, v115
  v_cvt_pk_bf16_f32 v114, v116, v117
  v_cvt_pk_bf16_f32 v115, v118, v119
  s_mov_b64 vcc, s[58:59]
  v_cndmask_b32_dpp v84, v112, v80, vcc row_ror:8 row_mask:0xf bank_mask:0xf
  v_cndmask_b32_dpp v85, v113, v81, vcc row_ror:8 row_mask:0xf bank_mask:0xf
  v_cndmask_b32_dpp v86, v114, v82, vcc row_ror:8 row_mask:0xf bank_mask:0xf
  v_cndmask_b32_dpp v87, v115, v83, vcc row_ror:8 row_mask:0xf bank_mask:0xf
  buffer_store_dwordx4 v[84:87], v251, s[16:19], s34 offen offset:128 sc1
  s_not_b64 vcc, s[58:59]
  v_cndmask_b32_dpp v116, v80, v112, vcc row_ror:8 row_mask:0xf bank_mask:0xf
  v_cndmask_b32_dpp v117, v81, v113, vcc row_ror:8 row_mask:0xf bank_mask:0xf
  v_cndmask_b32_dpp v118, v82, v114, vcc row_ror:8 row_mask:0xf bank_mask:0xf
  v_cndmask_b32_dpp v119, v83, v115, vcc row_ror:8 row_mask:0xf bank_mask:0xf
  buffer_store_dwordx4 v[116:119], v251, s[16:19], s34 offen offset:2176 sc1
  v_pk_mul_f32 v[120:121], v[120:121], v[238:239]
  v_pk_mul_f32 v[122:123], v[122:123], v[238:239]
  v_pk_mul_f32 v[124:125], v[124:125], v[238:239]
  v_pk_mul_f32 v[126:127], v[126:127], v[238:239]
  v_cvt_pk_bf16_f32 v120, v120, v121
  v_cvt_pk_bf16_f32 v121, v122, v123
  v_cvt_pk_bf16_f32 v122, v124, v125
  v_cvt_pk_bf16_f32 v123, v126, v127
  s_mov_b64 vcc, s[58:59]
  v_cndmask_b32_dpp v92, v120, v88, vcc row_ror:8 row_mask:0xf bank_mask:0xf
  v_cndmask_b32_dpp v93, v121, v89, vcc row_ror:8 row_mask:0xf bank_mask:0xf
  v_cndmask_b32_dpp v94, v122, v90, vcc row_ror:8 row_mask:0xf bank_mask:0xf
  v_cndmask_b32_dpp v95, v123, v91, vcc row_ror:8 row_mask:0xf bank_mask:0xf
  buffer_store_dwordx4 v[92:95], v251, s[16:19], s35 offen offset:128 sc1
  s_not_b64 vcc, s[58:59]
  v_cndmask_b32_dpp v124, v88, v120, vcc row_ror:8 row_mask:0xf bank_mask:0xf
  v_cndmask_b32_dpp v125, v89, v121, vcc row_ror:8 row_mask:0xf bank_mask:0xf
  v_cndmask_b32_dpp v126, v90, v122, vcc row_ror:8 row_mask:0xf bank_mask:0xf
  v_cndmask_b32_dpp v127, v91, v123, vcc row_ror:8 row_mask:0xf bank_mask:0xf
  buffer_store_dwordx4 v[124:127], v251, s[16:19], s35 offen offset:2176 sc1
  s_or_b64 s[54:55], s[46:47], s[48:49]
  s_or_b64 s[54:55], s[54:55], s[50:51]
  s_cmp_eq_u64 s[54:55], 0
  s_cbranch_scc1 L_end
  s_waitcnt vmcnt(0) lgkmcnt(0)
  s_lshl_b32 s3, s23, 12
  v_subrev_u32 v200, s3, v247
  v_mbcnt_lo_u32_b32 v189, -1, 0
  v_mbcnt_hi_u32_b32 v189, -1, v189
  v_lshlrev_b32 v201, 4, v189
  v_lshrrev_b32 v188, 2, v189
  v_lshlrev_b32 v188, 8, v188
  v_and_b32 v189, 3, v189
  v_lshl_add_u32 v188, v189, 4, v188
  v_add_u32 v202, s38, v188
  s_mov_b32 s56, 0
L_s_item:
  s_lshr_b32 s57, s56, 2
  s_lshl_b32 s58, s57, 1
  s_mov_b32 m0, s58
  s_nop 1
  s_movrels_b64 s[54:55], s[46:47]
  s_cmp_eq_u64 s[54:55], 0
  s_cbranch_scc1 L_s_next
  s_mov_b32 m0, s56
  s_nop 1
  s_movrels_b32 s59, s24
  s_mov_b32 m0, s57
  s_nop 1
  s_movrels_b32 s60, s20
  buffer_load_dwordx4 v[128:131], v247, s[12:15], s59 offen offset:0
  buffer_load_dwordx4 v[132:135], v247, s[12:15], s59 offen offset:64
  buffer_load_dwordx4 v[136:139], v247, s[12:15], s59 offen offset:128
  buffer_load_dwordx4 v[140:143], v247, s[12:15], s59 offen offset:192
  v_mov_b32 v188, 0xff800000
  s_mov_b32 s61, s60
  s_mov_b32 s63, 32
L_s_max:
  buffer_load_dwordx4 v[144:147], v200, s[4:7], s61 offen offset:0
  buffer_load_dwordx4 v[148:151], v200, s[4:7], s61 offen offset:64
  buffer_load_dwordx4 v[152:155], v200, s[4:7], s61 offen offset:128
  buffer_load_dwordx4 v[156:159], v200, s[4:7], s61 offen offset:192
  s_waitcnt vmcnt(0)
  v_mfma_f32_16x16x32_bf16 v[176:179], v[144:147], v[128:131], 0
  v_mfma_f32_16x16x32_bf16 v[176:179], v[148:151], v[132:135], v[176:179]
  v_mfma_f32_16x16x32_bf16 v[176:179], v[152:155], v[136:139], v[176:179]
  v_mfma_f32_16x16x32_bf16 v[176:179], v[156:159], v[140:143], v[176:179]
  s_nop 9
  v_max3_f32 v188, v188, v176, v177
  v_max3_f32 v188, v188, v178, v179
  s_add_u32 s61, s61, 4096
  s_sub_u32 s63, s63, 1
  s_cmp_lg_u32 s63, 0
  s_cbranch_scc1 L_s_max
  v_mov_b32 v189, v188
  s_nop 2
  v_permlane32_swap_b32 v188, v189
  s_nop 1
  v_max_f32 v188, v188, v189
  v_mov_b32 v189, v188
  s_nop 2
  v_permlane16_swap_b32 v188, v189
  s_nop 1
  v_max_f32 v188, v188, v189
  v_mul_f32 v203, s42, v188
  v_mov_b32 v0, 0
  v_mov_b32 v1, 0
  v_mov_b32 v2, 0
  v_mov_b32 v3, 0
  v_mov_b32 v4, 0
  v_mov_b32 v5, 0
  v_mov_b32 v6, 0
  v_mov_b32 v7, 0
  v_mov_b32 v8, 0
  v_mov_b32 v9, 0
  v_mov_b32 v10, 0
  v_mov_b32 v11, 0
  v_mov_b32 v12, 0
  v_mov_b32 v13, 0
  v_mov_b32 v14, 0
  v_mov_b32 v15, 0
  v_mov_b32 v16, 0
  v_mov_b32 v17, 0
  v_mov_b32 v18, 0
  v_mov_b32 v19, 0
  v_mov_b32 v20, 0
  v_mov_b32 v21, 0
  v_mov_b32 v22, 0
  v_mov_b32 v23, 0
  v_mov_b32 v24, 0
  v_mov_b32 v25, 0
  v_mov_b32 v26, 0
  v_mov_b32 v27, 0
  v_mov_b32 v28, 0
  v_mov_b32 v29, 0
  v_mov_b32 v30, 0
  v_mov_b32 v31, 0
  v_mov_b32 v192, 0
  v_mov_b32 v193, 0
  v_mov_b32 v194, 0
  v_mov_b32 v195, 0
  s_mov_b32 s61, s60
  s_mov_b32 s63, 16
L_s_pv:
  s_mov_b32 m0, s38
  s_add_u32 s3, s61, 0
  buffer_load_dwordx4 v[144:147], v200, s[4:7], s3 offen offset:0
  buffer_load_dwordx4 v[148:151], v200, s[4:7], s3 offen offset:64
  buffer_load_dwordx4 v[152:155], v200, s[4:7], s3 offen offset:128
  buffer_load_dwordx4 v[156:159], v200, s[4:7], s3 offen offset:192
  buffer_load_dwordx4 v201, s[8:11], s3 offen offset:0 lds
  buffer_load_dwordx4 v201, s[8:11], s3 offen offset:1024 lds
  buffer_load_dwordx4 v201, s[8:11], s3 offen offset:2048 lds
  buffer_load_dwordx4 v201, s[8:11], s3 offen offset:3072 lds
  s_waitcnt vmcnt(0)
  ds_read_b64_tr_b16 v[64:65], v202 offset:0
  ds_read_b64_tr_b16 v[68:69], v202 offset:8
  ds_read_b64_tr_b16 v[72:73], v202 offset:64
  ds_read_b64_tr_b16 v[76:77], v202 offset:72
  ds_read_b64_tr_b16 v[80:81], v202 offset:128
  ds_read_b64_tr_b16 v[84:85], v202 offset:136
  ds_read_b64_tr_b16 v[88:89], v202 offset:192
  ds_read_b64_tr_b16 v[92:93], v202 offset:200
  s_waitcnt lgkmcnt(0)
  s_add_u32 s3, s61, 4096
  buffer_load_dwordx4 v[160:163], v200, s[4:7], s3 offen offset:0
  buffer_load_dwordx4 v[164:167], v200, s[4:7], s3 offen offset:64
  buffer_load_dwordx4 v[168:171], v200, s[4:7], s3 offen offset:128
  buffer_load_dwordx4 v[172:175], v200, s[4:7], s3 offen offset:192
  buffer_load_dwordx4 v201, s[8:11], s3 offen offset:0 lds
  buffer_load_dwordx4 v201, s[8:11], s3 offen offset:1024 lds
  buffer_load_dwordx4 v201, s[8:11], s3 offen offset:2048 lds
  buffer_load_dwordx4 v201, s[8:11], s3 offen offset:3072 lds
  s_waitcnt vmcnt(0)
  ds_read_b64_tr_b16 v[66:67], v202 offset:0
  ds_read_b64_tr_b16 v[70:71], v202 offset:8
  ds_read_b64_tr_b16 v[74:75], v202 offset:64
  ds_read_b64_tr_b16 v[78:79], v202 offset:72
  ds_read_b64_tr_b16 v[82:83], v202 offset:128
  ds_read_b64_tr_b16 v[86:87], v202 offset:136
  ds_read_b64_tr_b16 v[90:91], v202 offset:192
  ds_read_b64_tr_b16 v[94:95], v202 offset:200
  s_waitcnt lgkmcnt(0)
  v_mfma_f32_16x16x32_bf16 v[176:179], v[144:147], v[128:131], 0
  v_mfma_f32_16x16x32_bf16 v[176:179], v[148:151], v[132:135], v[176:179]
  v_mfma_f32_16x16x32_bf16 v[176:179], v[152:155], v[136:139], v[176:179]
  v_mfma_f32_16x16x32_bf16 v[176:179], v[156:159], v[140:143], v[176:179]
  v_mfma_f32_16x16x32_bf16 v[180:183], v[160:163], v[128:131], 0
  v_mfma_f32_16x16x32_bf16 v[180:183], v[164:167], v[132:135], v[180:183]
  v_mfma_f32_16x16x32_bf16 v[180:183], v[168:171], v[136:139], v[180:183]
  v_mfma_f32_16x16x32_bf16 v[180:183], v[172:175], v[140:143], v[180:183]
  s_nop 9
  v_fma_f32 v176, v176, s42, -v203
  v_fma_f32 v177, v177, s42, -v203
  v_fma_f32 v178, v178, s42, -v203
  v_fma_f32 v179, v179, s42, -v203
  v_fma_f32 v180, v180, s42, -v203
  v_fma_f32 v181, v181, s42, -v203
  v_fma_f32 v182, v182, s42, -v203
  v_fma_f32 v183, v183, s42, -v203
  v_exp_f32 v176, v176
  v_exp_f32 v177, v177
  v_exp_f32 v178, v178
  v_exp_f32 v179, v179
  v_exp_f32 v180, v180
  v_exp_f32 v181, v181
  v_exp_f32 v182, v182
  v_exp_f32 v183, v183
  s_nop 1
  v_cvt_pk_bf16_f32 v184, v176, v177
  v_cvt_pk_bf16_f32 v185, v178, v179
  v_cvt_pk_bf16_f32 v186, v180, v181
  v_cvt_pk_bf16_f32 v187, v182, v183
  s_nop 2
  v_mfma_f32_16x16x32_bf16 v[192:195], a[208:211], v[184:187], v[192:195]
  v_mfma_f32_16x16x32_bf16 v[0:3], v[64:67], v[184:187], v[0:3]
  v_mfma_f32_16x16x32_bf16 v[4:7], v[68:71], v[184:187], v[4:7]
  v_mfma_f32_16x16x32_bf16 v[8:11], v[72:75], v[184:187], v[8:11]
  v_mfma_f32_16x16x32_bf16 v[12:15], v[76:79], v[184:187], v[12:15]
  v_mfma_f32_16x16x32_bf16 v[16:19], v[80:83], v[184:187], v[16:19]
  v_mfma_f32_16x16x32_bf16 v[20:23], v[84:87], v[184:187], v[20:23]
  v_mfma_f32_16x16x32_bf16 v[24:27], v[88:91], v[184:187], v[24:27]
  v_mfma_f32_16x16x32_bf16 v[28:31], v[92:95], v[184:187], v[28:31]
  s_nop 3
  s_add_u32 s61, s61, 8192
  s_sub_u32 s63, s63, 1
  s_cmp_lg_u32 s63, 0
  s_cbranch_scc1 L_s_pv
  s_nop 9
  v_rcp_f32 v189, v192
  s_nop 1
  v_mul_f32 v0, v189, v0
  v_mul_f32 v1, v189, v1
  v_mul_f32 v2, v189, v2
  v_mul_f32 v3, v189, v3
  v_mul_f32 v4, v189, v4
  v_mul_f32 v5, v189, v5
  v_mul_f32 v6, v189, v6
  v_mul_f32 v7, v189, v7
  v_mul_f32 v8, v189, v8
  v_mul_f32 v9, v189, v9
  v_mul_f32 v10, v189, v10
  v_mul_f32 v11, v189, v11
  v_mul_f32 v12, v189, v12
  v_mul_f32 v13, v189, v13
  v_mul_f32 v14, v189, v14
  v_mul_f32 v15, v189, v15
  v_mul_f32 v16, v189, v16
  v_mul_f32 v17, v189, v17
  v_mul_f32 v18, v189, v18
  v_mul_f32 v19, v189, v19
  v_mul_f32 v20, v189, v20
  v_mul_f32 v21, v189, v21
  v_mul_f32 v22, v189, v22
  v_mul_f32 v23, v189, v23
  v_mul_f32 v24, v189, v24
  v_mul_f32 v25, v189, v25
  v_mul_f32 v26, v189, v26
  v_mul_f32 v27, v189, v27
  v_mul_f32 v28, v189, v28
  v_mul_f32 v29, v189, v29
  v_mul_f32 v30, v189, v30
  v_mul_f32 v31, v189, v31
  v_cvt_pk_bf16_f32 v0, v0, v1
  v_cvt_pk_bf16_f32 v1, v2, v3
  v_cvt_pk_bf16_f32 v2, v4, v5
  v_cvt_pk_bf16_f32 v3, v6, v7
  buffer_store_dwordx4 v[0:3], v247, s[16:19], s59 offen offset:0
  v_cvt_pk_bf16_f32 v8, v8, v9
  v_cvt_pk_bf16_f32 v9, v10, v11
  v_cvt_pk_bf16_f32 v10, v12, v13
  v_cvt_pk_bf16_f32 v11, v14, v15
  buffer_store_dwordx4 v[8:11], v247, s[16:19], s59 offen offset:64
  v_cvt_pk_bf16_f32 v16, v16, v17
  v_cvt_pk_bf16_f32 v17, v18, v19
  v_cvt_pk_bf16_f32 v18, v20, v21
  v_cvt_pk_bf16_f32 v19, v22, v23
  buffer_store_dwordx4 v[16:19], v247, s[16:19], s59 offen offset:128
  v_cvt_pk_bf16_f32 v24, v24, v25
  v_cvt_pk_bf16_f32 v25, v26, v27
  v_cvt_pk_bf16_f32 v26, v28, v29
  v_cvt_pk_bf16_f32 v27, v30, v31
  buffer_store_dwordx4 v[24:27], v247, s[16:19], s59 offen offset:192
  s_waitcnt vmcnt(0)
L_s_next:
  s_add_u32 s56, s56, 1
  s_cmp_lt_u32 s56, 12
  s_cbranch_scc1 L_s_item
L_end:
  s_endpgm
.if L_end - L_main < 65536
  .fill (65536 - (L_end - L_main)) / 4, 4, 0xbf810000
.endif
.section .rodata,"a"
.p2align 6
.amdhsa_kernel standalone__gqa_softmax__near_ridge_kernel
  .amdhsa_next_free_vgpr 512
  .amdhsa_next_free_sgpr 102
  .amdhsa_accum_offset 256
  .amdhsa_group_segment_fixed_size 0
  .amdhsa_kernarg_size 48
  .amdhsa_user_sgpr_count 2
  .amdhsa_user_sgpr_kernarg_segment_ptr 1
  .amdhsa_system_sgpr_workgroup_id_x 1
  .amdhsa_float_denorm_mode_32 3
.end_amdhsa_kernel
```
